```python
import torch

def _softmax(x, axis=-1):
    return torch.softmax(x, dim=axis)
def _gelu(x):
    return torch.nn.functional.gelu(x, approximate="tanh")
def _silu(x):
    return torch.nn.functional.silu(x)
def _sigmoid(x):
    return torch.sigmoid(x)
def _layernorm(x, axis=-1, eps=1e-5):
    m = x.mean(dim=axis, keepdim=True)
    v = x.var(dim=axis, keepdim=True, unbiased=False)
    return (x - m) / torch.sqrt(v + eps)
def _scatter_add(tgt, idx, src, axis=0):
    return tgt.clone().index_add_(axis, idx, src)
def _segment_sum(src, seg, n):
    out = torch.zeros((n,) + src.shape[1:], dtype=src.dtype)
    return out.index_add_(0, seg, src)
def _pad(x, pw):
    flat = tuple(v for pair in reversed(pw) for v in pair)
    return torch.nn.functional.pad(x, flat)

kernel_name = 'concat_heads__compressed_kv_cla__softmax_full_mha__prompt'

def setup_inputs():

    _w = (lambda a: (lambda t: t.to(torch.bfloat16) if t.is_floating_point() else t)(torch.as_tensor(a)))
    def _A_setup():
        B, H, Sq, Sk, D, M = 1, 32, 2048, 2048, 128, 576
        Dc = 4 * D
        return {
            "x": _w((lambda *s: torch.randn(*s, dtype=torch.bfloat16) * 0.4)(B, Sq, M)),
            "c_kv": _w((lambda *s: torch.randn(*s, dtype=torch.bfloat16) * 1.6)(B, Sk, Dc)),
            "w_q": _w((lambda *s: torch.randn(*s, dtype=torch.bfloat16) * 6.4)(M, H, D) * (M ** -0.5)),
            "w_uk": _w((lambda *s: torch.randn(*s, dtype=torch.bfloat16) * 6.4)(Dc, H, D) * (Dc ** -0.5)),
            "w_uv": _w((lambda *s: torch.randn(*s, dtype=torch.bfloat16) * 1.6)(Dc, H, D) * (Dc ** -0.5)),
            "w_o": _w((lambda *s: torch.randn(*s, dtype=torch.bfloat16) * 1.6)(H, D, M) * ((H * D) ** -0.5)),
        }
    _A_in = _A_setup()

    def _B_setup():
        B, S, D = 1, 2048, 576
        return {
            "x": _w((lambda *s: torch.randn(*s, dtype=torch.bfloat16) * 0.4)(B, S, D)),
            "wqkv": _w((lambda *s: torch.randn(*s, dtype=torch.bfloat16) * 0.4)(D, 3 * D)),
            "wo": _w((lambda *s: torch.randn(*s, dtype=torch.bfloat16) * 0.05)(D, D)),
        }
    _B_in = _B_setup()

    return {
        "A_x": _A_in["x"],
        "A_c_kv": _A_in["c_kv"],
        "A_w_q": _A_in["w_q"],
        "A_w_uk": _A_in["w_uk"],
        "A_w_uv": _A_in["w_uv"],
        "A_w_o": _A_in["w_o"],
        "B_x": _B_in["x"],
        "B_wqkv": _B_in["wqkv"],
        "B_wo": _B_in["wo"],
    }

def reference(A_x, A_c_kv, A_w_q, A_w_uk, A_w_uv, A_w_o, B_x, B_wqkv, B_wo):
    def _A_ref(x, c_kv, w_q, w_uk, w_uv, w_o):
        B, Sq, M = x.shape[0], x.shape[1], x.shape[2]
        Sk = c_kv.shape[1]
        H, D = w_q.shape[1], w_q.shape[2]
        q = torch.einsum("bqm,mhd->bhqd", x, w_q)
        k = torch.einsum("bkc,chd->bhkd", c_kv, w_uk)
        v = torch.einsum("bkc,chd->bhkd", c_kv, w_uv)
        scores = torch.einsum("bhqd,bhkd->bhqk", q, k) * (D ** -0.5)
        off = Sk - Sq
        qi = torch.arange(Sq)[:, None]
        kj = torch.arange(Sk)[None, :]
        cmask = kj <= (qi + off)
        scores = torch.where(cmask[None, None], scores, -1e9)
        p = _softmax(scores, axis=-1)
        ctx = torch.einsum("bhqk,bhkd->bhqd", p, v)
        return torch.einsum("bhqd,hdm->bqm", ctx, w_o)

    def _B_ref(x, wqkv, wo):
        B, S, D = x.shape
        H = 32; Dh = D // H
        qkv = (lambda x, *d: x.permute(*d))((x @ wqkv).reshape(B, S, 3, H, Dh), 2, 0, 3, 1, 4)
        q, k, v = qkv[0], qkv[1], qkv[2]
        scale = Dh ** -0.5
        scores = torch.einsum("bhqd,bhkd->bhqk", q, k) * scale
        p = _softmax(scores, axis=-1)
        o = torch.einsum("bhqk,bhkd->bhqd", p, v)
        return (lambda x, *d: x.permute(*d))(o, 0, 2, 1, 3).reshape(B, S, D) @ wo

    a = _A_ref(A_x, A_c_kv, A_w_q, A_w_uk, A_w_uv, A_w_o)
    b = _B_ref(B_x, B_wqkv, B_wo)
    return torch.concatenate([a, b], axis=-1)
```

```asm
; @launch kernel=proj_kernel grid=(256,1,1) block=(256,1,1) lds=163840
; @launch kernel=mix_kernel grid=(256,1,1) block=(768,1,1) lds=156672
; @launch kernel=oprojb_kernel grid=(384,1,1) block=(256,1,1) lds=49152
.amdgcn_target "amdgcn-amd-amdhsa--gfx950"
.text
.globl proj_kernel
.p2align 8
.type proj_kernel,@function
proj_kernel:
    s_cmp_ge_u32 s2, 256
    s_cbranch_scc1 L_pj_end
    s_load_dwordx16 s[48:63], s[0:1], 0
    s_load_dwordx2 s[64:65], s[0:1], 64
    s_load_dwordx2 s[66:67], s[0:1], 88
    v_lshrrev_b32 v38, 6, v0
    v_and_b32 v0, 63, v0
    s_nop 0
    v_readfirstlane_b32 s68, v38
    s_and_b32 s72, s2, 7
    s_lshr_b32 s73, s2, 3
    s_lshl_b32 s3, s73, 2
    s_add_u32 s3, s3, s68
    s_getpc_b64 s[4:5]
L_pc_pj:
    s_add_u32 s4, s4, proj_kernel-L_pc_pj
    s_addc_u32 s5, s5, -1
    s_mul_i32 s6, s3, ((((L_end_proj_kernel-proj_kernel)>>7)+127)>>7)
    v_min_u32 v250, ((((L_end_proj_kernel-proj_kernel)>>7)+127)>>7)-1, v0
    v_add_u32 v250, s6, v250
    v_min_u32 v250, ((L_end_proj_kernel-proj_kernel)>>7)-1, v250
    v_lshlrev_b32 v250, 7, v250
    global_load_dword v251, v250, s[4:5]
    s_lshl_b32 s3, s2, 2
    s_add_u32 s3, s3, s68
    s_getpc_b64 s[4:5]
L_pc_pj2:
    s_add_u32 s4, s4, mix_kernel-L_pc_pj2
    s_addc_u32 s5, s5, 0
    s_mul_i32 s6, s3, ((((L_end_oprojb_kernel-mix_kernel)>>7)+1023)>>10)
    v_min_u32 v252, ((((L_end_oprojb_kernel-mix_kernel)>>7)+1023)>>10)-1, v0
    v_add_u32 v252, s6, v252
    v_min_u32 v252, ((L_end_oprojb_kernel-mix_kernel)>>7)-1, v252
    v_lshlrev_b32 v252, 7, v252
    global_load_dword v253, v252, s[4:5]
    v_lshrrev_b32 v38, 4, v0
    v_add_u32 v38, 0, v38
    v_and_b32 v39, 7, v0
    v_xor_b32 v38, v38, v39
    v_lshlrev_b32 v38, 4, v38
    v_lshrrev_b32 v39, 3, v0
    v_mul_u32_u24 v39, 1024, v39
    v_add_u32 v2, v38, v39
    v_lshrrev_b32 v38, 5, v0
    v_add_u32 v39, 0, v38
    v_lshlrev_b32 v39, 2, v39
    v_and_b32 v6, 31, v0
    v_xor_b32 v6, v6, v39
    v_lshlrev_b32 v6, 4, v6
    v_lshlrev_b32 v38, 13, v38
    v_add_u32 v6, v6, v38
    v_lshrrev_b32 v38, 4, v0
    v_add_u32 v38, 4, v38
    v_and_b32 v39, 7, v0
    v_xor_b32 v38, v38, v39
    v_lshlrev_b32 v38, 4, v38
    v_lshrrev_b32 v39, 3, v0
    v_mul_u32_u24 v39, 1024, v39
    v_add_u32 v3, v38, v39
    v_lshrrev_b32 v38, 5, v0
    v_add_u32 v39, 2, v38
    v_lshlrev_b32 v39, 2, v39
    v_and_b32 v7, 31, v0
    v_xor_b32 v7, v7, v39
    v_lshlrev_b32 v7, 4, v7
    v_lshlrev_b32 v38, 13, v38
    v_add_u32 v7, v7, v38
    s_lshl_b32 s84, s68, 12
    s_lshl_b32 s85, s68, 13
    s_and_b32 s86, s72, 1
    s_lshr_b32 s87, s72, 1
    s_and_b32 s92, s73, 3
    s_lshl_b32 s69, s86, 2
    s_add_u32 s92, s92, s69
    s_lshr_b32 s93, s73, 2
    s_lshl_b32 s69, s87, 3
    s_add_u32 s93, s93, s69
    s_lshr_b32 s74, s93, 4
    s_and_b32 s93, s93, 15
    s_lshl_b32 s78, s92, 18
    s_lshl_b32 s69, s68, 16
    s_add_u32 s78, s78, s69
    s_lshl_b32 s79, s68, 16
    s_lshl_b32 s69, s93, 9
    s_add_u32 s79, s79, s69
    s_waitcnt lgkmcnt(0)
    s_cmp_eq_u32 s74, 0
    s_cselect_b32 s12, s54, s56
    s_cselect_b32 s13, s55, s57
    s_mov_b32 s14, 4194304
    s_mov_b32 s15, 0x00020000
    s_mov_b32 s8, s50
    s_mov_b32 s9, s51
    s_mov_b32 s10, 2097152
    s_mov_b32 s11, 0x00020000
    s_add_u32 m0, s84, 0
    s_add_u32 s69, s79, 0
    buffer_load_dwordx4 v6, s[12:15], s69 offen lds
    s_add_u32 m0, s84, 1024
    s_add_u32 s69, s79, 16384
    buffer_load_dwordx4 v7, s[12:15], s69 offen lds
    s_add_u32 m0, s84, 2048
    s_add_u32 s69, s79, 32768
    buffer_load_dwordx4 v6, s[12:15], s69 offen lds
    s_add_u32 m0, s84, 3072
    s_add_u32 s69, s79, 49152
    buffer_load_dwordx4 v7, s[12:15], s69 offen lds
    s_add_u32 m0, s85, 65536
    s_add_u32 s69, s78, 0
    buffer_load_dwordx4 v2, s[8:11], s69 offen lds
    s_add_u32 m0, s85, 66560
    s_add_u32 s69, s78, 8192
    buffer_load_dwordx4 v3, s[8:11], s69 offen lds
    s_add_u32 m0, s85, 67584
    s_add_u32 s69, s78, 16384
    buffer_load_dwordx4 v2, s[8:11], s69 offen lds
    s_add_u32 m0, s85, 68608
    s_add_u32 s69, s78, 24576
    buffer_load_dwordx4 v3, s[8:11], s69 offen lds
    s_add_u32 m0, s85, 69632
    s_add_u32 s69, s78, 32768
    buffer_load_dwordx4 v2, s[8:11], s69 offen lds
    s_add_u32 m0, s85, 70656
    s_add_u32 s69, s78, 40960
    buffer_load_dwordx4 v3, s[8:11], s69 offen lds
    s_add_u32 m0, s85, 71680
    s_add_u32 s69, s78, 49152
    buffer_load_dwordx4 v2, s[8:11], s69 offen lds
    s_add_u32 m0, s85, 72704
    s_add_u32 s69, s78, 57344
    buffer_load_dwordx4 v3, s[8:11], s69 offen lds
    s_add_u32 m0, s84, 16384
    s_add_u32 s69, s79, 262144
    buffer_load_dwordx4 v6, s[12:15], s69 offen lds
    s_add_u32 m0, s84, 17408
    s_add_u32 s69, s79, 278528
    buffer_load_dwordx4 v7, s[12:15], s69 offen lds
    s_add_u32 m0, s84, 18432
    s_add_u32 s69, s79, 294912
    buffer_load_dwordx4 v6, s[12:15], s69 offen lds
    s_add_u32 m0, s84, 19456
    s_add_u32 s69, s79, 311296
    buffer_load_dwordx4 v7, s[12:15], s69 offen lds
    v_lshlrev_b32 v37, 4, v0
    v_lshrrev_b32 v38, 4, v0
    v_add_u32 v38, 0, v38
    v_and_b32 v39, 7, v0
    v_xor_b32 v38, v38, v39
    v_lshlrev_b32 v38, 4, v38
    v_lshrrev_b32 v39, 3, v0
    v_mul_u32_u24 v39, 1152, v39
    v_add_u32 v4, v38, v39
    v_lshrrev_b32 v38, 4, v0
    v_add_u32 v38, 4, v38
    v_and_b32 v39, 7, v0
    v_xor_b32 v38, v38, v39
    v_lshlrev_b32 v38, 4, v38
    v_lshrrev_b32 v39, 3, v0
    v_mul_u32_u24 v39, 1152, v39
    v_add_u32 v5, v38, v39
    v_lshrrev_b32 v38, 4, v0
    v_lshlrev_b32 v39, 2, v38
    v_and_b32 v8, 15, v0
    v_xor_b32 v8, v8, v39
    v_lshlrev_b32 v8, 4, v8
    v_mul_u32_u24 v38, 3456, v38
    v_add_u32 v8, v8, v38
    s_mov_b32 s24, s60
    s_mov_b32 s25, s61
    s_mov_b32 s26, 2359296
    s_mov_b32 s27, 0x00020000
    s_mov_b32 s28, s62
    s_mov_b32 s29, s63
    s_mov_b32 s30, 1990656
    s_mov_b32 s31, 0x00020000
    s_mov_b32 s16, s48
    s_mov_b32 s17, s49
    s_mov_b32 s18, 2359296
    s_mov_b32 s19, 0x00020000
    s_mov_b32 s20, s52
    s_mov_b32 s21, s53
    s_mov_b32 s22, 4718592
    s_mov_b32 s23, 0x00020000
    s_mov_b32 s32, s66
    s_mov_b32 s33, s67
    s_mov_b32 s34, 92274688
    s_mov_b32 s35, 0x00020000
    s_mov_b32 s36, s58
    s_mov_b32 s37, s59
    s_mov_b32 s38, 4718592
    s_mov_b32 s39, 0x00020000
    s_mov_b32 s40, s64
    s_mov_b32 s41, s65
    s_mov_b32 s42, 663552
    s_mov_b32 s43, 0x00020000
    s_lshr_b32 s76, s68, 1
    s_and_b32 s77, s68, 1
    s_lshl_b32 s69, s93, 1
    s_add_u32 s69, s69, s77
    s_lshl_b32 s69, s69, 19
    s_lshl_b32 s56, s92, 3
    s_lshl_b32 s70, s76, 2
    s_add_u32 s56, s56, s70
    s_lshl_b32 s56, s56, 13
    s_add_u32 s69, s69, s56
    s_cmp_eq_u32 s74, 0
    s_mov_b32 s56, 16777216
    s_cselect_b32 s56, 0, s56
    s_mov_b32 s70, 1024
    s_cselect_b32 s70, 2048, s70
    s_mov_b32 s71, 4096
    s_cselect_b32 s71, 1024, s71
    s_add_u32 s69, s69, s56
    s_mul_i32 s56, s70, 0
    s_add_u32 s44, s69, s56
    s_add_u32 s45, s44, s71
    s_mul_i32 s56, s70, 1
    s_add_u32 s46, s69, s56
    s_add_u32 s47, s46, s71
    s_mul_i32 s56, s70, 2
    s_add_u32 s48, s69, s56
    s_add_u32 s49, s48, s71
    s_mul_i32 s56, s70, 3
    s_add_u32 s50, s69, s56
    s_add_u32 s51, s50, s71
    s_and_b32 s70, s73, 7
    s_lshl_b32 s69, s86, 3
    s_add_u32 s70, s70, s69
    s_lshr_b32 s71, s73, 3
    s_lshl_b32 s69, s87, 2
    s_add_u32 s71, s71, s69
    s_lshl_b32 s69, s70, 2
    s_add_u32 s69, s69, s68
    s_mul_i32 s80, s69, 36864
    s_lshl_b32 s81, s68, 17
    s_lshl_b32 s69, s71, 9
    s_add_u32 s81, s81, s69
    s_lshl_b32 s69, s71, 1
    s_add_u32 s69, s69, s76
    s_lshl_b32 s69, s69, 19
    s_lshl_b32 s56, s70, 15
    s_add_u32 s69, s69, s56
    s_lshl_b32 s56, s77, 12
    s_add_u32 s69, s69, s56
    s_add_u32 s52, s69, 33554432
    s_mov_b32 s53, 0x3e0293ee
    s_and_b32 s59, s73, 7
    s_lshr_b32 s69, s73, 3
    s_lshl_b32 s58, s72, 2
    s_add_u32 s58, s58, s69
    s_lshl_b32 s3, s93, 2
    s_lshl_b32 s69, s59, 7
    s_sub_u32 s56, 1792, s69
    s_cmp_ge_u32 s68, 2
    s_cselect_b32 s69, s56, s69
    s_lshl_b32 s56, s68, 6
    s_add_u32 s69, s69, s56
    s_mul_i32 s80, s69, 1152
    s_lshl_b32 s81, s68, 17
    s_lshl_b32 s69, s58, 8
    s_add_u32 s81, s81, s69
    v_lshrrev_b32 v38, 4, v0
    v_lshlrev_b32 v39, 2, v38
    v_and_b32 v1, 15, v0
    v_xor_b32 v1, v1, v39
    v_lshlrev_b32 v1, 4, v1
    v_lshlrev_b32 v38, 13, v38
    v_add_u32 v1, v1, v38
    s_load_dwordx2 s[64:65], s[0:1], 80
    s_lshl_b32 s69, s59, 5
    s_add_u32 s69, s69, s58
    s_cmp_ge_u32 s69, 112
    s_mov_b32 s56, -112
    s_cselect_b32 s56, 112, s56
    s_sub_u32 s56, s69, s56
    s_and_b32 s55, s56, 15
    s_lshr_b32 s54, s56, 4
    s_cmp_ge_u32 s54, 9
    s_cselect_b32 s75, 1, 0
    s_cmp_lt_u32 s69, 32
    s_cselect_b32 s75, 2, s75
    s_lshl_b32 s69, s55, 2
    s_add_u32 s69, s69, s68
    s_mul_i32 s82, s69, 36864
    s_mul_i32 s83, s68, 55296
    s_lshl_b32 s69, s54, 8
    s_add_u32 s83, s83, s69
    s_add_u32 m0, s84, 32768
    s_add_u32 s69, s79, 524288
    buffer_load_dwordx4 v6, s[12:15], s69 offen lds
    s_add_u32 m0, s84, 33792
    s_add_u32 s69, s79, 540672
    buffer_load_dwordx4 v7, s[12:15], s69 offen lds
    s_add_u32 m0, s84, 34816
    s_add_u32 s69, s79, 557056
    buffer_load_dwordx4 v6, s[12:15], s69 offen lds
    s_add_u32 m0, s84, 35840
    s_add_u32 s69, s79, 573440
    buffer_load_dwordx4 v7, s[12:15], s69 offen lds
    s_add_u32 m0, s85, 98304
    s_add_u32 s69, s78, 128
    buffer_load_dwordx4 v2, s[8:11], s69 offen lds
    s_add_u32 m0, s85, 99328
    s_add_u32 s69, s78, 8320
    buffer_load_dwordx4 v3, s[8:11], s69 offen lds
    s_add_u32 m0, s85, 100352
    s_add_u32 s69, s78, 16512
    buffer_load_dwordx4 v2, s[8:11], s69 offen lds
    s_add_u32 m0, s85, 101376
    s_add_u32 s69, s78, 24704
    buffer_load_dwordx4 v3, s[8:11], s69 offen lds
    s_add_u32 m0, s85, 102400
    s_add_u32 s69, s78, 32896
    buffer_load_dwordx4 v2, s[8:11], s69 offen lds
    s_add_u32 m0, s85, 103424
    s_add_u32 s69, s78, 41088
    buffer_load_dwordx4 v3, s[8:11], s69 offen lds
    s_add_u32 m0, s85, 104448
    s_add_u32 s69, s78, 49280
    buffer_load_dwordx4 v2, s[8:11], s69 offen lds
    s_add_u32 m0, s85, 105472
    s_add_u32 s69, s78, 57472
    buffer_load_dwordx4 v3, s[8:11], s69 offen lds
    s_add_u32 m0, s84, 49152
    s_add_u32 s69, s79, 786432
    buffer_load_dwordx4 v6, s[12:15], s69 offen lds
    s_add_u32 m0, s84, 50176
    s_add_u32 s69, s79, 802816
    buffer_load_dwordx4 v7, s[12:15], s69 offen lds
    s_add_u32 m0, s84, 51200
    s_add_u32 s69, s79, 819200
    buffer_load_dwordx4 v6, s[12:15], s69 offen lds
    s_add_u32 m0, s84, 52224
    s_add_u32 s69, s79, 835584
    buffer_load_dwordx4 v7, s[12:15], s69 offen lds
    s_add_u32 m0, s85, 131072
    s_add_u32 s69, s78, 256
    buffer_load_dwordx4 v2, s[8:11], s69 offen lds
    s_add_u32 m0, s85, 132096
    s_add_u32 s69, s78, 8448
    buffer_load_dwordx4 v3, s[8:11], s69 offen lds
    s_add_u32 m0, s85, 133120
    s_add_u32 s69, s78, 16640
    buffer_load_dwordx4 v2, s[8:11], s69 offen lds
    s_add_u32 m0, s85, 134144
    s_add_u32 s69, s78, 24832
    buffer_load_dwordx4 v3, s[8:11], s69 offen lds
    s_add_u32 m0, s85, 135168
    s_add_u32 s69, s78, 33024
    buffer_load_dwordx4 v2, s[8:11], s69 offen lds
    s_add_u32 m0, s85, 136192
    s_add_u32 s69, s78, 41216
    buffer_load_dwordx4 v3, s[8:11], s69 offen lds
    s_add_u32 m0, s85, 137216
    s_add_u32 s69, s78, 49408
    buffer_load_dwordx4 v2, s[8:11], s69 offen lds
    s_add_u32 m0, s85, 138240
    s_add_u32 s69, s78, 57600
    buffer_load_dwordx4 v3, s[8:11], s69 offen lds
    v_and_b32 v38, 31, v0
    v_lshlrev_b32 v104, 7, v38
    v_lshrrev_b32 v105, 5, v0
    v_lshrrev_b32 v106, 1, v0
    v_and_b32 v106, 7, v106
    v_add_u32 v38, 0, v105
    v_xor_b32 v38, v38, v106
    v_lshl_add_u32 v21, v38, 4, v104
    s_lshl_b32 s69, s76, 14
    s_add_u32 s69, s69, 65536
    v_add_u32 v9, s69, v21
    v_add_u32 v13, 65536, v9
    s_lshl_b32 s69, s76, 13
    v_add_u32 v29, s69, v21
    v_add_u32 v38, 2, v105
    v_xor_b32 v38, v38, v106
    v_lshl_add_u32 v22, v38, 4, v104
    s_lshl_b32 s69, s76, 14
    s_add_u32 s69, s69, 65536
    v_add_u32 v10, s69, v22
    v_add_u32 v14, 65536, v10
    s_lshl_b32 s69, s76, 13
    v_add_u32 v30, s69, v22
    v_add_u32 v38, 4, v105
    v_xor_b32 v38, v38, v106
    v_lshl_add_u32 v23, v38, 4, v104
    s_lshl_b32 s69, s76, 14
    s_add_u32 s69, s69, 65536
    v_add_u32 v11, s69, v23
    v_add_u32 v15, 65536, v11
    s_lshl_b32 s69, s76, 13
    v_add_u32 v31, s69, v23
    v_add_u32 v38, 6, v105
    v_xor_b32 v38, v38, v106
    v_lshl_add_u32 v24, v38, 4, v104
    s_lshl_b32 s69, s76, 14
    s_add_u32 s69, s69, 65536
    v_add_u32 v12, s69, v24
    v_add_u32 v16, 65536, v12
    s_lshl_b32 s69, s76, 13
    v_add_u32 v32, s69, v24
    v_lshrrev_b32 v104, 5, v0
    v_lshlrev_b32 v104, 3, v104
    v_and_b32 v105, 15, v0
    v_lshrrev_b32 v105, 2, v105
    v_add_u32 v104, v104, v105
    v_lshlrev_b32 v105, 2, v105
    v_lshrrev_b32 v106, 4, v0
    v_and_b32 v106, 1, v106
    v_lshlrev_b32 v106, 1, v106
    v_and_b32 v107, 3, v0
    v_lshrrev_b32 v107, 1, v107
    v_add_u32 v106, v106, v107
    v_and_b32 v107, 1, v0
    v_lshlrev_b32 v107, 3, v107
    s_mul_i32 s69, s77, 8
    s_add_u32 s69, s69, 0
    v_xor_b32 v38, s69, v105
    v_add_u32 v38, v38, v106
    v_lshl_add_u32 v38, v38, 4, v107
    v_lshl_add_u32 v33, v104, 8, v38
    v_add_u32 v33, 65536, v33
    v_add_u32 v35, 65536, v33
    s_mul_i32 s69, s77, 8
    s_add_u32 s69, s69, 4
    v_xor_b32 v38, s69, v105
    v_add_u32 v38, v38, v106
    v_lshl_add_u32 v38, v38, 4, v107
    v_lshl_add_u32 v34, v104, 8, v38
    v_add_u32 v34, 65536, v34
    v_add_u32 v36, 65536, v34
    s_mul_i32 s69, s77, 16
    s_add_u32 s69, s69, 0
    v_xor_b32 v38, s69, v105
    v_add_u32 v38, v38, v106
    v_lshl_add_u32 v38, v38, 4, v107
    v_lshl_add_u32 v17, v104, 9, v38
    s_mul_i32 s69, s77, 16
    s_add_u32 s69, s69, 4
    v_xor_b32 v38, s69, v105
    v_add_u32 v38, v38, v106
    v_lshl_add_u32 v38, v38, 4, v107
    v_lshl_add_u32 v18, v104, 9, v38
    s_mul_i32 s69, s77, 16
    s_add_u32 s69, s69, 8
    v_xor_b32 v38, s69, v105
    v_add_u32 v38, v38, v106
    v_lshl_add_u32 v38, v38, 4, v107
    v_lshl_add_u32 v19, v104, 9, v38
    s_mul_i32 s69, s77, 16
    s_add_u32 s69, s69, 12
    v_xor_b32 v38, s69, v105
    v_add_u32 v38, v38, v106
    v_lshl_add_u32 v38, v38, 4, v107
    v_lshl_add_u32 v20, v104, 9, v38
    v_xor_b32 v38, 0, v105
    v_add_u32 v38, v38, v106
    v_lshl_add_u32 v38, v38, 4, v107
    v_lshl_add_u32 v25, v104, 8, v38
    v_xor_b32 v38, 4, v105
    v_add_u32 v38, v38, v106
    v_lshl_add_u32 v38, v38, 4, v107
    v_lshl_add_u32 v26, v104, 8, v38
    v_xor_b32 v38, 8, v105
    v_add_u32 v38, v38, v106
    v_lshl_add_u32 v38, v38, 4, v107
    v_lshl_add_u32 v27, v104, 8, v38
    v_xor_b32 v38, 12, v105
    v_add_u32 v38, v38, v106
    v_lshl_add_u32 v38, v38, 4, v107
    v_lshl_add_u32 v28, v104, 8, v38
    s_lshl_b32 s69, s68, 12
    s_add_u32 s69, s69, 65536
    v_add_u32 v21, s69, v21
    v_add_u32 v22, s69, v22
    v_add_u32 v23, s69, v23
    v_add_u32 v24, s69, v24
    s_waitcnt lgkmcnt(0)
    s_mov_b32 s60, s64
    s_mov_b32 s61, s65
    s_mov_b32 s62, 256
    s_mov_b32 s63, 0x00020000
    v_mov_b32 v254, 0
    v_mov_b32 v255, 1
    s_lshl_b32 s3, s3, 10
    s_add_u32 s3, s3, 91226112
    s_waitcnt vmcnt(28)
    s_barrier
    ds_read_b128 v[40:43], v9 offset:0
    ds_read_b128 v[44:47], v9 offset:4096
    ds_read_b128 v[48:51], v9 offset:8192
    ds_read_b128 v[52:55], v9 offset:12288
    ds_read_b64_tr_b16 v[72:73], v17 offset:0
    ds_read_b64_tr_b16 v[74:75], v17 offset:2048
    ds_read_b64_tr_b16 v[76:77], v18 offset:0
    ds_read_b64_tr_b16 v[78:79], v18 offset:2048
    ds_read_b64_tr_b16 v[80:81], v19 offset:0
    ds_read_b64_tr_b16 v[82:83], v19 offset:2048
    ds_read_b64_tr_b16 v[84:85], v20 offset:0
    ds_read_b64_tr_b16 v[86:87], v20 offset:2048
    s_waitcnt lgkmcnt(0)
    s_cmp_lg_u32 s74, 0
    s_cbranch_scc1 L_pj_V
    v_mfma_f32_32x32x16_bf16 a[0:15], v[72:75], v[40:43], 0
    v_mfma_f32_32x32x16_bf16 a[16:31], v[76:79], v[40:43], 0
    ds_read_b128 v[56:59], v10 offset:0
    v_mfma_f32_32x32x16_bf16 a[32:47], v[80:83], v[40:43], 0
    ds_read_b128 v[60:63], v10 offset:4096
    v_mfma_f32_32x32x16_bf16 a[48:63], v[84:87], v[40:43], 0
    ds_read_b128 v[64:67], v10 offset:8192
    v_mfma_f32_32x32x16_bf16 a[64:79], v[72:75], v[44:47], 0
    ds_read_b128 v[68:71], v10 offset:12288
    v_mfma_f32_32x32x16_bf16 a[80:95], v[76:79], v[44:47], 0
    ds_read_b64_tr_b16 v[88:89], v17 offset:8192
    v_mfma_f32_32x32x16_bf16 a[96:111], v[80:83], v[44:47], 0
    ds_read_b64_tr_b16 v[90:91], v17 offset:10240
    v_mfma_f32_32x32x16_bf16 a[112:127], v[84:87], v[44:47], 0
    v_mfma_f32_32x32x16_bf16 a[128:143], v[72:75], v[48:51], 0
    ds_read_b64_tr_b16 v[92:93], v18 offset:8192
    v_mfma_f32_32x32x16_bf16 a[144:159], v[76:79], v[48:51], 0
    ds_read_b64_tr_b16 v[94:95], v18 offset:10240
    v_mfma_f32_32x32x16_bf16 a[160:175], v[80:83], v[48:51], 0
    ds_read_b64_tr_b16 v[96:97], v19 offset:8192
    v_mfma_f32_32x32x16_bf16 a[176:191], v[84:87], v[48:51], 0
    ds_read_b64_tr_b16 v[98:99], v19 offset:10240
    v_mfma_f32_32x32x16_bf16 a[192:207], v[72:75], v[52:55], 0
    ds_read_b64_tr_b16 v[100:101], v20 offset:8192
    v_mfma_f32_32x32x16_bf16 a[208:223], v[76:79], v[52:55], 0
    ds_read_b64_tr_b16 v[102:103], v20 offset:10240
    v_mfma_f32_32x32x16_bf16 a[224:239], v[80:83], v[52:55], 0
    v_mfma_f32_32x32x16_bf16 a[240:255], v[84:87], v[52:55], 0
    s_waitcnt vmcnt(24) lgkmcnt(0)
    s_barrier
    s_cmp_ge_u32 s2, 16
    s_cbranch_scc1 L_pj_za_0
    s_cmp_lg_u32 s68, 0
    s_cbranch_scc1 L_pj_za_0
    s_lshl_b32 s66, s2, 12
    s_add_u32 s66, s66, 91226112
    buffer_store_dword v254, v254, s[32:35], s66 offen sc1
L_pj_za_0:
    v_mfma_f32_32x32x16_bf16 a[0:15], v[88:91], v[56:59], a[0:15]
    s_add_u32 m0, s84, 0
    s_add_u32 s69, s79, 1048576
    buffer_load_dwordx4 v6, s[12:15], s69 offen lds
    v_mfma_f32_32x32x16_bf16 a[16:31], v[92:95], v[56:59], a[16:31]
    v_mfma_f32_32x32x16_bf16 a[32:47], v[96:99], v[56:59], a[32:47]
    ds_read_b128 v[40:43], v11 offset:0
    v_mfma_f32_32x32x16_bf16 a[48:63], v[100:103], v[56:59], a[48:63]
    ds_read_b128 v[44:47], v11 offset:4096
    v_mfma_f32_32x32x16_bf16 a[64:79], v[88:91], v[60:63], a[64:79]
    ds_read_b128 v[48:51], v11 offset:8192
    v_mfma_f32_32x32x16_bf16 a[80:95], v[92:95], v[60:63], a[80:95]
    ds_read_b128 v[52:55], v11 offset:12288
    v_mfma_f32_32x32x16_bf16 a[96:111], v[96:99], v[60:63], a[96:111]
    ds_read_b64_tr_b16 v[72:73], v17 offset:16384
    v_mfma_f32_32x32x16_bf16 a[112:127], v[100:103], v[60:63], a[112:127]
    ds_read_b64_tr_b16 v[74:75], v17 offset:18432
    v_mfma_f32_32x32x16_bf16 a[128:143], v[88:91], v[64:67], a[128:143]
    ds_read_b64_tr_b16 v[76:77], v18 offset:16384
    v_mfma_f32_32x32x16_bf16 a[144:159], v[92:95], v[64:67], a[144:159]
    s_add_u32 m0, s84, 1024
    s_add_u32 s69, s79, 1064960
    buffer_load_dwordx4 v7, s[12:15], s69 offen lds
    v_mfma_f32_32x32x16_bf16 a[160:175], v[96:99], v[64:67], a[160:175]
    ds_read_b64_tr_b16 v[78:79], v18 offset:18432
    v_mfma_f32_32x32x16_bf16 a[176:191], v[100:103], v[64:67], a[176:191]
    ds_read_b64_tr_b16 v[80:81], v19 offset:16384
    ds_read_b64_tr_b16 v[82:83], v19 offset:18432
    v_mfma_f32_32x32x16_bf16 a[192:207], v[88:91], v[68:71], a[192:207]
    ds_read_b64_tr_b16 v[84:85], v20 offset:16384
    v_mfma_f32_32x32x16_bf16 a[208:223], v[92:95], v[68:71], a[208:223]
    ds_read_b64_tr_b16 v[86:87], v20 offset:18432
    v_mfma_f32_32x32x16_bf16 a[224:239], v[96:99], v[68:71], a[224:239]
    s_add_u32 m0, s84, 2048
    s_add_u32 s69, s79, 1081344
    buffer_load_dwordx4 v6, s[12:15], s69 offen lds
    v_mfma_f32_32x32x16_bf16 a[240:255], v[100:103], v[68:71], a[240:255]
    s_waitcnt lgkmcnt(0)
    v_mfma_f32_32x32x16_bf16 a[0:15], v[72:75], v[40:43], a[0:15]
    ds_read_b128 v[56:59], v12 offset:0
    v_mfma_f32_32x32x16_bf16 a[16:31], v[76:79], v[40:43], a[16:31]
    s_lshl_b32 s98, s2, 2
    s_add_u32 s98, s98, s68
    v_mfma_f32_32x32x16_bf16 a[32:47], v[80:83], v[40:43], a[32:47]
    ds_read_b128 v[60:63], v12 offset:4096
    v_mfma_f32_32x32x16_bf16 a[48:63], v[84:87], v[40:43], a[48:63]
    ds_read_b128 v[64:67], v12 offset:8192
    ds_read_b128 v[68:71], v12 offset:12288
    v_mfma_f32_32x32x16_bf16 a[64:79], v[72:75], v[44:47], a[64:79]
    ds_read_b64_tr_b16 v[88:89], v17 offset:24576
    v_mfma_f32_32x32x16_bf16 a[80:95], v[76:79], v[44:47], a[80:95]
    ds_read_b64_tr_b16 v[90:91], v17 offset:26624
    v_mfma_f32_32x32x16_bf16 a[96:111], v[80:83], v[44:47], a[96:111]
    s_add_u32 m0, s84, 3072
    s_add_u32 s69, s79, 1097728
    buffer_load_dwordx4 v7, s[12:15], s69 offen lds
    v_mfma_f32_32x32x16_bf16 a[112:127], v[84:87], v[44:47], a[112:127]
    ds_read_b64_tr_b16 v[92:93], v18 offset:24576
    v_mfma_f32_32x32x16_bf16 a[128:143], v[72:75], v[48:51], a[128:143]
    s_mul_i32 s99, s98, 18
    v_mfma_f32_32x32x16_bf16 a[144:159], v[76:79], v[48:51], a[144:159]
    ds_read_b64_tr_b16 v[94:95], v18 offset:26624
    v_mfma_f32_32x32x16_bf16 a[160:175], v[80:83], v[48:51], a[160:175]
    ds_read_b64_tr_b16 v[96:97], v19 offset:24576
    v_mfma_f32_32x32x16_bf16 a[176:191], v[84:87], v[48:51], a[176:191]
    ds_read_b64_tr_b16 v[98:99], v19 offset:26624
    v_mfma_f32_32x32x16_bf16 a[192:207], v[72:75], v[52:55], a[192:207]
    ds_read_b64_tr_b16 v[100:101], v20 offset:24576
    v_mfma_f32_32x32x16_bf16 a[208:223], v[76:79], v[52:55], a[208:223]
    ds_read_b64_tr_b16 v[102:103], v20 offset:26624
    v_mfma_f32_32x32x16_bf16 a[224:239], v[80:83], v[52:55], a[224:239]
    v_mfma_f32_32x32x16_bf16 a[240:255], v[84:87], v[52:55], a[240:255]
    s_waitcnt vmcnt(16) lgkmcnt(0)
    s_barrier
    v_mfma_f32_32x32x16_bf16 a[0:15], v[88:91], v[56:59], a[0:15]
    s_add_u32 m0, s84, 16384
    s_add_u32 s69, s79, 1310720
    buffer_load_dwordx4 v6, s[12:15], s69 offen lds
    v_mfma_f32_32x32x16_bf16 a[16:31], v[92:95], v[56:59], a[16:31]
    ds_read_b128 v[40:43], v9 offset:32768
    ds_read_b128 v[44:47], v9 offset:36864
    v_mfma_f32_32x32x16_bf16 a[32:47], v[96:99], v[56:59], a[32:47]
    ds_read_b128 v[48:51], v9 offset:40960
    ds_read_b128 v[52:55], v9 offset:45056
    ds_read_b64_tr_b16 v[72:73], v17 offset:32768
    v_mfma_f32_32x32x16_bf16 a[48:63], v[100:103], v[56:59], a[48:63]
    s_add_u32 m0, s84, 17408
    s_add_u32 s69, s79, 1327104
    buffer_load_dwordx4 v7, s[12:15], s69 offen lds
    v_mfma_f32_32x32x16_bf16 a[64:79], v[88:91], v[60:63], a[64:79]
    ds_read_b64_tr_b16 v[74:75], v17 offset:34816
    v_add_u32 v244, s99, v0
    v_mfma_f32_32x32x16_bf16 a[80:95], v[92:95], v[60:63], a[80:95]
    s_add_u32 m0, s84, 18432
    s_add_u32 s69, s79, 1343488
    buffer_load_dwordx4 v6, s[12:15], s69 offen lds
    v_mfma_f32_32x32x16_bf16 a[96:111], v[96:99], v[60:63], a[96:111]
    s_add_u32 m0, s84, 19456
    s_add_u32 s69, s79, 1359872
    buffer_load_dwordx4 v7, s[12:15], s69 offen lds
    v_mfma_f32_32x32x16_bf16 a[112:127], v[100:103], v[60:63], a[112:127]
    ds_read_b64_tr_b16 v[76:77], v18 offset:32768
    v_mfma_f32_32x32x16_bf16 a[128:143], v[88:91], v[64:67], a[128:143]
    ds_read_b64_tr_b16 v[78:79], v18 offset:34816
    ds_read_b64_tr_b16 v[80:81], v19 offset:32768
    v_mfma_f32_32x32x16_bf16 a[144:159], v[92:95], v[64:67], a[144:159]
    ds_read_b64_tr_b16 v[82:83], v19 offset:34816
    v_lshlrev_b32 v244, 7, v244
    v_mfma_f32_32x32x16_bf16 a[160:175], v[96:99], v[64:67], a[160:175]
    s_add_u32 m0, s85, 65536
    s_add_u32 s69, s78, 384
    buffer_load_dwordx4 v2, s[8:11], s69 offen lds
    v_mfma_f32_32x32x16_bf16 a[176:191], v[100:103], v[64:67], a[176:191]
    ds_read_b64_tr_b16 v[84:85], v20 offset:32768
    v_mfma_f32_32x32x16_bf16 a[192:207], v[88:91], v[68:71], a[192:207]
    s_add_u32 m0, s85, 66560
    s_add_u32 s69, s78, 8576
    buffer_load_dwordx4 v3, s[8:11], s69 offen lds
    v_mfma_f32_32x32x16_bf16 a[208:223], v[92:95], v[68:71], a[208:223]
    ds_read_b64_tr_b16 v[86:87], v20 offset:34816
    v_mfma_f32_32x32x16_bf16 a[224:239], v[96:99], v[68:71], a[224:239]
    s_add_u32 m0, s85, 67584
    s_add_u32 s69, s78, 16768
    buffer_load_dwordx4 v2, s[8:11], s69 offen lds
    v_mfma_f32_32x32x16_bf16 a[240:255], v[100:103], v[68:71], a[240:255]
    v_mov_b32 v251, 0xf0000000
    s_waitcnt lgkmcnt(0)
    v_mfma_f32_32x32x16_bf16 a[0:15], v[72:75], v[40:43], a[0:15]
    ds_read_b128 v[56:59], v10 offset:32768
    v_mfma_f32_32x32x16_bf16 a[16:31], v[76:79], v[40:43], a[16:31]
    ds_read_b128 v[60:63], v10 offset:36864
    ds_read_b128 v[64:67], v10 offset:40960
    v_mfma_f32_32x32x16_bf16 a[32:47], v[80:83], v[40:43], a[32:47]
    s_add_u32 m0, s85, 68608
    s_add_u32 s69, s78, 24960
    buffer_load_dwordx4 v3, s[8:11], s69 offen lds
    v_mfma_f32_32x32x16_bf16 a[48:63], v[84:87], v[40:43], a[48:63]
    ds_read_b128 v[68:71], v10 offset:45056
    ds_read_b64_tr_b16 v[88:89], v17 offset:40960
    v_mfma_f32_32x32x16_bf16 a[64:79], v[72:75], v[44:47], a[64:79]
    s_add_u32 m0, s85, 69632
    s_add_u32 s69, s78, 33152
    buffer_load_dwordx4 v2, s[8:11], s69 offen lds
    v_mfma_f32_32x32x16_bf16 a[80:95], v[76:79], v[44:47], a[80:95]
    ds_read_b64_tr_b16 v[90:91], v17 offset:43008
    v_mfma_f32_32x32x16_bf16 a[96:111], v[80:83], v[44:47], a[96:111]
    ds_read_b64_tr_b16 v[92:93], v18 offset:40960
    v_mfma_f32_32x32x16_bf16 a[112:127], v[84:87], v[44:47], a[112:127]
    s_add_u32 m0, s85, 70656
    s_add_u32 s69, s78, 41344
    buffer_load_dwordx4 v3, s[8:11], s69 offen lds
    v_mfma_f32_32x32x16_bf16 a[128:143], v[72:75], v[48:51], a[128:143]
    s_add_u32 m0, s85, 71680
    s_add_u32 s69, s78, 49536
    buffer_load_dwordx4 v2, s[8:11], s69 offen lds
    v_mfma_f32_32x32x16_bf16 a[144:159], v[76:79], v[48:51], a[144:159]
    ds_read_b64_tr_b16 v[94:95], v18 offset:43008
    ds_read_b64_tr_b16 v[96:97], v19 offset:40960
    v_mfma_f32_32x32x16_bf16 a[160:175], v[80:83], v[48:51], a[160:175]
    v_cmp_gt_u32 vcc, 18, v0
    s_nop 1
    v_cndmask_b32 v244, v251, v244, vcc
    v_mfma_f32_32x32x16_bf16 a[176:191], v[84:87], v[48:51], a[176:191]
    ds_read_b64_tr_b16 v[98:99], v19 offset:43008
    v_mfma_f32_32x32x16_bf16 a[192:207], v[72:75], v[52:55], a[192:207]
    ds_read_b64_tr_b16 v[100:101], v20 offset:40960
    v_mfma_f32_32x32x16_bf16 a[208:223], v[76:79], v[52:55], a[208:223]
    ds_read_b64_tr_b16 v[102:103], v20 offset:43008
    v_mfma_f32_32x32x16_bf16 a[224:239], v[80:83], v[52:55], a[224:239]
    s_add_u32 m0, s85, 72704
    s_add_u32 s69, s78, 57728
    buffer_load_dwordx4 v3, s[8:11], s69 offen lds
    v_mfma_f32_32x32x16_bf16 a[240:255], v[84:87], v[52:55], a[240:255]
    s_waitcnt vmcnt(24) lgkmcnt(0)
    s_barrier
    v_mfma_f32_32x32x16_bf16 a[0:15], v[88:91], v[56:59], a[0:15]
    ds_read_b128 v[40:43], v11 offset:32768
    v_mfma_f32_32x32x16_bf16 a[16:31], v[92:95], v[56:59], a[16:31]
    s_add_u32 m0, s84, 32768
    s_add_u32 s69, s79, 1572864
    buffer_load_dwordx4 v6, s[12:15], s69 offen lds
    v_mfma_f32_32x32x16_bf16 a[32:47], v[96:99], v[56:59], a[32:47]
    buffer_load_dword v252, v244, s[16:19], 0 offen
    v_mfma_f32_32x32x16_bf16 a[48:63], v[100:103], v[56:59], a[48:63]
    ds_read_b128 v[44:47], v11 offset:36864
    v_mfma_f32_32x32x16_bf16 a[64:79], v[88:91], v[60:63], a[64:79]
    ds_read_b128 v[48:51], v11 offset:40960
    v_mfma_f32_32x32x16_bf16 a[80:95], v[92:95], v[60:63], a[80:95]
    s_mul_i32 s99, s98, 36
    v_mfma_f32_32x32x16_bf16 a[96:111], v[96:99], v[60:63], a[96:111]
    ds_read_b128 v[52:55], v11 offset:45056
    v_mfma_f32_32x32x16_bf16 a[112:127], v[100:103], v[60:63], a[112:127]
    ds_read_b64_tr_b16 v[72:73], v17 offset:49152
    v_mfma_f32_32x32x16_bf16 a[128:143], v[88:91], v[64:67], a[128:143]
    ds_read_b64_tr_b16 v[74:75], v17 offset:51200
    v_mfma_f32_32x32x16_bf16 a[144:159], v[92:95], v[64:67], a[144:159]
    ds_read_b64_tr_b16 v[76:77], v18 offset:49152
    ds_read_b64_tr_b16 v[78:79], v18 offset:51200
    v_mfma_f32_32x32x16_bf16 a[160:175], v[96:99], v[64:67], a[160:175]
    s_add_u32 m0, s84, 33792
    s_add_u32 s69, s79, 1589248
    buffer_load_dwordx4 v7, s[12:15], s69 offen lds
    v_mfma_f32_32x32x16_bf16 a[176:191], v[100:103], v[64:67], a[176:191]
    ds_read_b64_tr_b16 v[80:81], v19 offset:49152
    ds_read_b64_tr_b16 v[82:83], v19 offset:51200
    v_mfma_f32_32x32x16_bf16 a[192:207], v[88:91], v[68:71], a[192:207]
    ds_read_b64_tr_b16 v[84:85], v20 offset:49152
    v_mfma_f32_32x32x16_bf16 a[208:223], v[92:95], v[68:71], a[208:223]
    ds_read_b64_tr_b16 v[86:87], v20 offset:51200
    v_mfma_f32_32x32x16_bf16 a[224:239], v[96:99], v[68:71], a[224:239]
    s_add_u32 m0, s84, 34816
    s_add_u32 s69, s79, 1605632
    buffer_load_dwordx4 v6, s[12:15], s69 offen lds
    v_mfma_f32_32x32x16_bf16 a[240:255], v[100:103], v[68:71], a[240:255]
    s_waitcnt lgkmcnt(0)
    v_mfma_f32_32x32x16_bf16 a[0:15], v[72:75], v[40:43], a[0:15]
    ds_read_b128 v[56:59], v12 offset:32768
    v_mfma_f32_32x32x16_bf16 a[16:31], v[76:79], v[40:43], a[16:31]
    ds_read_b128 v[60:63], v12 offset:36864
    v_mfma_f32_32x32x16_bf16 a[32:47], v[80:83], v[40:43], a[32:47]
    v_mfma_f32_32x32x16_bf16 a[48:63], v[84:87], v[40:43], a[48:63]
    ds_read_b128 v[64:67], v12 offset:40960
    v_mfma_f32_32x32x16_bf16 a[64:79], v[72:75], v[44:47], a[64:79]
    ds_read_b128 v[68:71], v12 offset:45056
    v_mfma_f32_32x32x16_bf16 a[80:95], v[76:79], v[44:47], a[80:95]
    v_add_u32 v245, s99, v0
    v_lshlrev_b32 v245, 7, v245
    v_mfma_f32_32x32x16_bf16 a[96:111], v[80:83], v[44:47], a[96:111]
    ds_read_b64_tr_b16 v[88:89], v17 offset:57344
    v_mfma_f32_32x32x16_bf16 a[112:127], v[84:87], v[44:47], a[112:127]
    ds_read_b64_tr_b16 v[90:91], v17 offset:59392
    v_mfma_f32_32x32x16_bf16 a[128:143], v[72:75], v[48:51], a[128:143]
    s_add_u32 m0, s84, 35840
    s_add_u32 s69, s79, 1622016
    buffer_load_dwordx4 v7, s[12:15], s69 offen lds
    v_mfma_f32_32x32x16_bf16 a[144:159], v[76:79], v[48:51], a[144:159]
    ds_read_b64_tr_b16 v[92:93], v18 offset:57344
    v_mfma_f32_32x32x16_bf16 a[160:175], v[80:83], v[48:51], a[160:175]
    ds_read_b64_tr_b16 v[94:95], v18 offset:59392
    v_mfma_f32_32x32x16_bf16 a[176:191], v[84:87], v[48:51], a[176:191]
    ds_read_b64_tr_b16 v[96:97], v19 offset:57344
    v_mfma_f32_32x32x16_bf16 a[192:207], v[72:75], v[52:55], a[192:207]
    ds_read_b64_tr_b16 v[98:99], v19 offset:59392
    v_mfma_f32_32x32x16_bf16 a[208:223], v[76:79], v[52:55], a[208:223]
    ds_read_b64_tr_b16 v[100:101], v20 offset:57344
    ds_read_b64_tr_b16 v[102:103], v20 offset:59392
    v_mfma_f32_32x32x16_bf16 a[224:239], v[80:83], v[52:55], a[224:239]
    v_mov_b32 v251, 0xf0000000
    v_mfma_f32_32x32x16_bf16 a[240:255], v[84:87], v[52:55], a[240:255]
    s_waitcnt vmcnt(17) lgkmcnt(0)
    s_barrier
    v_mfma_f32_32x32x16_bf16 a[0:15], v[88:91], v[56:59], a[0:15]
    ds_read_b128 v[40:43], v13 offset:0
    ds_read_b128 v[44:47], v13 offset:4096
    v_mfma_f32_32x32x16_bf16 a[16:31], v[92:95], v[56:59], a[16:31]
    s_add_u32 m0, s84, 49152
    s_add_u32 s69, s79, 1835008
    buffer_load_dwordx4 v6, s[12:15], s69 offen lds
    v_mfma_f32_32x32x16_bf16 a[32:47], v[96:99], v[56:59], a[32:47]
    s_add_u32 m0, s84, 50176
    s_add_u32 s69, s79, 1851392
    buffer_load_dwordx4 v7, s[12:15], s69 offen lds
    v_mfma_f32_32x32x16_bf16 a[48:63], v[100:103], v[56:59], a[48:63]
    ds_read_b128 v[48:51], v13 offset:8192
    ds_read_b128 v[52:55], v13 offset:12288
    v_mfma_f32_32x32x16_bf16 a[64:79], v[88:91], v[60:63], a[64:79]
    ds_read_b64_tr_b16 v[72:73], v17 offset:0
    ds_read_b64_tr_b16 v[74:75], v17 offset:2048
    v_mfma_f32_32x32x16_bf16 a[80:95], v[92:95], v[60:63], a[80:95]
    v_cmp_gt_u32 vcc, 36, v0
    s_nop 1
    v_cndmask_b32 v245, v251, v245, vcc
    v_mfma_f32_32x32x16_bf16 a[96:111], v[96:99], v[60:63], a[96:111]
    ds_read_b64_tr_b16 v[76:77], v18 offset:0
    v_mfma_f32_32x32x16_bf16 a[112:127], v[100:103], v[60:63], a[112:127]
    s_add_u32 m0, s84, 51200
    s_add_u32 s69, s79, 1867776
    buffer_load_dwordx4 v6, s[12:15], s69 offen lds
    v_mfma_f32_32x32x16_bf16 a[128:143], v[88:91], v[64:67], a[128:143]
    s_add_u32 m0, s84, 52224
    s_add_u32 s69, s79, 1884160
    buffer_load_dwordx4 v7, s[12:15], s69 offen lds
    v_mfma_f32_32x32x16_bf16 a[144:159], v[92:95], v[64:67], a[144:159]
    ds_read_b64_tr_b16 v[78:79], v18 offset:2048
    ds_read_b64_tr_b16 v[80:81], v19 offset:0
    v_mfma_f32_32x32x16_bf16 a[160:175], v[96:99], v[64:67], a[160:175]
    s_add_u32 m0, s85, 98304
    s_add_u32 s69, s78, 512
    buffer_load_dwordx4 v2, s[8:11], s69 offen lds
    v_mfma_f32_32x32x16_bf16 a[176:191], v[100:103], v[64:67], a[176:191]
    buffer_load_dword v252, v245, s[20:23], 0 offen
    v_mfma_f32_32x32x16_bf16 a[192:207], v[88:91], v[68:71], a[192:207]
    ds_read_b64_tr_b16 v[82:83], v19 offset:2048
    ds_read_b64_tr_b16 v[84:85], v20 offset:0
    v_mfma_f32_32x32x16_bf16 a[208:223], v[92:95], v[68:71], a[208:223]
    ds_read_b64_tr_b16 v[86:87], v20 offset:2048
    v_mfma_f32_32x32x16_bf16 a[224:239], v[96:99], v[68:71], a[224:239]
    s_add_u32 m0, s85, 99328
    s_add_u32 s69, s78, 8704
    buffer_load_dwordx4 v3, s[8:11], s69 offen lds
    v_mfma_f32_32x32x16_bf16 a[240:255], v[100:103], v[68:71], a[240:255]
    s_mul_i32 s99, s98, 18
    s_waitcnt lgkmcnt(0)
    v_mfma_f32_32x32x16_bf16 a[0:15], v[72:75], v[40:43], a[0:15]
    s_add_u32 m0, s85, 100352
    s_add_u32 s69, s78, 16896
    buffer_load_dwordx4 v2, s[8:11], s69 offen lds
    v_mfma_f32_32x32x16_bf16 a[16:31], v[76:79], v[40:43], a[16:31]
    ds_read_b128 v[56:59], v14 offset:0
    ds_read_b128 v[60:63], v14 offset:4096
    v_mfma_f32_32x32x16_bf16 a[32:47], v[80:83], v[40:43], a[32:47]
    s_add_u32 m0, s85, 101376
    s_add_u32 s69, s78, 25088
    buffer_load_dwordx4 v3, s[8:11], s69 offen lds
    v_mfma_f32_32x32x16_bf16 a[48:63], v[84:87], v[40:43], a[48:63]
    ds_read_b128 v[64:67], v14 offset:8192
    v_mfma_f32_32x32x16_bf16 a[64:79], v[72:75], v[44:47], a[64:79]
    ds_read_b128 v[68:71], v14 offset:12288
    v_mfma_f32_32x32x16_bf16 a[80:95], v[76:79], v[44:47], a[80:95]
    ds_read_b64_tr_b16 v[88:89], v17 offset:8192
    v_mfma_f32_32x32x16_bf16 a[96:111], v[80:83], v[44:47], a[96:111]
    s_add_u32 m0, s85, 102400
    s_add_u32 s69, s78, 33280
    buffer_load_dwordx4 v2, s[8:11], s69 offen lds
    v_mfma_f32_32x32x16_bf16 a[112:127], v[84:87], v[44:47], a[112:127]
    ds_read_b64_tr_b16 v[90:91], v17 offset:10240
    v_mfma_f32_32x32x16_bf16 a[128:143], v[72:75], v[48:51], a[128:143]
    s_add_u32 m0, s85, 103424
    s_add_u32 s69, s78, 41472
    buffer_load_dwordx4 v3, s[8:11], s69 offen lds
    v_mfma_f32_32x32x16_bf16 a[144:159], v[76:79], v[48:51], a[144:159]
    ds_read_b64_tr_b16 v[92:93], v18 offset:8192
    ds_read_b64_tr_b16 v[94:95], v18 offset:10240
    v_mfma_f32_32x32x16_bf16 a[160:175], v[80:83], v[48:51], a[160:175]
    ds_read_b64_tr_b16 v[96:97], v19 offset:8192
    v_add_u32 v246, s99, v0
    v_mfma_f32_32x32x16_bf16 a[176:191], v[84:87], v[48:51], a[176:191]
    s_add_u32 m0, s85, 104448
    s_add_u32 s69, s78, 49664
    buffer_load_dwordx4 v2, s[8:11], s69 offen lds
    v_mfma_f32_32x32x16_bf16 a[192:207], v[72:75], v[52:55], a[192:207]
    ds_read_b64_tr_b16 v[98:99], v19 offset:10240
    ds_read_b64_tr_b16 v[100:101], v20 offset:8192
    v_mfma_f32_32x32x16_bf16 a[208:223], v[76:79], v[52:55], a[208:223]
    ds_read_b64_tr_b16 v[102:103], v20 offset:10240
    v_mfma_f32_32x32x16_bf16 a[224:239], v[80:83], v[52:55], a[224:239]
    s_add_u32 m0, s85, 105472
    s_add_u32 s69, s78, 57856
    buffer_load_dwordx4 v3, s[8:11], s69 offen lds
    v_mfma_f32_32x32x16_bf16 a[240:255], v[84:87], v[52:55], a[240:255]
    s_waitcnt vmcnt(26) lgkmcnt(0)
    s_barrier
    v_mfma_f32_32x32x16_bf16 a[0:15], v[88:91], v[56:59], a[0:15]
    s_add_u32 m0, s84, 0
    s_add_u32 s69, s79, 2097152
    buffer_load_dwordx4 v6, s[12:15], s69 offen lds
    v_mfma_f32_32x32x16_bf16 a[16:31], v[92:95], v[56:59], a[16:31]
    ds_read_b128 v[40:43], v15 offset:0
    v_mfma_f32_32x32x16_bf16 a[32:47], v[96:99], v[56:59], a[32:47]
    ds_read_b128 v[44:47], v15 offset:4096
    v_mfma_f32_32x32x16_bf16 a[48:63], v[100:103], v[56:59], a[48:63]
    v_lshlrev_b32 v246, 7, v246
    v_mfma_f32_32x32x16_bf16 a[64:79], v[88:91], v[60:63], a[64:79]
    ds_read_b128 v[48:51], v15 offset:8192
    v_mfma_f32_32x32x16_bf16 a[80:95], v[92:95], v[60:63], a[80:95]
    ds_read_b128 v[52:55], v15 offset:12288
    v_mfma_f32_32x32x16_bf16 a[96:111], v[96:99], v[60:63], a[96:111]
    ds_read_b64_tr_b16 v[72:73], v17 offset:16384
    ds_read_b64_tr_b16 v[74:75], v17 offset:18432
    v_mfma_f32_32x32x16_bf16 a[112:127], v[100:103], v[60:63], a[112:127]
    ds_read_b64_tr_b16 v[76:77], v18 offset:16384
    v_mfma_f32_32x32x16_bf16 a[128:143], v[88:91], v[64:67], a[128:143]
    ds_read_b64_tr_b16 v[78:79], v18 offset:18432
    v_mfma_f32_32x32x16_bf16 a[144:159], v[92:95], v[64:67], a[144:159]
    s_add_u32 m0, s84, 1024
    s_add_u32 s69, s79, 2113536
    buffer_load_dwordx4 v7, s[12:15], s69 offen lds
    v_mfma_f32_32x32x16_bf16 a[160:175], v[96:99], v[64:67], a[160:175]
    ds_read_b64_tr_b16 v[80:81], v19 offset:16384
    v_mfma_f32_32x32x16_bf16 a[176:191], v[100:103], v[64:67], a[176:191]
    ds_read_b64_tr_b16 v[82:83], v19 offset:18432
    v_mov_b32 v251, 0xf0000000
    v_mfma_f32_32x32x16_bf16 a[192:207], v[88:91], v[68:71], a[192:207]
    ds_read_b64_tr_b16 v[84:85], v20 offset:16384
    ds_read_b64_tr_b16 v[86:87], v20 offset:18432
    v_mfma_f32_32x32x16_bf16 a[208:223], v[92:95], v[68:71], a[208:223]
    v_cmp_gt_u32 vcc, 18, v0
    s_nop 1
    v_cndmask_b32 v246, v251, v246, vcc
    v_mfma_f32_32x32x16_bf16 a[224:239], v[96:99], v[68:71], a[224:239]
    s_add_u32 m0, s84, 2048
    s_add_u32 s69, s79, 2129920
    buffer_load_dwordx4 v6, s[12:15], s69 offen lds
    v_mfma_f32_32x32x16_bf16 a[240:255], v[100:103], v[68:71], a[240:255]
    s_waitcnt lgkmcnt(0)
    v_mfma_f32_32x32x16_bf16 a[0:15], v[72:75], v[40:43], a[0:15]
    ds_read_b128 v[56:59], v16 offset:0
    v_mfma_f32_32x32x16_bf16 a[16:31], v[76:79], v[40:43], a[16:31]
    ds_read_b128 v[60:63], v16 offset:4096
    v_mfma_f32_32x32x16_bf16 a[32:47], v[80:83], v[40:43], a[32:47]
    ds_read_b128 v[64:67], v16 offset:8192
    ds_read_b128 v[68:71], v16 offset:12288
    v_mfma_f32_32x32x16_bf16 a[48:63], v[84:87], v[40:43], a[48:63]
    buffer_load_dword v252, v246, s[24:27], 0 offen
    v_mfma_f32_32x32x16_bf16 a[64:79], v[72:75], v[44:47], a[64:79]
    ds_read_b64_tr_b16 v[88:89], v17 offset:24576
    v_mfma_f32_32x32x16_bf16 a[80:95], v[76:79], v[44:47], a[80:95]
    v_mfma_f32_32x32x16_bf16 a[96:111], v[80:83], v[44:47], a[96:111]
    ds_read_b64_tr_b16 v[90:91], v17 offset:26624
    v_mfma_f32_32x32x16_bf16 a[112:127], v[84:87], v[44:47], a[112:127]
    s_add_u32 m0, s84, 3072
    s_add_u32 s69, s79, 2146304
    buffer_load_dwordx4 v7, s[12:15], s69 offen lds
    v_mfma_f32_32x32x16_bf16 a[128:143], v[72:75], v[48:51], a[128:143]
    ds_read_b64_tr_b16 v[92:93], v18 offset:24576
    v_mfma_f32_32x32x16_bf16 a[144:159], v[76:79], v[48:51], a[144:159]
    ds_read_b64_tr_b16 v[94:95], v18 offset:26624
    v_mfma_f32_32x32x16_bf16 a[160:175], v[80:83], v[48:51], a[160:175]
    ds_read_b64_tr_b16 v[96:97], v19 offset:24576
    v_mfma_f32_32x32x16_bf16 a[176:191], v[84:87], v[48:51], a[176:191]
    ds_read_b64_tr_b16 v[98:99], v19 offset:26624
    v_mfma_f32_32x32x16_bf16 a[192:207], v[72:75], v[52:55], a[192:207]
    ds_read_b64_tr_b16 v[100:101], v20 offset:24576
    v_mfma_f32_32x32x16_bf16 a[208:223], v[76:79], v[52:55], a[208:223]
    ds_read_b64_tr_b16 v[102:103], v20 offset:26624
    v_mfma_f32_32x32x16_bf16 a[224:239], v[80:83], v[52:55], a[224:239]
    s_mul_i32 s99, s98, 16
    v_mfma_f32_32x32x16_bf16 a[240:255], v[84:87], v[52:55], a[240:255]
    s_waitcnt vmcnt(18) lgkmcnt(0)
    s_barrier
    v_mfma_f32_32x32x16_bf16 a[0:15], v[88:91], v[56:59], a[0:15]
    s_add_u32 m0, s84, 16384
    s_add_u32 s69, s79, 2359296
    buffer_load_dwordx4 v6, s[12:15], s69 offen lds
    v_mfma_f32_32x32x16_bf16 a[16:31], v[92:95], v[56:59], a[16:31]
    ds_read_b128 v[40:43], v9 offset:0
    ds_read_b128 v[44:47], v9 offset:4096
    ds_read_b128 v[48:51], v9 offset:8192
    v_mfma_f32_32x32x16_bf16 a[32:47], v[96:99], v[56:59], a[32:47]
    s_add_u32 m0, s84, 17408
    s_add_u32 s69, s79, 2375680
    buffer_load_dwordx4 v7, s[12:15], s69 offen lds
    v_mfma_f32_32x32x16_bf16 a[48:63], v[100:103], v[56:59], a[48:63]
    ds_read_b128 v[52:55], v9 offset:12288
    ds_read_b64_tr_b16 v[72:73], v17 offset:32768
    v_mfma_f32_32x32x16_bf16 a[64:79], v[88:91], v[60:63], a[64:79]
    ds_read_b64_tr_b16 v[74:75], v17 offset:34816
    v_mfma_f32_32x32x16_bf16 a[80:95], v[92:95], v[60:63], a[80:95]
    s_add_u32 m0, s84, 18432
    s_add_u32 s69, s79, 2392064
    buffer_load_dwordx4 v6, s[12:15], s69 offen lds
    v_mfma_f32_32x32x16_bf16 a[96:111], v[96:99], v[60:63], a[96:111]
    ds_read_b64_tr_b16 v[76:77], v18 offset:32768
    v_mfma_f32_32x32x16_bf16 a[112:127], v[100:103], v[60:63], a[112:127]
    s_add_u32 m0, s84, 19456
    s_add_u32 s69, s79, 2408448
    buffer_load_dwordx4 v7, s[12:15], s69 offen lds
    v_mfma_f32_32x32x16_bf16 a[128:143], v[88:91], v[64:67], a[128:143]
    v_add_u32 v247, s99, v0
    v_lshlrev_b32 v247, 7, v247
    v_mfma_f32_32x32x16_bf16 a[144:159], v[92:95], v[64:67], a[144:159]
    ds_read_b64_tr_b16 v[78:79], v18 offset:34816
    ds_read_b64_tr_b16 v[80:81], v19 offset:32768
    v_mfma_f32_32x32x16_bf16 a[160:175], v[96:99], v[64:67], a[160:175]
    s_add_u32 m0, s85, 131072
    s_add_u32 s69, s78, 640
    buffer_load_dwordx4 v2, s[8:11], s69 offen lds
    v_mfma_f32_32x32x16_bf16 a[176:191], v[100:103], v[64:67], a[176:191]
    ds_read_b64_tr_b16 v[82:83], v19 offset:34816
    v_mfma_f32_32x32x16_bf16 a[192:207], v[88:91], v[68:71], a[192:207]
    ds_read_b64_tr_b16 v[84:85], v20 offset:32768
    v_mfma_f32_32x32x16_bf16 a[208:223], v[92:95], v[68:71], a[208:223]
    ds_read_b64_tr_b16 v[86:87], v20 offset:34816
    v_mfma_f32_32x32x16_bf16 a[224:239], v[96:99], v[68:71], a[224:239]
    s_add_u32 m0, s85, 132096
    s_add_u32 s69, s78, 8832
    buffer_load_dwordx4 v3, s[8:11], s69 offen lds
    v_mfma_f32_32x32x16_bf16 a[240:255], v[100:103], v[68:71], a[240:255]
    v_mov_b32 v251, 0xf0000000
    s_waitcnt lgkmcnt(0)
    v_mfma_f32_32x32x16_bf16 a[0:15], v[72:75], v[40:43], a[0:15]
    s_add_u32 m0, s85, 133120
    s_add_u32 s69, s78, 17024
    buffer_load_dwordx4 v2, s[8:11], s69 offen lds
    v_mfma_f32_32x32x16_bf16 a[16:31], v[76:79], v[40:43], a[16:31]
    ds_read_b128 v[56:59], v10 offset:0
    ds_read_b128 v[60:63], v10 offset:4096
    v_mfma_f32_32x32x16_bf16 a[32:47], v[80:83], v[40:43], a[32:47]
    s_add_u32 m0, s85, 134144
    s_add_u32 s69, s78, 25216
    buffer_load_dwordx4 v3, s[8:11], s69 offen lds
    v_mfma_f32_32x32x16_bf16 a[48:63], v[84:87], v[40:43], a[48:63]
    ds_read_b128 v[64:67], v10 offset:8192
    ds_read_b128 v[68:71], v10 offset:12288
    v_mfma_f32_32x32x16_bf16 a[64:79], v[72:75], v[44:47], a[64:79]
    s_add_u32 m0, s85, 135168
    s_add_u32 s69, s78, 33408
    buffer_load_dwordx4 v2, s[8:11], s69 offen lds
    v_mfma_f32_32x32x16_bf16 a[80:95], v[76:79], v[44:47], a[80:95]
    ds_read_b64_tr_b16 v[88:89], v17 offset:40960
    ds_read_b64_tr_b16 v[90:91], v17 offset:43008
    v_mfma_f32_32x32x16_bf16 a[96:111], v[80:83], v[44:47], a[96:111]
    s_add_u32 m0, s85, 136192
    s_add_u32 s69, s78, 41600
    buffer_load_dwordx4 v3, s[8:11], s69 offen lds
    v_mfma_f32_32x32x16_bf16 a[112:127], v[84:87], v[44:47], a[112:127]
    v_cmp_gt_u32 vcc, 16, v0
    s_nop 1
    v_cndmask_b32 v247, v251, v247, vcc
    v_mfma_f32_32x32x16_bf16 a[128:143], v[72:75], v[48:51], a[128:143]
    ds_read_b64_tr_b16 v[92:93], v18 offset:40960
    ds_read_b64_tr_b16 v[94:95], v18 offset:43008
    v_mfma_f32_32x32x16_bf16 a[144:159], v[76:79], v[48:51], a[144:159]
    ds_read_b64_tr_b16 v[96:97], v19 offset:40960
    v_mfma_f32_32x32x16_bf16 a[160:175], v[80:83], v[48:51], a[160:175]
    s_add_u32 m0, s85, 137216
    s_add_u32 s69, s78, 49792
    buffer_load_dwordx4 v2, s[8:11], s69 offen lds
    v_mfma_f32_32x32x16_bf16 a[176:191], v[84:87], v[48:51], a[176:191]
    ds_read_b64_tr_b16 v[98:99], v19 offset:43008
    v_mfma_f32_32x32x16_bf16 a[192:207], v[72:75], v[52:55], a[192:207]
    s_add_u32 m0, s85, 138240
    s_add_u32 s69, s78, 57984
    buffer_load_dwordx4 v3, s[8:11], s69 offen lds
    v_mfma_f32_32x32x16_bf16 a[208:223], v[76:79], v[52:55], a[208:223]
    ds_read_b64_tr_b16 v[100:101], v20 offset:40960
    ds_read_b64_tr_b16 v[102:103], v20 offset:43008
    v_mfma_f32_32x32x16_bf16 a[224:239], v[80:83], v[52:55], a[224:239]
    buffer_load_dword v252, v247, s[28:31], 0 offen
    v_mfma_f32_32x32x16_bf16 a[240:255], v[84:87], v[52:55], a[240:255]
    s_waitcnt vmcnt(27) lgkmcnt(0)
    s_barrier
    s_cmp_ge_u32 s2, 16
    s_cbranch_scc1 L_pj_zb_0
    s_cmp_lg_u32 s68, 0
    s_cbranch_scc1 L_pj_zb_0
    s_mov_b64 exec, 1
    buffer_atomic_add v255, v254, s[60:63], 0 offen sc1
    s_mov_b64 exec, -1
L_pj_zb_0:
    v_mfma_f32_32x32x16_bf16 a[0:15], v[88:91], v[56:59], a[0:15]
    ds_read_b128 v[40:43], v11 offset:0
    v_mfma_f32_32x32x16_bf16 a[16:31], v[92:95], v[56:59], a[16:31]
    ds_read_b128 v[44:47], v11 offset:4096
    v_mfma_f32_32x32x16_bf16 a[32:47], v[96:99], v[56:59], a[32:47]
    s_add_u32 m0, s84, 32768
    s_add_u32 s69, s79, 2621440
    buffer_load_dwordx4 v6, s[12:15], s69 offen lds
    v_mfma_f32_32x32x16_bf16 a[48:63], v[100:103], v[56:59], a[48:63]
    ds_read_b128 v[48:51], v11 offset:8192
    v_mfma_f32_32x32x16_bf16 a[64:79], v[88:91], v[60:63], a[64:79]
    ds_read_b128 v[52:55], v11 offset:12288
    v_mfma_f32_32x32x16_bf16 a[80:95], v[92:95], v[60:63], a[80:95]
    ds_read_b64_tr_b16 v[72:73], v17 offset:49152
    v_mfma_f32_32x32x16_bf16 a[96:111], v[96:99], v[60:63], a[96:111]
    ds_read_b64_tr_b16 v[74:75], v17 offset:51200
    ds_read_b64_tr_b16 v[76:77], v18 offset:49152
    v_mfma_f32_32x32x16_bf16 a[112:127], v[100:103], v[60:63], a[112:127]
    s_add_u32 m0, s84, 33792
    s_add_u32 s69, s79, 2637824
    buffer_load_dwordx4 v7, s[12:15], s69 offen lds
    v_mfma_f32_32x32x16_bf16 a[128:143], v[88:91], v[64:67], a[128:143]
    s_mul_i32 s99, s98, 36
    v_mfma_f32_32x32x16_bf16 a[144:159], v[92:95], v[64:67], a[144:159]
    ds_read_b64_tr_b16 v[78:79], v18 offset:51200
    v_mfma_f32_32x32x16_bf16 a[160:175], v[96:99], v[64:67], a[160:175]
    ds_read_b64_tr_b16 v[80:81], v19 offset:49152
    v_mfma_f32_32x32x16_bf16 a[176:191], v[100:103], v[64:67], a[176:191]
    ds_read_b64_tr_b16 v[82:83], v19 offset:51200
    v_mfma_f32_32x32x16_bf16 a[192:207], v[88:91], v[68:71], a[192:207]
    ds_read_b64_tr_b16 v[84:85], v20 offset:49152
    ds_read_b64_tr_b16 v[86:87], v20 offset:51200
    v_mfma_f32_32x32x16_bf16 a[208:223], v[92:95], v[68:71], a[208:223]
    s_add_u32 m0, s84, 34816
    s_add_u32 s69, s79, 2654208
    buffer_load_dwordx4 v6, s[12:15], s69 offen lds
    v_mfma_f32_32x32x16_bf16 a[224:239], v[96:99], v[68:71], a[224:239]
    v_add_u32 v248, s99, v0
    v_mfma_f32_32x32x16_bf16 a[240:255], v[100:103], v[68:71], a[240:255]
    s_waitcnt lgkmcnt(0)
    v_mfma_f32_32x32x16_bf16 a[0:15], v[72:75], v[40:43], a[0:15]
    v_mfma_f32_32x32x16_bf16 a[16:31], v[76:79], v[40:43], a[16:31]
    ds_read_b128 v[56:59], v12 offset:0
    v_mfma_f32_32x32x16_bf16 a[32:47], v[80:83], v[40:43], a[32:47]
    ds_read_b128 v[60:63], v12 offset:4096
    v_mfma_f32_32x32x16_bf16 a[48:63], v[84:87], v[40:43], a[48:63]
    ds_read_b128 v[64:67], v12 offset:8192
    v_mfma_f32_32x32x16_bf16 a[64:79], v[72:75], v[44:47], a[64:79]
    ds_read_b128 v[68:71], v12 offset:12288
    v_mfma_f32_32x32x16_bf16 a[80:95], v[76:79], v[44:47], a[80:95]
    v_mfma_f32_32x32x16_bf16 a[96:111], v[80:83], v[44:47], a[96:111]
    ds_read_b64_tr_b16 v[88:89], v17 offset:57344
    v_mfma_f32_32x32x16_bf16 a[112:127], v[84:87], v[44:47], a[112:127]
    ds_read_b64_tr_b16 v[90:91], v17 offset:59392
    v_mfma_f32_32x32x16_bf16 a[128:143], v[72:75], v[48:51], a[128:143]
    s_add_u32 m0, s84, 35840
    s_add_u32 s69, s79, 2670592
    buffer_load_dwordx4 v7, s[12:15], s69 offen lds
    v_mfma_f32_32x32x16_bf16 a[144:159], v[76:79], v[48:51], a[144:159]
    ds_read_b64_tr_b16 v[92:93], v18 offset:57344
    v_mfma_f32_32x32x16_bf16 a[160:175], v[80:83], v[48:51], a[160:175]
    ds_read_b64_tr_b16 v[94:95], v18 offset:59392
    ds_read_b64_tr_b16 v[96:97], v19 offset:57344
    v_mfma_f32_32x32x16_bf16 a[176:191], v[84:87], v[48:51], a[176:191]
    ds_read_b64_tr_b16 v[98:99], v19 offset:59392
    v_mfma_f32_32x32x16_bf16 a[192:207], v[72:75], v[52:55], a[192:207]
    ds_read_b64_tr_b16 v[100:101], v20 offset:57344
    v_mfma_f32_32x32x16_bf16 a[208:223], v[76:79], v[52:55], a[208:223]
    ds_read_b64_tr_b16 v[102:103], v20 offset:59392
    v_mfma_f32_32x32x16_bf16 a[224:239], v[80:83], v[52:55], a[224:239]
    v_mfma_f32_32x32x16_bf16 a[240:255], v[84:87], v[52:55], a[240:255]
    s_waitcnt vmcnt(17) lgkmcnt(0)
    s_barrier
    v_mfma_f32_32x32x16_bf16 a[0:15], v[88:91], v[56:59], a[0:15]
    s_add_u32 m0, s84, 49152
    s_add_u32 s69, s79, 2883584
    buffer_load_dwordx4 v6, s[12:15], s69 offen lds
    v_mfma_f32_32x32x16_bf16 a[16:31], v[92:95], v[56:59], a[16:31]
    ds_read_b128 v[40:43], v9 offset:32768
    ds_read_b128 v[44:47], v9 offset:36864
    v_mfma_f32_32x32x16_bf16 a[32:47], v[96:99], v[56:59], a[32:47]
    s_add_u32 m0, s84, 50176
    s_add_u32 s69, s79, 2899968
    buffer_load_dwordx4 v7, s[12:15], s69 offen lds
    v_mfma_f32_32x32x16_bf16 a[48:63], v[100:103], v[56:59], a[48:63]
    v_lshlrev_b32 v248, 7, v248
    v_mov_b32 v251, 0xf0000000
    v_mfma_f32_32x32x16_bf16 a[64:79], v[88:91], v[60:63], a[64:79]
    ds_read_b128 v[48:51], v9 offset:40960
    ds_read_b128 v[52:55], v9 offset:45056
    v_mfma_f32_32x32x16_bf16 a[80:95], v[92:95], v[60:63], a[80:95]
    v_cmp_gt_u32 vcc, 36, v0
    s_nop 1
    v_cndmask_b32 v248, v251, v248, vcc
    v_mfma_f32_32x32x16_bf16 a[96:111], v[96:99], v[60:63], a[96:111]
    s_add_u32 m0, s84, 51200
    s_add_u32 s69, s79, 2916352
    buffer_load_dwordx4 v6, s[12:15], s69 offen lds
    v_mfma_f32_32x32x16_bf16 a[112:127], v[100:103], v[60:63], a[112:127]
    ds_read_b64_tr_b16 v[72:73], v17 offset:0
    ds_read_b64_tr_b16 v[74:75], v17 offset:2048
    v_mfma_f32_32x32x16_bf16 a[128:143], v[88:91], v[64:67], a[128:143]
    ds_read_b64_tr_b16 v[76:77], v18 offset:0
    ds_read_b64_tr_b16 v[78:79], v18 offset:2048
    v_mfma_f32_32x32x16_bf16 a[144:159], v[92:95], v[64:67], a[144:159]
    s_add_u32 m0, s84, 52224
    s_add_u32 s69, s79, 2932736
    buffer_load_dwordx4 v7, s[12:15], s69 offen lds
    v_mfma_f32_32x32x16_bf16 a[160:175], v[96:99], v[64:67], a[160:175]
    ds_read_b64_tr_b16 v[80:81], v19 offset:0
    ds_read_b64_tr_b16 v[82:83], v19 offset:2048
    ds_read_b64_tr_b16 v[84:85], v20 offset:0
    v_mfma_f32_32x32x16_bf16 a[176:191], v[100:103], v[64:67], a[176:191]
    s_add_u32 m0, s85, 65536
    s_add_u32 s69, s78, 768
    buffer_load_dwordx4 v2, s[8:11], s69 offen lds
    v_mfma_f32_32x32x16_bf16 a[192:207], v[88:91], v[68:71], a[192:207]
    ds_read_b64_tr_b16 v[86:87], v20 offset:2048
    buffer_load_dword v252, v248, s[36:39], 0 offen
    v_mfma_f32_32x32x16_bf16 a[208:223], v[92:95], v[68:71], a[208:223]
    s_add_u32 m0, s85, 66560
    s_add_u32 s69, s78, 8960
    buffer_load_dwordx4 v3, s[8:11], s69 offen lds
    v_mfma_f32_32x32x16_bf16 a[224:239], v[96:99], v[68:71], a[224:239]
    s_add_u32 m0, s85, 67584
    s_add_u32 s69, s78, 17152
    buffer_load_dwordx4 v2, s[8:11], s69 offen lds
    v_mfma_f32_32x32x16_bf16 a[240:255], v[100:103], v[68:71], a[240:255]
    s_waitcnt lgkmcnt(0)
    v_mfma_f32_32x32x16_bf16 a[0:15], v[72:75], v[40:43], a[0:15]
    ds_read_b128 v[56:59], v10 offset:32768
    ds_read_b128 v[60:63], v10 offset:36864
    v_mfma_f32_32x32x16_bf16 a[16:31], v[76:79], v[40:43], a[16:31]
    s_add_u32 m0, s85, 68608
    s_add_u32 s69, s78, 25344
    buffer_load_dwordx4 v3, s[8:11], s69 offen lds
    v_mfma_f32_32x32x16_bf16 a[32:47], v[80:83], v[40:43], a[32:47]
    ds_read_b128 v[64:67], v10 offset:40960
    v_mfma_f32_32x32x16_bf16 a[48:63], v[84:87], v[40:43], a[48:63]
    ds_read_b128 v[68:71], v10 offset:45056
    v_mfma_f32_32x32x16_bf16 a[64:79], v[72:75], v[44:47], a[64:79]
    ds_read_b64_tr_b16 v[88:89], v17 offset:8192
    v_mfma_f32_32x32x16_bf16 a[80:95], v[76:79], v[44:47], a[80:95]
    s_add_u32 m0, s85, 69632
    s_add_u32 s69, s78, 33536
    buffer_load_dwordx4 v2, s[8:11], s69 offen lds
    v_mfma_f32_32x32x16_bf16 a[96:111], v[80:83], v[44:47], a[96:111]
    s_add_u32 m0, s85, 70656
    s_add_u32 s69, s78, 41728
    buffer_load_dwordx4 v3, s[8:11], s69 offen lds
    v_mfma_f32_32x32x16_bf16 a[112:127], v[84:87], v[44:47], a[112:127]
    ds_read_b64_tr_b16 v[90:91], v17 offset:10240
    s_mul_i32 s99, s98, 6
    v_mfma_f32_32x32x16_bf16 a[128:143], v[72:75], v[48:51], a[128:143]
    ds_read_b64_tr_b16 v[92:93], v18 offset:8192
    ds_read_b64_tr_b16 v[94:95], v18 offset:10240
    v_mfma_f32_32x32x16_bf16 a[144:159], v[76:79], v[48:51], a[144:159]
    ds_read_b64_tr_b16 v[96:97], v19 offset:8192
    v_add_u32 v249, s99, v0
    v_mfma_f32_32x32x16_bf16 a[160:175], v[80:83], v[48:51], a[160:175]
    s_add_u32 m0, s85, 71680
    s_add_u32 s69, s78, 49920
    buffer_load_dwordx4 v2, s[8:11], s69 offen lds
    v_mfma_f32_32x32x16_bf16 a[176:191], v[84:87], v[48:51], a[176:191]
    ds_read_b64_tr_b16 v[98:99], v19 offset:10240
    ds_read_b64_tr_b16 v[100:101], v20 offset:8192
    v_mfma_f32_32x32x16_bf16 a[192:207], v[72:75], v[52:55], a[192:207]
    s_add_u32 m0, s85, 72704
    s_add_u32 s69, s78, 58112
    buffer_load_dwordx4 v3, s[8:11], s69 offen lds
    v_mfma_f32_32x32x16_bf16 a[208:223], v[76:79], v[52:55], a[208:223]
    ds_read_b64_tr_b16 v[102:103], v20 offset:10240
    v_mfma_f32_32x32x16_bf16 a[224:239], v[80:83], v[52:55], a[224:239]
    v_lshlrev_b32 v249, 7, v249
    v_mfma_f32_32x32x16_bf16 a[240:255], v[84:87], v[52:55], a[240:255]
    s_waitcnt vmcnt(26) lgkmcnt(0)
    s_barrier
    v_mfma_f32_32x32x16_bf16 a[0:15], v[88:91], v[56:59], a[0:15]
    s_add_u32 m0, s84, 0
    s_add_u32 s69, s79, 3145728
    buffer_load_dwordx4 v6, s[12:15], s69 offen lds
    v_mfma_f32_32x32x16_bf16 a[16:31], v[92:95], v[56:59], a[16:31]
    ds_read_b128 v[40:43], v11 offset:32768
    v_mfma_f32_32x32x16_bf16 a[32:47], v[96:99], v[56:59], a[32:47]
    ds_read_b128 v[44:47], v11 offset:36864
    v_mfma_f32_32x32x16_bf16 a[48:63], v[100:103], v[56:59], a[48:63]
    ds_read_b128 v[48:51], v11 offset:40960
    v_mfma_f32_32x32x16_bf16 a[64:79], v[88:91], v[60:63], a[64:79]
    ds_read_b128 v[52:55], v11 offset:45056
    v_mfma_f32_32x32x16_bf16 a[80:95], v[92:95], v[60:63], a[80:95]
    ds_read_b64_tr_b16 v[72:73], v17 offset:16384
    v_mfma_f32_32x32x16_bf16 a[96:111], v[96:99], v[60:63], a[96:111]
    ds_read_b64_tr_b16 v[74:75], v17 offset:18432
    v_mfma_f32_32x32x16_bf16 a[112:127], v[100:103], v[60:63], a[112:127]
    ds_read_b64_tr_b16 v[76:77], v18 offset:16384
    v_mfma_f32_32x32x16_bf16 a[128:143], v[88:91], v[64:67], a[128:143]
    s_add_u32 m0, s84, 1024
    s_add_u32 s69, s79, 3162112
    buffer_load_dwordx4 v7, s[12:15], s69 offen lds
    v_mfma_f32_32x32x16_bf16 a[144:159], v[92:95], v[64:67], a[144:159]
    ds_read_b64_tr_b16 v[78:79], v18 offset:18432
    v_mfma_f32_32x32x16_bf16 a[160:175], v[96:99], v[64:67], a[160:175]
    ds_read_b64_tr_b16 v[80:81], v19 offset:16384
    v_mov_b32 v251, 0xf0000000
    v_mfma_f32_32x32x16_bf16 a[176:191], v[100:103], v[64:67], a[176:191]
    ds_read_b64_tr_b16 v[82:83], v19 offset:18432
    v_mfma_f32_32x32x16_bf16 a[192:207], v[88:91], v[68:71], a[192:207]
    ds_read_b64_tr_b16 v[84:85], v20 offset:16384
    v_mfma_f32_32x32x16_bf16 a[208:223], v[92:95], v[68:71], a[208:223]
    ds_read_b64_tr_b16 v[86:87], v20 offset:18432
    v_mfma_f32_32x32x16_bf16 a[224:239], v[96:99], v[68:71], a[224:239]
    v_cmp_gt_u32 vcc, 6, v0
    s_nop 1
    v_cndmask_b32 v249, v251, v249, vcc
    v_mfma_f32_32x32x16_bf16 a[240:255], v[100:103], v[68:71], a[240:255]
    s_waitcnt lgkmcnt(0)
    v_mfma_f32_32x32x16_bf16 a[0:15], v[72:75], v[40:43], a[0:15]
    s_add_u32 m0, s84, 2048
    s_add_u32 s69, s79, 3178496
    buffer_load_dwordx4 v6, s[12:15], s69 offen lds
    v_mfma_f32_32x32x16_bf16 a[16:31], v[76:79], v[40:43], a[16:31]
    ds_read_b128 v[56:59], v12 offset:32768
    v_mfma_f32_32x32x16_bf16 a[32:47], v[80:83], v[40:43], a[32:47]
    ds_read_b128 v[60:63], v12 offset:36864
    v_mfma_f32_32x32x16_bf16 a[48:63], v[84:87], v[40:43], a[48:63]
    v_mfma_f32_32x32x16_bf16 a[64:79], v[72:75], v[44:47], a[64:79]
    ds_read_b128 v[64:67], v12 offset:40960
    v_mfma_f32_32x32x16_bf16 a[80:95], v[76:79], v[44:47], a[80:95]
    ds_read_b128 v[68:71], v12 offset:45056
    v_mfma_f32_32x32x16_bf16 a[96:111], v[80:83], v[44:47], a[96:111]
    ds_read_b64_tr_b16 v[88:89], v17 offset:24576
    v_mfma_f32_32x32x16_bf16 a[112:127], v[84:87], v[44:47], a[112:127]
    buffer_load_dword v252, v249, s[40:43], 0 offen
    v_mfma_f32_32x32x16_bf16 a[128:143], v[72:75], v[48:51], a[128:143]
    ds_read_b64_tr_b16 v[90:91], v17 offset:26624
    ds_read_b64_tr_b16 v[92:93], v18 offset:24576
    v_mfma_f32_32x32x16_bf16 a[144:159], v[76:79], v[48:51], a[144:159]
    s_add_u32 m0, s84, 3072
    s_add_u32 s69, s79, 3194880
    buffer_load_dwordx4 v7, s[12:15], s69 offen lds
    v_mfma_f32_32x32x16_bf16 a[160:175], v[80:83], v[48:51], a[160:175]
    ds_read_b64_tr_b16 v[94:95], v18 offset:26624
    ds_read_b64_tr_b16 v[96:97], v19 offset:24576
    v_mfma_f32_32x32x16_bf16 a[176:191], v[84:87], v[48:51], a[176:191]
    ds_read_b64_tr_b16 v[98:99], v19 offset:26624
    v_mfma_f32_32x32x16_bf16 a[192:207], v[72:75], v[52:55], a[192:207]
    ds_read_b64_tr_b16 v[100:101], v20 offset:24576
    v_mfma_f32_32x32x16_bf16 a[208:223], v[76:79], v[52:55], a[208:223]
    ds_read_b64_tr_b16 v[102:103], v20 offset:26624
    v_mfma_f32_32x32x16_bf16 a[224:239], v[80:83], v[52:55], a[224:239]
    v_mfma_f32_32x32x16_bf16 a[240:255], v[84:87], v[52:55], a[240:255]
    s_waitcnt vmcnt(18) lgkmcnt(0)
    s_barrier
    v_mfma_f32_32x32x16_bf16 a[0:15], v[88:91], v[56:59], a[0:15]
    ds_read_b128 v[40:43], v13 offset:0
    v_mfma_f32_32x32x16_bf16 a[16:31], v[92:95], v[56:59], a[16:31]
    ds_read_b128 v[44:47], v13 offset:4096
    v_mfma_f32_32x32x16_bf16 a[32:47], v[96:99], v[56:59], a[32:47]
    s_add_u32 m0, s84, 16384
    s_add_u32 s69, s79, 3407872
    buffer_load_dwordx4 v6, s[12:15], s69 offen lds
    v_mfma_f32_32x32x16_bf16 a[48:63], v[100:103], v[56:59], a[48:63]
    s_add_u32 m0, s84, 17408
    s_add_u32 s69, s79, 3424256
    buffer_load_dwordx4 v7, s[12:15], s69 offen lds
    v_mfma_f32_32x32x16_bf16 a[64:79], v[88:91], v[60:63], a[64:79]
    ds_read_b128 v[48:51], v13 offset:8192
    ds_read_b128 v[52:55], v13 offset:12288
    ds_read_b64_tr_b16 v[72:73], v17 offset:32768
    v_mfma_f32_32x32x16_bf16 a[80:95], v[92:95], v[60:63], a[80:95]
    s_add_u32 m0, s84, 18432
    s_add_u32 s69, s79, 3440640
    buffer_load_dwordx4 v6, s[12:15], s69 offen lds
    v_mfma_f32_32x32x16_bf16 a[96:111], v[96:99], v[60:63], a[96:111]
    ds_read_b64_tr_b16 v[74:75], v17 offset:34816
    v_mfma_f32_32x32x16_bf16 a[112:127], v[100:103], v[60:63], a[112:127]
    s_add_u32 m0, s84, 19456
    s_add_u32 s69, s79, 3457024
    buffer_load_dwordx4 v7, s[12:15], s69 offen lds
    v_mfma_f32_32x32x16_bf16 a[128:143], v[88:91], v[64:67], a[128:143]
    ds_read_b64_tr_b16 v[76:77], v18 offset:32768
    ds_read_b64_tr_b16 v[78:79], v18 offset:34816
    ds_read_b64_tr_b16 v[80:81], v19 offset:32768
    v_mfma_f32_32x32x16_bf16 a[144:159], v[92:95], v[64:67], a[144:159]
    s_add_u32 m0, s85, 98304
    s_add_u32 s69, s78, 896
    buffer_load_dwordx4 v2, s[8:11], s69 offen lds
    v_mfma_f32_32x32x16_bf16 a[160:175], v[96:99], v[64:67], a[160:175]
    ds_read_b64_tr_b16 v[82:83], v19 offset:34816
    v_mfma_f32_32x32x16_bf16 a[176:191], v[100:103], v[64:67], a[176:191]
    ds_read_b64_tr_b16 v[84:85], v20 offset:32768
    v_mfma_f32_32x32x16_bf16 a[192:207], v[88:91], v[68:71], a[192:207]
    s_add_u32 m0, s85, 99328
    s_add_u32 s69, s78, 9088
    buffer_load_dwordx4 v3, s[8:11], s69 offen lds
    v_mfma_f32_32x32x16_bf16 a[208:223], v[92:95], v[68:71], a[208:223]
    ds_read_b64_tr_b16 v[86:87], v20 offset:34816
    v_mfma_f32_32x32x16_bf16 a[224:239], v[96:99], v[68:71], a[224:239]
    v_mfma_f32_32x32x16_bf16 a[240:255], v[100:103], v[68:71], a[240:255]
    s_waitcnt lgkmcnt(0)
    v_mfma_f32_32x32x16_bf16 a[0:15], v[72:75], v[40:43], a[0:15]
    ds_read_b128 v[56:59], v14 offset:0
    v_mfma_f32_32x32x16_bf16 a[16:31], v[76:79], v[40:43], a[16:31]
    s_add_u32 m0, s85, 100352
    s_add_u32 s69, s78, 17280
    buffer_load_dwordx4 v2, s[8:11], s69 offen lds
    v_mfma_f32_32x32x16_bf16 a[32:47], v[80:83], v[40:43], a[32:47]
    ds_read_b128 v[60:63], v14 offset:4096
    v_mfma_f32_32x32x16_bf16 a[48:63], v[84:87], v[40:43], a[48:63]
    s_add_u32 m0, s85, 101376
    s_add_u32 s69, s78, 25472
    buffer_load_dwordx4 v3, s[8:11], s69 offen lds
    v_mfma_f32_32x32x16_bf16 a[64:79], v[72:75], v[44:47], a[64:79]
    ds_read_b128 v[64:67], v14 offset:8192
    ds_read_b128 v[68:71], v14 offset:12288
    ds_read_b64_tr_b16 v[88:89], v17 offset:40960
    v_mfma_f32_32x32x16_bf16 a[80:95], v[76:79], v[44:47], a[80:95]
    s_add_u32 m0, s85, 102400
    s_add_u32 s69, s78, 33664
    buffer_load_dwordx4 v2, s[8:11], s69 offen lds
    v_mfma_f32_32x32x16_bf16 a[96:111], v[80:83], v[44:47], a[96:111]
    ds_read_b64_tr_b16 v[90:91], v17 offset:43008
    ds_read_b64_tr_b16 v[92:93], v18 offset:40960
    v_mfma_f32_32x32x16_bf16 a[112:127], v[84:87], v[44:47], a[112:127]
    s_add_u32 m0, s85, 103424
    s_add_u32 s69, s78, 41856
    buffer_load_dwordx4 v3, s[8:11], s69 offen lds
    v_mfma_f32_32x32x16_bf16 a[128:143], v[72:75], v[48:51], a[128:143]
    ds_read_b64_tr_b16 v[94:95], v18 offset:43008
    v_mfma_f32_32x32x16_bf16 a[144:159], v[76:79], v[48:51], a[144:159]
    ds_read_b64_tr_b16 v[96:97], v19 offset:40960
    v_mfma_f32_32x32x16_bf16 a[160:175], v[80:83], v[48:51], a[160:175]
    s_add_u32 m0, s85, 104448
    s_add_u32 s69, s78, 50048
    buffer_load_dwordx4 v2, s[8:11], s69 offen lds
    v_mfma_f32_32x32x16_bf16 a[176:191], v[84:87], v[48:51], a[176:191]
    ds_read_b64_tr_b16 v[98:99], v19 offset:43008
    v_mfma_f32_32x32x16_bf16 a[192:207], v[72:75], v[52:55], a[192:207]
    s_add_u32 m0, s85, 105472
    s_add_u32 s69, s78, 58240
    buffer_load_dwordx4 v3, s[8:11], s69 offen lds
    v_mfma_f32_32x32x16_bf16 a[208:223], v[76:79], v[52:55], a[208:223]
    ds_read_b64_tr_b16 v[100:101], v20 offset:40960
    ds_read_b64_tr_b16 v[102:103], v20 offset:43008
    v_mfma_f32_32x32x16_bf16 a[224:239], v[80:83], v[52:55], a[224:239]
    v_mfma_f32_32x32x16_bf16 a[240:255], v[84:87], v[52:55], a[240:255]
    s_waitcnt vmcnt(26) lgkmcnt(0)
    s_barrier
    v_mfma_f32_32x32x16_bf16 a[0:15], v[88:91], v[56:59], a[0:15]
    s_add_u32 m0, s84, 32768
    s_add_u32 s69, s79, 3670016
    buffer_load_dwordx4 v6, s[12:15], s69 offen lds
    v_mfma_f32_32x32x16_bf16 a[16:31], v[92:95], v[56:59], a[16:31]
    ds_read_b128 v[40:43], v15 offset:0
    ds_read_b128 v[44:47], v15 offset:4096
    v_mfma_f32_32x32x16_bf16 a[32:47], v[96:99], v[56:59], a[32:47]
    ds_read_b128 v[48:51], v15 offset:8192
    v_mfma_f32_32x32x16_bf16 a[48:63], v[100:103], v[56:59], a[48:63]
    ds_read_b128 v[52:55], v15 offset:12288
    v_mfma_f32_32x32x16_bf16 a[64:79], v[88:91], v[60:63], a[64:79]
    ds_read_b64_tr_b16 v[72:73], v17 offset:49152
    v_mfma_f32_32x32x16_bf16 a[80:95], v[92:95], v[60:63], a[80:95]
    ds_read_b64_tr_b16 v[74:75], v17 offset:51200
    v_mfma_f32_32x32x16_bf16 a[96:111], v[96:99], v[60:63], a[96:111]
    s_add_u32 m0, s84, 33792
    s_add_u32 s69, s79, 3686400
    buffer_load_dwordx4 v7, s[12:15], s69 offen lds
    v_mfma_f32_32x32x16_bf16 a[112:127], v[100:103], v[60:63], a[112:127]
    v_mfma_f32_32x32x16_bf16 a[128:143], v[88:91], v[64:67], a[128:143]
    ds_read_b64_tr_b16 v[76:77], v18 offset:49152
    v_mfma_f32_32x32x16_bf16 a[144:159], v[92:95], v[64:67], a[144:159]
    ds_read_b64_tr_b16 v[78:79], v18 offset:51200
    v_mfma_f32_32x32x16_bf16 a[160:175], v[96:99], v[64:67], a[160:175]
    ds_read_b64_tr_b16 v[80:81], v19 offset:49152
    v_mfma_f32_32x32x16_bf16 a[176:191], v[100:103], v[64:67], a[176:191]
    ds_read_b64_tr_b16 v[82:83], v19 offset:51200
    v_mfma_f32_32x32x16_bf16 a[192:207], v[88:91], v[68:71], a[192:207]
    ds_read_b64_tr_b16 v[84:85], v20 offset:49152
    v_mfma_f32_32x32x16_bf16 a[208:223], v[92:95], v[68:71], a[208:223]
    ds_read_b64_tr_b16 v[86:87], v20 offset:51200
    v_mfma_f32_32x32x16_bf16 a[224:239], v[96:99], v[68:71], a[224:239]
    s_add_u32 m0, s84, 34816
    s_add_u32 s69, s79, 3702784
    buffer_load_dwordx4 v6, s[12:15], s69 offen lds
    v_mfma_f32_32x32x16_bf16 a[240:255], v[100:103], v[68:71], a[240:255]
    s_waitcnt lgkmcnt(0)
    v_mfma_f32_32x32x16_bf16 a[0:15], v[72:75], v[40:43], a[0:15]
    ds_read_b128 v[56:59], v16 offset:0
    v_mfma_f32_32x32x16_bf16 a[16:31], v[76:79], v[40:43], a[16:31]
    ds_read_b128 v[60:63], v16 offset:4096
    v_mfma_f32_32x32x16_bf16 a[32:47], v[80:83], v[40:43], a[32:47]
    ds_read_b128 v[64:67], v16 offset:8192
    v_mfma_f32_32x32x16_bf16 a[48:63], v[84:87], v[40:43], a[48:63]
    ds_read_b128 v[68:71], v16 offset:12288
    v_mfma_f32_32x32x16_bf16 a[64:79], v[72:75], v[44:47], a[64:79]
    ds_read_b64_tr_b16 v[88:89], v17 offset:57344
    v_mfma_f32_32x32x16_bf16 a[80:95], v[76:79], v[44:47], a[80:95]
    ds_read_b64_tr_b16 v[90:91], v17 offset:59392
    v_mfma_f32_32x32x16_bf16 a[96:111], v[80:83], v[44:47], a[96:111]
    ds_read_b64_tr_b16 v[92:93], v18 offset:57344
    v_mfma_f32_32x32x16_bf16 a[112:127], v[84:87], v[44:47], a[112:127]
    s_add_u32 m0, s84, 35840
    s_add_u32 s69, s79, 3719168
    buffer_load_dwordx4 v7, s[12:15], s69 offen lds
    v_mfma_f32_32x32x16_bf16 a[128:143], v[72:75], v[48:51], a[128:143]
    ds_read_b64_tr_b16 v[94:95], v18 offset:59392
    v_mfma_f32_32x32x16_bf16 a[144:159], v[76:79], v[48:51], a[144:159]
    ds_read_b64_tr_b16 v[96:97], v19 offset:57344
    v_mfma_f32_32x32x16_bf16 a[160:175], v[80:83], v[48:51], a[160:175]
    ds_read_b64_tr_b16 v[98:99], v19 offset:59392
    v_mfma_f32_32x32x16_bf16 a[176:191], v[84:87], v[48:51], a[176:191]
    ds_read_b64_tr_b16 v[100:101], v20 offset:57344
    v_mfma_f32_32x32x16_bf16 a[192:207], v[72:75], v[52:55], a[192:207]
    ds_read_b64_tr_b16 v[102:103], v20 offset:59392
    v_mfma_f32_32x32x16_bf16 a[208:223], v[76:79], v[52:55], a[208:223]
    v_mfma_f32_32x32x16_bf16 a[224:239], v[80:83], v[52:55], a[224:239]
    v_mfma_f32_32x32x16_bf16 a[240:255], v[84:87], v[52:55], a[240:255]
    s_waitcnt vmcnt(16) lgkmcnt(0)
    s_barrier
    v_mfma_f32_32x32x16_bf16 a[0:15], v[88:91], v[56:59], a[0:15]
    s_add_u32 m0, s84, 49152
    s_add_u32 s69, s79, 3932160
    buffer_load_dwordx4 v6, s[12:15], s69 offen lds
    v_mfma_f32_32x32x16_bf16 a[16:31], v[92:95], v[56:59], a[16:31]
    s_add_u32 m0, s84, 50176
    s_add_u32 s69, s79, 3948544
    buffer_load_dwordx4 v7, s[12:15], s69 offen lds
    v_mfma_f32_32x32x16_bf16 a[32:47], v[96:99], v[56:59], a[32:47]
    ds_read_b128 v[40:43], v9 offset:0
    v_mfma_f32_32x32x16_bf16 a[48:63], v[100:103], v[56:59], a[48:63]
    ds_read_b128 v[44:47], v9 offset:4096
    v_mfma_f32_32x32x16_bf16 a[64:79], v[88:91], v[60:63], a[64:79]
    ds_read_b128 v[48:51], v9 offset:8192
    v_mfma_f32_32x32x16_bf16 a[80:95], v[92:95], v[60:63], a[80:95]
    s_add_u32 m0, s84, 51200
    s_add_u32 s69, s79, 3964928
    buffer_load_dwordx4 v6, s[12:15], s69 offen lds
    v_mfma_f32_32x32x16_bf16 a[96:111], v[96:99], v[60:63], a[96:111]
    ds_read_b128 v[52:55], v9 offset:12288
    ds_read_b64_tr_b16 v[72:73], v17 offset:0
    ds_read_b64_tr_b16 v[74:75], v17 offset:2048
    v_mfma_f32_32x32x16_bf16 a[112:127], v[100:103], v[60:63], a[112:127]
    s_add_u32 m0, s84, 52224
    s_add_u32 s69, s79, 3981312
    buffer_load_dwordx4 v7, s[12:15], s69 offen lds
    v_mfma_f32_32x32x16_bf16 a[128:143], v[88:91], v[64:67], a[128:143]
    ds_read_b64_tr_b16 v[76:77], v18 offset:0
    v_mfma_f32_32x32x16_bf16 a[144:159], v[92:95], v[64:67], a[144:159]
    ds_read_b64_tr_b16 v[78:79], v18 offset:2048
    ds_read_b64_tr_b16 v[80:81], v19 offset:0
    v_mfma_f32_32x32x16_bf16 a[160:175], v[96:99], v[64:67], a[160:175]
    ds_read_b64_tr_b16 v[82:83], v19 offset:2048
    ds_read_b64_tr_b16 v[84:85], v20 offset:0
    v_mfma_f32_32x32x16_bf16 a[176:191], v[100:103], v[64:67], a[176:191]
    s_add_u32 m0, s85, 131072
    s_add_u32 s69, s80, 0
    buffer_load_dwordx4 v4, s[16:19], s69 offen lds
    v_mfma_f32_32x32x16_bf16 a[192:207], v[88:91], v[68:71], a[192:207]
    s_add_u32 m0, s85, 132096
    s_add_u32 s69, s80, 9216
    buffer_load_dwordx4 v5, s[16:19], s69 offen lds
    v_mfma_f32_32x32x16_bf16 a[208:223], v[92:95], v[68:71], a[208:223]
    ds_read_b64_tr_b16 v[86:87], v20 offset:2048
    v_mfma_f32_32x32x16_bf16 a[224:239], v[96:99], v[68:71], a[224:239]
    s_add_u32 m0, s85, 133120
    s_add_u32 s69, s80, 18432
    buffer_load_dwordx4 v4, s[16:19], s69 offen lds
    v_mfma_f32_32x32x16_bf16 a[240:255], v[100:103], v[68:71], a[240:255]
    s_waitcnt lgkmcnt(0)
    v_mfma_f32_32x32x16_bf16 a[0:15], v[72:75], v[40:43], a[0:15]
    ds_read_b128 v[56:59], v10 offset:0
    v_mfma_f32_32x32x16_bf16 a[16:31], v[76:79], v[40:43], a[16:31]
    ds_read_b128 v[60:63], v10 offset:4096
    v_mfma_f32_32x32x16_bf16 a[32:47], v[80:83], v[40:43], a[32:47]
    ds_read_b128 v[64:67], v10 offset:8192
    v_mfma_f32_32x32x16_bf16 a[48:63], v[84:87], v[40:43], a[48:63]
    s_add_u32 m0, s85, 134144
    s_add_u32 s69, s80, 27648
    buffer_load_dwordx4 v5, s[16:19], s69 offen lds
    v_mfma_f32_32x32x16_bf16 a[64:79], v[72:75], v[44:47], a[64:79]
    ds_read_b128 v[68:71], v10 offset:12288
    ds_read_b64_tr_b16 v[88:89], v17 offset:8192
    v_mfma_f32_32x32x16_bf16 a[80:95], v[76:79], v[44:47], a[80:95]
    ds_read_b64_tr_b16 v[90:91], v17 offset:10240
    v_mfma_f32_32x32x16_bf16 a[96:111], v[80:83], v[44:47], a[96:111]
    s_add_u32 m0, s85, 135168
    s_add_u32 s69, s80, 36864
    buffer_load_dwordx4 v4, s[16:19], s69 offen lds
    v_mfma_f32_32x32x16_bf16 a[112:127], v[84:87], v[44:47], a[112:127]
    s_add_u32 m0, s85, 136192
    s_add_u32 s69, s80, 46080
    buffer_load_dwordx4 v5, s[16:19], s69 offen lds
    v_mfma_f32_32x32x16_bf16 a[128:143], v[72:75], v[48:51], a[128:143]
    ds_read_b64_tr_b16 v[92:93], v18 offset:8192
    v_mfma_f32_32x32x16_bf16 a[144:159], v[76:79], v[48:51], a[144:159]
    ds_read_b64_tr_b16 v[94:95], v18 offset:10240
    v_mfma_f32_32x32x16_bf16 a[160:175], v[80:83], v[48:51], a[160:175]
    s_add_u32 m0, s85, 137216
    s_add_u32 s69, s80, 55296
    buffer_load_dwordx4 v4, s[16:19], s69 offen lds
    v_mfma_f32_32x32x16_bf16 a[176:191], v[84:87], v[48:51], a[176:191]
    ds_read_b64_tr_b16 v[96:97], v19 offset:8192
    ds_read_b64_tr_b16 v[98:99], v19 offset:10240
    v_mfma_f32_32x32x16_bf16 a[192:207], v[72:75], v[52:55], a[192:207]
    ds_read_b64_tr_b16 v[100:101], v20 offset:8192
    v_mfma_f32_32x32x16_bf16 a[208:223], v[76:79], v[52:55], a[208:223]
    ds_read_b64_tr_b16 v[102:103], v20 offset:10240
    v_mfma_f32_32x32x16_bf16 a[224:239], v[80:83], v[52:55], a[224:239]
    s_add_u32 m0, s85, 138240
    s_add_u32 s69, s80, 64512
    buffer_load_dwordx4 v5, s[16:19], s69 offen lds
    v_mfma_f32_32x32x16_bf16 a[240:255], v[84:87], v[52:55], a[240:255]
    s_waitcnt vmcnt(24) lgkmcnt(0)
    s_barrier
    v_mfma_f32_32x32x16_bf16 a[0:15], v[88:91], v[56:59], a[0:15]
    ds_read_b128 v[40:43], v11 offset:0
    v_mfma_f32_32x32x16_bf16 a[16:31], v[92:95], v[56:59], a[16:31]
    v_mfma_f32_32x32x16_bf16 a[32:47], v[96:99], v[56:59], a[32:47]
    ds_read_b128 v[44:47], v11 offset:4096
    v_mfma_f32_32x32x16_bf16 a[48:63], v[100:103], v[56:59], a[48:63]
    s_add_u32 m0, s84, 0
    s_add_u32 s69, s81, 0
    buffer_load_dwordx4 v1, s[20:23], s69 offen lds
    v_mfma_f32_32x32x16_bf16 a[64:79], v[88:91], v[60:63], a[64:79]
    ds_read_b128 v[48:51], v11 offset:8192
    v_mfma_f32_32x32x16_bf16 a[80:95], v[92:95], v[60:63], a[80:95]
    ds_read_b128 v[52:55], v11 offset:12288
    v_mfma_f32_32x32x16_bf16 a[96:111], v[96:99], v[60:63], a[96:111]
    ds_read_b64_tr_b16 v[72:73], v17 offset:16384
    v_mfma_f32_32x32x16_bf16 a[112:127], v[100:103], v[60:63], a[112:127]
    s_add_u32 m0, s84, 1024
    s_add_u32 s69, s81, 32768
    buffer_load_dwordx4 v1, s[20:23], s69 offen lds
    v_mfma_f32_32x32x16_bf16 a[128:143], v[88:91], v[64:67], a[128:143]
    ds_read_b64_tr_b16 v[74:75], v17 offset:18432
    v_mfma_f32_32x32x16_bf16 a[144:159], v[92:95], v[64:67], a[144:159]
    ds_read_b64_tr_b16 v[76:77], v18 offset:16384
    v_mfma_f32_32x32x16_bf16 a[160:175], v[96:99], v[64:67], a[160:175]
    ds_read_b64_tr_b16 v[78:79], v18 offset:18432
    ds_read_b64_tr_b16 v[80:81], v19 offset:16384
    v_mfma_f32_32x32x16_bf16 a[176:191], v[100:103], v[64:67], a[176:191]
    ds_read_b64_tr_b16 v[82:83], v19 offset:18432
    v_mfma_f32_32x32x16_bf16 a[192:207], v[88:91], v[68:71], a[192:207]
    ds_read_b64_tr_b16 v[84:85], v20 offset:16384
    v_mfma_f32_32x32x16_bf16 a[208:223], v[92:95], v[68:71], a[208:223]
    ds_read_b64_tr_b16 v[86:87], v20 offset:18432
    v_mfma_f32_32x32x16_bf16 a[224:239], v[96:99], v[68:71], a[224:239]
    s_add_u32 m0, s84, 2048
    s_add_u32 s69, s81, 65536
    buffer_load_dwordx4 v1, s[20:23], s69 offen lds
    v_mfma_f32_32x32x16_bf16 a[240:255], v[100:103], v[68:71], a[240:255]
    s_waitcnt lgkmcnt(0)
    v_mfma_f32_32x32x16_bf16 a[0:15], v[72:75], v[40:43], a[0:15]
    ds_read_b128 v[56:59], v12 offset:0
    ds_read_b128 v[60:63], v12 offset:4096
    v_mfma_f32_32x32x16_bf16 a[16:31], v[76:79], v[40:43], a[16:31]
    ds_read_b128 v[64:67], v12 offset:8192
    v_mfma_f32_32x32x16_bf16 a[32:47], v[80:83], v[40:43], a[32:47]
    ds_read_b128 v[68:71], v12 offset:12288
    v_mfma_f32_32x32x16_bf16 a[48:63], v[84:87], v[40:43], a[48:63]
    ds_read_b64_tr_b16 v[88:89], v17 offset:24576
    v_mfma_f32_32x32x16_bf16 a[64:79], v[72:75], v[44:47], a[64:79]
    ds_read_b64_tr_b16 v[90:91], v17 offset:26624
    v_mfma_f32_32x32x16_bf16 a[80:95], v[76:79], v[44:47], a[80:95]
    ds_read_b64_tr_b16 v[92:93], v18 offset:24576
    v_mfma_f32_32x32x16_bf16 a[96:111], v[80:83], v[44:47], a[96:111]
    v_add_u32 v13, 65536, v21
    v_mfma_f32_32x32x16_bf16 a[112:127], v[84:87], v[44:47], a[112:127]
    v_add_u32 v14, 65536, v22
    v_mfma_f32_32x32x16_bf16 a[128:143], v[72:75], v[48:51], a[128:143]
    s_add_u32 m0, s84, 3072
    s_add_u32 s69, s81, 98304
    buffer_load_dwordx4 v1, s[20:23], s69 offen lds
    v_mfma_f32_32x32x16_bf16 a[144:159], v[76:79], v[48:51], a[144:159]
    ds_read_b64_tr_b16 v[94:95], v18 offset:26624
    v_mfma_f32_32x32x16_bf16 a[160:175], v[80:83], v[48:51], a[160:175]
    ds_read_b64_tr_b16 v[96:97], v19 offset:24576
    v_mfma_f32_32x32x16_bf16 a[176:191], v[84:87], v[48:51], a[176:191]
    ds_read_b64_tr_b16 v[98:99], v19 offset:26624
    v_mfma_f32_32x32x16_bf16 a[192:207], v[72:75], v[52:55], a[192:207]
    ds_read_b64_tr_b16 v[100:101], v20 offset:24576
    v_mfma_f32_32x32x16_bf16 a[208:223], v[76:79], v[52:55], a[208:223]
    ds_read_b64_tr_b16 v[102:103], v20 offset:26624
    v_mfma_f32_32x32x16_bf16 a[224:239], v[80:83], v[52:55], a[224:239]
    v_add_u32 v15, 65536, v23
    v_mfma_f32_32x32x16_bf16 a[240:255], v[84:87], v[52:55], a[240:255]
    s_waitcnt vmcnt(16) lgkmcnt(0)
    s_barrier
    v_mfma_f32_32x32x16_bf16 a[0:15], v[88:91], v[56:59], a[0:15]
    s_add_u32 m0, s84, 16384
    s_add_u32 s69, s81, 524288
    buffer_load_dwordx4 v1, s[20:23], s69 offen lds
    v_mfma_f32_32x32x16_bf16 a[16:31], v[92:95], v[56:59], a[16:31]
    ds_read_b128 v[40:43], v9 offset:32768
    ds_read_b128 v[44:47], v9 offset:36864
    ds_read_b128 v[48:51], v9 offset:40960
    v_mfma_f32_32x32x16_bf16 a[32:47], v[96:99], v[56:59], a[32:47]
    s_add_u32 m0, s84, 17408
    s_add_u32 s69, s81, 557056
    buffer_load_dwordx4 v1, s[20:23], s69 offen lds
    v_mfma_f32_32x32x16_bf16 a[48:63], v[100:103], v[56:59], a[48:63]
    ds_read_b128 v[52:55], v9 offset:45056
    v_mfma_f32_32x32x16_bf16 a[64:79], v[88:91], v[60:63], a[64:79]
    ds_read_b64_tr_b16 v[72:73], v17 offset:32768
    ds_read_b64_tr_b16 v[74:75], v17 offset:34816
    v_mfma_f32_32x32x16_bf16 a[80:95], v[92:95], v[60:63], a[80:95]
    s_add_u32 m0, s84, 18432
    s_add_u32 s69, s81, 589824
    buffer_load_dwordx4 v1, s[20:23], s69 offen lds
    v_mfma_f32_32x32x16_bf16 a[96:111], v[96:99], v[60:63], a[96:111]
    s_add_u32 m0, s84, 19456
    s_add_u32 s69, s81, 622592
    buffer_load_dwordx4 v1, s[20:23], s69 offen lds
    v_mfma_f32_32x32x16_bf16 a[112:127], v[100:103], v[60:63], a[112:127]
    ds_read_b64_tr_b16 v[76:77], v18 offset:32768
    ds_read_b64_tr_b16 v[78:79], v18 offset:34816
    v_mfma_f32_32x32x16_bf16 a[128:143], v[88:91], v[64:67], a[128:143]
    ds_read_b64_tr_b16 v[80:81], v19 offset:32768
    v_mfma_f32_32x32x16_bf16 a[144:159], v[92:95], v[64:67], a[144:159]
    ds_read_b64_tr_b16 v[82:83], v19 offset:34816
    v_mfma_f32_32x32x16_bf16 a[160:175], v[96:99], v[64:67], a[160:175]
    s_add_u32 m0, s85, 65536
    s_add_u32 s69, s80, 128
    buffer_load_dwordx4 v4, s[16:19], s69 offen lds
    v_mfma_f32_32x32x16_bf16 a[176:191], v[100:103], v[64:67], a[176:191]
    ds_read_b64_tr_b16 v[84:85], v20 offset:32768
    v_mfma_f32_32x32x16_bf16 a[192:207], v[88:91], v[68:71], a[192:207]
    s_add_u32 m0, s85, 66560
    s_add_u32 s69, s80, 9344
    buffer_load_dwordx4 v5, s[16:19], s69 offen lds
    v_mfma_f32_32x32x16_bf16 a[208:223], v[92:95], v[68:71], a[208:223]
    ds_read_b64_tr_b16 v[86:87], v20 offset:34816
    v_add_u32 v16, 65536, v24
    v_mfma_f32_32x32x16_bf16 a[224:239], v[96:99], v[68:71], a[224:239]
    s_add_u32 m0, s85, 67584
    s_add_u32 s69, s80, 18560
    buffer_load_dwordx4 v4, s[16:19], s69 offen lds
    v_mfma_f32_32x32x16_bf16 a[240:255], v[100:103], v[68:71], a[240:255]
    s_waitcnt lgkmcnt(0)
    v_mfma_f32_32x32x16_bf16 a[0:15], v[72:75], v[40:43], a[0:15]
    ds_read_b128 v[56:59], v10 offset:32768
    v_mfma_f32_32x32x16_bf16 a[16:31], v[76:79], v[40:43], a[16:31]
    ds_read_b128 v[60:63], v10 offset:36864
    v_mfma_f32_32x32x16_bf16 a[32:47], v[80:83], v[40:43], a[32:47]
    ds_read_b128 v[64:67], v10 offset:40960
    ds_read_b128 v[68:71], v10 offset:45056
    v_mfma_f32_32x32x16_bf16 a[48:63], v[84:87], v[40:43], a[48:63]
    s_add_u32 m0, s85, 68608
    s_add_u32 s69, s80, 27776
    buffer_load_dwordx4 v5, s[16:19], s69 offen lds
    v_mfma_f32_32x32x16_bf16 a[64:79], v[72:75], v[44:47], a[64:79]
    s_add_u32 m0, s85, 69632
    s_add_u32 s69, s80, 36992
    buffer_load_dwordx4 v4, s[16:19], s69 offen lds
    v_mfma_f32_32x32x16_bf16 a[80:95], v[76:79], v[44:47], a[80:95]
    ds_read_b64_tr_b16 v[88:89], v17 offset:40960
    v_mfma_f32_32x32x16_bf16 a[96:111], v[80:83], v[44:47], a[96:111]
    ds_read_b64_tr_b16 v[90:91], v17 offset:43008
    v_mfma_f32_32x32x16_bf16 a[112:127], v[84:87], v[44:47], a[112:127]
    s_add_u32 m0, s85, 70656
    s_add_u32 s69, s80, 46208
    buffer_load_dwordx4 v5, s[16:19], s69 offen lds
    v_mfma_f32_32x32x16_bf16 a[128:143], v[72:75], v[48:51], a[128:143]
    ds_read_b64_tr_b16 v[92:93], v18 offset:40960
    ds_read_b64_tr_b16 v[94:95], v18 offset:43008
    v_mfma_f32_32x32x16_bf16 a[144:159], v[76:79], v[48:51], a[144:159]
    s_add_u32 m0, s85, 71680
    s_add_u32 s69, s80, 55424
    buffer_load_dwordx4 v4, s[16:19], s69 offen lds
    v_mfma_f32_32x32x16_bf16 a[160:175], v[80:83], v[48:51], a[160:175]
    ds_read_b64_tr_b16 v[96:97], v19 offset:40960
    ds_read_b64_tr_b16 v[98:99], v19 offset:43008
    v_mfma_f32_32x32x16_bf16 a[176:191], v[84:87], v[48:51], a[176:191]
    ds_read_b64_tr_b16 v[100:101], v20 offset:40960
    v_mfma_f32_32x32x16_bf16 a[192:207], v[72:75], v[52:55], a[192:207]
    s_add_u32 m0, s85, 72704
    s_add_u32 s69, s80, 64640
    buffer_load_dwordx4 v5, s[16:19], s69 offen lds
    v_mfma_f32_32x32x16_bf16 a[208:223], v[76:79], v[52:55], a[208:223]
    ds_read_b64_tr_b16 v[102:103], v20 offset:43008
    v_mfma_f32_32x32x16_bf16 a[224:239], v[80:83], v[52:55], a[224:239]
    v_mfma_f32_32x32x16_bf16 a[240:255], v[84:87], v[52:55], a[240:255]
    s_waitcnt vmcnt(24) lgkmcnt(0)
    s_barrier
    v_mfma_f32_32x32x16_bf16 a[0:15], v[88:91], v[56:59], a[0:15]
    ds_read_b128 v[40:43], v11 offset:32768
    v_mfma_f32_32x32x16_bf16 a[16:31], v[92:95], v[56:59], a[16:31]
    s_add_u32 m0, s84, 32768
    s_add_u32 s69, s81, 1048576
    buffer_load_dwordx4 v1, s[20:23], s69 offen lds
    v_mfma_f32_32x32x16_bf16 a[32:47], v[96:99], v[56:59], a[32:47]
    ds_read_b128 v[44:47], v11 offset:36864
    v_mfma_f32_32x32x16_bf16 a[48:63], v[100:103], v[56:59], a[48:63]
    ds_read_b128 v[48:51], v11 offset:40960
    v_mfma_f32_32x32x16_bf16 a[64:79], v[88:91], v[60:63], a[64:79]
    ds_read_b128 v[52:55], v11 offset:45056
    v_mfma_f32_32x32x16_bf16 a[80:95], v[92:95], v[60:63], a[80:95]
    v_mfma_f32_32x32x16_bf16 a[96:111], v[96:99], v[60:63], a[96:111]
    ds_read_b64_tr_b16 v[72:73], v17 offset:49152
    v_mfma_f32_32x32x16_bf16 a[112:127], v[100:103], v[60:63], a[112:127]
    ds_read_b64_tr_b16 v[74:75], v17 offset:51200
    v_mfma_f32_32x32x16_bf16 a[128:143], v[88:91], v[64:67], a[128:143]
    ds_read_b64_tr_b16 v[76:77], v18 offset:49152
    v_mfma_f32_32x32x16_bf16 a[144:159], v[92:95], v[64:67], a[144:159]
    s_add_u32 m0, s84, 33792
    s_add_u32 s69, s81, 1081344
    buffer_load_dwordx4 v1, s[20:23], s69 offen lds
    v_mfma_f32_32x32x16_bf16 a[160:175], v[96:99], v[64:67], a[160:175]
    ds_read_b64_tr_b16 v[78:79], v18 offset:51200
    v_mfma_f32_32x32x16_bf16 a[176:191], v[100:103], v[64:67], a[176:191]
    ds_read_b64_tr_b16 v[80:81], v19 offset:49152
    v_mfma_f32_32x32x16_bf16 a[192:207], v[88:91], v[68:71], a[192:207]
    ds_read_b64_tr_b16 v[82:83], v19 offset:51200
    ds_read_b64_tr_b16 v[84:85], v20 offset:49152
    v_mfma_f32_32x32x16_bf16 a[208:223], v[92:95], v[68:71], a[208:223]
    ds_read_b64_tr_b16 v[86:87], v20 offset:51200
    v_mfma_f32_32x32x16_bf16 a[224:239], v[96:99], v[68:71], a[224:239]
    v_mfma_f32_32x32x16_bf16 a[240:255], v[100:103], v[68:71], a[240:255]
    s_waitcnt lgkmcnt(0)
    v_mfma_f32_32x32x16_bf16 a[0:15], v[72:75], v[40:43], a[0:15]
    s_add_u32 m0, s84, 34816
    s_add_u32 s69, s81, 1114112
    buffer_load_dwordx4 v1, s[20:23], s69 offen lds
    v_mfma_f32_32x32x16_bf16 a[16:31], v[76:79], v[40:43], a[16:31]
    v_mfma_f32_32x32x16_bf16 a[32:47], v[80:83], v[40:43], a[32:47]
    ds_read_b128 v[56:59], v12 offset:32768
    ds_read_b128 v[60:63], v12 offset:36864
    v_mfma_f32_32x32x16_bf16 a[48:63], v[84:87], v[40:43], a[48:63]
    ds_read_b128 v[64:67], v12 offset:40960
    v_mfma_f32_32x32x16_bf16 a[64:79], v[72:75], v[44:47], a[64:79]
    ds_read_b128 v[68:71], v12 offset:45056
    v_mfma_f32_32x32x16_bf16 a[80:95], v[76:79], v[44:47], a[80:95]
    ds_read_b64_tr_b16 v[88:89], v17 offset:57344
    v_mfma_f32_32x32x16_bf16 a[96:111], v[80:83], v[44:47], a[96:111]
    ds_read_b64_tr_b16 v[90:91], v17 offset:59392
    v_mfma_f32_32x32x16_bf16 a[112:127], v[84:87], v[44:47], a[112:127]
    ds_read_b64_tr_b16 v[92:93], v18 offset:57344
    v_mfma_f32_32x32x16_bf16 a[128:143], v[72:75], v[48:51], a[128:143]
    s_add_u32 m0, s84, 35840
    s_add_u32 s69, s81, 1146880
    buffer_load_dwordx4 v1, s[20:23], s69 offen lds
    v_mfma_f32_32x32x16_bf16 a[144:159], v[76:79], v[48:51], a[144:159]
    ds_read_b64_tr_b16 v[94:95], v18 offset:59392
    v_mfma_f32_32x32x16_bf16 a[160:175], v[80:83], v[48:51], a[160:175]
    ds_read_b64_tr_b16 v[96:97], v19 offset:57344
    v_mfma_f32_32x32x16_bf16 a[176:191], v[84:87], v[48:51], a[176:191]
    ds_read_b64_tr_b16 v[98:99], v19 offset:59392
    v_mfma_f32_32x32x16_bf16 a[192:207], v[72:75], v[52:55], a[192:207]
    ds_read_b64_tr_b16 v[100:101], v20 offset:57344
    v_mfma_f32_32x32x16_bf16 a[208:223], v[76:79], v[52:55], a[208:223]
    ds_read_b64_tr_b16 v[102:103], v20 offset:59392
    v_mfma_f32_32x32x16_bf16 a[224:239], v[80:83], v[52:55], a[224:239]
    v_mfma_f32_32x32x16_bf16 a[240:255], v[84:87], v[52:55], a[240:255]
    s_waitcnt vmcnt(16) lgkmcnt(0)
    s_barrier
    v_mfma_f32_32x32x16_bf16 a[0:15], v[88:91], v[56:59], a[0:15]
    s_add_u32 m0, s84, 49152
    s_add_u32 s69, s81, 1572864
    buffer_load_dwordx4 v1, s[20:23], s69 offen lds
    v_mfma_f32_32x32x16_bf16 a[16:31], v[92:95], v[56:59], a[16:31]
    ds_read_b128 v[40:43], v13 offset:0
    ds_read_b128 v[44:47], v13 offset:16384
    v_mfma_f32_32x32x16_bf16 a[32:47], v[96:99], v[56:59], a[32:47]
    s_add_u32 m0, s84, 50176
    s_add_u32 s69, s81, 1605632
    buffer_load_dwordx4 v1, s[20:23], s69 offen lds
    v_mfma_f32_32x32x16_bf16 a[48:63], v[100:103], v[56:59], a[48:63]
    ds_read_b64_tr_b16 v[72:73], v25 offset:0
    v_mfma_f32_32x32x16_bf16 a[64:79], v[88:91], v[60:63], a[64:79]
    s_add_u32 m0, s84, 51200
    s_add_u32 s69, s81, 1638400
    buffer_load_dwordx4 v1, s[20:23], s69 offen lds
    v_mfma_f32_32x32x16_bf16 a[80:95], v[92:95], v[60:63], a[80:95]
    s_add_u32 m0, s84, 52224
    s_add_u32 s69, s81, 1671168
    buffer_load_dwordx4 v1, s[20:23], s69 offen lds
    v_mfma_f32_32x32x16_bf16 a[96:111], v[96:99], v[60:63], a[96:111]
    ds_read_b64_tr_b16 v[74:75], v25 offset:1024
    ds_read_b64_tr_b16 v[76:77], v26 offset:0
    v_mfma_f32_32x32x16_bf16 a[112:127], v[100:103], v[60:63], a[112:127]
    ds_read_b64_tr_b16 v[78:79], v26 offset:1024
    ds_read_b64_tr_b16 v[80:81], v27 offset:0
    v_mfma_f32_32x32x16_bf16 a[128:143], v[88:91], v[64:67], a[128:143]
    s_add_u32 m0, s85, 98304
    s_add_u32 s69, s80, 256
    buffer_load_dwordx4 v4, s[16:19], s69 offen lds
    v_mfma_f32_32x32x16_bf16 a[144:159], v[92:95], v[64:67], a[144:159]
    ds_read_b64_tr_b16 v[82:83], v27 offset:1024
    v_mfma_f32_32x32x16_bf16 a[160:175], v[96:99], v[64:67], a[160:175]
    s_add_u32 m0, s85, 99328
    s_add_u32 s69, s80, 9472
    buffer_load_dwordx4 v5, s[16:19], s69 offen lds
    v_mfma_f32_32x32x16_bf16 a[176:191], v[100:103], v[64:67], a[176:191]
    ds_read_b64_tr_b16 v[84:85], v28 offset:0
    v_mfma_f32_32x32x16_bf16 a[192:207], v[88:91], v[68:71], a[192:207]
    s_add_u32 m0, s85, 100352
    s_add_u32 s69, s80, 18688
    buffer_load_dwordx4 v4, s[16:19], s69 offen lds
    v_mfma_f32_32x32x16_bf16 a[208:223], v[92:95], v[68:71], a[208:223]
    ds_read_b64_tr_b16 v[86:87], v28 offset:1024
    v_mfma_f32_32x32x16_bf16 a[224:239], v[96:99], v[68:71], a[224:239]
    s_add_u32 m0, s85, 101376
    s_add_u32 s69, s80, 27904
    buffer_load_dwordx4 v5, s[16:19], s69 offen lds
    v_mfma_f32_32x32x16_bf16 a[240:255], v[100:103], v[68:71], a[240:255]
    s_waitcnt lgkmcnt(0)
    s_branch L_pj_A
L_pj_V:
    v_mfma_f32_32x32x16_bf16 a[0:15], v[40:43], v[72:75], 0
    v_mfma_f32_32x32x16_bf16 a[16:31], v[40:43], v[76:79], 0
    ds_read_b128 v[56:59], v10 offset:0
    v_mfma_f32_32x32x16_bf16 a[32:47], v[40:43], v[80:83], 0
    ds_read_b128 v[60:63], v10 offset:4096
    v_mfma_f32_32x32x16_bf16 a[48:63], v[40:43], v[84:87], 0
    ds_read_b128 v[64:67], v10 offset:8192
    v_mfma_f32_32x32x16_bf16 a[64:79], v[44:47], v[72:75], 0
    ds_read_b128 v[68:71], v10 offset:12288
    v_mfma_f32_32x32x16_bf16 a[80:95], v[44:47], v[76:79], 0
    ds_read_b64_tr_b16 v[88:89], v17 offset:8192
    v_mfma_f32_32x32x16_bf16 a[96:111], v[44:47], v[80:83], 0
    ds_read_b64_tr_b16 v[90:91], v17 offset:10240
    v_mfma_f32_32x32x16_bf16 a[112:127], v[44:47], v[84:87], 0
    v_mfma_f32_32x32x16_bf16 a[128:143], v[48:51], v[72:75], 0
    ds_read_b64_tr_b16 v[92:93], v18 offset:8192
    v_mfma_f32_32x32x16_bf16 a[144:159], v[48:51], v[76:79], 0
    ds_read_b64_tr_b16 v[94:95], v18 offset:10240
    v_mfma_f32_32x32x16_bf16 a[160:175], v[48:51], v[80:83], 0
    ds_read_b64_tr_b16 v[96:97], v19 offset:8192
    v_mfma_f32_32x32x16_bf16 a[176:191], v[48:51], v[84:87], 0
    ds_read_b64_tr_b16 v[98:99], v19 offset:10240
    v_mfma_f32_32x32x16_bf16 a[192:207], v[52:55], v[72:75], 0
    ds_read_b64_tr_b16 v[100:101], v20 offset:8192
    v_mfma_f32_32x32x16_bf16 a[208:223], v[52:55], v[76:79], 0
    ds_read_b64_tr_b16 v[102:103], v20 offset:10240
    v_mfma_f32_32x32x16_bf16 a[224:239], v[52:55], v[80:83], 0
    v_mfma_f32_32x32x16_bf16 a[240:255], v[52:55], v[84:87], 0
    s_waitcnt vmcnt(24) lgkmcnt(0)
    s_barrier
    s_cmp_ge_u32 s2, 16
    s_cbranch_scc1 L_pj_za_1
    s_cmp_lg_u32 s68, 0
    s_cbranch_scc1 L_pj_za_1
    s_lshl_b32 s66, s2, 12
    s_add_u32 s66, s66, 91226112
    buffer_store_dword v254, v254, s[32:35], s66 offen sc1
L_pj_za_1:
    v_mfma_f32_32x32x16_bf16 a[0:15], v[56:59], v[88:91], a[0:15]
    s_add_u32 m0, s84, 0
    s_add_u32 s69, s79, 1048576
    buffer_load_dwordx4 v6, s[12:15], s69 offen lds
    v_mfma_f32_32x32x16_bf16 a[16:31], v[56:59], v[92:95], a[16:31]
    v_mfma_f32_32x32x16_bf16 a[32:47], v[56:59], v[96:99], a[32:47]
    ds_read_b128 v[40:43], v11 offset:0
    v_mfma_f32_32x32x16_bf16 a[48:63], v[56:59], v[100:103], a[48:63]
    ds_read_b128 v[44:47], v11 offset:4096
    v_mfma_f32_32x32x16_bf16 a[64:79], v[60:63], v[88:91], a[64:79]
    ds_read_b128 v[48:51], v11 offset:8192
    v_mfma_f32_32x32x16_bf16 a[80:95], v[60:63], v[92:95], a[80:95]
    ds_read_b128 v[52:55], v11 offset:12288
    v_mfma_f32_32x32x16_bf16 a[96:111], v[60:63], v[96:99], a[96:111]
    ds_read_b64_tr_b16 v[72:73], v17 offset:16384
    v_mfma_f32_32x32x16_bf16 a[112:127], v[60:63], v[100:103], a[112:127]
    ds_read_b64_tr_b16 v[74:75], v17 offset:18432
    v_mfma_f32_32x32x16_bf16 a[128:143], v[64:67], v[88:91], a[128:143]
    ds_read_b64_tr_b16 v[76:77], v18 offset:16384
    v_mfma_f32_32x32x16_bf16 a[144:159], v[64:67], v[92:95], a[144:159]
    s_add_u32 m0, s84, 1024
    s_add_u32 s69, s79, 1064960
    buffer_load_dwordx4 v7, s[12:15], s69 offen lds
    v_mfma_f32_32x32x16_bf16 a[160:175], v[64:67], v[96:99], a[160:175]
    ds_read_b64_tr_b16 v[78:79], v18 offset:18432
    v_mfma_f32_32x32x16_bf16 a[176:191], v[64:67], v[100:103], a[176:191]
    ds_read_b64_tr_b16 v[80:81], v19 offset:16384
    ds_read_b64_tr_b16 v[82:83], v19 offset:18432
    v_mfma_f32_32x32x16_bf16 a[192:207], v[68:71], v[88:91], a[192:207]
    ds_read_b64_tr_b16 v[84:85], v20 offset:16384
    v_mfma_f32_32x32x16_bf16 a[208:223], v[68:71], v[92:95], a[208:223]
    ds_read_b64_tr_b16 v[86:87], v20 offset:18432
    v_mfma_f32_32x32x16_bf16 a[224:239], v[68:71], v[96:99], a[224:239]
    s_add_u32 m0, s84, 2048
    s_add_u32 s69, s79, 1081344
    buffer_load_dwordx4 v6, s[12:15], s69 offen lds
    v_mfma_f32_32x32x16_bf16 a[240:255], v[68:71], v[100:103], a[240:255]
    s_waitcnt lgkmcnt(0)
    v_mfma_f32_32x32x16_bf16 a[0:15], v[40:43], v[72:75], a[0:15]
    ds_read_b128 v[56:59], v12 offset:0
    v_mfma_f32_32x32x16_bf16 a[16:31], v[40:43], v[76:79], a[16:31]
    s_lshl_b32 s98, s2, 2
    s_add_u32 s98, s98, s68
    v_mfma_f32_32x32x16_bf16 a[32:47], v[40:43], v[80:83], a[32:47]
    ds_read_b128 v[60:63], v12 offset:4096
    v_mfma_f32_32x32x16_bf16 a[48:63], v[40:43], v[84:87], a[48:63]
    ds_read_b128 v[64:67], v12 offset:8192
    ds_read_b128 v[68:71], v12 offset:12288
    v_mfma_f32_32x32x16_bf16 a[64:79], v[44:47], v[72:75], a[64:79]
    ds_read_b64_tr_b16 v[88:89], v17 offset:24576
    v_mfma_f32_32x32x16_bf16 a[80:95], v[44:47], v[76:79], a[80:95]
    ds_read_b64_tr_b16 v[90:91], v17 offset:26624
    v_mfma_f32_32x32x16_bf16 a[96:111], v[44:47], v[80:83], a[96:111]
    s_add_u32 m0, s84, 3072
    s_add_u32 s69, s79, 1097728
    buffer_load_dwordx4 v7, s[12:15], s69 offen lds
    v_mfma_f32_32x32x16_bf16 a[112:127], v[44:47], v[84:87], a[112:127]
    ds_read_b64_tr_b16 v[92:93], v18 offset:24576
    v_mfma_f32_32x32x16_bf16 a[128:143], v[48:51], v[72:75], a[128:143]
    s_mul_i32 s99, s98, 18
    v_mfma_f32_32x32x16_bf16 a[144:159], v[48:51], v[76:79], a[144:159]
    ds_read_b64_tr_b16 v[94:95], v18 offset:26624
    v_mfma_f32_32x32x16_bf16 a[160:175], v[48:51], v[80:83], a[160:175]
    ds_read_b64_tr_b16 v[96:97], v19 offset:24576
    v_mfma_f32_32x32x16_bf16 a[176:191], v[48:51], v[84:87], a[176:191]
    ds_read_b64_tr_b16 v[98:99], v19 offset:26624
    v_mfma_f32_32x32x16_bf16 a[192:207], v[52:55], v[72:75], a[192:207]
    ds_read_b64_tr_b16 v[100:101], v20 offset:24576
    v_mfma_f32_32x32x16_bf16 a[208:223], v[52:55], v[76:79], a[208:223]
    ds_read_b64_tr_b16 v[102:103], v20 offset:26624
    v_mfma_f32_32x32x16_bf16 a[224:239], v[52:55], v[80:83], a[224:239]
    v_mfma_f32_32x32x16_bf16 a[240:255], v[52:55], v[84:87], a[240:255]
    s_waitcnt vmcnt(16) lgkmcnt(0)
    s_barrier
    v_mfma_f32_32x32x16_bf16 a[0:15], v[56:59], v[88:91], a[0:15]
    s_add_u32 m0, s84, 16384
    s_add_u32 s69, s79, 1310720
    buffer_load_dwordx4 v6, s[12:15], s69 offen lds
    v_mfma_f32_32x32x16_bf16 a[16:31], v[56:59], v[92:95], a[16:31]
    ds_read_b128 v[40:43], v9 offset:32768
    ds_read_b128 v[44:47], v9 offset:36864
    v_mfma_f32_32x32x16_bf16 a[32:47], v[56:59], v[96:99], a[32:47]
    ds_read_b128 v[48:51], v9 offset:40960
    ds_read_b128 v[52:55], v9 offset:45056
    ds_read_b64_tr_b16 v[72:73], v17 offset:32768
    v_mfma_f32_32x32x16_bf16 a[48:63], v[56:59], v[100:103], a[48:63]
    s_add_u32 m0, s84, 17408
    s_add_u32 s69, s79, 1327104
    buffer_load_dwordx4 v7, s[12:15], s69 offen lds
    v_mfma_f32_32x32x16_bf16 a[64:79], v[60:63], v[88:91], a[64:79]
    ds_read_b64_tr_b16 v[74:75], v17 offset:34816
    v_add_u32 v244, s99, v0
    v_mfma_f32_32x32x16_bf16 a[80:95], v[60:63], v[92:95], a[80:95]
    s_add_u32 m0, s84, 18432
    s_add_u32 s69, s79, 1343488
    buffer_load_dwordx4 v6, s[12:15], s69 offen lds
    v_mfma_f32_32x32x16_bf16 a[96:111], v[60:63], v[96:99], a[96:111]
    s_add_u32 m0, s84, 19456
    s_add_u32 s69, s79, 1359872
    buffer_load_dwordx4 v7, s[12:15], s69 offen lds
    v_mfma_f32_32x32x16_bf16 a[112:127], v[60:63], v[100:103], a[112:127]
    ds_read_b64_tr_b16 v[76:77], v18 offset:32768
    v_mfma_f32_32x32x16_bf16 a[128:143], v[64:67], v[88:91], a[128:143]
    ds_read_b64_tr_b16 v[78:79], v18 offset:34816
    ds_read_b64_tr_b16 v[80:81], v19 offset:32768
    v_mfma_f32_32x32x16_bf16 a[144:159], v[64:67], v[92:95], a[144:159]
    ds_read_b64_tr_b16 v[82:83], v19 offset:34816
    v_lshlrev_b32 v244, 7, v244
    v_mfma_f32_32x32x16_bf16 a[160:175], v[64:67], v[96:99], a[160:175]
    s_add_u32 m0, s85, 65536
    s_add_u32 s69, s78, 384
    buffer_load_dwordx4 v2, s[8:11], s69 offen lds
    v_mfma_f32_32x32x16_bf16 a[176:191], v[64:67], v[100:103], a[176:191]
    ds_read_b64_tr_b16 v[84:85], v20 offset:32768
    v_mfma_f32_32x32x16_bf16 a[192:207], v[68:71], v[88:91], a[192:207]
    s_add_u32 m0, s85, 66560
    s_add_u32 s69, s78, 8576
    buffer_load_dwordx4 v3, s[8:11], s69 offen lds
    v_mfma_f32_32x32x16_bf16 a[208:223], v[68:71], v[92:95], a[208:223]
    ds_read_b64_tr_b16 v[86:87], v20 offset:34816
    v_mfma_f32_32x32x16_bf16 a[224:239], v[68:71], v[96:99], a[224:239]
    s_add_u32 m0, s85, 67584
    s_add_u32 s69, s78, 16768
    buffer_load_dwordx4 v2, s[8:11], s69 offen lds
    v_mfma_f32_32x32x16_bf16 a[240:255], v[68:71], v[100:103], a[240:255]
    v_mov_b32 v251, 0xf0000000
    s_waitcnt lgkmcnt(0)
    v_mfma_f32_32x32x16_bf16 a[0:15], v[40:43], v[72:75], a[0:15]
    ds_read_b128 v[56:59], v10 offset:32768
    v_mfma_f32_32x32x16_bf16 a[16:31], v[40:43], v[76:79], a[16:31]
    ds_read_b128 v[60:63], v10 offset:36864
    ds_read_b128 v[64:67], v10 offset:40960
    v_mfma_f32_32x32x16_bf16 a[32:47], v[40:43], v[80:83], a[32:47]
    s_add_u32 m0, s85, 68608
    s_add_u32 s69, s78, 24960
    buffer_load_dwordx4 v3, s[8:11], s69 offen lds
    v_mfma_f32_32x32x16_bf16 a[48:63], v[40:43], v[84:87], a[48:63]
    ds_read_b128 v[68:71], v10 offset:45056
    ds_read_b64_tr_b16 v[88:89], v17 offset:40960
    v_mfma_f32_32x32x16_bf16 a[64:79], v[44:47], v[72:75], a[64:79]
    s_add_u32 m0, s85, 69632
    s_add_u32 s69, s78, 33152
    buffer_load_dwordx4 v2, s[8:11], s69 offen lds
    v_mfma_f32_32x32x16_bf16 a[80:95], v[44:47], v[76:79], a[80:95]
    ds_read_b64_tr_b16 v[90:91], v17 offset:43008
    v_mfma_f32_32x32x16_bf16 a[96:111], v[44:47], v[80:83], a[96:111]
    ds_read_b64_tr_b16 v[92:93], v18 offset:40960
    v_mfma_f32_32x32x16_bf16 a[112:127], v[44:47], v[84:87], a[112:127]
    s_add_u32 m0, s85, 70656
    s_add_u32 s69, s78, 41344
    buffer_load_dwordx4 v3, s[8:11], s69 offen lds
    v_mfma_f32_32x32x16_bf16 a[128:143], v[48:51], v[72:75], a[128:143]
    s_add_u32 m0, s85, 71680
    s_add_u32 s69, s78, 49536
    buffer_load_dwordx4 v2, s[8:11], s69 offen lds
    v_mfma_f32_32x32x16_bf16 a[144:159], v[48:51], v[76:79], a[144:159]
    ds_read_b64_tr_b16 v[94:95], v18 offset:43008
    ds_read_b64_tr_b16 v[96:97], v19 offset:40960
    v_mfma_f32_32x32x16_bf16 a[160:175], v[48:51], v[80:83], a[160:175]
    v_cmp_gt_u32 vcc, 18, v0
    s_nop 1
    v_cndmask_b32 v244, v251, v244, vcc
    v_mfma_f32_32x32x16_bf16 a[176:191], v[48:51], v[84:87], a[176:191]
    ds_read_b64_tr_b16 v[98:99], v19 offset:43008
    v_mfma_f32_32x32x16_bf16 a[192:207], v[52:55], v[72:75], a[192:207]
    ds_read_b64_tr_b16 v[100:101], v20 offset:40960
    v_mfma_f32_32x32x16_bf16 a[208:223], v[52:55], v[76:79], a[208:223]
    ds_read_b64_tr_b16 v[102:103], v20 offset:43008
    v_mfma_f32_32x32x16_bf16 a[224:239], v[52:55], v[80:83], a[224:239]
    s_add_u32 m0, s85, 72704
    s_add_u32 s69, s78, 57728
    buffer_load_dwordx4 v3, s[8:11], s69 offen lds
    v_mfma_f32_32x32x16_bf16 a[240:255], v[52:55], v[84:87], a[240:255]
    s_waitcnt vmcnt(24) lgkmcnt(0)
    s_barrier
    v_mfma_f32_32x32x16_bf16 a[0:15], v[56:59], v[88:91], a[0:15]
    ds_read_b128 v[40:43], v11 offset:32768
    v_mfma_f32_32x32x16_bf16 a[16:31], v[56:59], v[92:95], a[16:31]
    s_add_u32 m0, s84, 32768
    s_add_u32 s69, s79, 1572864
    buffer_load_dwordx4 v6, s[12:15], s69 offen lds
    v_mfma_f32_32x32x16_bf16 a[32:47], v[56:59], v[96:99], a[32:47]
    buffer_load_dword v252, v244, s[16:19], 0 offen
    v_mfma_f32_32x32x16_bf16 a[48:63], v[56:59], v[100:103], a[48:63]
    ds_read_b128 v[44:47], v11 offset:36864
    v_mfma_f32_32x32x16_bf16 a[64:79], v[60:63], v[88:91], a[64:79]
    ds_read_b128 v[48:51], v11 offset:40960
    v_mfma_f32_32x32x16_bf16 a[80:95], v[60:63], v[92:95], a[80:95]
    s_mul_i32 s99, s98, 36
    v_mfma_f32_32x32x16_bf16 a[96:111], v[60:63], v[96:99], a[96:111]
    ds_read_b128 v[52:55], v11 offset:45056
    v_mfma_f32_32x32x16_bf16 a[112:127], v[60:63], v[100:103], a[112:127]
    ds_read_b64_tr_b16 v[72:73], v17 offset:49152
    v_mfma_f32_32x32x16_bf16 a[128:143], v[64:67], v[88:91], a[128:143]
    ds_read_b64_tr_b16 v[74:75], v17 offset:51200
    v_mfma_f32_32x32x16_bf16 a[144:159], v[64:67], v[92:95], a[144:159]
    ds_read_b64_tr_b16 v[76:77], v18 offset:49152
    ds_read_b64_tr_b16 v[78:79], v18 offset:51200
    v_mfma_f32_32x32x16_bf16 a[160:175], v[64:67], v[96:99], a[160:175]
    s_add_u32 m0, s84, 33792
    s_add_u32 s69, s79, 1589248
    buffer_load_dwordx4 v7, s[12:15], s69 offen lds
    v_mfma_f32_32x32x16_bf16 a[176:191], v[64:67], v[100:103], a[176:191]
    ds_read_b64_tr_b16 v[80:81], v19 offset:49152
    ds_read_b64_tr_b16 v[82:83], v19 offset:51200
    v_mfma_f32_32x32x16_bf16 a[192:207], v[68:71], v[88:91], a[192:207]
    ds_read_b64_tr_b16 v[84:85], v20 offset:49152
    v_mfma_f32_32x32x16_bf16 a[208:223], v[68:71], v[92:95], a[208:223]
    ds_read_b64_tr_b16 v[86:87], v20 offset:51200
    v_mfma_f32_32x32x16_bf16 a[224:239], v[68:71], v[96:99], a[224:239]
    s_add_u32 m0, s84, 34816
    s_add_u32 s69, s79, 1605632
    buffer_load_dwordx4 v6, s[12:15], s69 offen lds
    v_mfma_f32_32x32x16_bf16 a[240:255], v[68:71], v[100:103], a[240:255]
    s_waitcnt lgkmcnt(0)
    v_mfma_f32_32x32x16_bf16 a[0:15], v[40:43], v[72:75], a[0:15]
    ds_read_b128 v[56:59], v12 offset:32768
    v_mfma_f32_32x32x16_bf16 a[16:31], v[40:43], v[76:79], a[16:31]
    ds_read_b128 v[60:63], v12 offset:36864
    v_mfma_f32_32x32x16_bf16 a[32:47], v[40:43], v[80:83], a[32:47]
    v_mfma_f32_32x32x16_bf16 a[48:63], v[40:43], v[84:87], a[48:63]
    ds_read_b128 v[64:67], v12 offset:40960
    v_mfma_f32_32x32x16_bf16 a[64:79], v[44:47], v[72:75], a[64:79]
    ds_read_b128 v[68:71], v12 offset:45056
    v_mfma_f32_32x32x16_bf16 a[80:95], v[44:47], v[76:79], a[80:95]
    v_add_u32 v245, s99, v0
    v_lshlrev_b32 v245, 7, v245
    v_mfma_f32_32x32x16_bf16 a[96:111], v[44:47], v[80:83], a[96:111]
    ds_read_b64_tr_b16 v[88:89], v17 offset:57344
    v_mfma_f32_32x32x16_bf16 a[112:127], v[44:47], v[84:87], a[112:127]
    ds_read_b64_tr_b16 v[90:91], v17 offset:59392
    v_mfma_f32_32x32x16_bf16 a[128:143], v[48:51], v[72:75], a[128:143]
    s_add_u32 m0, s84, 35840
    s_add_u32 s69, s79, 1622016
    buffer_load_dwordx4 v7, s[12:15], s69 offen lds
    v_mfma_f32_32x32x16_bf16 a[144:159], v[48:51], v[76:79], a[144:159]
    ds_read_b64_tr_b16 v[92:93], v18 offset:57344
    v_mfma_f32_32x32x16_bf16 a[160:175], v[48:51], v[80:83], a[160:175]
    ds_read_b64_tr_b16 v[94:95], v18 offset:59392
    v_mfma_f32_32x32x16_bf16 a[176:191], v[48:51], v[84:87], a[176:191]
    ds_read_b64_tr_b16 v[96:97], v19 offset:57344
    v_mfma_f32_32x32x16_bf16 a[192:207], v[52:55], v[72:75], a[192:207]
    ds_read_b64_tr_b16 v[98:99], v19 offset:59392
    v_mfma_f32_32x32x16_bf16 a[208:223], v[52:55], v[76:79], a[208:223]
    ds_read_b64_tr_b16 v[100:101], v20 offset:57344
    ds_read_b64_tr_b16 v[102:103], v20 offset:59392
    v_mfma_f32_32x32x16_bf16 a[224:239], v[52:55], v[80:83], a[224:239]
    v_mov_b32 v251, 0xf0000000
    v_mfma_f32_32x32x16_bf16 a[240:255], v[52:55], v[84:87], a[240:255]
    s_waitcnt vmcnt(17) lgkmcnt(0)
    s_barrier
    v_mfma_f32_32x32x16_bf16 a[0:15], v[56:59], v[88:91], a[0:15]
    ds_read_b128 v[40:43], v13 offset:0
    ds_read_b128 v[44:47], v13 offset:4096
    v_mfma_f32_32x32x16_bf16 a[16:31], v[56:59], v[92:95], a[16:31]
    s_add_u32 m0, s84, 49152
    s_add_u32 s69, s79, 1835008
    buffer_load_dwordx4 v6, s[12:15], s69 offen lds
    v_mfma_f32_32x32x16_bf16 a[32:47], v[56:59], v[96:99], a[32:47]
    s_add_u32 m0, s84, 50176
    s_add_u32 s69, s79, 1851392
    buffer_load_dwordx4 v7, s[12:15], s69 offen lds
    v_mfma_f32_32x32x16_bf16 a[48:63], v[56:59], v[100:103], a[48:63]
    ds_read_b128 v[48:51], v13 offset:8192
    ds_read_b128 v[52:55], v13 offset:12288
    v_mfma_f32_32x32x16_bf16 a[64:79], v[60:63], v[88:91], a[64:79]
    ds_read_b64_tr_b16 v[72:73], v17 offset:0
    ds_read_b64_tr_b16 v[74:75], v17 offset:2048
    v_mfma_f32_32x32x16_bf16 a[80:95], v[60:63], v[92:95], a[80:95]
    v_cmp_gt_u32 vcc, 36, v0
    s_nop 1
    v_cndmask_b32 v245, v251, v245, vcc
    v_mfma_f32_32x32x16_bf16 a[96:111], v[60:63], v[96:99], a[96:111]
    ds_read_b64_tr_b16 v[76:77], v18 offset:0
    v_mfma_f32_32x32x16_bf16 a[112:127], v[60:63], v[100:103], a[112:127]
    s_add_u32 m0, s84, 51200
    s_add_u32 s69, s79, 1867776
    buffer_load_dwordx4 v6, s[12:15], s69 offen lds
    v_mfma_f32_32x32x16_bf16 a[128:143], v[64:67], v[88:91], a[128:143]
    s_add_u32 m0, s84, 52224
    s_add_u32 s69, s79, 1884160
    buffer_load_dwordx4 v7, s[12:15], s69 offen lds
    v_mfma_f32_32x32x16_bf16 a[144:159], v[64:67], v[92:95], a[144:159]
    ds_read_b64_tr_b16 v[78:79], v18 offset:2048
    ds_read_b64_tr_b16 v[80:81], v19 offset:0
    v_mfma_f32_32x32x16_bf16 a[160:175], v[64:67], v[96:99], a[160:175]
    s_add_u32 m0, s85, 98304
    s_add_u32 s69, s78, 512
    buffer_load_dwordx4 v2, s[8:11], s69 offen lds
    v_mfma_f32_32x32x16_bf16 a[176:191], v[64:67], v[100:103], a[176:191]
    buffer_load_dword v252, v245, s[20:23], 0 offen
    v_mfma_f32_32x32x16_bf16 a[192:207], v[68:71], v[88:91], a[192:207]
    ds_read_b64_tr_b16 v[82:83], v19 offset:2048
    ds_read_b64_tr_b16 v[84:85], v20 offset:0
    v_mfma_f32_32x32x16_bf16 a[208:223], v[68:71], v[92:95], a[208:223]
    ds_read_b64_tr_b16 v[86:87], v20 offset:2048
    v_mfma_f32_32x32x16_bf16 a[224:239], v[68:71], v[96:99], a[224:239]
    s_add_u32 m0, s85, 99328
    s_add_u32 s69, s78, 8704
    buffer_load_dwordx4 v3, s[8:11], s69 offen lds
    v_mfma_f32_32x32x16_bf16 a[240:255], v[68:71], v[100:103], a[240:255]
    s_mul_i32 s99, s98, 18
    s_waitcnt lgkmcnt(0)
    v_mfma_f32_32x32x16_bf16 a[0:15], v[40:43], v[72:75], a[0:15]
    s_add_u32 m0, s85, 100352
    s_add_u32 s69, s78, 16896
    buffer_load_dwordx4 v2, s[8:11], s69 offen lds
    v_mfma_f32_32x32x16_bf16 a[16:31], v[40:43], v[76:79], a[16:31]
    ds_read_b128 v[56:59], v14 offset:0
    ds_read_b128 v[60:63], v14 offset:4096
    v_mfma_f32_32x32x16_bf16 a[32:47], v[40:43], v[80:83], a[32:47]
    s_add_u32 m0, s85, 101376
    s_add_u32 s69, s78, 25088
    buffer_load_dwordx4 v3, s[8:11], s69 offen lds
    v_mfma_f32_32x32x16_bf16 a[48:63], v[40:43], v[84:87], a[48:63]
    ds_read_b128 v[64:67], v14 offset:8192
    v_mfma_f32_32x32x16_bf16 a[64:79], v[44:47], v[72:75], a[64:79]
    ds_read_b128 v[68:71], v14 offset:12288
    v_mfma_f32_32x32x16_bf16 a[80:95], v[44:47], v[76:79], a[80:95]
    ds_read_b64_tr_b16 v[88:89], v17 offset:8192
    v_mfma_f32_32x32x16_bf16 a[96:111], v[44:47], v[80:83], a[96:111]
    s_add_u32 m0, s85, 102400
    s_add_u32 s69, s78, 33280
    buffer_load_dwordx4 v2, s[8:11], s69 offen lds
    v_mfma_f32_32x32x16_bf16 a[112:127], v[44:47], v[84:87], a[112:127]
    ds_read_b64_tr_b16 v[90:91], v17 offset:10240
    v_mfma_f32_32x32x16_bf16 a[128:143], v[48:51], v[72:75], a[128:143]
    s_add_u32 m0, s85, 103424
    s_add_u32 s69, s78, 41472
    buffer_load_dwordx4 v3, s[8:11], s69 offen lds
    v_mfma_f32_32x32x16_bf16 a[144:159], v[48:51], v[76:79], a[144:159]
    ds_read_b64_tr_b16 v[92:93], v18 offset:8192
    ds_read_b64_tr_b16 v[94:95], v18 offset:10240
    v_mfma_f32_32x32x16_bf16 a[160:175], v[48:51], v[80:83], a[160:175]
    ds_read_b64_tr_b16 v[96:97], v19 offset:8192
    v_add_u32 v246, s99, v0
    v_mfma_f32_32x32x16_bf16 a[176:191], v[48:51], v[84:87], a[176:191]
    s_add_u32 m0, s85, 104448
    s_add_u32 s69, s78, 49664
    buffer_load_dwordx4 v2, s[8:11], s69 offen lds
    v_mfma_f32_32x32x16_bf16 a[192:207], v[52:55], v[72:75], a[192:207]
    ds_read_b64_tr_b16 v[98:99], v19 offset:10240
    ds_read_b64_tr_b16 v[100:101], v20 offset:8192
    v_mfma_f32_32x32x16_bf16 a[208:223], v[52:55], v[76:79], a[208:223]
    ds_read_b64_tr_b16 v[102:103], v20 offset:10240
    v_mfma_f32_32x32x16_bf16 a[224:239], v[52:55], v[80:83], a[224:239]
    s_add_u32 m0, s85, 105472
    s_add_u32 s69, s78, 57856
    buffer_load_dwordx4 v3, s[8:11], s69 offen lds
    v_mfma_f32_32x32x16_bf16 a[240:255], v[52:55], v[84:87], a[240:255]
    s_waitcnt vmcnt(26) lgkmcnt(0)
    s_barrier
    v_mfma_f32_32x32x16_bf16 a[0:15], v[56:59], v[88:91], a[0:15]
    s_add_u32 m0, s84, 0
    s_add_u32 s69, s79, 2097152
    buffer_load_dwordx4 v6, s[12:15], s69 offen lds
    v_mfma_f32_32x32x16_bf16 a[16:31], v[56:59], v[92:95], a[16:31]
    ds_read_b128 v[40:43], v15 offset:0
    v_mfma_f32_32x32x16_bf16 a[32:47], v[56:59], v[96:99], a[32:47]
    ds_read_b128 v[44:47], v15 offset:4096
    v_mfma_f32_32x32x16_bf16 a[48:63], v[56:59], v[100:103], a[48:63]
    v_lshlrev_b32 v246, 7, v246
    v_mfma_f32_32x32x16_bf16 a[64:79], v[60:63], v[88:91], a[64:79]
    ds_read_b128 v[48:51], v15 offset:8192
    v_mfma_f32_32x32x16_bf16 a[80:95], v[60:63], v[92:95], a[80:95]
    ds_read_b128 v[52:55], v15 offset:12288
    v_mfma_f32_32x32x16_bf16 a[96:111], v[60:63], v[96:99], a[96:111]
    ds_read_b64_tr_b16 v[72:73], v17 offset:16384
    ds_read_b64_tr_b16 v[74:75], v17 offset:18432
    v_mfma_f32_32x32x16_bf16 a[112:127], v[60:63], v[100:103], a[112:127]
    ds_read_b64_tr_b16 v[76:77], v18 offset:16384
    v_mfma_f32_32x32x16_bf16 a[128:143], v[64:67], v[88:91], a[128:143]
    ds_read_b64_tr_b16 v[78:79], v18 offset:18432
    v_mfma_f32_32x32x16_bf16 a[144:159], v[64:67], v[92:95], a[144:159]
    s_add_u32 m0, s84, 1024
    s_add_u32 s69, s79, 2113536
    buffer_load_dwordx4 v7, s[12:15], s69 offen lds
    v_mfma_f32_32x32x16_bf16 a[160:175], v[64:67], v[96:99], a[160:175]
    ds_read_b64_tr_b16 v[80:81], v19 offset:16384
    v_mfma_f32_32x32x16_bf16 a[176:191], v[64:67], v[100:103], a[176:191]
    ds_read_b64_tr_b16 v[82:83], v19 offset:18432
    v_mov_b32 v251, 0xf0000000
    v_mfma_f32_32x32x16_bf16 a[192:207], v[68:71], v[88:91], a[192:207]
    ds_read_b64_tr_b16 v[84:85], v20 offset:16384
    ds_read_b64_tr_b16 v[86:87], v20 offset:18432
    v_mfma_f32_32x32x16_bf16 a[208:223], v[68:71], v[92:95], a[208:223]
    v_cmp_gt_u32 vcc, 18, v0
    s_nop 1
    v_cndmask_b32 v246, v251, v246, vcc
    v_mfma_f32_32x32x16_bf16 a[224:239], v[68:71], v[96:99], a[224:239]
    s_add_u32 m0, s84, 2048
    s_add_u32 s69, s79, 2129920
    buffer_load_dwordx4 v6, s[12:15], s69 offen lds
    v_mfma_f32_32x32x16_bf16 a[240:255], v[68:71], v[100:103], a[240:255]
    s_waitcnt lgkmcnt(0)
    v_mfma_f32_32x32x16_bf16 a[0:15], v[40:43], v[72:75], a[0:15]
    ds_read_b128 v[56:59], v16 offset:0
    v_mfma_f32_32x32x16_bf16 a[16:31], v[40:43], v[76:79], a[16:31]
    ds_read_b128 v[60:63], v16 offset:4096
    v_mfma_f32_32x32x16_bf16 a[32:47], v[40:43], v[80:83], a[32:47]
    ds_read_b128 v[64:67], v16 offset:8192
    ds_read_b128 v[68:71], v16 offset:12288
    v_mfma_f32_32x32x16_bf16 a[48:63], v[40:43], v[84:87], a[48:63]
    buffer_load_dword v252, v246, s[24:27], 0 offen
    v_mfma_f32_32x32x16_bf16 a[64:79], v[44:47], v[72:75], a[64:79]
    ds_read_b64_tr_b16 v[88:89], v17 offset:24576
    v_mfma_f32_32x32x16_bf16 a[80:95], v[44:47], v[76:79], a[80:95]
    v_mfma_f32_32x32x16_bf16 a[96:111], v[44:47], v[80:83], a[96:111]
    ds_read_b64_tr_b16 v[90:91], v17 offset:26624
    v_mfma_f32_32x32x16_bf16 a[112:127], v[44:47], v[84:87], a[112:127]
    s_add_u32 m0, s84, 3072
    s_add_u32 s69, s79, 2146304
    buffer_load_dwordx4 v7, s[12:15], s69 offen lds
    v_mfma_f32_32x32x16_bf16 a[128:143], v[48:51], v[72:75], a[128:143]
    ds_read_b64_tr_b16 v[92:93], v18 offset:24576
    v_mfma_f32_32x32x16_bf16 a[144:159], v[48:51], v[76:79], a[144:159]
    ds_read_b64_tr_b16 v[94:95], v18 offset:26624
    v_mfma_f32_32x32x16_bf16 a[160:175], v[48:51], v[80:83], a[160:175]
    ds_read_b64_tr_b16 v[96:97], v19 offset:24576
    v_mfma_f32_32x32x16_bf16 a[176:191], v[48:51], v[84:87], a[176:191]
    ds_read_b64_tr_b16 v[98:99], v19 offset:26624
    v_mfma_f32_32x32x16_bf16 a[192:207], v[52:55], v[72:75], a[192:207]
    ds_read_b64_tr_b16 v[100:101], v20 offset:24576
    v_mfma_f32_32x32x16_bf16 a[208:223], v[52:55], v[76:79], a[208:223]
    ds_read_b64_tr_b16 v[102:103], v20 offset:26624
    v_mfma_f32_32x32x16_bf16 a[224:239], v[52:55], v[80:83], a[224:239]
    s_mul_i32 s99, s98, 16
    v_mfma_f32_32x32x16_bf16 a[240:255], v[52:55], v[84:87], a[240:255]
    s_waitcnt vmcnt(18) lgkmcnt(0)
    s_barrier
    v_mfma_f32_32x32x16_bf16 a[0:15], v[56:59], v[88:91], a[0:15]
    s_add_u32 m0, s84, 16384
    s_add_u32 s69, s79, 2359296
    buffer_load_dwordx4 v6, s[12:15], s69 offen lds
    v_mfma_f32_32x32x16_bf16 a[16:31], v[56:59], v[92:95], a[16:31]
    ds_read_b128 v[40:43], v9 offset:0
    ds_read_b128 v[44:47], v9 offset:4096
    ds_read_b128 v[48:51], v9 offset:8192
    v_mfma_f32_32x32x16_bf16 a[32:47], v[56:59], v[96:99], a[32:47]
    s_add_u32 m0, s84, 17408
    s_add_u32 s69, s79, 2375680
    buffer_load_dwordx4 v7, s[12:15], s69 offen lds
    v_mfma_f32_32x32x16_bf16 a[48:63], v[56:59], v[100:103], a[48:63]
    ds_read_b128 v[52:55], v9 offset:12288
    ds_read_b64_tr_b16 v[72:73], v17 offset:32768
    v_mfma_f32_32x32x16_bf16 a[64:79], v[60:63], v[88:91], a[64:79]
    ds_read_b64_tr_b16 v[74:75], v17 offset:34816
    v_mfma_f32_32x32x16_bf16 a[80:95], v[60:63], v[92:95], a[80:95]
    s_add_u32 m0, s84, 18432
    s_add_u32 s69, s79, 2392064
    buffer_load_dwordx4 v6, s[12:15], s69 offen lds
    v_mfma_f32_32x32x16_bf16 a[96:111], v[60:63], v[96:99], a[96:111]
    ds_read_b64_tr_b16 v[76:77], v18 offset:32768
    v_mfma_f32_32x32x16_bf16 a[112:127], v[60:63], v[100:103], a[112:127]
    s_add_u32 m0, s84, 19456
    s_add_u32 s69, s79, 2408448
    buffer_load_dwordx4 v7, s[12:15], s69 offen lds
    v_mfma_f32_32x32x16_bf16 a[128:143], v[64:67], v[88:91], a[128:143]
    v_add_u32 v247, s99, v0
    v_lshlrev_b32 v247, 7, v247
    v_mfma_f32_32x32x16_bf16 a[144:159], v[64:67], v[92:95], a[144:159]
    ds_read_b64_tr_b16 v[78:79], v18 offset:34816
    ds_read_b64_tr_b16 v[80:81], v19 offset:32768
    v_mfma_f32_32x32x16_bf16 a[160:175], v[64:67], v[96:99], a[160:175]
    s_add_u32 m0, s85, 131072
    s_add_u32 s69, s78, 640
    buffer_load_dwordx4 v2, s[8:11], s69 offen lds
    v_mfma_f32_32x32x16_bf16 a[176:191], v[64:67], v[100:103], a[176:191]
    ds_read_b64_tr_b16 v[82:83], v19 offset:34816
    v_mfma_f32_32x32x16_bf16 a[192:207], v[68:71], v[88:91], a[192:207]
    ds_read_b64_tr_b16 v[84:85], v20 offset:32768
    v_mfma_f32_32x32x16_bf16 a[208:223], v[68:71], v[92:95], a[208:223]
    ds_read_b64_tr_b16 v[86:87], v20 offset:34816
    v_mfma_f32_32x32x16_bf16 a[224:239], v[68:71], v[96:99], a[224:239]
    s_add_u32 m0, s85, 132096
    s_add_u32 s69, s78, 8832
    buffer_load_dwordx4 v3, s[8:11], s69 offen lds
    v_mfma_f32_32x32x16_bf16 a[240:255], v[68:71], v[100:103], a[240:255]
    v_mov_b32 v251, 0xf0000000
    s_waitcnt lgkmcnt(0)
    v_mfma_f32_32x32x16_bf16 a[0:15], v[40:43], v[72:75], a[0:15]
    s_add_u32 m0, s85, 133120
    s_add_u32 s69, s78, 17024
    buffer_load_dwordx4 v2, s[8:11], s69 offen lds
    v_mfma_f32_32x32x16_bf16 a[16:31], v[40:43], v[76:79], a[16:31]
    ds_read_b128 v[56:59], v10 offset:0
    ds_read_b128 v[60:63], v10 offset:4096
    v_mfma_f32_32x32x16_bf16 a[32:47], v[40:43], v[80:83], a[32:47]
    s_add_u32 m0, s85, 134144
    s_add_u32 s69, s78, 25216
    buffer_load_dwordx4 v3, s[8:11], s69 offen lds
    v_mfma_f32_32x32x16_bf16 a[48:63], v[40:43], v[84:87], a[48:63]
    ds_read_b128 v[64:67], v10 offset:8192
    ds_read_b128 v[68:71], v10 offset:12288
    v_mfma_f32_32x32x16_bf16 a[64:79], v[44:47], v[72:75], a[64:79]
    s_add_u32 m0, s85, 135168
    s_add_u32 s69, s78, 33408
    buffer_load_dwordx4 v2, s[8:11], s69 offen lds
    v_mfma_f32_32x32x16_bf16 a[80:95], v[44:47], v[76:79], a[80:95]
    ds_read_b64_tr_b16 v[88:89], v17 offset:40960
    ds_read_b64_tr_b16 v[90:91], v17 offset:43008
    v_mfma_f32_32x32x16_bf16 a[96:111], v[44:47], v[80:83], a[96:111]
    s_add_u32 m0, s85, 136192
    s_add_u32 s69, s78, 41600
    buffer_load_dwordx4 v3, s[8:11], s69 offen lds
    v_mfma_f32_32x32x16_bf16 a[112:127], v[44:47], v[84:87], a[112:127]
    v_cmp_gt_u32 vcc, 16, v0
    s_nop 1
    v_cndmask_b32 v247, v251, v247, vcc
    v_mfma_f32_32x32x16_bf16 a[128:143], v[48:51], v[72:75], a[128:143]
    ds_read_b64_tr_b16 v[92:93], v18 offset:40960
    ds_read_b64_tr_b16 v[94:95], v18 offset:43008
    v_mfma_f32_32x32x16_bf16 a[144:159], v[48:51], v[76:79], a[144:159]
    ds_read_b64_tr_b16 v[96:97], v19 offset:40960
    v_mfma_f32_32x32x16_bf16 a[160:175], v[48:51], v[80:83], a[160:175]
    s_add_u32 m0, s85, 137216
    s_add_u32 s69, s78, 49792
    buffer_load_dwordx4 v2, s[8:11], s69 offen lds
    v_mfma_f32_32x32x16_bf16 a[176:191], v[48:51], v[84:87], a[176:191]
    ds_read_b64_tr_b16 v[98:99], v19 offset:43008
    v_mfma_f32_32x32x16_bf16 a[192:207], v[52:55], v[72:75], a[192:207]
    s_add_u32 m0, s85, 138240
    s_add_u32 s69, s78, 57984
    buffer_load_dwordx4 v3, s[8:11], s69 offen lds
    v_mfma_f32_32x32x16_bf16 a[208:223], v[52:55], v[76:79], a[208:223]
    ds_read_b64_tr_b16 v[100:101], v20 offset:40960
    ds_read_b64_tr_b16 v[102:103], v20 offset:43008
    v_mfma_f32_32x32x16_bf16 a[224:239], v[52:55], v[80:83], a[224:239]
    buffer_load_dword v252, v247, s[28:31], 0 offen
    v_mfma_f32_32x32x16_bf16 a[240:255], v[52:55], v[84:87], a[240:255]
    s_waitcnt vmcnt(27) lgkmcnt(0)
    s_barrier
    s_cmp_ge_u32 s2, 16
    s_cbranch_scc1 L_pj_zb_1
    s_cmp_lg_u32 s68, 0
    s_cbranch_scc1 L_pj_zb_1
    s_mov_b64 exec, 1
    buffer_atomic_add v255, v254, s[60:63], 0 offen sc1
    s_mov_b64 exec, -1
L_pj_zb_1:
    v_mfma_f32_32x32x16_bf16 a[0:15], v[56:59], v[88:91], a[0:15]
    ds_read_b128 v[40:43], v11 offset:0
    v_mfma_f32_32x32x16_bf16 a[16:31], v[56:59], v[92:95], a[16:31]
    ds_read_b128 v[44:47], v11 offset:4096
    v_mfma_f32_32x32x16_bf16 a[32:47], v[56:59], v[96:99], a[32:47]
    s_add_u32 m0, s84, 32768
    s_add_u32 s69, s79, 2621440
    buffer_load_dwordx4 v6, s[12:15], s69 offen lds
    v_mfma_f32_32x32x16_bf16 a[48:63], v[56:59], v[100:103], a[48:63]
    ds_read_b128 v[48:51], v11 offset:8192
    v_mfma_f32_32x32x16_bf16 a[64:79], v[60:63], v[88:91], a[64:79]
    ds_read_b128 v[52:55], v11 offset:12288
    v_mfma_f32_32x32x16_bf16 a[80:95], v[60:63], v[92:95], a[80:95]
    ds_read_b64_tr_b16 v[72:73], v17 offset:49152
    v_mfma_f32_32x32x16_bf16 a[96:111], v[60:63], v[96:99], a[96:111]
    ds_read_b64_tr_b16 v[74:75], v17 offset:51200
    ds_read_b64_tr_b16 v[76:77], v18 offset:49152
    v_mfma_f32_32x32x16_bf16 a[112:127], v[60:63], v[100:103], a[112:127]
    s_add_u32 m0, s84, 33792
    s_add_u32 s69, s79, 2637824
    buffer_load_dwordx4 v7, s[12:15], s69 offen lds
    v_mfma_f32_32x32x16_bf16 a[128:143], v[64:67], v[88:91], a[128:143]
    s_mul_i32 s99, s98, 36
    v_mfma_f32_32x32x16_bf16 a[144:159], v[64:67], v[92:95], a[144:159]
    ds_read_b64_tr_b16 v[78:79], v18 offset:51200
    v_mfma_f32_32x32x16_bf16 a[160:175], v[64:67], v[96:99], a[160:175]
    ds_read_b64_tr_b16 v[80:81], v19 offset:49152
    v_mfma_f32_32x32x16_bf16 a[176:191], v[64:67], v[100:103], a[176:191]
    ds_read_b64_tr_b16 v[82:83], v19 offset:51200
    v_mfma_f32_32x32x16_bf16 a[192:207], v[68:71], v[88:91], a[192:207]
    ds_read_b64_tr_b16 v[84:85], v20 offset:49152
    ds_read_b64_tr_b16 v[86:87], v20 offset:51200
    v_mfma_f32_32x32x16_bf16 a[208:223], v[68:71], v[92:95], a[208:223]
    s_add_u32 m0, s84, 34816
    s_add_u32 s69, s79, 2654208
    buffer_load_dwordx4 v6, s[12:15], s69 offen lds
    v_mfma_f32_32x32x16_bf16 a[224:239], v[68:71], v[96:99], a[224:239]
    v_add_u32 v248, s99, v0
    v_mfma_f32_32x32x16_bf16 a[240:255], v[68:71], v[100:103], a[240:255]
    s_waitcnt lgkmcnt(0)
    v_mfma_f32_32x32x16_bf16 a[0:15], v[40:43], v[72:75], a[0:15]
    v_mfma_f32_32x32x16_bf16 a[16:31], v[40:43], v[76:79], a[16:31]
    ds_read_b128 v[56:59], v12 offset:0
    v_mfma_f32_32x32x16_bf16 a[32:47], v[40:43], v[80:83], a[32:47]
    ds_read_b128 v[60:63], v12 offset:4096
    v_mfma_f32_32x32x16_bf16 a[48:63], v[40:43], v[84:87], a[48:63]
    ds_read_b128 v[64:67], v12 offset:8192
    v_mfma_f32_32x32x16_bf16 a[64:79], v[44:47], v[72:75], a[64:79]
    ds_read_b128 v[68:71], v12 offset:12288
    v_mfma_f32_32x32x16_bf16 a[80:95], v[44:47], v[76:79], a[80:95]
    v_mfma_f32_32x32x16_bf16 a[96:111], v[44:47], v[80:83], a[96:111]
    ds_read_b64_tr_b16 v[88:89], v17 offset:57344
    v_mfma_f32_32x32x16_bf16 a[112:127], v[44:47], v[84:87], a[112:127]
    ds_read_b64_tr_b16 v[90:91], v17 offset:59392
    v_mfma_f32_32x32x16_bf16 a[128:143], v[48:51], v[72:75], a[128:143]
    s_add_u32 m0, s84, 35840
    s_add_u32 s69, s79, 2670592
    buffer_load_dwordx4 v7, s[12:15], s69 offen lds
    v_mfma_f32_32x32x16_bf16 a[144:159], v[48:51], v[76:79], a[144:159]
    ds_read_b64_tr_b16 v[92:93], v18 offset:57344
    v_mfma_f32_32x32x16_bf16 a[160:175], v[48:51], v[80:83], a[160:175]
    ds_read_b64_tr_b16 v[94:95], v18 offset:59392
    ds_read_b64_tr_b16 v[96:97], v19 offset:57344
    v_mfma_f32_32x32x16_bf16 a[176:191], v[48:51], v[84:87], a[176:191]
    ds_read_b64_tr_b16 v[98:99], v19 offset:59392
    v_mfma_f32_32x32x16_bf16 a[192:207], v[52:55], v[72:75], a[192:207]
    ds_read_b64_tr_b16 v[100:101], v20 offset:57344
    v_mfma_f32_32x32x16_bf16 a[208:223], v[52:55], v[76:79], a[208:223]
    ds_read_b64_tr_b16 v[102:103], v20 offset:59392
    v_mfma_f32_32x32x16_bf16 a[224:239], v[52:55], v[80:83], a[224:239]
    v_mfma_f32_32x32x16_bf16 a[240:255], v[52:55], v[84:87], a[240:255]
    s_waitcnt vmcnt(17) lgkmcnt(0)
    s_barrier
    v_mfma_f32_32x32x16_bf16 a[0:15], v[56:59], v[88:91], a[0:15]
    s_add_u32 m0, s84, 49152
    s_add_u32 s69, s79, 2883584
    buffer_load_dwordx4 v6, s[12:15], s69 offen lds
    v_mfma_f32_32x32x16_bf16 a[16:31], v[56:59], v[92:95], a[16:31]
    ds_read_b128 v[40:43], v9 offset:32768
    ds_read_b128 v[44:47], v9 offset:36864
    v_mfma_f32_32x32x16_bf16 a[32:47], v[56:59], v[96:99], a[32:47]
    s_add_u32 m0, s84, 50176
    s_add_u32 s69, s79, 2899968
    buffer_load_dwordx4 v7, s[12:15], s69 offen lds
    v_mfma_f32_32x32x16_bf16 a[48:63], v[56:59], v[100:103], a[48:63]
    v_lshlrev_b32 v248, 7, v248
    v_mov_b32 v251, 0xf0000000
    v_mfma_f32_32x32x16_bf16 a[64:79], v[60:63], v[88:91], a[64:79]
    ds_read_b128 v[48:51], v9 offset:40960
    ds_read_b128 v[52:55], v9 offset:45056
    v_mfma_f32_32x32x16_bf16 a[80:95], v[60:63], v[92:95], a[80:95]
    v_cmp_gt_u32 vcc, 36, v0
    s_nop 1
    v_cndmask_b32 v248, v251, v248, vcc
    v_mfma_f32_32x32x16_bf16 a[96:111], v[60:63], v[96:99], a[96:111]
    s_add_u32 m0, s84, 51200
    s_add_u32 s69, s79, 2916352
    buffer_load_dwordx4 v6, s[12:15], s69 offen lds
    v_mfma_f32_32x32x16_bf16 a[112:127], v[60:63], v[100:103], a[112:127]
    ds_read_b64_tr_b16 v[72:73], v17 offset:0
    ds_read_b64_tr_b16 v[74:75], v17 offset:2048
    v_mfma_f32_32x32x16_bf16 a[128:143], v[64:67], v[88:91], a[128:143]
    ds_read_b64_tr_b16 v[76:77], v18 offset:0
    ds_read_b64_tr_b16 v[78:79], v18 offset:2048
    v_mfma_f32_32x32x16_bf16 a[144:159], v[64:67], v[92:95], a[144:159]
    s_add_u32 m0, s84, 52224
    s_add_u32 s69, s79, 2932736
    buffer_load_dwordx4 v7, s[12:15], s69 offen lds
    v_mfma_f32_32x32x16_bf16 a[160:175], v[64:67], v[96:99], a[160:175]
    ds_read_b64_tr_b16 v[80:81], v19 offset:0
    ds_read_b64_tr_b16 v[82:83], v19 offset:2048
    ds_read_b64_tr_b16 v[84:85], v20 offset:0
    v_mfma_f32_32x32x16_bf16 a[176:191], v[64:67], v[100:103], a[176:191]
    s_add_u32 m0, s85, 65536
    s_add_u32 s69, s78, 768
    buffer_load_dwordx4 v2, s[8:11], s69 offen lds
    v_mfma_f32_32x32x16_bf16 a[192:207], v[68:71], v[88:91], a[192:207]
    ds_read_b64_tr_b16 v[86:87], v20 offset:2048
    buffer_load_dword v252, v248, s[36:39], 0 offen
    v_mfma_f32_32x32x16_bf16 a[208:223], v[68:71], v[92:95], a[208:223]
    s_add_u32 m0, s85, 66560
    s_add_u32 s69, s78, 8960
    buffer_load_dwordx4 v3, s[8:11], s69 offen lds
    v_mfma_f32_32x32x16_bf16 a[224:239], v[68:71], v[96:99], a[224:239]
    s_add_u32 m0, s85, 67584
    s_add_u32 s69, s78, 17152
    buffer_load_dwordx4 v2, s[8:11], s69 offen lds
    v_mfma_f32_32x32x16_bf16 a[240:255], v[68:71], v[100:103], a[240:255]
    s_waitcnt lgkmcnt(0)
    v_mfma_f32_32x32x16_bf16 a[0:15], v[40:43], v[72:75], a[0:15]
    ds_read_b128 v[56:59], v10 offset:32768
    ds_read_b128 v[60:63], v10 offset:36864
    v_mfma_f32_32x32x16_bf16 a[16:31], v[40:43], v[76:79], a[16:31]
    s_add_u32 m0, s85, 68608
    s_add_u32 s69, s78, 25344
    buffer_load_dwordx4 v3, s[8:11], s69 offen lds
    v_mfma_f32_32x32x16_bf16 a[32:47], v[40:43], v[80:83], a[32:47]
    ds_read_b128 v[64:67], v10 offset:40960
    v_mfma_f32_32x32x16_bf16 a[48:63], v[40:43], v[84:87], a[48:63]
    ds_read_b128 v[68:71], v10 offset:45056
    v_mfma_f32_32x32x16_bf16 a[64:79], v[44:47], v[72:75], a[64:79]
    ds_read_b64_tr_b16 v[88:89], v17 offset:8192
    v_mfma_f32_32x32x16_bf16 a[80:95], v[44:47], v[76:79], a[80:95]
    s_add_u32 m0, s85, 69632
    s_add_u32 s69, s78, 33536
    buffer_load_dwordx4 v2, s[8:11], s69 offen lds
    v_mfma_f32_32x32x16_bf16 a[96:111], v[44:47], v[80:83], a[96:111]
    s_add_u32 m0, s85, 70656
    s_add_u32 s69, s78, 41728
    buffer_load_dwordx4 v3, s[8:11], s69 offen lds
    v_mfma_f32_32x32x16_bf16 a[112:127], v[44:47], v[84:87], a[112:127]
    ds_read_b64_tr_b16 v[90:91], v17 offset:10240
    s_mul_i32 s99, s98, 6
    v_mfma_f32_32x32x16_bf16 a[128:143], v[48:51], v[72:75], a[128:143]
    ds_read_b64_tr_b16 v[92:93], v18 offset:8192
    ds_read_b64_tr_b16 v[94:95], v18 offset:10240
    v_mfma_f32_32x32x16_bf16 a[144:159], v[48:51], v[76:79], a[144:159]
    ds_read_b64_tr_b16 v[96:97], v19 offset:8192
    v_add_u32 v249, s99, v0
    v_mfma_f32_32x32x16_bf16 a[160:175], v[48:51], v[80:83], a[160:175]
    s_add_u32 m0, s85, 71680
    s_add_u32 s69, s78, 49920
    buffer_load_dwordx4 v2, s[8:11], s69 offen lds
    v_mfma_f32_32x32x16_bf16 a[176:191], v[48:51], v[84:87], a[176:191]
    ds_read_b64_tr_b16 v[98:99], v19 offset:10240
    ds_read_b64_tr_b16 v[100:101], v20 offset:8192
    v_mfma_f32_32x32x16_bf16 a[192:207], v[52:55], v[72:75], a[192:207]
    s_add_u32 m0, s85, 72704
    s_add_u32 s69, s78, 58112
    buffer_load_dwordx4 v3, s[8:11], s69 offen lds
    v_mfma_f32_32x32x16_bf16 a[208:223], v[52:55], v[76:79], a[208:223]
    ds_read_b64_tr_b16 v[102:103], v20 offset:10240
    v_mfma_f32_32x32x16_bf16 a[224:239], v[52:55], v[80:83], a[224:239]
    v_lshlrev_b32 v249, 7, v249
    v_mfma_f32_32x32x16_bf16 a[240:255], v[52:55], v[84:87], a[240:255]
    s_waitcnt vmcnt(26) lgkmcnt(0)
    s_barrier
    v_mfma_f32_32x32x16_bf16 a[0:15], v[56:59], v[88:91], a[0:15]
    s_add_u32 m0, s84, 0
    s_add_u32 s69, s79, 3145728
    buffer_load_dwordx4 v6, s[12:15], s69 offen lds
    v_mfma_f32_32x32x16_bf16 a[16:31], v[56:59], v[92:95], a[16:31]
    ds_read_b128 v[40:43], v11 offset:32768
    v_mfma_f32_32x32x16_bf16 a[32:47], v[56:59], v[96:99], a[32:47]
    ds_read_b128 v[44:47], v11 offset:36864
    v_mfma_f32_32x32x16_bf16 a[48:63], v[56:59], v[100:103], a[48:63]
    ds_read_b128 v[48:51], v11 offset:40960
    v_mfma_f32_32x32x16_bf16 a[64:79], v[60:63], v[88:91], a[64:79]
    ds_read_b128 v[52:55], v11 offset:45056
    v_mfma_f32_32x32x16_bf16 a[80:95], v[60:63], v[92:95], a[80:95]
    ds_read_b64_tr_b16 v[72:73], v17 offset:16384
    v_mfma_f32_32x32x16_bf16 a[96:111], v[60:63], v[96:99], a[96:111]
    ds_read_b64_tr_b16 v[74:75], v17 offset:18432
    v_mfma_f32_32x32x16_bf16 a[112:127], v[60:63], v[100:103], a[112:127]
    ds_read_b64_tr_b16 v[76:77], v18 offset:16384
    v_mfma_f32_32x32x16_bf16 a[128:143], v[64:67], v[88:91], a[128:143]
    s_add_u32 m0, s84, 1024
    s_add_u32 s69, s79, 3162112
    buffer_load_dwordx4 v7, s[12:15], s69 offen lds
    v_mfma_f32_32x32x16_bf16 a[144:159], v[64:67], v[92:95], a[144:159]
    ds_read_b64_tr_b16 v[78:79], v18 offset:18432
    v_mfma_f32_32x32x16_bf16 a[160:175], v[64:67], v[96:99], a[160:175]
    ds_read_b64_tr_b16 v[80:81], v19 offset:16384
    v_mov_b32 v251, 0xf0000000
    v_mfma_f32_32x32x16_bf16 a[176:191], v[64:67], v[100:103], a[176:191]
    ds_read_b64_tr_b16 v[82:83], v19 offset:18432
    v_mfma_f32_32x32x16_bf16 a[192:207], v[68:71], v[88:91], a[192:207]
    ds_read_b64_tr_b16 v[84:85], v20 offset:16384
    v_mfma_f32_32x32x16_bf16 a[208:223], v[68:71], v[92:95], a[208:223]
    ds_read_b64_tr_b16 v[86:87], v20 offset:18432
    v_mfma_f32_32x32x16_bf16 a[224:239], v[68:71], v[96:99], a[224:239]
    v_cmp_gt_u32 vcc, 6, v0
    s_nop 1
    v_cndmask_b32 v249, v251, v249, vcc
    v_mfma_f32_32x32x16_bf16 a[240:255], v[68:71], v[100:103], a[240:255]
    s_waitcnt lgkmcnt(0)
    v_mfma_f32_32x32x16_bf16 a[0:15], v[40:43], v[72:75], a[0:15]
    s_add_u32 m0, s84, 2048
    s_add_u32 s69, s79, 3178496
    buffer_load_dwordx4 v6, s[12:15], s69 offen lds
    v_mfma_f32_32x32x16_bf16 a[16:31], v[40:43], v[76:79], a[16:31]
    ds_read_b128 v[56:59], v12 offset:32768
    v_mfma_f32_32x32x16_bf16 a[32:47], v[40:43], v[80:83], a[32:47]
    ds_read_b128 v[60:63], v12 offset:36864
    v_mfma_f32_32x32x16_bf16 a[48:63], v[40:43], v[84:87], a[48:63]
    v_mfma_f32_32x32x16_bf16 a[64:79], v[44:47], v[72:75], a[64:79]
    ds_read_b128 v[64:67], v12 offset:40960
    v_mfma_f32_32x32x16_bf16 a[80:95], v[44:47], v[76:79], a[80:95]
    ds_read_b128 v[68:71], v12 offset:45056
    v_mfma_f32_32x32x16_bf16 a[96:111], v[44:47], v[80:83], a[96:111]
    ds_read_b64_tr_b16 v[88:89], v17 offset:24576
    v_mfma_f32_32x32x16_bf16 a[112:127], v[44:47], v[84:87], a[112:127]
    buffer_load_dword v252, v249, s[40:43], 0 offen
    v_mfma_f32_32x32x16_bf16 a[128:143], v[48:51], v[72:75], a[128:143]
    ds_read_b64_tr_b16 v[90:91], v17 offset:26624
    ds_read_b64_tr_b16 v[92:93], v18 offset:24576
    v_mfma_f32_32x32x16_bf16 a[144:159], v[48:51], v[76:79], a[144:159]
    s_add_u32 m0, s84, 3072
    s_add_u32 s69, s79, 3194880
    buffer_load_dwordx4 v7, s[12:15], s69 offen lds
    v_mfma_f32_32x32x16_bf16 a[160:175], v[48:51], v[80:83], a[160:175]
    ds_read_b64_tr_b16 v[94:95], v18 offset:26624
    ds_read_b64_tr_b16 v[96:97], v19 offset:24576
    v_mfma_f32_32x32x16_bf16 a[176:191], v[48:51], v[84:87], a[176:191]
    ds_read_b64_tr_b16 v[98:99], v19 offset:26624
    v_mfma_f32_32x32x16_bf16 a[192:207], v[52:55], v[72:75], a[192:207]
    ds_read_b64_tr_b16 v[100:101], v20 offset:24576
    v_mfma_f32_32x32x16_bf16 a[208:223], v[52:55], v[76:79], a[208:223]
    ds_read_b64_tr_b16 v[102:103], v20 offset:26624
    v_mfma_f32_32x32x16_bf16 a[224:239], v[52:55], v[80:83], a[224:239]
    v_mfma_f32_32x32x16_bf16 a[240:255], v[52:55], v[84:87], a[240:255]
    s_waitcnt vmcnt(18) lgkmcnt(0)
    s_barrier
    v_mfma_f32_32x32x16_bf16 a[0:15], v[56:59], v[88:91], a[0:15]
    ds_read_b128 v[40:43], v13 offset:0
    v_mfma_f32_32x32x16_bf16 a[16:31], v[56:59], v[92:95], a[16:31]
    ds_read_b128 v[44:47], v13 offset:4096
    v_mfma_f32_32x32x16_bf16 a[32:47], v[56:59], v[96:99], a[32:47]
    s_add_u32 m0, s84, 16384
    s_add_u32 s69, s79, 3407872
    buffer_load_dwordx4 v6, s[12:15], s69 offen lds
    v_mfma_f32_32x32x16_bf16 a[48:63], v[56:59], v[100:103], a[48:63]
    s_add_u32 m0, s84, 17408
    s_add_u32 s69, s79, 3424256
    buffer_load_dwordx4 v7, s[12:15], s69 offen lds
    v_mfma_f32_32x32x16_bf16 a[64:79], v[60:63], v[88:91], a[64:79]
    ds_read_b128 v[48:51], v13 offset:8192
    ds_read_b128 v[52:55], v13 offset:12288
    ds_read_b64_tr_b16 v[72:73], v17 offset:32768
    v_mfma_f32_32x32x16_bf16 a[80:95], v[60:63], v[92:95], a[80:95]
    s_add_u32 m0, s84, 18432
    s_add_u32 s69, s79, 3440640
    buffer_load_dwordx4 v6, s[12:15], s69 offen lds
    v_mfma_f32_32x32x16_bf16 a[96:111], v[60:63], v[96:99], a[96:111]
    ds_read_b64_tr_b16 v[74:75], v17 offset:34816
    v_mfma_f32_32x32x16_bf16 a[112:127], v[60:63], v[100:103], a[112:127]
    s_add_u32 m0, s84, 19456
    s_add_u32 s69, s79, 3457024
    buffer_load_dwordx4 v7, s[12:15], s69 offen lds
    v_mfma_f32_32x32x16_bf16 a[128:143], v[64:67], v[88:91], a[128:143]
    ds_read_b64_tr_b16 v[76:77], v18 offset:32768
    ds_read_b64_tr_b16 v[78:79], v18 offset:34816
    ds_read_b64_tr_b16 v[80:81], v19 offset:32768
    v_mfma_f32_32x32x16_bf16 a[144:159], v[64:67], v[92:95], a[144:159]
    s_add_u32 m0, s85, 98304
    s_add_u32 s69, s78, 896
    buffer_load_dwordx4 v2, s[8:11], s69 offen lds
    v_mfma_f32_32x32x16_bf16 a[160:175], v[64:67], v[96:99], a[160:175]
    ds_read_b64_tr_b16 v[82:83], v19 offset:34816
    v_mfma_f32_32x32x16_bf16 a[176:191], v[64:67], v[100:103], a[176:191]
    ds_read_b64_tr_b16 v[84:85], v20 offset:32768
    v_mfma_f32_32x32x16_bf16 a[192:207], v[68:71], v[88:91], a[192:207]
    s_add_u32 m0, s85, 99328
    s_add_u32 s69, s78, 9088
    buffer_load_dwordx4 v3, s[8:11], s69 offen lds
    v_mfma_f32_32x32x16_bf16 a[208:223], v[68:71], v[92:95], a[208:223]
    ds_read_b64_tr_b16 v[86:87], v20 offset:34816
    v_mfma_f32_32x32x16_bf16 a[224:239], v[68:71], v[96:99], a[224:239]
    v_mfma_f32_32x32x16_bf16 a[240:255], v[68:71], v[100:103], a[240:255]
    s_waitcnt lgkmcnt(0)
    v_mfma_f32_32x32x16_bf16 a[0:15], v[40:43], v[72:75], a[0:15]
    ds_read_b128 v[56:59], v14 offset:0
    v_mfma_f32_32x32x16_bf16 a[16:31], v[40:43], v[76:79], a[16:31]
    s_add_u32 m0, s85, 100352
    s_add_u32 s69, s78, 17280
    buffer_load_dwordx4 v2, s[8:11], s69 offen lds
    v_mfma_f32_32x32x16_bf16 a[32:47], v[40:43], v[80:83], a[32:47]
    ds_read_b128 v[60:63], v14 offset:4096
    v_mfma_f32_32x32x16_bf16 a[48:63], v[40:43], v[84:87], a[48:63]
    s_add_u32 m0, s85, 101376
    s_add_u32 s69, s78, 25472
    buffer_load_dwordx4 v3, s[8:11], s69 offen lds
    v_mfma_f32_32x32x16_bf16 a[64:79], v[44:47], v[72:75], a[64:79]
    ds_read_b128 v[64:67], v14 offset:8192
    ds_read_b128 v[68:71], v14 offset:12288
    ds_read_b64_tr_b16 v[88:89], v17 offset:40960
    v_mfma_f32_32x32x16_bf16 a[80:95], v[44:47], v[76:79], a[80:95]
    s_add_u32 m0, s85, 102400
    s_add_u32 s69, s78, 33664
    buffer_load_dwordx4 v2, s[8:11], s69 offen lds
    v_mfma_f32_32x32x16_bf16 a[96:111], v[44:47], v[80:83], a[96:111]
    ds_read_b64_tr_b16 v[90:91], v17 offset:43008
    ds_read_b64_tr_b16 v[92:93], v18 offset:40960
    v_mfma_f32_32x32x16_bf16 a[112:127], v[44:47], v[84:87], a[112:127]
    s_add_u32 m0, s85, 103424
    s_add_u32 s69, s78, 41856
    buffer_load_dwordx4 v3, s[8:11], s69 offen lds
    v_mfma_f32_32x32x16_bf16 a[128:143], v[48:51], v[72:75], a[128:143]
    ds_read_b64_tr_b16 v[94:95], v18 offset:43008
    v_mfma_f32_32x32x16_bf16 a[144:159], v[48:51], v[76:79], a[144:159]
    ds_read_b64_tr_b16 v[96:97], v19 offset:40960
    v_mfma_f32_32x32x16_bf16 a[160:175], v[48:51], v[80:83], a[160:175]
    s_add_u32 m0, s85, 104448
    s_add_u32 s69, s78, 50048
    buffer_load_dwordx4 v2, s[8:11], s69 offen lds
    v_mfma_f32_32x32x16_bf16 a[176:191], v[48:51], v[84:87], a[176:191]
    ds_read_b64_tr_b16 v[98:99], v19 offset:43008
    v_mfma_f32_32x32x16_bf16 a[192:207], v[52:55], v[72:75], a[192:207]
    s_add_u32 m0, s85, 105472
    s_add_u32 s69, s78, 58240
    buffer_load_dwordx4 v3, s[8:11], s69 offen lds
    v_mfma_f32_32x32x16_bf16 a[208:223], v[52:55], v[76:79], a[208:223]
    ds_read_b64_tr_b16 v[100:101], v20 offset:40960
    ds_read_b64_tr_b16 v[102:103], v20 offset:43008
    v_mfma_f32_32x32x16_bf16 a[224:239], v[52:55], v[80:83], a[224:239]
    v_mfma_f32_32x32x16_bf16 a[240:255], v[52:55], v[84:87], a[240:255]
    s_waitcnt vmcnt(26) lgkmcnt(0)
    s_barrier
    v_mfma_f32_32x32x16_bf16 a[0:15], v[56:59], v[88:91], a[0:15]
    s_add_u32 m0, s84, 32768
    s_add_u32 s69, s79, 3670016
    buffer_load_dwordx4 v6, s[12:15], s69 offen lds
    v_mfma_f32_32x32x16_bf16 a[16:31], v[56:59], v[92:95], a[16:31]
    ds_read_b128 v[40:43], v15 offset:0
    ds_read_b128 v[44:47], v15 offset:4096
    v_mfma_f32_32x32x16_bf16 a[32:47], v[56:59], v[96:99], a[32:47]
    ds_read_b128 v[48:51], v15 offset:8192
    v_mfma_f32_32x32x16_bf16 a[48:63], v[56:59], v[100:103], a[48:63]
    ds_read_b128 v[52:55], v15 offset:12288
    v_mfma_f32_32x32x16_bf16 a[64:79], v[60:63], v[88:91], a[64:79]
    ds_read_b64_tr_b16 v[72:73], v17 offset:49152
    v_mfma_f32_32x32x16_bf16 a[80:95], v[60:63], v[92:95], a[80:95]
    ds_read_b64_tr_b16 v[74:75], v17 offset:51200
    v_mfma_f32_32x32x16_bf16 a[96:111], v[60:63], v[96:99], a[96:111]
    s_add_u32 m0, s84, 33792
    s_add_u32 s69, s79, 3686400
    buffer_load_dwordx4 v7, s[12:15], s69 offen lds
    v_mfma_f32_32x32x16_bf16 a[112:127], v[60:63], v[100:103], a[112:127]
    v_mfma_f32_32x32x16_bf16 a[128:143], v[64:67], v[88:91], a[128:143]
    ds_read_b64_tr_b16 v[76:77], v18 offset:49152
    v_mfma_f32_32x32x16_bf16 a[144:159], v[64:67], v[92:95], a[144:159]
    ds_read_b64_tr_b16 v[78:79], v18 offset:51200
    v_mfma_f32_32x32x16_bf16 a[160:175], v[64:67], v[96:99], a[160:175]
    ds_read_b64_tr_b16 v[80:81], v19 offset:49152
    v_mfma_f32_32x32x16_bf16 a[176:191], v[64:67], v[100:103], a[176:191]
    ds_read_b64_tr_b16 v[82:83], v19 offset:51200
    v_mfma_f32_32x32x16_bf16 a[192:207], v[68:71], v[88:91], a[192:207]
    ds_read_b64_tr_b16 v[84:85], v20 offset:49152
    v_mfma_f32_32x32x16_bf16 a[208:223], v[68:71], v[92:95], a[208:223]
    ds_read_b64_tr_b16 v[86:87], v20 offset:51200
    v_mfma_f32_32x32x16_bf16 a[224:239], v[68:71], v[96:99], a[224:239]
    s_add_u32 m0, s84, 34816
    s_add_u32 s69, s79, 3702784
    buffer_load_dwordx4 v6, s[12:15], s69 offen lds
    v_mfma_f32_32x32x16_bf16 a[240:255], v[68:71], v[100:103], a[240:255]
    s_waitcnt lgkmcnt(0)
    v_mfma_f32_32x32x16_bf16 a[0:15], v[40:43], v[72:75], a[0:15]
    ds_read_b128 v[56:59], v16 offset:0
    v_mfma_f32_32x32x16_bf16 a[16:31], v[40:43], v[76:79], a[16:31]
    ds_read_b128 v[60:63], v16 offset:4096
    v_mfma_f32_32x32x16_bf16 a[32:47], v[40:43], v[80:83], a[32:47]
    ds_read_b128 v[64:67], v16 offset:8192
    v_mfma_f32_32x32x16_bf16 a[48:63], v[40:43], v[84:87], a[48:63]
    ds_read_b128 v[68:71], v16 offset:12288
    v_mfma_f32_32x32x16_bf16 a[64:79], v[44:47], v[72:75], a[64:79]
    ds_read_b64_tr_b16 v[88:89], v17 offset:57344
    v_mfma_f32_32x32x16_bf16 a[80:95], v[44:47], v[76:79], a[80:95]
    ds_read_b64_tr_b16 v[90:91], v17 offset:59392
    v_mfma_f32_32x32x16_bf16 a[96:111], v[44:47], v[80:83], a[96:111]
    ds_read_b64_tr_b16 v[92:93], v18 offset:57344
    v_mfma_f32_32x32x16_bf16 a[112:127], v[44:47], v[84:87], a[112:127]
    s_add_u32 m0, s84, 35840
    s_add_u32 s69, s79, 3719168
    buffer_load_dwordx4 v7, s[12:15], s69 offen lds
    v_mfma_f32_32x32x16_bf16 a[128:143], v[48:51], v[72:75], a[128:143]
    ds_read_b64_tr_b16 v[94:95], v18 offset:59392
    v_mfma_f32_32x32x16_bf16 a[144:159], v[48:51], v[76:79], a[144:159]
    ds_read_b64_tr_b16 v[96:97], v19 offset:57344
    v_mfma_f32_32x32x16_bf16 a[160:175], v[48:51], v[80:83], a[160:175]
    ds_read_b64_tr_b16 v[98:99], v19 offset:59392
    v_mfma_f32_32x32x16_bf16 a[176:191], v[48:51], v[84:87], a[176:191]
    ds_read_b64_tr_b16 v[100:101], v20 offset:57344
    v_mfma_f32_32x32x16_bf16 a[192:207], v[52:55], v[72:75], a[192:207]
    ds_read_b64_tr_b16 v[102:103], v20 offset:59392
    v_mfma_f32_32x32x16_bf16 a[208:223], v[52:55], v[76:79], a[208:223]
    v_mfma_f32_32x32x16_bf16 a[224:239], v[52:55], v[80:83], a[224:239]
    v_mfma_f32_32x32x16_bf16 a[240:255], v[52:55], v[84:87], a[240:255]
    s_waitcnt vmcnt(16) lgkmcnt(0)
    s_barrier
    v_mfma_f32_32x32x16_bf16 a[0:15], v[56:59], v[88:91], a[0:15]
    s_add_u32 m0, s84, 49152
    s_add_u32 s69, s79, 3932160
    buffer_load_dwordx4 v6, s[12:15], s69 offen lds
    v_mfma_f32_32x32x16_bf16 a[16:31], v[56:59], v[92:95], a[16:31]
    s_add_u32 m0, s84, 50176
    s_add_u32 s69, s79, 3948544
    buffer_load_dwordx4 v7, s[12:15], s69 offen lds
    v_mfma_f32_32x32x16_bf16 a[32:47], v[56:59], v[96:99], a[32:47]
    ds_read_b128 v[40:43], v9 offset:0
    v_mfma_f32_32x32x16_bf16 a[48:63], v[56:59], v[100:103], a[48:63]
    ds_read_b128 v[44:47], v9 offset:4096
    v_mfma_f32_32x32x16_bf16 a[64:79], v[60:63], v[88:91], a[64:79]
    ds_read_b128 v[48:51], v9 offset:8192
    v_mfma_f32_32x32x16_bf16 a[80:95], v[60:63], v[92:95], a[80:95]
    s_add_u32 m0, s84, 51200
    s_add_u32 s69, s79, 3964928
    buffer_load_dwordx4 v6, s[12:15], s69 offen lds
    v_mfma_f32_32x32x16_bf16 a[96:111], v[60:63], v[96:99], a[96:111]
    ds_read_b128 v[52:55], v9 offset:12288
    ds_read_b64_tr_b16 v[72:73], v17 offset:0
    ds_read_b64_tr_b16 v[74:75], v17 offset:2048
    v_mfma_f32_32x32x16_bf16 a[112:127], v[60:63], v[100:103], a[112:127]
    s_add_u32 m0, s84, 52224
    s_add_u32 s69, s79, 3981312
    buffer_load_dwordx4 v7, s[12:15], s69 offen lds
    v_mfma_f32_32x32x16_bf16 a[128:143], v[64:67], v[88:91], a[128:143]
    ds_read_b64_tr_b16 v[76:77], v18 offset:0
    v_mfma_f32_32x32x16_bf16 a[144:159], v[64:67], v[92:95], a[144:159]
    ds_read_b64_tr_b16 v[78:79], v18 offset:2048
    ds_read_b64_tr_b16 v[80:81], v19 offset:0
    v_mfma_f32_32x32x16_bf16 a[160:175], v[64:67], v[96:99], a[160:175]
    ds_read_b64_tr_b16 v[82:83], v19 offset:2048
    ds_read_b64_tr_b16 v[84:85], v20 offset:0
    v_mfma_f32_32x32x16_bf16 a[176:191], v[64:67], v[100:103], a[176:191]
    s_add_u32 m0, s85, 131072
    s_add_u32 s69, s80, 0
    buffer_load_dwordx4 v4, s[16:19], s69 offen lds
    v_mfma_f32_32x32x16_bf16 a[192:207], v[68:71], v[88:91], a[192:207]
    s_add_u32 m0, s85, 132096
    s_add_u32 s69, s80, 9216
    buffer_load_dwordx4 v5, s[16:19], s69 offen lds
    v_mfma_f32_32x32x16_bf16 a[208:223], v[68:71], v[92:95], a[208:223]
    ds_read_b64_tr_b16 v[86:87], v20 offset:2048
    v_mfma_f32_32x32x16_bf16 a[224:239], v[68:71], v[96:99], a[224:239]
    s_add_u32 m0, s85, 133120
    s_add_u32 s69, s80, 18432
    buffer_load_dwordx4 v4, s[16:19], s69 offen lds
    v_mfma_f32_32x32x16_bf16 a[240:255], v[68:71], v[100:103], a[240:255]
    s_waitcnt lgkmcnt(0)
    v_mfma_f32_32x32x16_bf16 a[0:15], v[40:43], v[72:75], a[0:15]
    ds_read_b128 v[56:59], v10 offset:0
    v_mfma_f32_32x32x16_bf16 a[16:31], v[40:43], v[76:79], a[16:31]
    ds_read_b128 v[60:63], v10 offset:4096
    v_mfma_f32_32x32x16_bf16 a[32:47], v[40:43], v[80:83], a[32:47]
    ds_read_b128 v[64:67], v10 offset:8192
    v_mfma_f32_32x32x16_bf16 a[48:63], v[40:43], v[84:87], a[48:63]
    s_add_u32 m0, s85, 134144
    s_add_u32 s69, s80, 27648
    buffer_load_dwordx4 v5, s[16:19], s69 offen lds
    v_mfma_f32_32x32x16_bf16 a[64:79], v[44:47], v[72:75], a[64:79]
    ds_read_b128 v[68:71], v10 offset:12288
    ds_read_b64_tr_b16 v[88:89], v17 offset:8192
    v_mfma_f32_32x32x16_bf16 a[80:95], v[44:47], v[76:79], a[80:95]
    ds_read_b64_tr_b16 v[90:91], v17 offset:10240
    v_mfma_f32_32x32x16_bf16 a[96:111], v[44:47], v[80:83], a[96:111]
    s_add_u32 m0, s85, 135168
    s_add_u32 s69, s80, 36864
    buffer_load_dwordx4 v4, s[16:19], s69 offen lds
    v_mfma_f32_32x32x16_bf16 a[112:127], v[44:47], v[84:87], a[112:127]
    s_add_u32 m0, s85, 136192
    s_add_u32 s69, s80, 46080
    buffer_load_dwordx4 v5, s[16:19], s69 offen lds
    v_mfma_f32_32x32x16_bf16 a[128:143], v[48:51], v[72:75], a[128:143]
    ds_read_b64_tr_b16 v[92:93], v18 offset:8192
    v_mfma_f32_32x32x16_bf16 a[144:159], v[48:51], v[76:79], a[144:159]
    ds_read_b64_tr_b16 v[94:95], v18 offset:10240
    v_mfma_f32_32x32x16_bf16 a[160:175], v[48:51], v[80:83], a[160:175]
    s_add_u32 m0, s85, 137216
    s_add_u32 s69, s80, 55296
    buffer_load_dwordx4 v4, s[16:19], s69 offen lds
    v_mfma_f32_32x32x16_bf16 a[176:191], v[48:51], v[84:87], a[176:191]
    ds_read_b64_tr_b16 v[96:97], v19 offset:8192
    ds_read_b64_tr_b16 v[98:99], v19 offset:10240
    v_mfma_f32_32x32x16_bf16 a[192:207], v[52:55], v[72:75], a[192:207]
    ds_read_b64_tr_b16 v[100:101], v20 offset:8192
    v_mfma_f32_32x32x16_bf16 a[208:223], v[52:55], v[76:79], a[208:223]
    ds_read_b64_tr_b16 v[102:103], v20 offset:10240
    v_mfma_f32_32x32x16_bf16 a[224:239], v[52:55], v[80:83], a[224:239]
    s_add_u32 m0, s85, 138240
    s_add_u32 s69, s80, 64512
    buffer_load_dwordx4 v5, s[16:19], s69 offen lds
    v_mfma_f32_32x32x16_bf16 a[240:255], v[52:55], v[84:87], a[240:255]
    s_waitcnt vmcnt(24) lgkmcnt(0)
    s_barrier
    v_mfma_f32_32x32x16_bf16 a[0:15], v[56:59], v[88:91], a[0:15]
    ds_read_b128 v[40:43], v11 offset:0
    v_mfma_f32_32x32x16_bf16 a[16:31], v[56:59], v[92:95], a[16:31]
    v_mfma_f32_32x32x16_bf16 a[32:47], v[56:59], v[96:99], a[32:47]
    ds_read_b128 v[44:47], v11 offset:4096
    v_mfma_f32_32x32x16_bf16 a[48:63], v[56:59], v[100:103], a[48:63]
    s_add_u32 m0, s84, 0
    s_add_u32 s69, s81, 0
    buffer_load_dwordx4 v1, s[20:23], s69 offen lds
    v_mfma_f32_32x32x16_bf16 a[64:79], v[60:63], v[88:91], a[64:79]
    ds_read_b128 v[48:51], v11 offset:8192
    v_mfma_f32_32x32x16_bf16 a[80:95], v[60:63], v[92:95], a[80:95]
    ds_read_b128 v[52:55], v11 offset:12288
    v_mfma_f32_32x32x16_bf16 a[96:111], v[60:63], v[96:99], a[96:111]
    ds_read_b64_tr_b16 v[72:73], v17 offset:16384
    v_mfma_f32_32x32x16_bf16 a[112:127], v[60:63], v[100:103], a[112:127]
    s_add_u32 m0, s84, 1024
    s_add_u32 s69, s81, 32768
    buffer_load_dwordx4 v1, s[20:23], s69 offen lds
    v_mfma_f32_32x32x16_bf16 a[128:143], v[64:67], v[88:91], a[128:143]
    ds_read_b64_tr_b16 v[74:75], v17 offset:18432
    v_mfma_f32_32x32x16_bf16 a[144:159], v[64:67], v[92:95], a[144:159]
    ds_read_b64_tr_b16 v[76:77], v18 offset:16384
    v_mfma_f32_32x32x16_bf16 a[160:175], v[64:67], v[96:99], a[160:175]
    ds_read_b64_tr_b16 v[78:79], v18 offset:18432
    ds_read_b64_tr_b16 v[80:81], v19 offset:16384
    v_mfma_f32_32x32x16_bf16 a[176:191], v[64:67], v[100:103], a[176:191]
    ds_read_b64_tr_b16 v[82:83], v19 offset:18432
    v_mfma_f32_32x32x16_bf16 a[192:207], v[68:71], v[88:91], a[192:207]
    ds_read_b64_tr_b16 v[84:85], v20 offset:16384
    v_mfma_f32_32x32x16_bf16 a[208:223], v[68:71], v[92:95], a[208:223]
    ds_read_b64_tr_b16 v[86:87], v20 offset:18432
    v_mfma_f32_32x32x16_bf16 a[224:239], v[68:71], v[96:99], a[224:239]
    s_add_u32 m0, s84, 2048
    s_add_u32 s69, s81, 65536
    buffer_load_dwordx4 v1, s[20:23], s69 offen lds
    v_mfma_f32_32x32x16_bf16 a[240:255], v[68:71], v[100:103], a[240:255]
    s_waitcnt lgkmcnt(0)
    v_mfma_f32_32x32x16_bf16 a[0:15], v[40:43], v[72:75], a[0:15]
    ds_read_b128 v[56:59], v12 offset:0
    ds_read_b128 v[60:63], v12 offset:4096
    v_mfma_f32_32x32x16_bf16 a[16:31], v[40:43], v[76:79], a[16:31]
    ds_read_b128 v[64:67], v12 offset:8192
    v_mfma_f32_32x32x16_bf16 a[32:47], v[40:43], v[80:83], a[32:47]
    ds_read_b128 v[68:71], v12 offset:12288
    v_mfma_f32_32x32x16_bf16 a[48:63], v[40:43], v[84:87], a[48:63]
    ds_read_b64_tr_b16 v[88:89], v17 offset:24576
    v_mfma_f32_32x32x16_bf16 a[64:79], v[44:47], v[72:75], a[64:79]
    ds_read_b64_tr_b16 v[90:91], v17 offset:26624
    v_mfma_f32_32x32x16_bf16 a[80:95], v[44:47], v[76:79], a[80:95]
    ds_read_b64_tr_b16 v[92:93], v18 offset:24576
    v_mfma_f32_32x32x16_bf16 a[96:111], v[44:47], v[80:83], a[96:111]
    v_add_u32 v13, 65536, v21
    v_mfma_f32_32x32x16_bf16 a[112:127], v[44:47], v[84:87], a[112:127]
    v_add_u32 v14, 65536, v22
    v_mfma_f32_32x32x16_bf16 a[128:143], v[48:51], v[72:75], a[128:143]
    s_add_u32 m0, s84, 3072
    s_add_u32 s69, s81, 98304
    buffer_load_dwordx4 v1, s[20:23], s69 offen lds
    v_mfma_f32_32x32x16_bf16 a[144:159], v[48:51], v[76:79], a[144:159]
    ds_read_b64_tr_b16 v[94:95], v18 offset:26624
    v_mfma_f32_32x32x16_bf16 a[160:175], v[48:51], v[80:83], a[160:175]
    ds_read_b64_tr_b16 v[96:97], v19 offset:24576
    v_mfma_f32_32x32x16_bf16 a[176:191], v[48:51], v[84:87], a[176:191]
    ds_read_b64_tr_b16 v[98:99], v19 offset:26624
    v_mfma_f32_32x32x16_bf16 a[192:207], v[52:55], v[72:75], a[192:207]
    ds_read_b64_tr_b16 v[100:101], v20 offset:24576
    v_mfma_f32_32x32x16_bf16 a[208:223], v[52:55], v[76:79], a[208:223]
    ds_read_b64_tr_b16 v[102:103], v20 offset:26624
    v_mfma_f32_32x32x16_bf16 a[224:239], v[52:55], v[80:83], a[224:239]
    v_add_u32 v15, 65536, v23
    v_mfma_f32_32x32x16_bf16 a[240:255], v[52:55], v[84:87], a[240:255]
    s_waitcnt vmcnt(16) lgkmcnt(0)
    s_barrier
    v_mfma_f32_32x32x16_bf16 a[0:15], v[56:59], v[88:91], a[0:15]
    s_add_u32 m0, s84, 16384
    s_add_u32 s69, s81, 524288
    buffer_load_dwordx4 v1, s[20:23], s69 offen lds
    v_mfma_f32_32x32x16_bf16 a[16:31], v[56:59], v[92:95], a[16:31]
    ds_read_b128 v[40:43], v9 offset:32768
    ds_read_b128 v[44:47], v9 offset:36864
    ds_read_b128 v[48:51], v9 offset:40960
    v_mfma_f32_32x32x16_bf16 a[32:47], v[56:59], v[96:99], a[32:47]
    s_add_u32 m0, s84, 17408
    s_add_u32 s69, s81, 557056
    buffer_load_dwordx4 v1, s[20:23], s69 offen lds
    v_mfma_f32_32x32x16_bf16 a[48:63], v[56:59], v[100:103], a[48:63]
    ds_read_b128 v[52:55], v9 offset:45056
    v_mfma_f32_32x32x16_bf16 a[64:79], v[60:63], v[88:91], a[64:79]
    ds_read_b64_tr_b16 v[72:73], v17 offset:32768
    ds_read_b64_tr_b16 v[74:75], v17 offset:34816
    v_mfma_f32_32x32x16_bf16 a[80:95], v[60:63], v[92:95], a[80:95]
    s_add_u32 m0, s84, 18432
    s_add_u32 s69, s81, 589824
    buffer_load_dwordx4 v1, s[20:23], s69 offen lds
    v_mfma_f32_32x32x16_bf16 a[96:111], v[60:63], v[96:99], a[96:111]
    s_add_u32 m0, s84, 19456
    s_add_u32 s69, s81, 622592
    buffer_load_dwordx4 v1, s[20:23], s69 offen lds
    v_mfma_f32_32x32x16_bf16 a[112:127], v[60:63], v[100:103], a[112:127]
    ds_read_b64_tr_b16 v[76:77], v18 offset:32768
    ds_read_b64_tr_b16 v[78:79], v18 offset:34816
    v_mfma_f32_32x32x16_bf16 a[128:143], v[64:67], v[88:91], a[128:143]
    ds_read_b64_tr_b16 v[80:81], v19 offset:32768
    v_mfma_f32_32x32x16_bf16 a[144:159], v[64:67], v[92:95], a[144:159]
    ds_read_b64_tr_b16 v[82:83], v19 offset:34816
    v_mfma_f32_32x32x16_bf16 a[160:175], v[64:67], v[96:99], a[160:175]
    s_add_u32 m0, s85, 65536
    s_add_u32 s69, s80, 128
    buffer_load_dwordx4 v4, s[16:19], s69 offen lds
    v_mfma_f32_32x32x16_bf16 a[176:191], v[64:67], v[100:103], a[176:191]
    ds_read_b64_tr_b16 v[84:85], v20 offset:32768
    v_mfma_f32_32x32x16_bf16 a[192:207], v[68:71], v[88:91], a[192:207]
    s_add_u32 m0, s85, 66560
    s_add_u32 s69, s80, 9344
    buffer_load_dwordx4 v5, s[16:19], s69 offen lds
    v_mfma_f32_32x32x16_bf16 a[208:223], v[68:71], v[92:95], a[208:223]
    ds_read_b64_tr_b16 v[86:87], v20 offset:34816
    v_add_u32 v16, 65536, v24
    v_mfma_f32_32x32x16_bf16 a[224:239], v[68:71], v[96:99], a[224:239]
    s_add_u32 m0, s85, 67584
    s_add_u32 s69, s80, 18560
    buffer_load_dwordx4 v4, s[16:19], s69 offen lds
    v_mfma_f32_32x32x16_bf16 a[240:255], v[68:71], v[100:103], a[240:255]
    s_waitcnt lgkmcnt(0)
    v_mfma_f32_32x32x16_bf16 a[0:15], v[40:43], v[72:75], a[0:15]
    ds_read_b128 v[56:59], v10 offset:32768
    v_mfma_f32_32x32x16_bf16 a[16:31], v[40:43], v[76:79], a[16:31]
    ds_read_b128 v[60:63], v10 offset:36864
    v_mfma_f32_32x32x16_bf16 a[32:47], v[40:43], v[80:83], a[32:47]
    ds_read_b128 v[64:67], v10 offset:40960
    ds_read_b128 v[68:71], v10 offset:45056
    v_mfma_f32_32x32x16_bf16 a[48:63], v[40:43], v[84:87], a[48:63]
    s_add_u32 m0, s85, 68608
    s_add_u32 s69, s80, 27776
    buffer_load_dwordx4 v5, s[16:19], s69 offen lds
    v_mfma_f32_32x32x16_bf16 a[64:79], v[44:47], v[72:75], a[64:79]
    s_add_u32 m0, s85, 69632
    s_add_u32 s69, s80, 36992
    buffer_load_dwordx4 v4, s[16:19], s69 offen lds
    v_mfma_f32_32x32x16_bf16 a[80:95], v[44:47], v[76:79], a[80:95]
    ds_read_b64_tr_b16 v[88:89], v17 offset:40960
    v_mfma_f32_32x32x16_bf16 a[96:111], v[44:47], v[80:83], a[96:111]
    ds_read_b64_tr_b16 v[90:91], v17 offset:43008
    v_mfma_f32_32x32x16_bf16 a[112:127], v[44:47], v[84:87], a[112:127]
    s_add_u32 m0, s85, 70656
    s_add_u32 s69, s80, 46208
    buffer_load_dwordx4 v5, s[16:19], s69 offen lds
    v_mfma_f32_32x32x16_bf16 a[128:143], v[48:51], v[72:75], a[128:143]
    ds_read_b64_tr_b16 v[92:93], v18 offset:40960
    ds_read_b64_tr_b16 v[94:95], v18 offset:43008
    v_mfma_f32_32x32x16_bf16 a[144:159], v[48:51], v[76:79], a[144:159]
    s_add_u32 m0, s85, 71680
    s_add_u32 s69, s80, 55424
    buffer_load_dwordx4 v4, s[16:19], s69 offen lds
    v_mfma_f32_32x32x16_bf16 a[160:175], v[48:51], v[80:83], a[160:175]
    ds_read_b64_tr_b16 v[96:97], v19 offset:40960
    ds_read_b64_tr_b16 v[98:99], v19 offset:43008
    v_mfma_f32_32x32x16_bf16 a[176:191], v[48:51], v[84:87], a[176:191]
    ds_read_b64_tr_b16 v[100:101], v20 offset:40960
    v_mfma_f32_32x32x16_bf16 a[192:207], v[52:55], v[72:75], a[192:207]
    s_add_u32 m0, s85, 72704
    s_add_u32 s69, s80, 64640
    buffer_load_dwordx4 v5, s[16:19], s69 offen lds
    v_mfma_f32_32x32x16_bf16 a[208:223], v[52:55], v[76:79], a[208:223]
    ds_read_b64_tr_b16 v[102:103], v20 offset:43008
    v_mfma_f32_32x32x16_bf16 a[224:239], v[52:55], v[80:83], a[224:239]
    v_mfma_f32_32x32x16_bf16 a[240:255], v[52:55], v[84:87], a[240:255]
    s_waitcnt vmcnt(24) lgkmcnt(0)
    s_barrier
    v_mfma_f32_32x32x16_bf16 a[0:15], v[56:59], v[88:91], a[0:15]
    ds_read_b128 v[40:43], v11 offset:32768
    v_mfma_f32_32x32x16_bf16 a[16:31], v[56:59], v[92:95], a[16:31]
    s_add_u32 m0, s84, 32768
    s_add_u32 s69, s81, 1048576
    buffer_load_dwordx4 v1, s[20:23], s69 offen lds
    v_mfma_f32_32x32x16_bf16 a[32:47], v[56:59], v[96:99], a[32:47]
    ds_read_b128 v[44:47], v11 offset:36864
    v_mfma_f32_32x32x16_bf16 a[48:63], v[56:59], v[100:103], a[48:63]
    ds_read_b128 v[48:51], v11 offset:40960
    v_mfma_f32_32x32x16_bf16 a[64:79], v[60:63], v[88:91], a[64:79]
    ds_read_b128 v[52:55], v11 offset:45056
    v_mfma_f32_32x32x16_bf16 a[80:95], v[60:63], v[92:95], a[80:95]
    v_mfma_f32_32x32x16_bf16 a[96:111], v[60:63], v[96:99], a[96:111]
    ds_read_b64_tr_b16 v[72:73], v17 offset:49152
    v_mfma_f32_32x32x16_bf16 a[112:127], v[60:63], v[100:103], a[112:127]
    ds_read_b64_tr_b16 v[74:75], v17 offset:51200
    v_mfma_f32_32x32x16_bf16 a[128:143], v[64:67], v[88:91], a[128:143]
    ds_read_b64_tr_b16 v[76:77], v18 offset:49152
    v_mfma_f32_32x32x16_bf16 a[144:159], v[64:67], v[92:95], a[144:159]
    s_add_u32 m0, s84, 33792
    s_add_u32 s69, s81, 1081344
    buffer_load_dwordx4 v1, s[20:23], s69 offen lds
    v_mfma_f32_32x32x16_bf16 a[160:175], v[64:67], v[96:99], a[160:175]
    ds_read_b64_tr_b16 v[78:79], v18 offset:51200
    v_mfma_f32_32x32x16_bf16 a[176:191], v[64:67], v[100:103], a[176:191]
    ds_read_b64_tr_b16 v[80:81], v19 offset:49152
    v_mfma_f32_32x32x16_bf16 a[192:207], v[68:71], v[88:91], a[192:207]
    ds_read_b64_tr_b16 v[82:83], v19 offset:51200
    ds_read_b64_tr_b16 v[84:85], v20 offset:49152
    v_mfma_f32_32x32x16_bf16 a[208:223], v[68:71], v[92:95], a[208:223]
    ds_read_b64_tr_b16 v[86:87], v20 offset:51200
    v_mfma_f32_32x32x16_bf16 a[224:239], v[68:71], v[96:99], a[224:239]
    v_mfma_f32_32x32x16_bf16 a[240:255], v[68:71], v[100:103], a[240:255]
    s_waitcnt lgkmcnt(0)
    v_mfma_f32_32x32x16_bf16 a[0:15], v[40:43], v[72:75], a[0:15]
    s_add_u32 m0, s84, 34816
    s_add_u32 s69, s81, 1114112
    buffer_load_dwordx4 v1, s[20:23], s69 offen lds
    v_mfma_f32_32x32x16_bf16 a[16:31], v[40:43], v[76:79], a[16:31]
    v_mfma_f32_32x32x16_bf16 a[32:47], v[40:43], v[80:83], a[32:47]
    ds_read_b128 v[56:59], v12 offset:32768
    ds_read_b128 v[60:63], v12 offset:36864
    v_mfma_f32_32x32x16_bf16 a[48:63], v[40:43], v[84:87], a[48:63]
    ds_read_b128 v[64:67], v12 offset:40960
    v_mfma_f32_32x32x16_bf16 a[64:79], v[44:47], v[72:75], a[64:79]
    ds_read_b128 v[68:71], v12 offset:45056
    v_mfma_f32_32x32x16_bf16 a[80:95], v[44:47], v[76:79], a[80:95]
    ds_read_b64_tr_b16 v[88:89], v17 offset:57344
    v_mfma_f32_32x32x16_bf16 a[96:111], v[44:47], v[80:83], a[96:111]
    ds_read_b64_tr_b16 v[90:91], v17 offset:59392
    v_mfma_f32_32x32x16_bf16 a[112:127], v[44:47], v[84:87], a[112:127]
    ds_read_b64_tr_b16 v[92:93], v18 offset:57344
    v_mfma_f32_32x32x16_bf16 a[128:143], v[48:51], v[72:75], a[128:143]
    s_add_u32 m0, s84, 35840
    s_add_u32 s69, s81, 1146880
    buffer_load_dwordx4 v1, s[20:23], s69 offen lds
    v_mfma_f32_32x32x16_bf16 a[144:159], v[48:51], v[76:79], a[144:159]
    ds_read_b64_tr_b16 v[94:95], v18 offset:59392
    v_mfma_f32_32x32x16_bf16 a[160:175], v[48:51], v[80:83], a[160:175]
    ds_read_b64_tr_b16 v[96:97], v19 offset:57344
    v_mfma_f32_32x32x16_bf16 a[176:191], v[48:51], v[84:87], a[176:191]
    ds_read_b64_tr_b16 v[98:99], v19 offset:59392
    v_mfma_f32_32x32x16_bf16 a[192:207], v[52:55], v[72:75], a[192:207]
    ds_read_b64_tr_b16 v[100:101], v20 offset:57344
    v_mfma_f32_32x32x16_bf16 a[208:223], v[52:55], v[76:79], a[208:223]
    ds_read_b64_tr_b16 v[102:103], v20 offset:59392
    v_mfma_f32_32x32x16_bf16 a[224:239], v[52:55], v[80:83], a[224:239]
    v_mfma_f32_32x32x16_bf16 a[240:255], v[52:55], v[84:87], a[240:255]
    s_waitcnt vmcnt(16) lgkmcnt(0)
    s_barrier
    v_mfma_f32_32x32x16_bf16 a[0:15], v[56:59], v[88:91], a[0:15]
    s_add_u32 m0, s84, 49152
    s_add_u32 s69, s81, 1572864
    buffer_load_dwordx4 v1, s[20:23], s69 offen lds
    v_mfma_f32_32x32x16_bf16 a[16:31], v[56:59], v[92:95], a[16:31]
    ds_read_b128 v[40:43], v13 offset:0
    ds_read_b128 v[44:47], v13 offset:16384
    v_mfma_f32_32x32x16_bf16 a[32:47], v[56:59], v[96:99], a[32:47]
    s_add_u32 m0, s84, 50176
    s_add_u32 s69, s81, 1605632
    buffer_load_dwordx4 v1, s[20:23], s69 offen lds
    v_mfma_f32_32x32x16_bf16 a[48:63], v[56:59], v[100:103], a[48:63]
    ds_read_b64_tr_b16 v[72:73], v25 offset:0
    v_mfma_f32_32x32x16_bf16 a[64:79], v[60:63], v[88:91], a[64:79]
    s_add_u32 m0, s84, 51200
    s_add_u32 s69, s81, 1638400
    buffer_load_dwordx4 v1, s[20:23], s69 offen lds
    v_mfma_f32_32x32x16_bf16 a[80:95], v[60:63], v[92:95], a[80:95]
    s_add_u32 m0, s84, 52224
    s_add_u32 s69, s81, 1671168
    buffer_load_dwordx4 v1, s[20:23], s69 offen lds
    v_mfma_f32_32x32x16_bf16 a[96:111], v[60:63], v[96:99], a[96:111]
    ds_read_b64_tr_b16 v[74:75], v25 offset:1024
    ds_read_b64_tr_b16 v[76:77], v26 offset:0
    v_mfma_f32_32x32x16_bf16 a[112:127], v[60:63], v[100:103], a[112:127]
    ds_read_b64_tr_b16 v[78:79], v26 offset:1024
    ds_read_b64_tr_b16 v[80:81], v27 offset:0
    v_mfma_f32_32x32x16_bf16 a[128:143], v[64:67], v[88:91], a[128:143]
    s_add_u32 m0, s85, 98304
    s_add_u32 s69, s80, 256
    buffer_load_dwordx4 v4, s[16:19], s69 offen lds
    v_mfma_f32_32x32x16_bf16 a[144:159], v[64:67], v[92:95], a[144:159]
    ds_read_b64_tr_b16 v[82:83], v27 offset:1024
    v_mfma_f32_32x32x16_bf16 a[160:175], v[64:67], v[96:99], a[160:175]
    s_add_u32 m0, s85, 99328
    s_add_u32 s69, s80, 9472
    buffer_load_dwordx4 v5, s[16:19], s69 offen lds
    v_mfma_f32_32x32x16_bf16 a[176:191], v[64:67], v[100:103], a[176:191]
    ds_read_b64_tr_b16 v[84:85], v28 offset:0
    v_mfma_f32_32x32x16_bf16 a[192:207], v[68:71], v[88:91], a[192:207]
    s_add_u32 m0, s85, 100352
    s_add_u32 s69, s80, 18688
    buffer_load_dwordx4 v4, s[16:19], s69 offen lds
    v_mfma_f32_32x32x16_bf16 a[208:223], v[68:71], v[92:95], a[208:223]
    ds_read_b64_tr_b16 v[86:87], v28 offset:1024
    v_mfma_f32_32x32x16_bf16 a[224:239], v[68:71], v[96:99], a[224:239]
    s_add_u32 m0, s85, 101376
    s_add_u32 s69, s80, 27904
    buffer_load_dwordx4 v5, s[16:19], s69 offen lds
    v_mfma_f32_32x32x16_bf16 a[240:255], v[68:71], v[100:103], a[240:255]
    s_waitcnt lgkmcnt(0)
L_pj_A:
    s_lshr_b32 s66, s58, 1
    s_lshl_b32 s66, s66, 12
    s_add_u32 s66, s66, 91226112
    s_mov_b32 s67, 0
    v_mfma_f32_32x32x16_bf16 v[128:143], v[72:75], v[40:43], 0
    ds_read_b128 v[56:59], v14 offset:0
    v_mov_b32 v52, 1
    v_mov_b32 v53, 0
    v_mfma_f32_32x32x16_bf16 v[144:159], v[76:79], v[40:43], 0
    s_add_u32 m0, s85, 102400
    s_add_u32 s69, s80, 37120
    buffer_load_dwordx4 v4, s[16:19], s69 offen lds
    v_mfma_f32_32x32x16_bf16 v[160:175], v[80:83], v[40:43], 0
    ds_read_b128 v[60:63], v14 offset:16384
    ds_read_b64_tr_b16 v[88:89], v25 offset:4096
    ds_read_b64_tr_b16 v[90:91], v25 offset:5120
    v_mfma_f32_32x32x16_bf16 v[176:191], v[84:87], v[40:43], 0
    ds_read_b64_tr_b16 v[92:93], v26 offset:4096
    ds_read_b64_tr_b16 v[94:95], v26 offset:5120
    ds_read_b64_tr_b16 v[96:97], v27 offset:4096
    v_mfma_f32_32x32x16_bf16 v[192:207], v[72:75], v[44:47], 0
    ds_read_b64_tr_b16 v[98:99], v27 offset:5120
    ds_read_b64_tr_b16 v[100:101], v28 offset:4096
    ds_read_b64_tr_b16 v[102:103], v28 offset:5120
    v_mfma_f32_32x32x16_bf16 v[208:223], v[76:79], v[44:47], 0
    s_add_u32 m0, s85, 103424
    s_add_u32 s69, s80, 46336
    buffer_load_dwordx4 v5, s[16:19], s69 offen lds
    v_mfma_f32_32x32x16_bf16 v[224:239], v[80:83], v[44:47], 0
    v_accvgpr_read_b32 v104, a0
    v_accvgpr_read_b32 v105, a1
    v_accvgpr_read_b32 v106, a2
    v_accvgpr_read_b32 v107, a3
    v_accvgpr_read_b32 v108, a4
    v_mfma_f32_32x32x16_bf16 v[240:255], v[84:87], v[44:47], 0
    v_accvgpr_read_b32 v109, a5
    v_accvgpr_read_b32 v110, a6
    v_accvgpr_read_b32 v111, a7
    v_accvgpr_read_b32 v112, a8
    s_waitcnt lgkmcnt(0)
    v_mfma_f32_32x32x16_bf16 v[128:143], v[88:91], v[56:59], v[128:143]
    ds_read_b128 v[40:43], v15 offset:0
    ds_read_b128 v[44:47], v15 offset:16384
    ds_read_b64_tr_b16 v[72:73], v25 offset:8192
    v_accvgpr_read_b32 v113, a9
    v_mfma_f32_32x32x16_bf16 v[144:159], v[92:95], v[56:59], v[144:159]
    ds_read_b64_tr_b16 v[74:75], v25 offset:9216
    ds_read_b64_tr_b16 v[76:77], v26 offset:8192
    ds_read_b64_tr_b16 v[78:79], v26 offset:9216
    v_accvgpr_read_b32 v114, a10
    v_mfma_f32_32x32x16_bf16 v[160:175], v[96:99], v[56:59], v[160:175]
    v_accvgpr_read_b32 v115, a11
    v_accvgpr_read_b32 v116, a12
    v_accvgpr_read_b32 v117, a13
    v_accvgpr_read_b32 v118, a14
    v_accvgpr_read_b32 v119, a15
    v_mfma_f32_32x32x16_bf16 v[176:191], v[100:103], v[56:59], v[176:191]
    ds_read_b64_tr_b16 v[80:81], v27 offset:8192
    ds_read_b64_tr_b16 v[82:83], v27 offset:9216
    v_cvt_pk_bf16_f32 v120, v104, v105
    v_cvt_pk_bf16_f32 v121, v106, v107
    v_mfma_f32_32x32x16_bf16 v[192:207], v[88:91], v[60:63], v[192:207]
    s_add_u32 m0, s85, 104448
    s_add_u32 s69, s80, 55552
    buffer_load_dwordx4 v4, s[16:19], s69 offen lds
    v_mfma_f32_32x32x16_bf16 v[208:223], v[92:95], v[60:63], v[208:223]
    ds_read_b64_tr_b16 v[84:85], v28 offset:8192
    ds_read_b64_tr_b16 v[86:87], v28 offset:9216
    v_cvt_pk_bf16_f32 v122, v108, v109
    v_cvt_pk_bf16_f32 v123, v110, v111
    v_mfma_f32_32x32x16_bf16 v[224:239], v[96:99], v[60:63], v[224:239]
    v_cvt_pk_bf16_f32 v124, v112, v113
    v_cvt_pk_bf16_f32 v125, v114, v115
    v_cvt_pk_bf16_f32 v126, v116, v117
    v_cvt_pk_bf16_f32 v127, v118, v119
    v_mfma_f32_32x32x16_bf16 v[240:255], v[100:103], v[60:63], v[240:255]
    s_add_u32 s70, s44, 0
    buffer_store_dwordx4 v[120:123], v37, s[32:35], s70 offen sc1
    s_waitcnt lgkmcnt(0)
    v_mfma_f32_32x32x16_bf16 v[128:143], v[72:75], v[40:43], v[128:143]
    ds_read_b128 v[56:59], v16 offset:0
    s_add_u32 s70, s45, 0
    buffer_store_dwordx4 v[124:127], v37, s[32:35], s70 offen sc1
    v_mfma_f32_32x32x16_bf16 v[144:159], v[76:79], v[40:43], v[144:159]
    v_accvgpr_read_b32 v104, a16
    s_add_u32 m0, s85, 105472
    s_add_u32 s69, s80, 64768
    buffer_load_dwordx4 v5, s[16:19], s69 offen lds
    v_mfma_f32_32x32x16_bf16 v[160:175], v[80:83], v[40:43], v[160:175]
    ds_read_b128 v[60:63], v16 offset:16384
    ds_read_b64_tr_b16 v[88:89], v25 offset:12288
    v_accvgpr_read_b32 v105, a17
    v_accvgpr_read_b32 v106, a18
    v_accvgpr_read_b32 v107, a19
    v_mfma_f32_32x32x16_bf16 v[176:191], v[84:87], v[40:43], v[176:191]
    ds_read_b64_tr_b16 v[90:91], v25 offset:13312
    ds_read_b64_tr_b16 v[92:93], v26 offset:12288
    ds_read_b64_tr_b16 v[94:95], v26 offset:13312
    v_accvgpr_read_b32 v108, a20
    v_mfma_f32_32x32x16_bf16 v[192:207], v[72:75], v[44:47], v[192:207]
    ds_read_b64_tr_b16 v[96:97], v27 offset:12288
    ds_read_b64_tr_b16 v[98:99], v27 offset:13312
    ds_read_b64_tr_b16 v[100:101], v28 offset:12288
    v_accvgpr_read_b32 v109, a21
    v_mfma_f32_32x32x16_bf16 v[208:223], v[76:79], v[44:47], v[208:223]
    ds_read_b64_tr_b16 v[102:103], v28 offset:13312
    v_accvgpr_read_b32 v110, a22
    v_accvgpr_read_b32 v111, a23
    v_accvgpr_read_b32 v112, a24
    v_accvgpr_read_b32 v113, a25
    v_mfma_f32_32x32x16_bf16 v[224:239], v[80:83], v[44:47], v[224:239]
    v_accvgpr_read_b32 v114, a26
    v_accvgpr_read_b32 v115, a27
    v_accvgpr_read_b32 v116, a28
    v_accvgpr_read_b32 v117, a29
    v_accvgpr_read_b32 v118, a30
    v_accvgpr_read_b32 v119, a31
    v_mfma_f32_32x32x16_bf16 v[240:255], v[84:87], v[44:47], v[240:255]
    v_cvt_pk_bf16_f32 v120, v104, v105
    v_cvt_pk_bf16_f32 v121, v106, v107
    v_cvt_pk_bf16_f32 v122, v108, v109
    v_cvt_pk_bf16_f32 v123, v110, v111
    s_waitcnt vmcnt(18) lgkmcnt(0)
    s_barrier
    v_mfma_f32_32x32x16_bf16 v[128:143], v[88:91], v[56:59], v[128:143]
    ds_read_b128 v[40:43], v21 offset:0
    s_add_u32 m0, s84, 0
    s_add_u32 s69, s81, 2097152
    buffer_load_dwordx4 v1, s[20:23], s69 offen lds
    v_mfma_f32_32x32x16_bf16 v[144:159], v[92:95], v[56:59], v[144:159]
    ds_read_b128 v[44:47], v21 offset:16384
    ds_read_b64_tr_b16 v[72:73], v25 offset:16384
    ds_read_b64_tr_b16 v[74:75], v25 offset:17408
    v_cvt_pk_bf16_f32 v124, v112, v113
    v_cvt_pk_bf16_f32 v125, v114, v115
    v_mfma_f32_32x32x16_bf16 v[160:175], v[96:99], v[56:59], v[160:175]
    ds_read_b64_tr_b16 v[76:77], v26 offset:16384
    s_add_u32 m0, s84, 1024
    s_add_u32 s69, s81, 2129920
    buffer_load_dwordx4 v1, s[20:23], s69 offen lds
    v_mfma_f32_32x32x16_bf16 v[176:191], v[100:103], v[56:59], v[176:191]
    ds_read_b64_tr_b16 v[78:79], v26 offset:17408
    ds_read_b64_tr_b16 v[80:81], v27 offset:16384
    ds_read_b64_tr_b16 v[82:83], v27 offset:17408
    v_cvt_pk_bf16_f32 v126, v116, v117
    v_cvt_pk_bf16_f32 v127, v118, v119
    v_mfma_f32_32x32x16_bf16 v[192:207], v[88:91], v[60:63], v[192:207]
    s_add_u32 s70, s46, 0
    buffer_store_dwordx4 v[120:123], v37, s[32:35], s70 offen sc1
    s_add_u32 s70, s47, 0
    buffer_store_dwordx4 v[124:127], v37, s[32:35], s70 offen sc1
    v_mfma_f32_32x32x16_bf16 v[208:223], v[92:95], v[60:63], v[208:223]
    ds_read_b64_tr_b16 v[84:85], v28 offset:16384
    ds_read_b64_tr_b16 v[86:87], v28 offset:17408
    v_accvgpr_read_b32 v104, a32
    v_accvgpr_read_b32 v105, a33
    v_accvgpr_read_b32 v106, a34
    v_accvgpr_read_b32 v107, a35
    v_mfma_f32_32x32x16_bf16 v[224:239], v[96:99], v[60:63], v[224:239]
    v_accvgpr_read_b32 v108, a36
    v_accvgpr_read_b32 v109, a37
    s_add_u32 m0, s84, 2048
    s_add_u32 s69, s81, 2162688
    buffer_load_dwordx4 v1, s[20:23], s69 offen lds
    v_mfma_f32_32x32x16_bf16 v[240:255], v[100:103], v[60:63], v[240:255]
    s_add_u32 m0, s84, 3072
    s_add_u32 s69, s81, 2195456
    buffer_load_dwordx4 v1, s[20:23], s69 offen lds
    s_waitcnt lgkmcnt(0)
    v_mfma_f32_32x32x16_bf16 v[128:143], v[72:75], v[40:43], v[128:143]
    ds_read_b128 v[56:59], v22 offset:0
    ds_read_b128 v[60:63], v22 offset:16384
    v_accvgpr_read_b32 v110, a38
    v_accvgpr_read_b32 v111, a39
    v_accvgpr_read_b32 v112, a40
    v_accvgpr_read_b32 v113, a41
    v_mfma_f32_32x32x16_bf16 v[144:159], v[76:79], v[40:43], v[144:159]
    ds_read_b64_tr_b16 v[88:89], v25 offset:20480
    ds_read_b64_tr_b16 v[90:91], v25 offset:21504
    v_accvgpr_read_b32 v114, a42
    v_accvgpr_read_b32 v115, a43
    v_accvgpr_read_b32 v116, a44
    v_mfma_f32_32x32x16_bf16 v[160:175], v[80:83], v[40:43], v[160:175]
    ds_read_b64_tr_b16 v[92:93], v26 offset:20480
    s_add_u32 m0, s85, 131072
    s_add_u32 s69, s80, 384
    buffer_load_dwordx4 v4, s[16:19], s69 offen lds
    v_mfma_f32_32x32x16_bf16 v[176:191], v[84:87], v[40:43], v[176:191]
    ds_read_b64_tr_b16 v[94:95], v26 offset:21504
    ds_read_b64_tr_b16 v[96:97], v27 offset:20480
    v_accvgpr_read_b32 v117, a45
    v_accvgpr_read_b32 v118, a46
    v_accvgpr_read_b32 v119, a47
    v_cvt_pk_bf16_f32 v120, v104, v105
    v_mfma_f32_32x32x16_bf16 v[192:207], v[72:75], v[44:47], v[192:207]
    ds_read_b64_tr_b16 v[98:99], v27 offset:21504
    s_add_u32 m0, s85, 132096
    s_add_u32 s69, s80, 9600
    buffer_load_dwordx4 v5, s[16:19], s69 offen lds
    v_mfma_f32_32x32x16_bf16 v[208:223], v[76:79], v[44:47], v[208:223]
    ds_read_b64_tr_b16 v[100:101], v28 offset:20480
    ds_read_b64_tr_b16 v[102:103], v28 offset:21504
    v_cvt_pk_bf16_f32 v121, v106, v107
    v_cvt_pk_bf16_f32 v122, v108, v109
    v_cvt_pk_bf16_f32 v123, v110, v111
    v_cvt_pk_bf16_f32 v124, v112, v113
    v_mfma_f32_32x32x16_bf16 v[224:239], v[80:83], v[44:47], v[224:239]
    v_cvt_pk_bf16_f32 v125, v114, v115
    v_cvt_pk_bf16_f32 v126, v116, v117
    s_add_u32 m0, s85, 133120
    s_add_u32 s69, s80, 18816
    buffer_load_dwordx4 v4, s[16:19], s69 offen lds
    v_mfma_f32_32x32x16_bf16 v[240:255], v[84:87], v[44:47], v[240:255]
    v_cvt_pk_bf16_f32 v127, v118, v119
    s_add_u32 s70, s48, 0
    buffer_store_dwordx4 v[120:123], v37, s[32:35], s70 offen sc1
    s_waitcnt lgkmcnt(0)
    v_mfma_f32_32x32x16_bf16 v[128:143], v[88:91], v[56:59], v[128:143]
    ds_read_b128 v[40:43], v23 offset:0
    s_add_u32 s70, s49, 0
    buffer_store_dwordx4 v[124:127], v37, s[32:35], s70 offen sc1
    v_mfma_f32_32x32x16_bf16 v[144:159], v[92:95], v[56:59], v[144:159]
    ds_read_b128 v[44:47], v23 offset:16384
    ds_read_b64_tr_b16 v[72:73], v25 offset:24576
    ds_read_b64_tr_b16 v[74:75], v25 offset:25600
    v_accvgpr_read_b32 v104, a48
    v_accvgpr_read_b32 v105, a49
    v_mfma_f32_32x32x16_bf16 v[160:175], v[96:99], v[56:59], v[160:175]
    v_accvgpr_read_b32 v106, a50
    v_accvgpr_read_b32 v107, a51
    s_add_u32 m0, s85, 134144
    s_add_u32 s69, s80, 28032
    buffer_load_dwordx4 v5, s[16:19], s69 offen lds
    v_mfma_f32_32x32x16_bf16 v[176:191], v[100:103], v[56:59], v[176:191]
    ds_read_b64_tr_b16 v[76:77], v26 offset:24576
    ds_read_b64_tr_b16 v[78:79], v26 offset:25600
    ds_read_b64_tr_b16 v[80:81], v27 offset:24576
    v_accvgpr_read_b32 v108, a52
    v_accvgpr_read_b32 v109, a53
    v_mfma_f32_32x32x16_bf16 v[192:207], v[88:91], v[60:63], v[192:207]
    ds_read_b64_tr_b16 v[82:83], v27 offset:25600
    ds_read_b64_tr_b16 v[84:85], v28 offset:24576
    v_accvgpr_read_b32 v110, a54
    v_accvgpr_read_b32 v111, a55
    v_accvgpr_read_b32 v112, a56
    v_accvgpr_read_b32 v113, a57
    v_mfma_f32_32x32x16_bf16 v[208:223], v[92:95], v[60:63], v[208:223]
    ds_read_b64_tr_b16 v[86:87], v28 offset:25600
    s_add_u32 m0, s85, 135168
    s_add_u32 s69, s80, 37248
    buffer_load_dwordx4 v4, s[16:19], s69 offen lds
    v_mfma_f32_32x32x16_bf16 v[224:239], v[96:99], v[60:63], v[224:239]
    v_accvgpr_read_b32 v114, a58
    v_accvgpr_read_b32 v115, a59
    v_accvgpr_read_b32 v116, a60
    v_accvgpr_read_b32 v117, a61
    v_accvgpr_read_b32 v118, a62
    v_accvgpr_read_b32 v119, a63
    v_cvt_pk_bf16_f32 v120, v104, v105
    v_mfma_f32_32x32x16_bf16 v[240:255], v[100:103], v[60:63], v[240:255]
    v_cvt_pk_bf16_f32 v121, v106, v107
    s_add_u32 m0, s85, 136192
    s_add_u32 s69, s80, 46464
    buffer_load_dwordx4 v5, s[16:19], s69 offen lds
    s_waitcnt lgkmcnt(0)
    v_mfma_f32_32x32x16_bf16 v[128:143], v[72:75], v[40:43], v[128:143]
    ds_read_b128 v[56:59], v24 offset:0
    s_add_u32 m0, s85, 137216
    s_add_u32 s69, s80, 55680
    buffer_load_dwordx4 v4, s[16:19], s69 offen lds
    v_mfma_f32_32x32x16_bf16 v[144:159], v[76:79], v[40:43], v[144:159]
    ds_read_b128 v[60:63], v24 offset:16384
    ds_read_b64_tr_b16 v[88:89], v25 offset:28672
    ds_read_b64_tr_b16 v[90:91], v25 offset:29696
    v_cvt_pk_bf16_f32 v122, v108, v109
    v_cvt_pk_bf16_f32 v123, v110, v111
    v_mfma_f32_32x32x16_bf16 v[160:175], v[80:83], v[40:43], v[160:175]
    ds_read_b64_tr_b16 v[92:93], v26 offset:28672
    ds_read_b64_tr_b16 v[94:95], v26 offset:29696
    v_cvt_pk_bf16_f32 v124, v112, v113
    v_cvt_pk_bf16_f32 v125, v114, v115
    v_cvt_pk_bf16_f32 v126, v116, v117
    v_cvt_pk_bf16_f32 v127, v118, v119
    v_mfma_f32_32x32x16_bf16 v[176:191], v[84:87], v[40:43], v[176:191]
    s_add_u32 s70, s50, 0
    buffer_store_dwordx4 v[120:123], v37, s[32:35], s70 offen sc1
    s_add_u32 s70, s51, 0
    buffer_store_dwordx4 v[124:127], v37, s[32:35], s70 offen sc1
    v_mfma_f32_32x32x16_bf16 v[192:207], v[72:75], v[44:47], v[192:207]
    ds_read_b64_tr_b16 v[96:97], v27 offset:28672
    ds_read_b64_tr_b16 v[98:99], v27 offset:29696
    ds_read_b64_tr_b16 v[100:101], v28 offset:28672
    v_accvgpr_read_b32 v104, a64
    v_accvgpr_read_b32 v105, a65
    v_mfma_f32_32x32x16_bf16 v[208:223], v[76:79], v[44:47], v[208:223]
    ds_read_b64_tr_b16 v[102:103], v28 offset:29696
    s_add_u32 m0, s85, 138240
    s_add_u32 s69, s80, 64896
    buffer_load_dwordx4 v5, s[16:19], s69 offen lds
    v_mfma_f32_32x32x16_bf16 v[224:239], v[80:83], v[44:47], v[224:239]
    v_accvgpr_read_b32 v106, a66
    v_accvgpr_read_b32 v107, a67
    v_accvgpr_read_b32 v108, a68
    v_accvgpr_read_b32 v109, a69
    v_accvgpr_read_b32 v110, a70
    v_accvgpr_read_b32 v111, a71
    v_accvgpr_read_b32 v112, a72
    v_mfma_f32_32x32x16_bf16 v[240:255], v[84:87], v[44:47], v[240:255]
    v_accvgpr_read_b32 v113, a73
    v_accvgpr_read_b32 v114, a74
    v_accvgpr_read_b32 v115, a75
    v_accvgpr_read_b32 v116, a76
    v_accvgpr_read_b32 v117, a77
    s_waitcnt vmcnt(18) lgkmcnt(0)
    s_barrier
    v_mfma_f32_32x32x16_bf16 v[128:143], v[88:91], v[56:59], v[128:143]
    ds_read_b128 v[40:43], v21 offset:32768
    s_add_u32 m0, s84, 16384
    s_add_u32 s69, s81, 2621440
    buffer_load_dwordx4 v1, s[20:23], s69 offen lds
    v_mfma_f32_32x32x16_bf16 v[144:159], v[92:95], v[56:59], v[144:159]
    ds_read_b128 v[44:47], v21 offset:49152
    ds_read_b64_tr_b16 v[72:73], v25 offset:32768
    ds_read_b64_tr_b16 v[74:75], v25 offset:33792
    v_accvgpr_read_b32 v118, a78
    v_accvgpr_read_b32 v119, a79
    v_mfma_f32_32x32x16_bf16 v[160:175], v[96:99], v[56:59], v[160:175]
    ds_read_b64_tr_b16 v[76:77], v26 offset:32768
    s_add_u32 m0, s84, 17408
    s_add_u32 s69, s81, 2654208
    buffer_load_dwordx4 v1, s[20:23], s69 offen lds
    v_mfma_f32_32x32x16_bf16 v[176:191], v[100:103], v[56:59], v[176:191]
    ds_read_b64_tr_b16 v[78:79], v26 offset:33792
    ds_read_b64_tr_b16 v[80:81], v27 offset:32768
    ds_read_b64_tr_b16 v[82:83], v27 offset:33792
    v_cvt_pk_bf16_f32 v120, v104, v105
    v_cvt_pk_bf16_f32 v121, v106, v107
    v_mfma_f32_32x32x16_bf16 v[192:207], v[88:91], v[60:63], v[192:207]
    ds_read_b64_tr_b16 v[84:85], v28 offset:32768
    ds_read_b64_tr_b16 v[86:87], v28 offset:33792
    v_cvt_pk_bf16_f32 v122, v108, v109
    v_cvt_pk_bf16_f32 v123, v110, v111
    v_cvt_pk_bf16_f32 v124, v112, v113
    v_cvt_pk_bf16_f32 v125, v114, v115
    v_mfma_f32_32x32x16_bf16 v[208:223], v[92:95], v[60:63], v[208:223]
    v_cvt_pk_bf16_f32 v126, v116, v117
    v_cvt_pk_bf16_f32 v127, v118, v119
    s_add_u32 m0, s84, 18432
    s_add_u32 s69, s81, 2686976
    buffer_load_dwordx4 v1, s[20:23], s69 offen lds
    v_mfma_f32_32x32x16_bf16 v[224:239], v[96:99], v[60:63], v[224:239]
    s_add_u32 s70, s44, 8192
    buffer_store_dwordx4 v[120:123], v37, s[32:35], s70 offen sc1
    s_add_u32 m0, s84, 19456
    s_add_u32 s69, s81, 2719744
    buffer_load_dwordx4 v1, s[20:23], s69 offen lds
    v_mfma_f32_32x32x16_bf16 v[240:255], v[100:103], v[60:63], v[240:255]
    s_add_u32 s70, s45, 8192
    buffer_store_dwordx4 v[124:127], v37, s[32:35], s70 offen sc1
    s_waitcnt lgkmcnt(0)
    v_mfma_f32_32x32x16_bf16 v[128:143], v[72:75], v[40:43], v[128:143]
    ds_read_b128 v[56:59], v22 offset:32768
    v_accvgpr_read_b32 v104, a80
    v_accvgpr_read_b32 v105, a81
    v_accvgpr_read_b32 v106, a82
    v_accvgpr_read_b32 v107, a83
    v_accvgpr_read_b32 v108, a84
    v_mfma_f32_32x32x16_bf16 v[144:159], v[76:79], v[40:43], v[144:159]
    ds_read_b128 v[60:63], v22 offset:49152
    ds_read_b64_tr_b16 v[88:89], v25 offset:36864
    ds_read_b64_tr_b16 v[90:91], v25 offset:37888
    ds_read_b64_tr_b16 v[92:93], v26 offset:36864
    v_accvgpr_read_b32 v109, a85
    v_mfma_f32_32x32x16_bf16 v[160:175], v[80:83], v[40:43], v[160:175]
    v_accvgpr_read_b32 v110, a86
    v_accvgpr_read_b32 v111, a87
    s_add_u32 m0, s85, 65536
    s_add_u32 s69, s80, 512
    buffer_load_dwordx4 v4, s[16:19], s69 offen lds
    v_mfma_f32_32x32x16_bf16 v[176:191], v[84:87], v[40:43], v[176:191]
    ds_read_b64_tr_b16 v[94:95], v26 offset:37888
    ds_read_b64_tr_b16 v[96:97], v27 offset:36864
    v_accvgpr_read_b32 v112, a88
    v_accvgpr_read_b32 v113, a89
    v_accvgpr_read_b32 v114, a90
    v_mfma_f32_32x32x16_bf16 v[192:207], v[72:75], v[44:47], v[192:207]
    ds_read_b64_tr_b16 v[98:99], v27 offset:37888
    s_add_u32 m0, s85, 66560
    s_add_u32 s69, s80, 9728
    buffer_load_dwordx4 v5, s[16:19], s69 offen lds
    v_mfma_f32_32x32x16_bf16 v[208:223], v[76:79], v[44:47], v[208:223]
    ds_read_b64_tr_b16 v[100:101], v28 offset:36864
    ds_read_b64_tr_b16 v[102:103], v28 offset:37888
    v_accvgpr_read_b32 v115, a91
    v_accvgpr_read_b32 v116, a92
    v_accvgpr_read_b32 v117, a93
    v_accvgpr_read_b32 v118, a94
    v_mfma_f32_32x32x16_bf16 v[224:239], v[80:83], v[44:47], v[224:239]
    v_accvgpr_read_b32 v119, a95
    v_cvt_pk_bf16_f32 v120, v104, v105
    v_cvt_pk_bf16_f32 v121, v106, v107
    v_cvt_pk_bf16_f32 v122, v108, v109
    v_cvt_pk_bf16_f32 v123, v110, v111
    v_cvt_pk_bf16_f32 v124, v112, v113
    v_cvt_pk_bf16_f32 v125, v114, v115
    v_mfma_f32_32x32x16_bf16 v[240:255], v[84:87], v[44:47], v[240:255]
    v_cvt_pk_bf16_f32 v126, v116, v117
    s_add_u32 m0, s85, 67584
    s_add_u32 s69, s80, 18944
    buffer_load_dwordx4 v4, s[16:19], s69 offen lds
    s_waitcnt lgkmcnt(0)
    v_mfma_f32_32x32x16_bf16 v[128:143], v[88:91], v[56:59], v[128:143]
    ds_read_b128 v[40:43], v23 offset:32768
    ds_read_b128 v[44:47], v23 offset:49152
    ds_read_b64_tr_b16 v[72:73], v25 offset:40960
    ds_read_b64_tr_b16 v[74:75], v25 offset:41984
    v_cvt_pk_bf16_f32 v127, v118, v119
    v_mfma_f32_32x32x16_bf16 v[144:159], v[92:95], v[56:59], v[144:159]
    ds_read_b64_tr_b16 v[76:77], v26 offset:40960
    s_add_u32 m0, s85, 68608
    s_add_u32 s69, s80, 28160
    buffer_load_dwordx4 v5, s[16:19], s69 offen lds
    v_mfma_f32_32x32x16_bf16 v[160:175], v[96:99], v[56:59], v[160:175]
    ds_read_b64_tr_b16 v[78:79], v26 offset:41984
    s_add_u32 s70, s46, 8192
    buffer_store_dwordx4 v[120:123], v37, s[32:35], s70 offen sc1
    v_mfma_f32_32x32x16_bf16 v[176:191], v[100:103], v[56:59], v[176:191]
    ds_read_b64_tr_b16 v[80:81], v27 offset:40960
    s_add_u32 s70, s47, 8192
    buffer_store_dwordx4 v[124:127], v37, s[32:35], s70 offen sc1
    v_accvgpr_read_b32 v104, a96
    v_mfma_f32_32x32x16_bf16 v[192:207], v[88:91], v[60:63], v[192:207]
    ds_read_b64_tr_b16 v[82:83], v27 offset:41984
    s_add_u32 m0, s85, 69632
    s_add_u32 s69, s80, 37376
    buffer_load_dwordx4 v4, s[16:19], s69 offen lds
    v_mfma_f32_32x32x16_bf16 v[208:223], v[92:95], v[60:63], v[208:223]
    ds_read_b64_tr_b16 v[84:85], v28 offset:40960
    ds_read_b64_tr_b16 v[86:87], v28 offset:41984
    v_accvgpr_read_b32 v105, a97
    v_accvgpr_read_b32 v106, a98
    v_accvgpr_read_b32 v107, a99
    v_accvgpr_read_b32 v108, a100
    v_mfma_f32_32x32x16_bf16 v[224:239], v[96:99], v[60:63], v[224:239]
    v_accvgpr_read_b32 v109, a101
    v_accvgpr_read_b32 v110, a102
    v_accvgpr_read_b32 v111, a103
    v_accvgpr_read_b32 v112, a104
    v_accvgpr_read_b32 v113, a105
    v_accvgpr_read_b32 v114, a106
    v_accvgpr_read_b32 v115, a107
    v_mfma_f32_32x32x16_bf16 v[240:255], v[100:103], v[60:63], v[240:255]
    v_accvgpr_read_b32 v116, a108
    s_add_u32 m0, s85, 70656
    s_add_u32 s69, s80, 46592
    buffer_load_dwordx4 v5, s[16:19], s69 offen lds
    s_waitcnt lgkmcnt(0)
    v_mfma_f32_32x32x16_bf16 v[128:143], v[72:75], v[40:43], v[128:143]
    ds_read_b128 v[56:59], v24 offset:32768
    ds_read_b128 v[60:63], v24 offset:49152
    ds_read_b64_tr_b16 v[88:89], v25 offset:45056
    ds_read_b64_tr_b16 v[90:91], v25 offset:46080
    v_accvgpr_read_b32 v117, a109
    v_mfma_f32_32x32x16_bf16 v[144:159], v[76:79], v[40:43], v[144:159]
    v_accvgpr_read_b32 v118, a110
    v_accvgpr_read_b32 v119, a111
    s_add_u32 m0, s85, 71680
    s_add_u32 s69, s80, 55808
    buffer_load_dwordx4 v4, s[16:19], s69 offen lds
    v_mfma_f32_32x32x16_bf16 v[160:175], v[80:83], v[40:43], v[160:175]
    ds_read_b64_tr_b16 v[92:93], v26 offset:45056
    ds_read_b64_tr_b16 v[94:95], v26 offset:46080
    v_cvt_pk_bf16_f32 v120, v104, v105
    v_cvt_pk_bf16_f32 v121, v106, v107
    v_cvt_pk_bf16_f32 v122, v108, v109
    v_cvt_pk_bf16_f32 v123, v110, v111
    v_mfma_f32_32x32x16_bf16 v[176:191], v[84:87], v[40:43], v[176:191]
    ds_read_b64_tr_b16 v[96:97], v27 offset:45056
    s_add_u32 m0, s85, 72704
    s_add_u32 s69, s80, 65024
    buffer_load_dwordx4 v5, s[16:19], s69 offen lds
    v_mfma_f32_32x32x16_bf16 v[192:207], v[72:75], v[44:47], v[192:207]
    ds_read_b64_tr_b16 v[98:99], v27 offset:46080
    ds_read_b64_tr_b16 v[100:101], v28 offset:45056
    v_cvt_pk_bf16_f32 v124, v112, v113
    v_cvt_pk_bf16_f32 v125, v114, v115
    v_cvt_pk_bf16_f32 v126, v116, v117
    v_cvt_pk_bf16_f32 v127, v118, v119
    v_mfma_f32_32x32x16_bf16 v[208:223], v[76:79], v[44:47], v[208:223]
    ds_read_b64_tr_b16 v[102:103], v28 offset:46080
    s_add_u32 s70, s48, 8192
    buffer_store_dwordx4 v[120:123], v37, s[32:35], s70 offen sc1
    v_mfma_f32_32x32x16_bf16 v[224:239], v[80:83], v[44:47], v[224:239]
    s_add_u32 s70, s49, 8192
    buffer_store_dwordx4 v[124:127], v37, s[32:35], s70 offen sc1
    v_accvgpr_read_b32 v104, a112
    v_mfma_f32_32x32x16_bf16 v[240:255], v[84:87], v[44:47], v[240:255]
    v_accvgpr_read_b32 v105, a113
    v_accvgpr_read_b32 v106, a114
    v_accvgpr_read_b32 v107, a115
    v_accvgpr_read_b32 v108, a116
    v_accvgpr_read_b32 v109, a117
    s_waitcnt vmcnt(18) lgkmcnt(0)
    s_barrier
    v_mfma_f32_32x32x16_bf16 v[128:143], v[88:91], v[56:59], v[128:143]
    ds_read_b128 v[40:43], v13 offset:0
    s_add_u32 m0, s84, 32768
    s_add_u32 s69, s81, 3145728
    buffer_load_dwordx4 v1, s[20:23], s69 offen lds
    v_mfma_f32_32x32x16_bf16 v[144:159], v[92:95], v[56:59], v[144:159]
    ds_read_b128 v[44:47], v13 offset:16384
    ds_read_b64_tr_b16 v[72:73], v25 offset:49152
    ds_read_b64_tr_b16 v[74:75], v25 offset:50176
    v_accvgpr_read_b32 v110, a118
    v_accvgpr_read_b32 v111, a119
    v_mfma_f32_32x32x16_bf16 v[160:175], v[96:99], v[56:59], v[160:175]
    v_accvgpr_read_b32 v112, a120
    v_accvgpr_read_b32 v113, a121
    s_add_u32 m0, s84, 33792
    s_add_u32 s69, s81, 3178496
    buffer_load_dwordx4 v1, s[20:23], s69 offen lds
    v_mfma_f32_32x32x16_bf16 v[176:191], v[100:103], v[56:59], v[176:191]
    ds_read_b64_tr_b16 v[76:77], v26 offset:49152
    ds_read_b64_tr_b16 v[78:79], v26 offset:50176
    ds_read_b64_tr_b16 v[80:81], v27 offset:49152
    v_accvgpr_read_b32 v114, a122
    v_accvgpr_read_b32 v115, a123
    v_mfma_f32_32x32x16_bf16 v[192:207], v[88:91], v[60:63], v[192:207]
    ds_read_b64_tr_b16 v[82:83], v27 offset:50176
    ds_read_b64_tr_b16 v[84:85], v28 offset:49152
    ds_read_b64_tr_b16 v[86:87], v28 offset:50176
    v_accvgpr_read_b32 v116, a124
    v_accvgpr_read_b32 v117, a125
    v_mfma_f32_32x32x16_bf16 v[208:223], v[92:95], v[60:63], v[208:223]
    v_accvgpr_read_b32 v118, a126
    v_accvgpr_read_b32 v119, a127
    s_add_u32 m0, s84, 34816
    s_add_u32 s69, s81, 3211264
    buffer_load_dwordx4 v1, s[20:23], s69 offen lds
    v_mfma_f32_32x32x16_bf16 v[224:239], v[96:99], v[60:63], v[224:239]
    v_cvt_pk_bf16_f32 v120, v104, v105
    v_cvt_pk_bf16_f32 v121, v106, v107
    v_cvt_pk_bf16_f32 v122, v108, v109
    v_cvt_pk_bf16_f32 v123, v110, v111
    v_cvt_pk_bf16_f32 v124, v112, v113
    v_cvt_pk_bf16_f32 v125, v114, v115
    v_cvt_pk_bf16_f32 v126, v116, v117
    v_mfma_f32_32x32x16_bf16 v[240:255], v[100:103], v[60:63], v[240:255]
    v_cvt_pk_bf16_f32 v127, v118, v119
    s_add_u32 m0, s84, 35840
    s_add_u32 s69, s81, 3244032
    buffer_load_dwordx4 v1, s[20:23], s69 offen lds
    s_waitcnt lgkmcnt(0)
    v_mfma_f32_32x32x16_bf16 v[128:143], v[72:75], v[40:43], v[128:143]
    ds_read_b128 v[56:59], v14 offset:0
    ds_read_b128 v[60:63], v14 offset:16384
    ds_read_b64_tr_b16 v[88:89], v25 offset:53248
    ds_read_b64_tr_b16 v[90:91], v25 offset:54272
    v_mfma_f32_32x32x16_bf16 v[144:159], v[76:79], v[40:43], v[144:159]
    ds_read_b64_tr_b16 v[92:93], v26 offset:53248
    s_add_u32 s70, s50, 8192
    buffer_store_dwordx4 v[120:123], v37, s[32:35], s70 offen sc1
    v_mfma_f32_32x32x16_bf16 v[160:175], v[80:83], v[40:43], v[160:175]
    ds_read_b64_tr_b16 v[94:95], v26 offset:54272
    s_add_u32 s70, s51, 8192
    buffer_store_dwordx4 v[124:127], v37, s[32:35], s70 offen sc1
    v_accvgpr_read_b32 v104, a128
    v_mfma_f32_32x32x16_bf16 v[176:191], v[84:87], v[40:43], v[176:191]
    ds_read_b64_tr_b16 v[96:97], v27 offset:53248
    s_add_u32 m0, s85, 98304
    s_add_u32 s69, s80, 640
    buffer_load_dwordx4 v4, s[16:19], s69 offen lds
    v_mfma_f32_32x32x16_bf16 v[192:207], v[72:75], v[44:47], v[192:207]
    ds_read_b64_tr_b16 v[98:99], v27 offset:54272
    s_add_u32 m0, s85, 99328
    s_add_u32 s69, s80, 9856
    buffer_load_dwordx4 v5, s[16:19], s69 offen lds
    v_mfma_f32_32x32x16_bf16 v[208:223], v[76:79], v[44:47], v[208:223]
    ds_read_b64_tr_b16 v[100:101], v28 offset:53248
    ds_read_b64_tr_b16 v[102:103], v28 offset:54272
    v_accvgpr_read_b32 v105, a129
    v_accvgpr_read_b32 v106, a130
    v_accvgpr_read_b32 v107, a131
    v_accvgpr_read_b32 v108, a132
    v_mfma_f32_32x32x16_bf16 v[224:239], v[80:83], v[44:47], v[224:239]
    v_accvgpr_read_b32 v109, a133
    v_accvgpr_read_b32 v110, a134
    v_accvgpr_read_b32 v111, a135
    v_accvgpr_read_b32 v112, a136
    v_accvgpr_read_b32 v113, a137
    v_accvgpr_read_b32 v114, a138
    v_accvgpr_read_b32 v115, a139
    v_mfma_f32_32x32x16_bf16 v[240:255], v[84:87], v[44:47], v[240:255]
    v_accvgpr_read_b32 v116, a140
    s_add_u32 m0, s85, 100352
    s_add_u32 s69, s80, 19072
    buffer_load_dwordx4 v4, s[16:19], s69 offen lds
    s_waitcnt lgkmcnt(0)
    v_mfma_f32_32x32x16_bf16 v[128:143], v[88:91], v[56:59], v[128:143]
    ds_read_b128 v[40:43], v15 offset:0
    ds_read_b128 v[44:47], v15 offset:16384
    v_accvgpr_read_b32 v117, a141
    v_accvgpr_read_b32 v118, a142
    v_accvgpr_read_b32 v119, a143
    v_cvt_pk_bf16_f32 v120, v104, v105
    v_mfma_f32_32x32x16_bf16 v[144:159], v[92:95], v[56:59], v[144:159]
    ds_read_b64_tr_b16 v[72:73], v25 offset:57344
    ds_read_b64_tr_b16 v[74:75], v25 offset:58368
    ds_read_b64_tr_b16 v[76:77], v26 offset:57344
    v_cvt_pk_bf16_f32 v121, v106, v107
    v_cvt_pk_bf16_f32 v122, v108, v109
    v_mfma_f32_32x32x16_bf16 v[160:175], v[96:99], v[56:59], v[160:175]
    v_cvt_pk_bf16_f32 v123, v110, v111
    v_cvt_pk_bf16_f32 v124, v112, v113
    s_add_u32 m0, s85, 101376
    s_add_u32 s69, s80, 28288
    buffer_load_dwordx4 v5, s[16:19], s69 offen lds
    v_mfma_f32_32x32x16_bf16 v[176:191], v[100:103], v[56:59], v[176:191]
    ds_read_b64_tr_b16 v[78:79], v26 offset:58368
    ds_read_b64_tr_b16 v[80:81], v27 offset:57344
    ds_read_b64_tr_b16 v[82:83], v27 offset:58368
    v_cvt_pk_bf16_f32 v125, v114, v115
    v_cvt_pk_bf16_f32 v126, v116, v117
    v_mfma_f32_32x32x16_bf16 v[192:207], v[88:91], v[60:63], v[192:207]
    ds_read_b64_tr_b16 v[84:85], v28 offset:57344
    v_cvt_pk_bf16_f32 v127, v118, v119
    s_add_u32 m0, s85, 102400
    s_add_u32 s69, s80, 37504
    buffer_load_dwordx4 v4, s[16:19], s69 offen lds
    v_mfma_f32_32x32x16_bf16 v[208:223], v[92:95], v[60:63], v[208:223]
    ds_read_b64_tr_b16 v[86:87], v28 offset:58368
    s_add_u32 s70, s44, 16384
    buffer_store_dwordx4 v[120:123], v37, s[32:35], s70 offen sc1
    v_mfma_f32_32x32x16_bf16 v[224:239], v[96:99], v[60:63], v[224:239]
    s_add_u32 s70, s45, 16384
    buffer_store_dwordx4 v[124:127], v37, s[32:35], s70 offen sc1
    v_accvgpr_read_b32 v104, a144
    v_accvgpr_read_b32 v105, a145
    v_mfma_f32_32x32x16_bf16 v[240:255], v[100:103], v[60:63], v[240:255]
    v_accvgpr_read_b32 v106, a146
    s_add_u32 m0, s85, 103424
    s_add_u32 s69, s80, 46720
    buffer_load_dwordx4 v5, s[16:19], s69 offen lds
    s_waitcnt lgkmcnt(0)
    v_mfma_f32_32x32x16_bf16 v[128:143], v[72:75], v[40:43], v[128:143]
    ds_read_b128 v[56:59], v16 offset:0
    ds_read_b128 v[60:63], v16 offset:16384
    v_accvgpr_read_b32 v107, a147
    v_accvgpr_read_b32 v108, a148
    v_accvgpr_read_b32 v109, a149
    v_accvgpr_read_b32 v110, a150
    v_mfma_f32_32x32x16_bf16 v[144:159], v[76:79], v[40:43], v[144:159]
    ds_read_b64_tr_b16 v[88:89], v25 offset:61440
    ds_read_b64_tr_b16 v[90:91], v25 offset:62464
    ds_read_b64_tr_b16 v[92:93], v26 offset:61440
    v_accvgpr_read_b32 v111, a151
    v_accvgpr_read_b32 v112, a152
    v_mfma_f32_32x32x16_bf16 v[160:175], v[80:83], v[40:43], v[160:175]
    ds_read_b64_tr_b16 v[94:95], v26 offset:62464
    s_add_u32 m0, s85, 104448
    s_add_u32 s69, s80, 55936
    buffer_load_dwordx4 v4, s[16:19], s69 offen lds
    v_mfma_f32_32x32x16_bf16 v[176:191], v[84:87], v[40:43], v[176:191]
    ds_read_b64_tr_b16 v[96:97], v27 offset:61440
    ds_read_b64_tr_b16 v[98:99], v27 offset:62464
    v_accvgpr_read_b32 v113, a153
    v_accvgpr_read_b32 v114, a154
    v_accvgpr_read_b32 v115, a155
    v_accvgpr_read_b32 v116, a156
    v_mfma_f32_32x32x16_bf16 v[192:207], v[72:75], v[44:47], v[192:207]
    v_accvgpr_read_b32 v117, a157
    s_add_u32 m0, s85, 105472
    s_add_u32 s69, s80, 65152
    buffer_load_dwordx4 v5, s[16:19], s69 offen lds
    v_mfma_f32_32x32x16_bf16 v[208:223], v[76:79], v[44:47], v[208:223]
    ds_read_b64_tr_b16 v[100:101], v28 offset:61440
    ds_read_b64_tr_b16 v[102:103], v28 offset:62464
    v_accvgpr_read_b32 v118, a158
    v_accvgpr_read_b32 v119, a159
    v_cvt_pk_bf16_f32 v120, v104, v105
    v_cvt_pk_bf16_f32 v121, v106, v107
    v_mfma_f32_32x32x16_bf16 v[224:239], v[80:83], v[44:47], v[224:239]
    v_cvt_pk_bf16_f32 v122, v108, v109
    v_cvt_pk_bf16_f32 v123, v110, v111
    v_cvt_pk_bf16_f32 v124, v112, v113
    v_cvt_pk_bf16_f32 v125, v114, v115
    v_cvt_pk_bf16_f32 v126, v116, v117
    v_cvt_pk_bf16_f32 v127, v118, v119
    v_mfma_f32_32x32x16_bf16 v[240:255], v[84:87], v[44:47], v[240:255]
    s_add_u32 s70, s46, 16384
    buffer_store_dwordx4 v[120:123], v37, s[32:35], s70 offen sc1
    s_waitcnt vmcnt(19) lgkmcnt(0)
    s_barrier
    v_mfma_f32_32x32x16_bf16 v[128:143], v[88:91], v[56:59], v[128:143]
    ds_read_b128 v[40:43], v21 offset:0
    ds_read_b128 v[44:47], v21 offset:16384
    s_add_u32 m0, s84, 49152
    s_add_u32 s69, s81, 3670016
    buffer_load_dwordx4 v1, s[20:23], s69 offen lds
    v_mfma_f32_32x32x16_bf16 v[144:159], v[92:95], v[56:59], v[144:159]
    ds_read_b64_tr_b16 v[72:73], v25 offset:0
    ds_read_b64_tr_b16 v[74:75], v25 offset:1024
    s_add_u32 s70, s47, 16384
    buffer_store_dwordx4 v[124:127], v37, s[32:35], s70 offen sc1
    v_mfma_f32_32x32x16_bf16 v[160:175], v[96:99], v[56:59], v[160:175]
    v_accvgpr_read_b32 v104, a160
    v_accvgpr_read_b32 v105, a161
    s_add_u32 m0, s84, 50176
    s_add_u32 s69, s81, 3702784
    buffer_load_dwordx4 v1, s[20:23], s69 offen lds
    v_mfma_f32_32x32x16_bf16 v[176:191], v[100:103], v[56:59], v[176:191]
    ds_read_b64_tr_b16 v[76:77], v26 offset:0
    ds_read_b64_tr_b16 v[78:79], v26 offset:1024
    ds_read_b64_tr_b16 v[80:81], v27 offset:0
    v_accvgpr_read_b32 v106, a162
    v_accvgpr_read_b32 v107, a163
    v_mfma_f32_32x32x16_bf16 v[192:207], v[88:91], v[60:63], v[192:207]
    ds_read_b64_tr_b16 v[82:83], v27 offset:1024
    ds_read_b64_tr_b16 v[84:85], v28 offset:0
    ds_read_b64_tr_b16 v[86:87], v28 offset:1024
    v_accvgpr_read_b32 v108, a164
    v_accvgpr_read_b32 v109, a165
    v_mfma_f32_32x32x16_bf16 v[208:223], v[92:95], v[60:63], v[208:223]
    v_accvgpr_read_b32 v110, a166
    v_accvgpr_read_b32 v111, a167
    s_add_u32 m0, s84, 51200
    s_add_u32 s69, s81, 3735552
    buffer_load_dwordx4 v1, s[20:23], s69 offen lds
    v_mfma_f32_32x32x16_bf16 v[224:239], v[96:99], v[60:63], v[224:239]
    v_accvgpr_read_b32 v112, a168
    v_accvgpr_read_b32 v113, a169
    s_add_u32 m0, s84, 52224
    s_add_u32 s69, s81, 3768320
    buffer_load_dwordx4 v1, s[20:23], s69 offen lds
    v_mfma_f32_32x32x16_bf16 v[240:255], v[100:103], v[60:63], v[240:255]
    v_accvgpr_read_b32 v114, a170
    v_accvgpr_read_b32 v115, a171
    v_accvgpr_read_b32 v116, a172
    v_accvgpr_read_b32 v117, a173
    v_accvgpr_read_b32 v118, a174
    v_accvgpr_read_b32 v119, a175
    s_waitcnt lgkmcnt(0)
    v_mfma_f32_32x32x16_bf16 v[128:143], v[72:75], v[40:43], v[128:143]
    ds_read_b128 v[56:59], v22 offset:0
    v_cvt_pk_bf16_f32 v120, v104, v105
    v_cvt_pk_bf16_f32 v121, v106, v107
    v_cvt_pk_bf16_f32 v122, v108, v109
    v_cvt_pk_bf16_f32 v123, v110, v111
    v_cvt_pk_bf16_f32 v124, v112, v113
    v_mfma_f32_32x32x16_bf16 v[144:159], v[76:79], v[40:43], v[144:159]
    ds_read_b128 v[60:63], v22 offset:16384
    ds_read_b64_tr_b16 v[88:89], v25 offset:4096
    ds_read_b64_tr_b16 v[90:91], v25 offset:5120
    ds_read_b64_tr_b16 v[92:93], v26 offset:4096
    v_cvt_pk_bf16_f32 v125, v114, v115
    v_mfma_f32_32x32x16_bf16 v[160:175], v[80:83], v[40:43], v[160:175]
    v_cvt_pk_bf16_f32 v126, v116, v117
    v_cvt_pk_bf16_f32 v127, v118, v119
    s_add_u32 m0, s85, 131072
    s_add_u32 s69, s80, 768
    buffer_load_dwordx4 v4, s[16:19], s69 offen lds
    v_mfma_f32_32x32x16_bf16 v[176:191], v[84:87], v[40:43], v[176:191]
    ds_read_b64_tr_b16 v[94:95], v26 offset:5120
    s_add_u32 s70, s48, 16384
    buffer_store_dwordx4 v[120:123], v37, s[32:35], s70 offen sc1
    v_mfma_f32_32x32x16_bf16 v[192:207], v[72:75], v[44:47], v[192:207]
    ds_read_b64_tr_b16 v[96:97], v27 offset:4096
    ds_read_b64_tr_b16 v[98:99], v27 offset:5120
    s_add_u32 s70, s49, 16384
    buffer_store_dwordx4 v[124:127], v37, s[32:35], s70 offen sc1
    v_mfma_f32_32x32x16_bf16 v[208:223], v[76:79], v[44:47], v[208:223]
    ds_read_b64_tr_b16 v[100:101], v28 offset:4096
    ds_read_b64_tr_b16 v[102:103], v28 offset:5120
    s_add_u32 m0, s85, 132096
    s_add_u32 s69, s80, 9984
    buffer_load_dwordx4 v5, s[16:19], s69 offen lds
    v_mfma_f32_32x32x16_bf16 v[224:239], v[80:83], v[44:47], v[224:239]
    v_accvgpr_read_b32 v104, a176
    v_accvgpr_read_b32 v105, a177
    v_accvgpr_read_b32 v106, a178
    v_accvgpr_read_b32 v107, a179
    v_accvgpr_read_b32 v108, a180
    v_accvgpr_read_b32 v109, a181
    v_mfma_f32_32x32x16_bf16 v[240:255], v[84:87], v[44:47], v[240:255]
    s_add_u32 m0, s85, 133120
    s_add_u32 s69, s80, 19200
    buffer_load_dwordx4 v4, s[16:19], s69 offen lds
    s_waitcnt lgkmcnt(0)
    v_mfma_f32_32x32x16_bf16 v[128:143], v[88:91], v[56:59], v[128:143]
    ds_read_b128 v[40:43], v23 offset:0
    ds_read_b128 v[44:47], v23 offset:16384
    v_accvgpr_read_b32 v110, a182
    v_accvgpr_read_b32 v111, a183
    v_accvgpr_read_b32 v112, a184
    v_mfma_f32_32x32x16_bf16 v[144:159], v[92:95], v[56:59], v[144:159]
    ds_read_b64_tr_b16 v[72:73], v25 offset:8192
    ds_read_b64_tr_b16 v[74:75], v25 offset:9216
    ds_read_b64_tr_b16 v[76:77], v26 offset:8192
    v_accvgpr_read_b32 v113, a185
    v_accvgpr_read_b32 v114, a186
    v_mfma_f32_32x32x16_bf16 v[160:175], v[96:99], v[56:59], v[160:175]
    v_accvgpr_read_b32 v115, a187
    v_accvgpr_read_b32 v116, a188
    s_add_u32 m0, s85, 134144
    s_add_u32 s69, s80, 28416
    buffer_load_dwordx4 v5, s[16:19], s69 offen lds
    v_mfma_f32_32x32x16_bf16 v[176:191], v[100:103], v[56:59], v[176:191]
    ds_read_b64_tr_b16 v[78:79], v26 offset:9216
    ds_read_b64_tr_b16 v[80:81], v27 offset:8192
    v_accvgpr_read_b32 v117, a189
    v_accvgpr_read_b32 v118, a190
    v_accvgpr_read_b32 v119, a191
    v_cvt_pk_bf16_f32 v120, v104, v105
    v_mfma_f32_32x32x16_bf16 v[192:207], v[88:91], v[60:63], v[192:207]
    v_cvt_pk_bf16_f32 v121, v106, v107
    v_cvt_pk_bf16_f32 v122, v108, v109
    s_add_u32 m0, s85, 135168
    s_add_u32 s69, s80, 37632
    buffer_load_dwordx4 v4, s[16:19], s69 offen lds
    v_mfma_f32_32x32x16_bf16 v[208:223], v[92:95], v[60:63], v[208:223]
    ds_read_b64_tr_b16 v[82:83], v27 offset:9216
    ds_read_b64_tr_b16 v[84:85], v28 offset:8192
    ds_read_b64_tr_b16 v[86:87], v28 offset:9216
    v_cvt_pk_bf16_f32 v123, v110, v111
    v_cvt_pk_bf16_f32 v124, v112, v113
    v_mfma_f32_32x32x16_bf16 v[224:239], v[96:99], v[60:63], v[224:239]
    v_cvt_pk_bf16_f32 v125, v114, v115
    v_cvt_pk_bf16_f32 v126, v116, v117
    s_add_u32 m0, s85, 136192
    s_add_u32 s69, s80, 46848
    buffer_load_dwordx4 v5, s[16:19], s69 offen lds
    v_mfma_f32_32x32x16_bf16 v[240:255], v[100:103], v[60:63], v[240:255]
    v_cvt_pk_bf16_f32 v127, v118, v119
    s_add_u32 s70, s50, 16384
    buffer_store_dwordx4 v[120:123], v37, s[32:35], s70 offen sc1
    s_waitcnt lgkmcnt(0)
    v_mfma_f32_32x32x16_bf16 v[128:143], v[72:75], v[40:43], v[128:143]
    ds_read_b128 v[56:59], v24 offset:0
    s_add_u32 s70, s51, 16384
    buffer_store_dwordx4 v[124:127], v37, s[32:35], s70 offen sc1
    v_mfma_f32_32x32x16_bf16 v[144:159], v[76:79], v[40:43], v[144:159]
    ds_read_b128 v[60:63], v24 offset:16384
    s_add_u32 m0, s85, 137216
    s_add_u32 s69, s80, 56064
    buffer_load_dwordx4 v4, s[16:19], s69 offen lds
    v_mfma_f32_32x32x16_bf16 v[160:175], v[80:83], v[40:43], v[160:175]
    ds_read_b64_tr_b16 v[88:89], v25 offset:12288
    ds_read_b64_tr_b16 v[90:91], v25 offset:13312
    ds_read_b64_tr_b16 v[92:93], v26 offset:12288
    v_accvgpr_read_b32 v104, a192
    v_accvgpr_read_b32 v105, a193
    v_mfma_f32_32x32x16_bf16 v[176:191], v[84:87], v[40:43], v[176:191]
    ds_read_b64_tr_b16 v[94:95], v26 offset:13312
    v_accvgpr_read_b32 v106, a194
    v_accvgpr_read_b32 v107, a195
    v_accvgpr_read_b32 v108, a196
    v_accvgpr_read_b32 v109, a197
    v_accvgpr_read_b32 v110, a198
    v_mfma_f32_32x32x16_bf16 v[192:207], v[72:75], v[44:47], v[192:207]
    ds_read_b64_tr_b16 v[96:97], v27 offset:12288
    s_add_u32 m0, s85, 138240
    s_add_u32 s69, s80, 65280
    buffer_load_dwordx4 v5, s[16:19], s69 offen lds
    v_mfma_f32_32x32x16_bf16 v[208:223], v[76:79], v[44:47], v[208:223]
    ds_read_b64_tr_b16 v[98:99], v27 offset:13312
    ds_read_b64_tr_b16 v[100:101], v28 offset:12288
    ds_read_b64_tr_b16 v[102:103], v28 offset:13312
    v_accvgpr_read_b32 v111, a199
    v_mfma_f32_32x32x16_bf16 v[224:239], v[80:83], v[44:47], v[224:239]
    v_accvgpr_read_b32 v112, a200
    v_accvgpr_read_b32 v113, a201
    v_accvgpr_read_b32 v114, a202
    v_accvgpr_read_b32 v115, a203
    v_accvgpr_read_b32 v116, a204
    v_accvgpr_read_b32 v117, a205
    v_mfma_f32_32x32x16_bf16 v[240:255], v[84:87], v[44:47], v[240:255]
    v_accvgpr_read_b32 v118, a206
    v_accvgpr_read_b32 v119, a207
    v_cvt_pk_bf16_f32 v120, v104, v105
    v_cvt_pk_bf16_f32 v121, v106, v107
    s_waitcnt vmcnt(18) lgkmcnt(0)
    s_barrier
    v_mfma_f32_32x32x16_bf16 v[128:143], v[88:91], v[56:59], v[128:143]
    ds_read_b128 v[40:43], v21 offset:32768
    ds_read_b128 v[44:47], v21 offset:49152
    s_add_u32 m0, s84, 0
    s_add_u32 s69, s81, 4194304
    buffer_load_dwordx4 v1, s[20:23], s69 offen lds
    v_mfma_f32_32x32x16_bf16 v[144:159], v[92:95], v[56:59], v[144:159]
    ds_read_b64_tr_b16 v[72:73], v25 offset:16384
    ds_read_b64_tr_b16 v[74:75], v25 offset:17408
    ds_read_b64_tr_b16 v[76:77], v26 offset:16384
    v_cvt_pk_bf16_f32 v122, v108, v109
    v_cvt_pk_bf16_f32 v123, v110, v111
    v_cvt_pk_bf16_f32 v124, v112, v113
    v_mfma_f32_32x32x16_bf16 v[160:175], v[96:99], v[56:59], v[160:175]
    v_cvt_pk_bf16_f32 v125, v114, v115
    v_cvt_pk_bf16_f32 v126, v116, v117
    v_cvt_pk_bf16_f32 v127, v118, v119
    s_add_u32 m0, s84, 1024
    s_add_u32 s69, s81, 4227072
    buffer_load_dwordx4 v1, s[20:23], s69 offen lds
    v_mfma_f32_32x32x16_bf16 v[176:191], v[100:103], v[56:59], v[176:191]
    ds_read_b64_tr_b16 v[78:79], v26 offset:17408
    ds_read_b64_tr_b16 v[80:81], v27 offset:16384
    s_add_u32 s70, s44, 24576
    buffer_store_dwordx4 v[120:123], v37, s[32:35], s70 offen sc1
    v_mfma_f32_32x32x16_bf16 v[192:207], v[88:91], v[60:63], v[192:207]
    ds_read_b64_tr_b16 v[82:83], v27 offset:17408
    s_add_u32 s70, s45, 24576
    buffer_store_dwordx4 v[124:127], v37, s[32:35], s70 offen sc1
    v_accvgpr_read_b32 v104, a208
    v_accvgpr_read_b32 v105, a209
    v_mfma_f32_32x32x16_bf16 v[208:223], v[92:95], v[60:63], v[208:223]
    ds_read_b64_tr_b16 v[84:85], v28 offset:16384
    ds_read_b64_tr_b16 v[86:87], v28 offset:17408
    s_add_u32 m0, s84, 2048
    s_add_u32 s69, s81, 4259840
    buffer_load_dwordx4 v1, s[20:23], s69 offen lds
    v_mfma_f32_32x32x16_bf16 v[224:239], v[96:99], v[60:63], v[224:239]
    v_accvgpr_read_b32 v106, a210
    v_accvgpr_read_b32 v107, a211
    v_accvgpr_read_b32 v108, a212
    v_accvgpr_read_b32 v109, a213
    v_accvgpr_read_b32 v110, a214
    v_accvgpr_read_b32 v111, a215
    v_mfma_f32_32x32x16_bf16 v[240:255], v[100:103], v[60:63], v[240:255]
    v_accvgpr_read_b32 v112, a216
    s_add_u32 m0, s84, 3072
    s_add_u32 s69, s81, 4292608
    buffer_load_dwordx4 v1, s[20:23], s69 offen lds
    s_waitcnt lgkmcnt(0)
    v_mfma_f32_32x32x16_bf16 v[128:143], v[72:75], v[40:43], v[128:143]
    ds_read_b128 v[56:59], v22 offset:32768
    ds_read_b128 v[60:63], v22 offset:49152
    v_accvgpr_read_b32 v113, a217
    v_accvgpr_read_b32 v114, a218
    v_accvgpr_read_b32 v115, a219
    v_mfma_f32_32x32x16_bf16 v[144:159], v[76:79], v[40:43], v[144:159]
    ds_read_b64_tr_b16 v[88:89], v25 offset:20480
    ds_read_b64_tr_b16 v[90:91], v25 offset:21504
    ds_read_b64_tr_b16 v[92:93], v26 offset:20480
    v_accvgpr_read_b32 v116, a220
    v_accvgpr_read_b32 v117, a221
    v_mfma_f32_32x32x16_bf16 v[160:175], v[80:83], v[40:43], v[160:175]
    v_accvgpr_read_b32 v118, a222
    v_accvgpr_read_b32 v119, a223
    s_add_u32 m0, s85, 65536
    s_add_u32 s69, s80, 896
    buffer_load_dwordx4 v4, s[16:19], s69 offen lds
    v_mfma_f32_32x32x16_bf16 v[176:191], v[84:87], v[40:43], v[176:191]
    ds_read_b64_tr_b16 v[94:95], v26 offset:21504
    ds_read_b64_tr_b16 v[96:97], v27 offset:20480
    v_cvt_pk_bf16_f32 v120, v104, v105
    v_cvt_pk_bf16_f32 v121, v106, v107
    v_cvt_pk_bf16_f32 v122, v108, v109
    v_mfma_f32_32x32x16_bf16 v[192:207], v[72:75], v[44:47], v[192:207]
    ds_read_b64_tr_b16 v[98:99], v27 offset:21504
    ds_read_b64_tr_b16 v[100:101], v28 offset:20480
    v_cvt_pk_bf16_f32 v123, v110, v111
    v_cvt_pk_bf16_f32 v124, v112, v113
    v_cvt_pk_bf16_f32 v125, v114, v115
    v_mfma_f32_32x32x16_bf16 v[208:223], v[76:79], v[44:47], v[208:223]
    ds_read_b64_tr_b16 v[102:103], v28 offset:21504
    s_add_u32 m0, s85, 66560
    s_add_u32 s69, s80, 10112
    buffer_load_dwordx4 v5, s[16:19], s69 offen lds
    v_mfma_f32_32x32x16_bf16 v[224:239], v[80:83], v[44:47], v[224:239]
    v_cvt_pk_bf16_f32 v126, v116, v117
    v_cvt_pk_bf16_f32 v127, v118, v119
    s_add_u32 s70, s46, 24576
    buffer_store_dwordx4 v[120:123], v37, s[32:35], s70 offen sc1
    v_mfma_f32_32x32x16_bf16 v[240:255], v[84:87], v[44:47], v[240:255]
    s_add_u32 s70, s47, 24576
    buffer_store_dwordx4 v[124:127], v37, s[32:35], s70 offen sc1
    v_accvgpr_read_b32 v104, a224
    s_waitcnt lgkmcnt(0)
    v_mfma_f32_32x32x16_bf16 v[128:143], v[88:91], v[56:59], v[128:143]
    ds_read_b128 v[40:43], v23 offset:32768
    ds_read_b128 v[44:47], v23 offset:49152
    s_add_u32 m0, s85, 67584
    s_add_u32 s69, s80, 19328
    buffer_load_dwordx4 v4, s[16:19], s69 offen lds
    v_mfma_f32_32x32x16_bf16 v[144:159], v[92:95], v[56:59], v[144:159]
    ds_read_b64_tr_b16 v[72:73], v25 offset:24576
    ds_read_b64_tr_b16 v[74:75], v25 offset:25600
    v_accvgpr_read_b32 v105, a225
    v_accvgpr_read_b32 v106, a226
    v_accvgpr_read_b32 v107, a227
    v_accvgpr_read_b32 v108, a228
    v_mfma_f32_32x32x16_bf16 v[160:175], v[96:99], v[56:59], v[160:175]
    v_accvgpr_read_b32 v109, a229
    v_accvgpr_read_b32 v110, a230
    s_add_u32 m0, s85, 68608
    s_add_u32 s69, s80, 28544
    buffer_load_dwordx4 v5, s[16:19], s69 offen lds
    v_mfma_f32_32x32x16_bf16 v[176:191], v[100:103], v[56:59], v[176:191]
    ds_read_b64_tr_b16 v[76:77], v26 offset:24576
    ds_read_b64_tr_b16 v[78:79], v26 offset:25600
    ds_read_b64_tr_b16 v[80:81], v27 offset:24576
    v_accvgpr_read_b32 v111, a231
    v_accvgpr_read_b32 v112, a232
    v_mfma_f32_32x32x16_bf16 v[192:207], v[88:91], v[60:63], v[192:207]
    ds_read_b64_tr_b16 v[82:83], v27 offset:25600
    s_add_u32 m0, s85, 69632
    s_add_u32 s69, s80, 37760
    buffer_load_dwordx4 v4, s[16:19], s69 offen lds
    v_mfma_f32_32x32x16_bf16 v[208:223], v[92:95], v[60:63], v[208:223]
    ds_read_b64_tr_b16 v[84:85], v28 offset:24576
    ds_read_b64_tr_b16 v[86:87], v28 offset:25600
    v_accvgpr_read_b32 v113, a233
    v_accvgpr_read_b32 v114, a234
    v_accvgpr_read_b32 v115, a235
    v_accvgpr_read_b32 v116, a236
    v_mfma_f32_32x32x16_bf16 v[224:239], v[96:99], v[60:63], v[224:239]
    v_accvgpr_read_b32 v117, a237
    v_accvgpr_read_b32 v118, a238
    v_accvgpr_read_b32 v119, a239
    v_cvt_pk_bf16_f32 v120, v104, v105
    v_cvt_pk_bf16_f32 v121, v106, v107
    v_cvt_pk_bf16_f32 v122, v108, v109
    v_cvt_pk_bf16_f32 v123, v110, v111
    v_mfma_f32_32x32x16_bf16 v[240:255], v[100:103], v[60:63], v[240:255]
    s_add_u32 m0, s85, 70656
    s_add_u32 s69, s80, 46976
    buffer_load_dwordx4 v5, s[16:19], s69 offen lds
    s_waitcnt lgkmcnt(0)
    v_mfma_f32_32x32x16_bf16 v[128:143], v[72:75], v[40:43], v[128:143]
    ds_read_b128 v[56:59], v24 offset:32768
    ds_read_b128 v[60:63], v24 offset:49152
    s_add_u32 m0, s85, 71680
    s_add_u32 s69, s80, 56192
    buffer_load_dwordx4 v4, s[16:19], s69 offen lds
    v_mfma_f32_32x32x16_bf16 v[144:159], v[76:79], v[40:43], v[144:159]
    ds_read_b64_tr_b16 v[88:89], v25 offset:28672
    ds_read_b64_tr_b16 v[90:91], v25 offset:29696
    ds_read_b64_tr_b16 v[92:93], v26 offset:28672
    v_cvt_pk_bf16_f32 v124, v112, v113
    v_cvt_pk_bf16_f32 v125, v114, v115
    v_cvt_pk_bf16_f32 v126, v116, v117
    v_cvt_pk_bf16_f32 v127, v118, v119
    v_mfma_f32_32x32x16_bf16 v[160:175], v[80:83], v[40:43], v[160:175]
    s_add_u32 s70, s48, 24576
    buffer_store_dwordx4 v[120:123], v37, s[32:35], s70 offen sc1
    s_add_u32 s70, s49, 24576
    buffer_store_dwordx4 v[124:127], v37, s[32:35], s70 offen sc1
    v_mfma_f32_32x32x16_bf16 v[176:191], v[84:87], v[40:43], v[176:191]
    ds_read_b64_tr_b16 v[94:95], v26 offset:29696
    ds_read_b64_tr_b16 v[96:97], v27 offset:28672
    v_accvgpr_read_b32 v104, a240
    v_accvgpr_read_b32 v105, a241
    v_accvgpr_read_b32 v106, a242
    v_mfma_f32_32x32x16_bf16 v[192:207], v[72:75], v[44:47], v[192:207]
    ds_read_b64_tr_b16 v[98:99], v27 offset:29696
    ds_read_b64_tr_b16 v[100:101], v28 offset:28672
    ds_read_b64_tr_b16 v[102:103], v28 offset:29696
    v_accvgpr_read_b32 v107, a243
    v_accvgpr_read_b32 v108, a244
    v_mfma_f32_32x32x16_bf16 v[208:223], v[76:79], v[44:47], v[208:223]
    v_accvgpr_read_b32 v109, a245
    s_add_u32 m0, s85, 72704
    s_add_u32 s69, s80, 65408
    buffer_load_dwordx4 v5, s[16:19], s69 offen lds
    v_mfma_f32_32x32x16_bf16 v[224:239], v[80:83], v[44:47], v[224:239]
    v_accvgpr_read_b32 v110, a246
    v_accvgpr_read_b32 v111, a247
    v_accvgpr_read_b32 v112, a248
    v_accvgpr_read_b32 v113, a249
    v_accvgpr_read_b32 v114, a250
    v_accvgpr_read_b32 v115, a251
    v_mfma_f32_32x32x16_bf16 v[240:255], v[84:87], v[44:47], v[240:255]
    v_accvgpr_read_b32 v116, a252
    v_accvgpr_read_b32 v117, a253
    v_accvgpr_read_b32 v118, a254
    v_accvgpr_read_b32 v119, a255
    s_waitcnt vmcnt(18) lgkmcnt(0)
    s_barrier
    s_cmp_lg_u32 s68, 0
    s_cbranch_scc1 L_pj_h5
    buffer_load_dword v54, v53, s[60:63], 0 offen sc1
L_pj_h5:
    v_mfma_f32_32x32x16_bf16 v[128:143], v[88:91], v[56:59], v[128:143]
    ds_read_b128 v[40:43], v13 offset:0
    ds_read_b128 v[44:47], v13 offset:16384
    ds_read_b64_tr_b16 v[72:73], v25 offset:32768
    ds_read_b64_tr_b16 v[74:75], v25 offset:33792
    v_cvt_pk_bf16_f32 v120, v104, v105
    v_mfma_f32_32x32x16_bf16 v[144:159], v[92:95], v[56:59], v[144:159]
    v_cvt_pk_bf16_f32 v121, v106, v107
    s_add_u32 m0, s84, 16384
    s_add_u32 s69, s82, 0
    buffer_load_dwordx4 v4, s[24:27], s69 offen lds
    v_mfma_f32_32x32x16_bf16 v[160:175], v[96:99], v[56:59], v[160:175]
    v_cvt_pk_bf16_f32 v122, v108, v109
    s_add_u32 m0, s84, 17408
    s_add_u32 s69, s82, 9216
    buffer_load_dwordx4 v5, s[24:27], s69 offen lds
    v_mfma_f32_32x32x16_bf16 v[176:191], v[100:103], v[56:59], v[176:191]
    ds_read_b64_tr_b16 v[76:77], v26 offset:32768
    ds_read_b64_tr_b16 v[78:79], v26 offset:33792
    ds_read_b64_tr_b16 v[80:81], v27 offset:32768
    v_cvt_pk_bf16_f32 v123, v110, v111
    v_cvt_pk_bf16_f32 v124, v112, v113
    v_mfma_f32_32x32x16_bf16 v[192:207], v[88:91], v[60:63], v[192:207]
    ds_read_b64_tr_b16 v[82:83], v27 offset:33792
    ds_read_b64_tr_b16 v[84:85], v28 offset:32768
    ds_read_b64_tr_b16 v[86:87], v28 offset:33792
    v_cvt_pk_bf16_f32 v125, v114, v115
    v_cvt_pk_bf16_f32 v126, v116, v117
    v_mfma_f32_32x32x16_bf16 v[208:223], v[92:95], v[60:63], v[208:223]
    v_cvt_pk_bf16_f32 v127, v118, v119
    s_add_u32 m0, s84, 18432
    s_add_u32 s69, s82, 18432
    buffer_load_dwordx4 v4, s[24:27], s69 offen lds
    v_mfma_f32_32x32x16_bf16 v[224:239], v[96:99], v[60:63], v[224:239]
    s_add_u32 s70, s50, 24576
    buffer_store_dwordx4 v[120:123], v37, s[32:35], s70 offen sc1
    s_add_u32 s70, s51, 24576
    buffer_store_dwordx4 v[124:127], v37, s[32:35], s70 offen sc1
    v_mfma_f32_32x32x16_bf16 v[240:255], v[100:103], v[60:63], v[240:255]
    s_add_u32 m0, s84, 19456
    s_add_u32 s69, s82, 27648
    buffer_load_dwordx4 v5, s[24:27], s69 offen lds
    s_waitcnt lgkmcnt(0)
    v_mfma_f32_32x32x16_bf16 v[128:143], v[72:75], v[40:43], v[128:143]
    ds_read_b128 v[56:59], v14 offset:0
    ds_read_b128 v[60:63], v14 offset:16384
    v_mfma_f32_32x32x16_bf16 v[144:159], v[76:79], v[40:43], v[144:159]
    ds_read_b64_tr_b16 v[88:89], v25 offset:36864
    ds_read_b64_tr_b16 v[90:91], v25 offset:37888
    ds_read_b64_tr_b16 v[92:93], v26 offset:36864
    v_mfma_f32_32x32x16_bf16 v[160:175], v[80:83], v[40:43], v[160:175]
    s_add_u32 m0, s85, 98304
    s_add_u32 s69, s80, 1024
    buffer_load_dwordx4 v4, s[16:19], s69 offen lds
    v_mfma_f32_32x32x16_bf16 v[176:191], v[84:87], v[40:43], v[176:191]
    ds_read_b64_tr_b16 v[94:95], v26 offset:37888
    ds_read_b64_tr_b16 v[96:97], v27 offset:36864
    v_mfma_f32_32x32x16_bf16 v[192:207], v[72:75], v[44:47], v[192:207]
    s_add_u32 m0, s85, 99328
    s_add_u32 s69, s80, 10240
    buffer_load_dwordx4 v5, s[16:19], s69 offen lds
    v_mfma_f32_32x32x16_bf16 v[208:223], v[76:79], v[44:47], v[208:223]
    ds_read_b64_tr_b16 v[98:99], v27 offset:37888
    ds_read_b64_tr_b16 v[100:101], v28 offset:36864
    ds_read_b64_tr_b16 v[102:103], v28 offset:37888
    v_mfma_f32_32x32x16_bf16 v[224:239], v[80:83], v[44:47], v[224:239]
    s_add_u32 m0, s85, 100352
    s_add_u32 s69, s80, 19456
    buffer_load_dwordx4 v4, s[16:19], s69 offen lds
    v_mfma_f32_32x32x16_bf16 v[240:255], v[84:87], v[44:47], v[240:255]
    s_waitcnt lgkmcnt(0)
    v_mfma_f32_32x32x16_bf16 v[128:143], v[88:91], v[56:59], v[128:143]
    ds_read_b128 v[40:43], v15 offset:0
    ds_read_b128 v[44:47], v15 offset:16384
    ds_read_b64_tr_b16 v[72:73], v25 offset:40960
    ds_read_b64_tr_b16 v[74:75], v25 offset:41984
    v_mfma_f32_32x32x16_bf16 v[144:159], v[92:95], v[56:59], v[144:159]
    s_add_u32 m0, s85, 101376
    s_add_u32 s69, s80, 28672
    buffer_load_dwordx4 v5, s[16:19], s69 offen lds
    v_mfma_f32_32x32x16_bf16 v[160:175], v[96:99], v[56:59], v[160:175]
    ds_read_b64_tr_b16 v[76:77], v26 offset:40960
    ds_read_b64_tr_b16 v[78:79], v26 offset:41984
    ds_read_b64_tr_b16 v[80:81], v27 offset:40960
    v_mfma_f32_32x32x16_bf16 v[176:191], v[100:103], v[56:59], v[176:191]
    s_add_u32 m0, s85, 102400
    s_add_u32 s69, s80, 37888
    buffer_load_dwordx4 v4, s[16:19], s69 offen lds
    v_mfma_f32_32x32x16_bf16 v[192:207], v[88:91], v[60:63], v[192:207]
    ds_read_b64_tr_b16 v[82:83], v27 offset:41984
    ds_read_b64_tr_b16 v[84:85], v28 offset:40960
    ds_read_b64_tr_b16 v[86:87], v28 offset:41984
    v_mfma_f32_32x32x16_bf16 v[208:223], v[92:95], v[60:63], v[208:223]
    v_accvgpr_write_b32 a0, 0
    v_accvgpr_write_b32 a1, 0
    v_accvgpr_write_b32 a2, 0
    v_accvgpr_write_b32 a3, 0
    v_mfma_f32_32x32x16_bf16 v[224:239], v[96:99], v[60:63], v[224:239]
    s_add_u32 m0, s85, 103424
    s_add_u32 s69, s80, 47104
    buffer_load_dwordx4 v5, s[16:19], s69 offen lds
    v_mfma_f32_32x32x16_bf16 v[240:255], v[100:103], v[60:63], v[240:255]
    v_accvgpr_write_b32 a4, 0
    v_accvgpr_write_b32 a5, 0
    v_accvgpr_write_b32 a6, 0
    s_waitcnt lgkmcnt(0)
    v_mfma_f32_32x32x16_bf16 v[128:143], v[72:75], v[40:43], v[128:143]
    ds_read_b128 v[56:59], v16 offset:0
    ds_read_b128 v[60:63], v16 offset:16384
    v_accvgpr_write_b32 a7, 0
    v_accvgpr_write_b32 a8, 0
    v_mfma_f32_32x32x16_bf16 v[144:159], v[76:79], v[40:43], v[144:159]
    ds_read_b64_tr_b16 v[88:89], v25 offset:45056
    ds_read_b64_tr_b16 v[90:91], v25 offset:46080
    ds_read_b64_tr_b16 v[92:93], v26 offset:45056
    v_mfma_f32_32x32x16_bf16 v[160:175], v[80:83], v[40:43], v[160:175]
    s_add_u32 m0, s85, 104448
    s_add_u32 s69, s80, 56320
    buffer_load_dwordx4 v4, s[16:19], s69 offen lds
    v_mfma_f32_32x32x16_bf16 v[176:191], v[84:87], v[40:43], v[176:191]
    ds_read_b64_tr_b16 v[94:95], v26 offset:46080
    ds_read_b64_tr_b16 v[96:97], v27 offset:45056
    ds_read_b64_tr_b16 v[98:99], v27 offset:46080
    v_accvgpr_write_b32 a9, 0
    v_mfma_f32_32x32x16_bf16 v[192:207], v[72:75], v[44:47], v[192:207]
    s_add_u32 m0, s85, 105472
    s_add_u32 s69, s80, 65536
    buffer_load_dwordx4 v5, s[16:19], s69 offen lds
    v_mfma_f32_32x32x16_bf16 v[208:223], v[76:79], v[44:47], v[208:223]
    ds_read_b64_tr_b16 v[100:101], v28 offset:45056
    ds_read_b64_tr_b16 v[102:103], v28 offset:46080
    v_accvgpr_write_b32 a10, 0
    v_accvgpr_write_b32 a11, 0
    v_mfma_f32_32x32x16_bf16 v[224:239], v[80:83], v[44:47], v[224:239]
    v_accvgpr_write_b32 a12, 0
    v_accvgpr_write_b32 a13, 0
    v_accvgpr_write_b32 a14, 0
    v_accvgpr_write_b32 a15, 0
    v_mfma_f32_32x32x16_bf16 v[240:255], v[84:87], v[44:47], v[240:255]
    v_accvgpr_write_b32 a16, 0
    v_accvgpr_write_b32 a17, 0
    s_waitcnt vmcnt(14) lgkmcnt(0)
    s_barrier
    v_mfma_f32_32x32x16_bf16 v[128:143], v[88:91], v[56:59], v[128:143]
    ds_read_b128 v[40:43], v21 offset:0
    s_add_u32 m0, s84, 32768
    s_add_u32 s69, s82, 128
    buffer_load_dwordx4 v4, s[24:27], s69 offen lds
    v_mfma_f32_32x32x16_bf16 v[144:159], v[92:95], v[56:59], v[144:159]
    ds_read_b128 v[44:47], v21 offset:16384
    ds_read_b64_tr_b16 v[72:73], v25 offset:49152
    ds_read_b64_tr_b16 v[74:75], v25 offset:50176
    v_accvgpr_write_b32 a18, 0
    v_accvgpr_write_b32 a19, 0
    v_mfma_f32_32x32x16_bf16 v[160:175], v[96:99], v[56:59], v[160:175]
    ds_read_b64_tr_b16 v[76:77], v26 offset:49152
    s_add_u32 m0, s84, 33792
    s_add_u32 s69, s82, 9344
    buffer_load_dwordx4 v5, s[24:27], s69 offen lds
    v_mfma_f32_32x32x16_bf16 v[176:191], v[100:103], v[56:59], v[176:191]
    ds_read_b64_tr_b16 v[78:79], v26 offset:50176
    ds_read_b64_tr_b16 v[80:81], v27 offset:49152
    v_accvgpr_write_b32 a20, 0
    v_accvgpr_write_b32 a21, 0
    v_accvgpr_write_b32 a22, 0
    v_mfma_f32_32x32x16_bf16 v[192:207], v[88:91], v[60:63], v[192:207]
    ds_read_b64_tr_b16 v[82:83], v27 offset:50176
    ds_read_b64_tr_b16 v[84:85], v28 offset:49152
    v_accvgpr_write_b32 a23, 0
    v_accvgpr_write_b32 a24, 0
    v_accvgpr_write_b32 a25, 0
    v_mfma_f32_32x32x16_bf16 v[208:223], v[92:95], v[60:63], v[208:223]
    ds_read_b64_tr_b16 v[86:87], v28 offset:50176
    s_add_u32 m0, s84, 34816
    s_add_u32 s69, s82, 18560
    buffer_load_dwordx4 v4, s[24:27], s69 offen lds
    v_mfma_f32_32x32x16_bf16 v[224:239], v[96:99], v[60:63], v[224:239]
    v_accvgpr_write_b32 a26, 0
    s_add_u32 m0, s84, 35840
    s_add_u32 s69, s82, 27776
    buffer_load_dwordx4 v5, s[24:27], s69 offen lds
    v_mfma_f32_32x32x16_bf16 v[240:255], v[100:103], v[60:63], v[240:255]
    v_accvgpr_write_b32 a27, 0
    v_accvgpr_write_b32 a28, 0
    v_accvgpr_write_b32 a29, 0
    v_accvgpr_write_b32 a30, 0
    s_waitcnt lgkmcnt(0)
    v_mfma_f32_32x32x16_bf16 v[128:143], v[72:75], v[40:43], v[128:143]
    ds_read_b128 v[56:59], v22 offset:0
    ds_read_b128 v[60:63], v22 offset:16384
    ds_read_b64_tr_b16 v[88:89], v25 offset:53248
    ds_read_b64_tr_b16 v[90:91], v25 offset:54272
    v_mfma_f32_32x32x16_bf16 v[144:159], v[76:79], v[40:43], v[144:159]
    ds_read_b64_tr_b16 v[92:93], v26 offset:53248
    v_accvgpr_write_b32 a31, 0
    v_accvgpr_write_b32 a32, 0
    v_accvgpr_write_b32 a33, 0
    v_accvgpr_write_b32 a34, 0
    v_mfma_f32_32x32x16_bf16 v[160:175], v[80:83], v[40:43], v[160:175]
    s_add_u32 m0, s84, 131072
    s_add_u32 s69, s83, 0
    buffer_load_dwordx4 v8, s[28:31], s69 offen lds
    v_mfma_f32_32x32x16_bf16 v[176:191], v[84:87], v[40:43], v[176:191]
    ds_read_b64_tr_b16 v[94:95], v26 offset:54272
    ds_read_b64_tr_b16 v[96:97], v27 offset:53248
    v_accvgpr_write_b32 a35, 0
    v_accvgpr_write_b32 a36, 0
    v_accvgpr_write_b32 a37, 0
    v_mfma_f32_32x32x16_bf16 v[192:207], v[72:75], v[44:47], v[192:207]
    s_add_u32 m0, s84, 132096
    s_add_u32 s69, s83, 13824
    buffer_load_dwordx4 v8, s[28:31], s69 offen lds
    v_mfma_f32_32x32x16_bf16 v[208:223], v[76:79], v[44:47], v[208:223]
    ds_read_b64_tr_b16 v[98:99], v27 offset:54272
    ds_read_b64_tr_b16 v[100:101], v28 offset:53248
    ds_read_b64_tr_b16 v[102:103], v28 offset:54272
    v_accvgpr_write_b32 a38, 0
    v_mfma_f32_32x32x16_bf16 v[224:239], v[80:83], v[44:47], v[224:239]
    v_accvgpr_write_b32 a39, 0
    s_add_u32 m0, s84, 133120
    s_add_u32 s69, s83, 27648
    buffer_load_dwordx4 v8, s[28:31], s69 offen lds
    v_mfma_f32_32x32x16_bf16 v[240:255], v[84:87], v[44:47], v[240:255]
    v_accvgpr_write_b32 a40, 0
    v_accvgpr_write_b32 a41, 0
    v_accvgpr_write_b32 a42, 0
    v_accvgpr_write_b32 a43, 0
    s_waitcnt lgkmcnt(0)
    v_mfma_f32_32x32x16_bf16 v[128:143], v[88:91], v[56:59], v[128:143]
    ds_read_b128 v[40:43], v23 offset:0
    ds_read_b128 v[44:47], v23 offset:16384
    ds_read_b64_tr_b16 v[72:73], v25 offset:57344
    v_accvgpr_write_b32 a44, 0
    v_mfma_f32_32x32x16_bf16 v[144:159], v[92:95], v[56:59], v[144:159]
    ds_read_b64_tr_b16 v[74:75], v25 offset:58368
    ds_read_b64_tr_b16 v[76:77], v26 offset:57344
    v_accvgpr_write_b32 a45, 0
    v_accvgpr_write_b32 a46, 0
    v_mfma_f32_32x32x16_bf16 v[160:175], v[96:99], v[56:59], v[160:175]
    s_add_u32 m0, s84, 134144
    s_add_u32 s69, s83, 41472
    buffer_load_dwordx4 v8, s[28:31], s69 offen lds
    v_mfma_f32_32x32x16_bf16 v[176:191], v[100:103], v[56:59], v[176:191]
    ds_read_b64_tr_b16 v[78:79], v26 offset:58368
    ds_read_b64_tr_b16 v[80:81], v27 offset:57344
    ds_read_b64_tr_b16 v[82:83], v27 offset:58368
    v_accvgpr_write_b32 a47, 0
    v_mfma_f32_32x32x16_bf16 v[192:207], v[88:91], v[60:63], v[192:207]
    s_add_u32 m0, s84, 147456
    s_add_u32 s69, s83, 221184
    buffer_load_dwordx4 v8, s[28:31], s69 offen lds
    v_mfma_f32_32x32x16_bf16 v[208:223], v[92:95], v[60:63], v[208:223]
    ds_read_b64_tr_b16 v[84:85], v28 offset:57344
    ds_read_b64_tr_b16 v[86:87], v28 offset:58368
    v_accvgpr_write_b32 a48, 0
    v_accvgpr_write_b32 a49, 0
    v_mfma_f32_32x32x16_bf16 v[224:239], v[96:99], v[60:63], v[224:239]
    v_accvgpr_write_b32 a50, 0
    v_accvgpr_write_b32 a51, 0
    v_accvgpr_write_b32 a52, 0
    v_accvgpr_write_b32 a53, 0
    v_accvgpr_write_b32 a54, 0
    v_mfma_f32_32x32x16_bf16 v[240:255], v[100:103], v[60:63], v[240:255]
    s_add_u32 m0, s84, 148480
    s_add_u32 s69, s83, 235008
    buffer_load_dwordx4 v8, s[28:31], s69 offen lds
    s_waitcnt lgkmcnt(0)
    v_mfma_f32_32x32x16_bf16 v[128:143], v[72:75], v[40:43], v[128:143]
    ds_read_b128 v[56:59], v24 offset:0
    ds_read_b128 v[60:63], v24 offset:16384
    v_accvgpr_write_b32 a55, 0
    v_accvgpr_write_b32 a56, 0
    v_mfma_f32_32x32x16_bf16 v[144:159], v[76:79], v[40:43], v[144:159]
    s_add_u32 m0, s84, 149504
    s_add_u32 s69, s83, 248832
    buffer_load_dwordx4 v8, s[28:31], s69 offen lds
    v_mfma_f32_32x32x16_bf16 v[160:175], v[80:83], v[40:43], v[160:175]
    ds_read_b64_tr_b16 v[88:89], v25 offset:61440
    ds_read_b64_tr_b16 v[90:91], v25 offset:62464
    ds_read_b64_tr_b16 v[92:93], v26 offset:61440
    v_accvgpr_write_b32 a57, 0
    v_mfma_f32_32x32x16_bf16 v[176:191], v[84:87], v[40:43], v[176:191]
    ds_read_b64_tr_b16 v[94:95], v26 offset:62464
    ds_read_b64_tr_b16 v[96:97], v27 offset:61440
    v_accvgpr_write_b32 a58, 0
    v_accvgpr_write_b32 a59, 0
    v_mfma_f32_32x32x16_bf16 v[192:207], v[72:75], v[44:47], v[192:207]
    s_add_u32 m0, s84, 150528
    s_add_u32 s69, s83, 262656
    buffer_load_dwordx4 v8, s[28:31], s69 offen lds
    v_mfma_f32_32x32x16_bf16 v[208:223], v[76:79], v[44:47], v[208:223]
    ds_read_b64_tr_b16 v[98:99], v27 offset:62464
    ds_read_b64_tr_b16 v[100:101], v28 offset:61440
    ds_read_b64_tr_b16 v[102:103], v28 offset:62464
    v_accvgpr_write_b32 a60, 0
    v_mfma_f32_32x32x16_bf16 v[224:239], v[80:83], v[44:47], v[224:239]
    v_accvgpr_write_b32 a61, 0
    v_accvgpr_write_b32 a62, 0
    v_accvgpr_write_b32 a63, 0
    v_accvgpr_write_b32 a64, 0
    v_accvgpr_write_b32 a65, 0
    v_accvgpr_write_b32 a66, 0
    v_mfma_f32_32x32x16_bf16 v[240:255], v[84:87], v[44:47], v[240:255]
    v_accvgpr_write_b32 a67, 0
    v_accvgpr_write_b32 a68, 0
    v_accvgpr_write_b32 a69, 0
    s_waitcnt vmcnt(12) lgkmcnt(0)
    s_barrier
    v_mfma_f32_32x32x16_bf16 v[128:143], v[88:91], v[56:59], v[128:143]
    v_accvgpr_write_b32 a70, 0
    s_add_u32 m0, s84, 49152
    s_add_u32 s69, s82, 256
    buffer_load_dwordx4 v4, s[24:27], s69 offen lds
    v_mfma_f32_32x32x16_bf16 v[144:159], v[92:95], v[56:59], v[144:159]
    ds_read_b128 v[40:43], v21 offset:32768
    ds_read_b128 v[44:47], v21 offset:49152
    ds_read_b64_tr_b16 v[72:73], v25 offset:0
    v_accvgpr_write_b32 a71, 0
    v_mfma_f32_32x32x16_bf16 v[160:175], v[96:99], v[56:59], v[160:175]
    v_accvgpr_write_b32 a72, 0
    s_add_u32 m0, s84, 50176
    s_add_u32 s69, s82, 9472
    buffer_load_dwordx4 v5, s[24:27], s69 offen lds
    v_mfma_f32_32x32x16_bf16 v[176:191], v[100:103], v[56:59], v[176:191]
    ds_read_b64_tr_b16 v[74:75], v25 offset:1024
    ds_read_b64_tr_b16 v[76:77], v26 offset:0
    ds_read_b64_tr_b16 v[78:79], v26 offset:1024
    v_accvgpr_write_b32 a73, 0
    v_mfma_f32_32x32x16_bf16 v[192:207], v[88:91], v[60:63], v[192:207]
    ds_read_b64_tr_b16 v[80:81], v27 offset:0
    ds_read_b64_tr_b16 v[82:83], v27 offset:1024
    ds_read_b64_tr_b16 v[84:85], v28 offset:0
    v_accvgpr_write_b32 a74, 0
    v_mfma_f32_32x32x16_bf16 v[208:223], v[92:95], v[60:63], v[208:223]
    ds_read_b64_tr_b16 v[86:87], v28 offset:1024
    s_add_u32 m0, s84, 51200
    s_add_u32 s69, s82, 18688
    buffer_load_dwordx4 v4, s[24:27], s69 offen lds
    v_mfma_f32_32x32x16_bf16 v[224:239], v[96:99], v[60:63], v[224:239]
    v_accvgpr_write_b32 a75, 0
    v_accvgpr_write_b32 a76, 0
    v_accvgpr_write_b32 a77, 0
    v_accvgpr_write_b32 a78, 0
    v_mfma_f32_32x32x16_bf16 v[240:255], v[100:103], v[60:63], v[240:255]
    s_add_u32 m0, s84, 52224
    s_add_u32 s69, s82, 27904
    buffer_load_dwordx4 v5, s[24:27], s69 offen lds
    s_waitcnt lgkmcnt(0)
    v_mfma_f32_32x32x16_bf16 v[128:143], v[72:75], v[40:43], v[128:143]
    ds_read_b128 v[56:59], v22 offset:32768
    ds_read_b128 v[60:63], v22 offset:49152
    v_accvgpr_write_b32 a79, 0
    v_accvgpr_write_b32 a80, 0
    v_mfma_f32_32x32x16_bf16 v[144:159], v[76:79], v[40:43], v[144:159]
    ds_read_b64_tr_b16 v[88:89], v25 offset:4096
    ds_read_b64_tr_b16 v[90:91], v25 offset:5120
    ds_read_b64_tr_b16 v[92:93], v26 offset:4096
    v_accvgpr_write_b32 a81, 0
    v_mfma_f32_32x32x16_bf16 v[160:175], v[80:83], v[40:43], v[160:175]
    s_add_u32 m0, s84, 65536
    s_add_u32 s69, s83, 442368
    buffer_load_dwordx4 v8, s[28:31], s69 offen lds
    v_mfma_f32_32x32x16_bf16 v[176:191], v[84:87], v[40:43], v[176:191]
    ds_read_b64_tr_b16 v[94:95], v26 offset:5120
    ds_read_b64_tr_b16 v[96:97], v27 offset:4096
    ds_read_b64_tr_b16 v[98:99], v27 offset:5120
    v_accvgpr_write_b32 a82, 0
    v_mfma_f32_32x32x16_bf16 v[192:207], v[72:75], v[44:47], v[192:207]
    v_accvgpr_write_b32 a83, 0
    s_add_u32 m0, s84, 66560
    s_add_u32 s69, s83, 456192
    buffer_load_dwordx4 v8, s[28:31], s69 offen lds
    v_mfma_f32_32x32x16_bf16 v[208:223], v[76:79], v[44:47], v[208:223]
    ds_read_b64_tr_b16 v[100:101], v28 offset:4096
    ds_read_b64_tr_b16 v[102:103], v28 offset:5120
    v_accvgpr_write_b32 a84, 0
    v_accvgpr_write_b32 a85, 0
    v_accvgpr_write_b32 a86, 0
    v_mfma_f32_32x32x16_bf16 v[224:239], v[80:83], v[44:47], v[224:239]
    v_accvgpr_write_b32 a87, 0
    v_accvgpr_write_b32 a88, 0
    v_accvgpr_write_b32 a89, 0
    v_accvgpr_write_b32 a90, 0
    v_accvgpr_write_b32 a91, 0
    v_accvgpr_write_b32 a92, 0
    v_mfma_f32_32x32x16_bf16 v[240:255], v[84:87], v[44:47], v[240:255]
    s_add_u32 m0, s84, 67584
    s_add_u32 s69, s83, 470016
    buffer_load_dwordx4 v8, s[28:31], s69 offen lds
    s_waitcnt lgkmcnt(0)
    v_mfma_f32_32x32x16_bf16 v[128:143], v[88:91], v[56:59], v[128:143]
    ds_read_b128 v[40:43], v23 offset:32768
    ds_read_b128 v[44:47], v23 offset:49152
    ds_read_b64_tr_b16 v[72:73], v25 offset:8192
    ds_read_b64_tr_b16 v[74:75], v25 offset:9216
    v_mfma_f32_32x32x16_bf16 v[144:159], v[92:95], v[56:59], v[144:159]
    v_accvgpr_write_b32 a93, 0
    v_accvgpr_write_b32 a94, 0
    v_accvgpr_write_b32 a95, 0
    v_accvgpr_write_b32 a96, 0
    v_accvgpr_write_b32 a97, 0
    v_mfma_f32_32x32x16_bf16 v[160:175], v[96:99], v[56:59], v[160:175]
    s_add_u32 m0, s84, 68608
    s_add_u32 s69, s83, 483840
    buffer_load_dwordx4 v8, s[28:31], s69 offen lds
    v_mfma_f32_32x32x16_bf16 v[176:191], v[100:103], v[56:59], v[176:191]
    ds_read_b64_tr_b16 v[76:77], v26 offset:8192
    ds_read_b64_tr_b16 v[78:79], v26 offset:9216
    ds_read_b64_tr_b16 v[80:81], v27 offset:8192
    v_accvgpr_write_b32 a98, 0
    v_mfma_f32_32x32x16_bf16 v[192:207], v[88:91], v[60:63], v[192:207]
    ds_read_b64_tr_b16 v[82:83], v27 offset:9216
    ds_read_b64_tr_b16 v[84:85], v28 offset:8192
    ds_read_b64_tr_b16 v[86:87], v28 offset:9216
    v_accvgpr_write_b32 a99, 0
    v_mfma_f32_32x32x16_bf16 v[208:223], v[92:95], v[60:63], v[208:223]
    s_add_u32 m0, s84, 81920
    s_add_u32 s69, s83, 663552
    buffer_load_dwordx4 v8, s[28:31], s69 offen lds
    v_mfma_f32_32x32x16_bf16 v[224:239], v[96:99], v[60:63], v[224:239]
    v_accvgpr_write_b32 a100, 0
    v_accvgpr_write_b32 a101, 0
    v_accvgpr_write_b32 a102, 0
    v_accvgpr_write_b32 a103, 0
    v_accvgpr_write_b32 a104, 0
    v_mfma_f32_32x32x16_bf16 v[240:255], v[100:103], v[60:63], v[240:255]
    s_add_u32 m0, s84, 82944
    s_add_u32 s69, s83, 677376
    buffer_load_dwordx4 v8, s[28:31], s69 offen lds
    s_waitcnt lgkmcnt(0)
    v_mfma_f32_32x32x16_bf16 v[128:143], v[72:75], v[40:43], v[128:143]
    ds_read_b128 v[56:59], v24 offset:32768
    ds_read_b128 v[60:63], v24 offset:49152
    ds_read_b64_tr_b16 v[88:89], v25 offset:12288
    v_accvgpr_write_b32 a105, 0
    v_mfma_f32_32x32x16_bf16 v[144:159], v[76:79], v[40:43], v[144:159]
    v_accvgpr_write_b32 a106, 0
    s_add_u32 m0, s84, 83968
    s_add_u32 s69, s83, 691200
    buffer_load_dwordx4 v8, s[28:31], s69 offen lds
    v_mfma_f32_32x32x16_bf16 v[160:175], v[80:83], v[40:43], v[160:175]
    ds_read_b64_tr_b16 v[90:91], v25 offset:13312
    v_accvgpr_write_b32 a107, 0
    v_accvgpr_write_b32 a108, 0
    v_accvgpr_write_b32 a109, 0
    v_accvgpr_write_b32 a110, 0
    v_mfma_f32_32x32x16_bf16 v[176:191], v[84:87], v[40:43], v[176:191]
    ds_read_b64_tr_b16 v[92:93], v26 offset:12288
    ds_read_b64_tr_b16 v[94:95], v26 offset:13312
    ds_read_b64_tr_b16 v[96:97], v27 offset:12288
    ds_read_b64_tr_b16 v[98:99], v27 offset:13312
    v_mfma_f32_32x32x16_bf16 v[192:207], v[72:75], v[44:47], v[192:207]
    s_add_u32 m0, s84, 84992
    s_add_u32 s69, s83, 705024
    buffer_load_dwordx4 v8, s[28:31], s69 offen lds
    v_mfma_f32_32x32x16_bf16 v[208:223], v[76:79], v[44:47], v[208:223]
    ds_read_b64_tr_b16 v[100:101], v28 offset:12288
    ds_read_b64_tr_b16 v[102:103], v28 offset:13312
    v_accvgpr_write_b32 a111, 0
    v_mfma_f32_32x32x16_bf16 v[224:239], v[80:83], v[44:47], v[224:239]
    v_accvgpr_write_b32 a112, 0
    v_accvgpr_write_b32 a113, 0
    v_accvgpr_write_b32 a114, 0
    v_accvgpr_write_b32 a115, 0
    v_mfma_f32_32x32x16_bf16 v[240:255], v[84:87], v[44:47], v[240:255]
    v_accvgpr_write_b32 a116, 0
    v_accvgpr_write_b32 a117, 0
    s_waitcnt vmcnt(0) lgkmcnt(0)
    s_barrier
    s_cmp_lg_u32 s68, 0
    s_cbranch_scc1 L_pj_h7
    s_mov_b32 s64, 0x20000
L_pj_ini:
    s_waitcnt vmcnt(0)
    v_readfirstlane_b32 s65, v54
    s_sub_u32 s64, s64, 1
    s_cmp_ge_u32 s65, 16
    s_cbranch_scc1 L_pj_inid
    s_cmp_eq_u32 s64, 0
    s_cbranch_scc1 L_pj_inid
    s_sleep 8
    buffer_load_dword v54, v53, s[60:63], 0 offen sc1
    s_branch L_pj_ini
L_pj_inid:
    s_mov_b64 exec, 1
    buffer_atomic_add v52, v53, s[32:35], s3 offen sc1
    s_mov_b64 exec, -1
    buffer_load_dword v54, v53, s[32:35], s66 offen sc1
L_pj_h7:
    v_mfma_f32_32x32x16_bf16 v[128:143], v[88:91], v[56:59], v[128:143]
    s_add_u32 m0, s84, 0
    s_add_u32 s69, s82, 384
    buffer_load_dwordx4 v4, s[24:27], s69 offen lds
    v_mfma_f32_32x32x16_bf16 v[144:159], v[92:95], v[56:59], v[144:159]
    ds_read_b128 v[40:43], v29 offset:16384
    ds_read_b128 v[44:47], v29 offset:20480
    v_mfma_f32_32x32x16_bf16 v[160:175], v[96:99], v[56:59], v[160:175]
    s_add_u32 m0, s84, 1024
    s_add_u32 s69, s82, 9600
    buffer_load_dwordx4 v5, s[24:27], s69 offen lds
    v_mfma_f32_32x32x16_bf16 v[176:191], v[100:103], v[56:59], v[176:191]
    ds_read_b64_tr_b16 v[72:73], v35 offset:0
    v_accvgpr_write_b32 a118, 0
    v_accvgpr_write_b32 a119, 0
    v_accvgpr_write_b32 a120, 0
    v_accvgpr_write_b32 a121, 0
    v_mfma_f32_32x32x16_bf16 v[192:207], v[88:91], v[60:63], v[192:207]
    s_add_u32 m0, s84, 2048
    s_add_u32 s69, s82, 18816
    buffer_load_dwordx4 v4, s[24:27], s69 offen lds
    v_mfma_f32_32x32x16_bf16 v[208:223], v[92:95], v[60:63], v[208:223]
    ds_read_b64_tr_b16 v[74:75], v35 offset:1024
    ds_read_b64_tr_b16 v[76:77], v36 offset:0
    ds_read_b64_tr_b16 v[78:79], v36 offset:1024
    v_accvgpr_write_b32 a122, 0
    v_mfma_f32_32x32x16_bf16 v[224:239], v[96:99], v[60:63], v[224:239]
    v_accvgpr_write_b32 a123, 0
    v_accvgpr_write_b32 a124, 0
    v_accvgpr_write_b32 a125, 0
    v_accvgpr_write_b32 a126, 0
    v_accvgpr_write_b32 a127, 0
    v_mfma_f32_32x32x16_bf16 v[240:255], v[100:103], v[60:63], v[240:255]
    s_add_u32 m0, s84, 3072
    s_add_u32 s69, s82, 28032
    buffer_load_dwordx4 v5, s[24:27], s69 offen lds
    s_waitcnt lgkmcnt(0)
    s_lshl_b32 s92, s73, 2
    s_add_u32 s92, s92, s68
    s_getpc_b64 s[94:95]
L_pc_pj3:
    s_add_u32 s94, s94, L_pj_H-L_pc_pj3
    s_addc_u32 s95, s95, 0
    s_mul_i32 s96, s92, ((((L_end_proj_kernel-L_pj_H)>>7)+127)>>7)
    v_min_u32 v50, ((((L_end_proj_kernel-L_pj_H)>>7)+127)>>7)-1, v0
    v_add_u32 v50, s96, v50
    v_min_u32 v50, ((L_end_proj_kernel-L_pj_H)>>7)-1, v50
    v_lshlrev_b32 v50, 7, v50
    global_load_dword v51, v50, s[94:95]
    s_mov_b32 s98, s53
    s_mov_b32 s99, s53
    s_nop 7
    s_nop 3
    v_pk_mul_f32 v[128:129], v[128:129], s[98:99]
    v_pk_mul_f32 v[130:131], v[130:131], s[98:99]
    v_pk_mul_f32 v[132:133], v[132:133], s[98:99]
    v_pk_mul_f32 v[134:135], v[134:135], s[98:99]
    v_pk_mul_f32 v[136:137], v[136:137], s[98:99]
    v_pk_mul_f32 v[138:139], v[138:139], s[98:99]
    v_pk_mul_f32 v[140:141], v[140:141], s[98:99]
    v_pk_mul_f32 v[142:143], v[142:143], s[98:99]
    v_cvt_pk_bf16_f32 v128, v128, v129
    v_cvt_pk_bf16_f32 v129, v130, v131
    v_cvt_pk_bf16_f32 v130, v132, v133
    v_cvt_pk_bf16_f32 v131, v134, v135
    v_cvt_pk_bf16_f32 v132, v136, v137
    v_cvt_pk_bf16_f32 v133, v138, v139
    v_cvt_pk_bf16_f32 v134, v140, v141
    v_cvt_pk_bf16_f32 v135, v142, v143
    v_accvgpr_write_b32 a128, v128
    v_accvgpr_write_b32 a129, v129
    v_accvgpr_write_b32 a130, v130
    v_accvgpr_write_b32 a131, v131
    v_accvgpr_write_b32 a132, v132
    v_accvgpr_write_b32 a133, v133
    v_accvgpr_write_b32 a134, v134
    v_accvgpr_write_b32 a135, v135
    v_pk_mul_f32 v[144:145], v[144:145], s[98:99]
    v_pk_mul_f32 v[146:147], v[146:147], s[98:99]
    v_pk_mul_f32 v[148:149], v[148:149], s[98:99]
    v_pk_mul_f32 v[150:151], v[150:151], s[98:99]
    v_pk_mul_f32 v[152:153], v[152:153], s[98:99]
    v_pk_mul_f32 v[154:155], v[154:155], s[98:99]
    v_pk_mul_f32 v[156:157], v[156:157], s[98:99]
    v_pk_mul_f32 v[158:159], v[158:159], s[98:99]
    v_cvt_pk_bf16_f32 v144, v144, v145
    v_cvt_pk_bf16_f32 v145, v146, v147
    v_cvt_pk_bf16_f32 v146, v148, v149
    v_cvt_pk_bf16_f32 v147, v150, v151
    v_cvt_pk_bf16_f32 v148, v152, v153
    v_cvt_pk_bf16_f32 v149, v154, v155
    v_cvt_pk_bf16_f32 v150, v156, v157
    v_cvt_pk_bf16_f32 v151, v158, v159
    v_accvgpr_write_b32 a136, v144
    v_accvgpr_write_b32 a137, v145
    v_accvgpr_write_b32 a138, v146
    v_accvgpr_write_b32 a139, v147
    v_accvgpr_write_b32 a140, v148
    v_accvgpr_write_b32 a141, v149
    v_accvgpr_write_b32 a142, v150
    v_accvgpr_write_b32 a143, v151
    v_pk_mul_f32 v[160:161], v[160:161], s[98:99]
    v_pk_mul_f32 v[162:163], v[162:163], s[98:99]
    v_pk_mul_f32 v[164:165], v[164:165], s[98:99]
    v_pk_mul_f32 v[166:167], v[166:167], s[98:99]
    v_pk_mul_f32 v[168:169], v[168:169], s[98:99]
    v_pk_mul_f32 v[170:171], v[170:171], s[98:99]
    v_pk_mul_f32 v[172:173], v[172:173], s[98:99]
    v_pk_mul_f32 v[174:175], v[174:175], s[98:99]
    v_cvt_pk_bf16_f32 v160, v160, v161
    v_cvt_pk_bf16_f32 v161, v162, v163
    v_cvt_pk_bf16_f32 v162, v164, v165
    v_cvt_pk_bf16_f32 v163, v166, v167
    v_cvt_pk_bf16_f32 v164, v168, v169
    v_cvt_pk_bf16_f32 v165, v170, v171
    v_cvt_pk_bf16_f32 v166, v172, v173
    v_cvt_pk_bf16_f32 v167, v174, v175
    v_accvgpr_write_b32 a144, v160
    v_accvgpr_write_b32 a145, v161
    v_accvgpr_write_b32 a146, v162
    v_accvgpr_write_b32 a147, v163
    v_accvgpr_write_b32 a148, v164
    v_accvgpr_write_b32 a149, v165
    v_accvgpr_write_b32 a150, v166
    v_accvgpr_write_b32 a151, v167
    v_pk_mul_f32 v[176:177], v[176:177], s[98:99]
    v_pk_mul_f32 v[178:179], v[178:179], s[98:99]
    v_pk_mul_f32 v[180:181], v[180:181], s[98:99]
    v_pk_mul_f32 v[182:183], v[182:183], s[98:99]
    v_pk_mul_f32 v[184:185], v[184:185], s[98:99]
    v_pk_mul_f32 v[186:187], v[186:187], s[98:99]
    v_pk_mul_f32 v[188:189], v[188:189], s[98:99]
    v_pk_mul_f32 v[190:191], v[190:191], s[98:99]
    v_cvt_pk_bf16_f32 v176, v176, v177
    v_cvt_pk_bf16_f32 v177, v178, v179
    v_cvt_pk_bf16_f32 v178, v180, v181
    v_cvt_pk_bf16_f32 v179, v182, v183
    v_cvt_pk_bf16_f32 v180, v184, v185
    v_cvt_pk_bf16_f32 v181, v186, v187
    v_cvt_pk_bf16_f32 v182, v188, v189
    v_cvt_pk_bf16_f32 v183, v190, v191
    v_accvgpr_write_b32 a152, v176
    v_accvgpr_write_b32 a153, v177
    v_accvgpr_write_b32 a154, v178
    v_accvgpr_write_b32 a155, v179
    v_accvgpr_write_b32 a156, v180
    v_accvgpr_write_b32 a157, v181
    v_accvgpr_write_b32 a158, v182
    v_accvgpr_write_b32 a159, v183
    s_cmp_eq_u32 s75, 2
    s_cbranch_scc1 L_pj_BN
    s_cmp_lg_u32 s75, 0
    s_cbranch_scc1 L_pj_BV
    v_mfma_f32_32x32x16_bf16 v[128:143], v[72:75], v[40:43], 0
    ds_read_b128 v[56:59], v30 offset:16384
    v_mul_f32 v192, s53, v192
    v_mul_f32 v193, s53, v193
    v_mul_f32 v194, s53, v194
    v_mul_f32 v195, s53, v195
    s_add_u32 m0, s84, 98304
    s_add_u32 s69, s83, 884736
    buffer_load_dwordx4 v8, s[28:31], s69 offen lds
    v_mfma_f32_32x32x16_bf16 v[144:159], v[76:79], v[40:43], 0
    ds_read_b128 v[60:63], v30 offset:20480
    ds_read_b64_tr_b16 v[88:89], v35 offset:4096
    v_mul_f32 v196, s53, v196
    v_mul_f32 v197, s53, v197
    s_add_u32 m0, s84, 99328
    s_add_u32 s69, s83, 898560
    buffer_load_dwordx4 v8, s[28:31], s69 offen lds
    v_mfma_f32_32x32x16_bf16 v[160:175], v[72:75], v[44:47], 0
    ds_read_b64_tr_b16 v[90:91], v35 offset:5120
    ds_read_b64_tr_b16 v[92:93], v36 offset:4096
    ds_read_b64_tr_b16 v[94:95], v36 offset:5120
    s_add_u32 m0, s84, 100352
    s_add_u32 s69, s83, 912384
    buffer_load_dwordx4 v8, s[28:31], s69 offen lds
    v_mfma_f32_32x32x16_bf16 v[176:191], v[76:79], v[44:47], 0
    v_mul_f32 v198, s53, v198
    v_mul_f32 v199, s53, v199
    v_mul_f32 v200, s53, v200
    v_mul_f32 v201, s53, v201
    v_mul_f32 v202, s53, v202
    v_mul_f32 v203, s53, v203
    v_mul_f32 v204, s53, v204
    v_mul_f32 v205, s53, v205
    s_waitcnt lgkmcnt(0)
    v_mfma_f32_32x32x16_bf16 v[128:143], v[88:91], v[56:59], v[128:143]
    ds_read_b128 v[40:43], v31 offset:16384
    ds_read_b128 v[44:47], v31 offset:20480
    v_mul_f32 v206, s53, v206
    s_add_u32 m0, s84, 101376
    s_add_u32 s69, s83, 926208
    buffer_load_dwordx4 v8, s[28:31], s69 offen lds
    v_mfma_f32_32x32x16_bf16 v[144:159], v[92:95], v[56:59], v[144:159]
    ds_read_b64_tr_b16 v[72:73], v35 offset:8192
    ds_read_b64_tr_b16 v[74:75], v35 offset:9216
    v_mul_f32 v207, s53, v207
    s_add_u32 m0, s84, 114688
    s_add_u32 s69, s83, 1105920
    buffer_load_dwordx4 v8, s[28:31], s69 offen lds
    v_mfma_f32_32x32x16_bf16 v[160:175], v[88:91], v[60:63], v[160:175]
    ds_read_b64_tr_b16 v[76:77], v36 offset:8192
    ds_read_b64_tr_b16 v[78:79], v36 offset:9216
    v_cvt_pk_bf16_f32 v192, v192, v193
    s_add_u32 m0, s84, 115712
    s_add_u32 s69, s83, 1119744
    buffer_load_dwordx4 v8, s[28:31], s69 offen lds
    v_mfma_f32_32x32x16_bf16 v[176:191], v[92:95], v[60:63], v[176:191]
    v_cvt_pk_bf16_f32 v193, v194, v195
    v_cvt_pk_bf16_f32 v194, v196, v197
    v_cvt_pk_bf16_f32 v195, v198, v199
    v_cvt_pk_bf16_f32 v196, v200, v201
    v_cvt_pk_bf16_f32 v197, v202, v203
    v_cvt_pk_bf16_f32 v198, v204, v205
    v_cvt_pk_bf16_f32 v199, v206, v207
    s_waitcnt lgkmcnt(0)
    v_mfma_f32_32x32x16_bf16 v[128:143], v[72:75], v[40:43], v[128:143]
    ds_read_b128 v[56:59], v32 offset:16384
    v_accvgpr_write_b32 a160, v192
    v_accvgpr_write_b32 a161, v193
    s_add_u32 m0, s84, 116736
    s_add_u32 s69, s83, 1133568
    buffer_load_dwordx4 v8, s[28:31], s69 offen lds
    v_mfma_f32_32x32x16_bf16 v[144:159], v[76:79], v[40:43], v[144:159]
    ds_read_b128 v[60:63], v32 offset:20480
    v_accvgpr_write_b32 a162, v194
    v_accvgpr_write_b32 a163, v195
    s_add_u32 m0, s84, 117760
    s_add_u32 s69, s83, 1147392
    buffer_load_dwordx4 v8, s[28:31], s69 offen lds
    v_mfma_f32_32x32x16_bf16 v[160:175], v[72:75], v[44:47], v[160:175]
    ds_read_b64_tr_b16 v[88:89], v35 offset:12288
    ds_read_b64_tr_b16 v[90:91], v35 offset:13312
    ds_read_b64_tr_b16 v[92:93], v36 offset:12288
    ds_read_b64_tr_b16 v[94:95], v36 offset:13312
    v_accvgpr_write_b32 a164, v196
    v_accvgpr_write_b32 a165, v197
    v_mfma_f32_32x32x16_bf16 v[176:191], v[76:79], v[44:47], v[176:191]
    v_accvgpr_write_b32 a166, v198
    v_accvgpr_write_b32 a167, v199
    v_mul_f32 v208, s53, v208
    v_mul_f32 v209, s53, v209
    v_mul_f32 v210, s53, v210
    v_mul_f32 v211, s53, v211
    s_waitcnt vmcnt(24) lgkmcnt(0)
    s_barrier
    v_mfma_f32_32x32x16_bf16 v[128:143], v[88:91], v[56:59], v[128:143]
    v_mul_f32 v212, s53, v212
    v_mul_f32 v213, s53, v213
    v_mul_f32 v214, s53, v214
    s_add_u32 m0, s84, 16384
    s_add_u32 s69, s82, 512
    buffer_load_dwordx4 v4, s[24:27], s69 offen lds
    v_mfma_f32_32x32x16_bf16 v[144:159], v[92:95], v[56:59], v[144:159]
    ds_read_b128 v[40:43], v29 offset:32768
    ds_read_b128 v[44:47], v29 offset:36864
    ds_read_b64_tr_b16 v[72:73], v35 offset:16384
    v_mul_f32 v215, s53, v215
    v_mul_f32 v216, s53, v216
    v_mul_f32 v217, s53, v217
    v_mfma_f32_32x32x16_bf16 v[160:175], v[88:91], v[60:63], v[160:175]
    ds_read_b64_tr_b16 v[74:75], v35 offset:17408
    ds_read_b64_tr_b16 v[76:77], v36 offset:16384
    ds_read_b64_tr_b16 v[78:79], v36 offset:17408
    v_mul_f32 v218, s53, v218
    v_mul_f32 v219, s53, v219
    v_mul_f32 v220, s53, v220
    v_mfma_f32_32x32x16_bf16 v[176:191], v[92:95], v[60:63], v[176:191]
    v_mul_f32 v221, s53, v221
    s_add_u32 m0, s84, 17408
    s_add_u32 s69, s82, 9728
    buffer_load_dwordx4 v5, s[24:27], s69 offen lds
    s_waitcnt lgkmcnt(0)
    v_mfma_f32_32x32x16_bf16 v[128:143], v[72:75], v[40:43], v[128:143]
    ds_read_b128 v[56:59], v30 offset:32768
    ds_read_b128 v[60:63], v30 offset:36864
    v_mul_f32 v222, s53, v222
    v_mul_f32 v223, s53, v223
    v_cvt_pk_bf16_f32 v208, v208, v209
    v_cvt_pk_bf16_f32 v209, v210, v211
    v_cvt_pk_bf16_f32 v210, v212, v213
    v_mfma_f32_32x32x16_bf16 v[144:159], v[76:79], v[40:43], v[144:159]
    ds_read_b64_tr_b16 v[88:89], v35 offset:20480
    ds_read_b64_tr_b16 v[90:91], v35 offset:21504
    v_cvt_pk_bf16_f32 v211, v214, v215
    v_cvt_pk_bf16_f32 v212, v216, v217
    v_cvt_pk_bf16_f32 v213, v218, v219
    v_cvt_pk_bf16_f32 v214, v220, v221
    v_cvt_pk_bf16_f32 v215, v222, v223
    v_mfma_f32_32x32x16_bf16 v[160:175], v[72:75], v[44:47], v[160:175]
    ds_read_b64_tr_b16 v[92:93], v36 offset:20480
    ds_read_b64_tr_b16 v[94:95], v36 offset:21504
    v_accvgpr_write_b32 a168, v208
    v_accvgpr_write_b32 a169, v209
    v_accvgpr_write_b32 a170, v210
    v_accvgpr_write_b32 a171, v211
    v_accvgpr_write_b32 a172, v212
    v_mfma_f32_32x32x16_bf16 v[176:191], v[76:79], v[44:47], v[176:191]
    v_accvgpr_write_b32 a173, v213
    v_accvgpr_write_b32 a174, v214
    s_add_u32 m0, s84, 18432
    s_add_u32 s69, s82, 18944
    buffer_load_dwordx4 v4, s[24:27], s69 offen lds
    s_waitcnt lgkmcnt(0)
    v_mfma_f32_32x32x16_bf16 v[128:143], v[88:91], v[56:59], v[128:143]
    ds_read_b128 v[40:43], v31 offset:32768
    ds_read_b128 v[44:47], v31 offset:36864
    v_accvgpr_write_b32 a175, v215
    v_mul_f32 v224, s53, v224
    v_mul_f32 v225, s53, v225
    v_mul_f32 v226, s53, v226
    v_mul_f32 v227, s53, v227
    v_mfma_f32_32x32x16_bf16 v[144:159], v[92:95], v[56:59], v[144:159]
    ds_read_b64_tr_b16 v[72:73], v35 offset:24576
    ds_read_b64_tr_b16 v[74:75], v35 offset:25600
    v_mul_f32 v228, s53, v228
    v_mul_f32 v229, s53, v229
    v_mul_f32 v230, s53, v230
    v_mul_f32 v231, s53, v231
    v_mul_f32 v232, s53, v232
    v_mfma_f32_32x32x16_bf16 v[160:175], v[88:91], v[60:63], v[160:175]
    ds_read_b64_tr_b16 v[76:77], v36 offset:24576
    ds_read_b64_tr_b16 v[78:79], v36 offset:25600
    v_mul_f32 v233, s53, v233
    v_mul_f32 v234, s53, v234
    v_mul_f32 v235, s53, v235
    v_mul_f32 v236, s53, v236
    v_mul_f32 v237, s53, v237
    v_mfma_f32_32x32x16_bf16 v[176:191], v[92:95], v[60:63], v[176:191]
    v_mul_f32 v238, s53, v238
    v_mul_f32 v239, s53, v239
    s_add_u32 m0, s84, 19456
    s_add_u32 s69, s82, 28160
    buffer_load_dwordx4 v5, s[24:27], s69 offen lds
    s_waitcnt lgkmcnt(0)
    v_mfma_f32_32x32x16_bf16 v[128:143], v[72:75], v[40:43], v[128:143]
    ds_read_b128 v[56:59], v32 offset:32768
    v_cvt_pk_bf16_f32 v224, v224, v225
    v_cvt_pk_bf16_f32 v225, v226, v227
    v_cvt_pk_bf16_f32 v226, v228, v229
    v_cvt_pk_bf16_f32 v227, v230, v231
    v_cvt_pk_bf16_f32 v228, v232, v233
    v_cvt_pk_bf16_f32 v229, v234, v235
    v_cvt_pk_bf16_f32 v230, v236, v237
    v_mfma_f32_32x32x16_bf16 v[144:159], v[76:79], v[40:43], v[144:159]
    ds_read_b128 v[60:63], v32 offset:36864
    ds_read_b64_tr_b16 v[88:89], v35 offset:28672
    ds_read_b64_tr_b16 v[90:91], v35 offset:29696
    ds_read_b64_tr_b16 v[92:93], v36 offset:28672
    ds_read_b64_tr_b16 v[94:95], v36 offset:29696
    v_cvt_pk_bf16_f32 v231, v238, v239
    v_mfma_f32_32x32x16_bf16 v[160:175], v[72:75], v[44:47], v[160:175]
    v_accvgpr_write_b32 a176, v224
    v_accvgpr_write_b32 a177, v225
    v_accvgpr_write_b32 a178, v226
    v_accvgpr_write_b32 a179, v227
    v_accvgpr_write_b32 a180, v228
    v_accvgpr_write_b32 a181, v229
    v_accvgpr_write_b32 a182, v230
    v_accvgpr_write_b32 a183, v231
    v_mfma_f32_32x32x16_bf16 v[176:191], v[76:79], v[44:47], v[176:191]
    v_mul_f32 v240, s53, v240
    v_mul_f32 v241, s53, v241
    v_mul_f32 v242, s53, v242
    v_mul_f32 v243, s53, v243
    v_mul_f32 v244, s53, v244
    v_mul_f32 v245, s53, v245
    s_waitcnt vmcnt(16) lgkmcnt(0)
    s_barrier
    v_mfma_f32_32x32x16_bf16 v[128:143], v[88:91], v[56:59], v[128:143]
    ds_read_b128 v[40:43], v29 offset:49152
    ds_read_b128 v[44:47], v29 offset:53248
    s_add_u32 m0, s84, 32768
    s_add_u32 s69, s82, 640
    buffer_load_dwordx4 v4, s[24:27], s69 offen lds
    v_mfma_f32_32x32x16_bf16 v[144:159], v[92:95], v[56:59], v[144:159]
    ds_read_b64_tr_b16 v[72:73], v33 offset:0
    ds_read_b64_tr_b16 v[74:75], v33 offset:1024
    s_add_u32 m0, s84, 33792
    s_add_u32 s69, s82, 9856
    buffer_load_dwordx4 v5, s[24:27], s69 offen lds
    v_mfma_f32_32x32x16_bf16 v[160:175], v[88:91], v[60:63], v[160:175]
    ds_read_b64_tr_b16 v[76:77], v34 offset:0
    ds_read_b64_tr_b16 v[78:79], v34 offset:1024
    s_add_u32 m0, s84, 34816
    s_add_u32 s69, s82, 19072
    buffer_load_dwordx4 v4, s[24:27], s69 offen lds
    v_mfma_f32_32x32x16_bf16 v[176:191], v[92:95], v[60:63], v[176:191]
    v_mul_f32 v246, s53, v246
    v_mul_f32 v247, s53, v247
    s_add_u32 m0, s84, 35840
    s_add_u32 s69, s82, 28288
    buffer_load_dwordx4 v5, s[24:27], s69 offen lds
    s_waitcnt lgkmcnt(0)
    v_mfma_f32_32x32x16_bf16 v[128:143], v[72:75], v[40:43], v[128:143]
    ds_read_b128 v[56:59], v30 offset:49152
    ds_read_b128 v[60:63], v30 offset:53248
    ds_read_b64_tr_b16 v[88:89], v33 offset:4096
    v_mul_f32 v248, s53, v248
    v_mul_f32 v249, s53, v249
    v_mul_f32 v250, s53, v250
    v_mul_f32 v251, s53, v251
    v_mfma_f32_32x32x16_bf16 v[144:159], v[76:79], v[40:43], v[144:159]
    ds_read_b64_tr_b16 v[90:91], v33 offset:5120
    ds_read_b64_tr_b16 v[92:93], v34 offset:4096
    v_mul_f32 v252, s53, v252
    s_add_u32 m0, s84, 131072
    s_add_u32 s69, s83, 1327104
    buffer_load_dwordx4 v8, s[28:31], s69 offen lds
    v_mfma_f32_32x32x16_bf16 v[160:175], v[72:75], v[44:47], v[160:175]
    ds_read_b64_tr_b16 v[94:95], v34 offset:5120
    v_mul_f32 v253, s53, v253
    v_mul_f32 v254, s53, v254
    s_add_u32 m0, s84, 132096
    s_add_u32 s69, s83, 1340928
    buffer_load_dwordx4 v8, s[28:31], s69 offen lds
    v_mfma_f32_32x32x16_bf16 v[176:191], v[76:79], v[44:47], v[176:191]
    v_mul_f32 v255, s53, v255
    v_cvt_pk_bf16_f32 v240, v240, v241
    v_cvt_pk_bf16_f32 v241, v242, v243
    s_add_u32 m0, s84, 133120
    s_add_u32 s69, s83, 1354752
    buffer_load_dwordx4 v8, s[28:31], s69 offen lds
    s_waitcnt lgkmcnt(0)
    v_mfma_f32_32x32x16_bf16 v[128:143], v[88:91], v[56:59], v[128:143]
    ds_read_b128 v[40:43], v31 offset:49152
    ds_read_b128 v[44:47], v31 offset:53248
    ds_read_b64_tr_b16 v[72:73], v33 offset:8192
    s_add_u32 m0, s84, 134144
    s_add_u32 s69, s83, 1368576
    buffer_load_dwordx4 v8, s[28:31], s69 offen lds
    v_mfma_f32_32x32x16_bf16 v[144:159], v[92:95], v[56:59], v[144:159]
    ds_read_b64_tr_b16 v[74:75], v33 offset:9216
    v_cvt_pk_bf16_f32 v242, v244, v245
    v_cvt_pk_bf16_f32 v243, v246, v247
    v_cvt_pk_bf16_f32 v244, v248, v249
    v_cvt_pk_bf16_f32 v245, v250, v251
    v_cvt_pk_bf16_f32 v246, v252, v253
    v_cvt_pk_bf16_f32 v247, v254, v255
    v_accvgpr_write_b32 a184, v240
    v_mfma_f32_32x32x16_bf16 v[160:175], v[88:91], v[60:63], v[160:175]
    ds_read_b64_tr_b16 v[76:77], v34 offset:8192
    ds_read_b64_tr_b16 v[78:79], v34 offset:9216
    s_add_u32 m0, s84, 147456
    s_add_u32 s69, s83, 1548288
    buffer_load_dwordx4 v8, s[28:31], s69 offen lds
    v_mfma_f32_32x32x16_bf16 v[176:191], v[92:95], v[60:63], v[176:191]
    v_accvgpr_write_b32 a185, v241
    v_accvgpr_write_b32 a186, v242
    v_accvgpr_write_b32 a187, v243
    s_add_u32 m0, s84, 148480
    s_add_u32 s69, s83, 1562112
    buffer_load_dwordx4 v8, s[28:31], s69 offen lds
    s_waitcnt lgkmcnt(0)
    v_mfma_f32_32x32x16_bf16 v[128:143], v[72:75], v[40:43], v[128:143]
    v_accvgpr_write_b32 a188, v244
    v_accvgpr_write_b32 a189, v245
    v_accvgpr_write_b32 a190, v246
    v_accvgpr_write_b32 a191, v247
    s_add_u32 m0, s84, 149504
    s_add_u32 s69, s83, 1575936
    buffer_load_dwordx4 v8, s[28:31], s69 offen lds
    v_mfma_f32_32x32x16_bf16 v[144:159], v[76:79], v[40:43], v[144:159]
    ds_read_b128 v[56:59], v32 offset:49152
    s_add_u32 m0, s84, 150528
    s_add_u32 s69, s83, 1589760
    buffer_load_dwordx4 v8, s[28:31], s69 offen lds
    v_mfma_f32_32x32x16_bf16 v[160:175], v[72:75], v[44:47], v[160:175]
    ds_read_b128 v[60:63], v32 offset:53248
    ds_read_b64_tr_b16 v[88:89], v33 offset:12288
    ds_read_b64_tr_b16 v[90:91], v33 offset:13312
    ds_read_b64_tr_b16 v[92:93], v34 offset:12288
    ds_read_b64_tr_b16 v[94:95], v34 offset:13312
    v_mfma_f32_32x32x16_bf16 v[176:191], v[76:79], v[44:47], v[176:191]
    s_waitcnt vmcnt(24) lgkmcnt(0)
    s_barrier
    s_cmp_lg_u32 s68, 0
    s_cbranch_scc1 L_pj_ta0
    s_cmp_lg_u32 s67, 0
    s_cbranch_scc1 L_pj_ta0
    v_readfirstlane_b32 s65, v54
    s_nop 0
    s_cmp_ge_u32 s65, 16
    s_cbranch_scc0 L_pj_ta0_again
    buffer_inv sc1
    s_mov_b32 s67, 1
    s_branch L_pj_ta0
L_pj_ta0_again:
    buffer_load_dword v54, v53, s[32:35], s66 offen sc1
L_pj_ta0:
    v_mfma_f32_32x32x16_bf16 v[128:143], v[88:91], v[56:59], v[128:143]
    ds_read_b128 v[40:43], v29 offset:0
    s_add_u32 m0, s84, 49152
    s_add_u32 s69, s82, 768
    buffer_load_dwordx4 v4, s[24:27], s69 offen lds
    v_mfma_f32_32x32x16_bf16 v[144:159], v[92:95], v[56:59], v[144:159]
    ds_read_b128 v[44:47], v29 offset:4096
    ds_read_b64_tr_b16 v[72:73], v33 offset:16384
    v_mov_b32 v226, 0x3f803f80
    v_mov_b32 v227, 0x3f803f80
    v_mov_b32 v228, 0x3f803f80
    v_mov_b32 v229, 0x3f803f80
    v_mfma_f32_32x32x16_bf16 v[160:175], v[88:91], v[60:63], v[160:175]
    ds_read_b64_tr_b16 v[74:75], v33 offset:17408
    ds_read_b64_tr_b16 v[76:77], v34 offset:16384
    ds_read_b64_tr_b16 v[78:79], v34 offset:17408
    s_mov_b32 s4, 0
    s_mov_b32 s5, 0
    v_mfma_f32_32x32x16_bf16 v[176:191], v[92:95], v[60:63], v[176:191]
    s_add_u32 m0, s84, 50176
    s_add_u32 s69, s82, 9984
    buffer_load_dwordx4 v5, s[24:27], s69 offen lds
    s_waitcnt lgkmcnt(0)
    v_mfma_f32_32x32x16_bf16 v[128:143], v[72:75], v[40:43], v[128:143]
    ds_read_b128 v[56:59], v30 offset:0
    ds_read_b128 v[60:63], v30 offset:4096
    ds_read_b64_tr_b16 v[88:89], v33 offset:20480
    s_mov_b32 s6, 0
    v_mfma_f32_32x32x16_bf16 v[144:159], v[76:79], v[40:43], v[144:159]
    s_mov_b32 s7, 0
    v_mov_b32 v224, 0xf0000000
    v_mov_b32 v225, 0xf0000000
    s_lshl_b32 s97, s54, 7
    s_lshl_b32 s92, s77, 6
    v_mfma_f32_32x32x16_bf16 v[160:175], v[72:75], v[44:47], v[160:175]
    ds_read_b64_tr_b16 v[90:91], v33 offset:21504
    ds_read_b64_tr_b16 v[92:93], v34 offset:20480
    ds_read_b64_tr_b16 v[94:95], v34 offset:21504
    s_add_u32 s97, s97, s92
    v_mfma_f32_32x32x16_bf16 v[176:191], v[76:79], v[44:47], v[176:191]
    s_cmp_ge_u32 s97, 576
    s_cselect_b32 s96, 1, 0
    s_mov_b32 s57, 0x3eae1a93
    s_cselect_b32 s57, 0x3f800000, s57
    s_cselect_b32 s92, 576, 0
    s_sub_u32 s97, s97, s92
    s_waitcnt lgkmcnt(0)
    v_mfma_f32_32x32x16_bf16 v[128:143], v[88:91], v[56:59], v[128:143]
    ds_read_b128 v[40:43], v31 offset:0
    s_add_u32 m0, s84, 51200
    s_add_u32 s69, s82, 19200
    buffer_load_dwordx4 v4, s[24:27], s69 offen lds
    v_mfma_f32_32x32x16_bf16 v[144:159], v[92:95], v[56:59], v[144:159]
    ds_read_b128 v[44:47], v31 offset:4096
    ds_read_b64_tr_b16 v[72:73], v33 offset:24576
    v_and_b32 v118, 31, v0
    v_lshlrev_b32 v119, 1, v118
    v_add_u32 v119, s97, v119
    v_mfma_f32_32x32x16_bf16 v[160:175], v[88:91], v[60:63], v[160:175]
    ds_read_b64_tr_b16 v[74:75], v33 offset:25600
    ds_read_b64_tr_b16 v[76:77], v34 offset:24576
    ds_read_b64_tr_b16 v[78:79], v34 offset:25600
    v_mul_u32_u24 v104, 3641, v119
    v_lshrrev_b32 v104, 16, v104
    v_mfma_f32_32x32x16_bf16 v[176:191], v[92:95], v[60:63], v[176:191]
    s_add_u32 m0, s84, 52224
    s_add_u32 s69, s82, 28416
    buffer_load_dwordx4 v5, s[24:27], s69 offen lds
    s_waitcnt lgkmcnt(0)
    v_mfma_f32_32x32x16_bf16 v[128:143], v[72:75], v[40:43], v[128:143]
    ds_read_b128 v[56:59], v32 offset:0
    v_mul_u32_u24 v105, 18, v104
    v_sub_u32 v105, v119, v105
    v_lshrrev_b32 v106, 2, v105
    v_and_b32 v106, 1, v106
    v_mfma_f32_32x32x16_bf16 v[144:159], v[76:79], v[40:43], v[144:159]
    ds_read_b128 v[60:63], v32 offset:4096
    ds_read_b64_tr_b16 v[88:89], v33 offset:28672
    v_lshlrev_b32 v106, 9, v106
    v_and_b32 v107, 3, v105
    v_mfma_f32_32x32x16_bf16 v[160:175], v[72:75], v[44:47], v[160:175]
    ds_read_b64_tr_b16 v[90:91], v33 offset:29696
    ds_read_b64_tr_b16 v[92:93], v34 offset:28672
    ds_read_b64_tr_b16 v[94:95], v34 offset:29696
    v_lshrrev_b32 v107, 1, v107
    v_mfma_f32_32x32x16_bf16 v[176:191], v[76:79], v[44:47], v[176:191]
    v_lshrrev_b32 v108, 3, v105
    v_lshl_add_u32 v107, v108, 1, v107
    v_lshl_add_u32 v106, v107, 2, v106
    s_waitcnt vmcnt(16) lgkmcnt(0)
    s_barrier
    v_mfma_f32_32x32x16_bf16 v[128:143], v[88:91], v[56:59], v[128:143]
    ds_read_b128 v[40:43], v29 offset:16384
    ds_read_b128 v[44:47], v29 offset:20480
    s_add_u32 m0, s84, 0
    s_add_u32 s69, s82, 896
    buffer_load_dwordx4 v4, s[24:27], s69 offen lds
    v_mfma_f32_32x32x16_bf16 v[144:159], v[92:95], v[56:59], v[144:159]
    ds_read_b64_tr_b16 v[72:73], v33 offset:32768
    ds_read_b64_tr_b16 v[74:75], v33 offset:33792
    s_cmp_eq_u32 s96, 0
    s_mov_b32 s92, 151552
    s_cselect_b32 s92, 65536, s92
    s_mov_b32 s93, 151552
    s_cselect_b32 s93, 8192, s93
    v_mfma_f32_32x32x16_bf16 v[160:175], v[88:91], v[60:63], v[160:175]
    ds_read_b64_tr_b16 v[76:77], v34 offset:32768
    ds_read_b64_tr_b16 v[78:79], v34 offset:33792
    s_add_u32 m0, s84, 1024
    s_add_u32 s69, s82, 10112
    buffer_load_dwordx4 v5, s[24:27], s69 offen lds
    v_mfma_f32_32x32x16_bf16 v[176:191], v[92:95], v[60:63], v[176:191]
    v_mul_lo_u32 v107, v104, s92
    v_add_u32 v106, v106, v107
    s_add_u32 m0, s84, 2048
    s_add_u32 s69, s82, 19328
    buffer_load_dwordx4 v4, s[24:27], s69 offen lds
    s_waitcnt lgkmcnt(0)
    v_mfma_f32_32x32x16_bf16 v[128:143], v[72:75], v[40:43], v[128:143]
    ds_read_b128 v[56:59], v30 offset:16384
    v_mul_lo_u32 v107, v104, s93
    v_or_b32 v107, 0x80000000, v107
    v_cmp_eq_u32 vcc, 16, v105
    s_nop 1
    v_cndmask_b32 v112, v106, v107, vcc
    s_lshl_b32 s92, s55, 2
    v_mfma_f32_32x32x16_bf16 v[144:159], v[76:79], v[40:43], v[144:159]
    ds_read_b128 v[60:63], v30 offset:20480
    ds_read_b64_tr_b16 v[88:89], v33 offset:36864
    s_add_u32 m0, s84, 3072
    s_add_u32 s69, s82, 28544
    buffer_load_dwordx4 v5, s[24:27], s69 offen lds
    v_mfma_f32_32x32x16_bf16 v[160:175], v[72:75], v[44:47], v[160:175]
    ds_read_b64_tr_b16 v[90:91], v33 offset:37888
    ds_read_b64_tr_b16 v[92:93], v34 offset:36864
    ds_read_b64_tr_b16 v[94:95], v34 offset:37888
    s_lshl_b32 s93, s76, 1
    s_add_u32 s92, s92, s93
    s_add_u32 s92, s92, 0
    v_mfma_f32_32x32x16_bf16 v[176:191], v[76:79], v[44:47], v[176:191]
    s_lshr_b32 s95, s92, 3
    s_add_u32 m0, s84, 65536
    s_add_u32 s69, s83, 1769472
    buffer_load_dwordx4 v8, s[28:31], s69 offen lds
    s_waitcnt lgkmcnt(0)
    v_mfma_f32_32x32x16_bf16 v[128:143], v[88:91], v[56:59], v[128:143]
    ds_read_b128 v[40:43], v31 offset:16384
    ds_read_b128 v[44:47], v31 offset:20480
    ds_read_b64_tr_b16 v[72:73], v33 offset:40960
    s_mul_i32 s95, s95, 18944
    s_add_u32 s95, s95, 79691776
    v_mfma_f32_32x32x16_bf16 v[144:159], v[92:95], v[56:59], v[144:159]
    s_and_b32 s93, s92, 7
    s_lshl_b32 s93, s93, 10
    s_add_u32 m0, s84, 66560
    s_add_u32 s69, s83, 1783296
    buffer_load_dwordx4 v8, s[28:31], s69 offen lds
    v_mfma_f32_32x32x16_bf16 v[160:175], v[88:91], v[60:63], v[160:175]
    ds_read_b64_tr_b16 v[74:75], v33 offset:41984
    ds_read_b64_tr_b16 v[76:77], v34 offset:40960
    ds_read_b64_tr_b16 v[78:79], v34 offset:41984
    s_add_u32 s93, s93, s95
    s_and_b32 s94, s92, 4
    v_mfma_f32_32x32x16_bf16 v[176:191], v[92:95], v[60:63], v[176:191]
    s_add_u32 m0, s84, 67584
    s_add_u32 s69, s83, 1797120
    buffer_load_dwordx4 v8, s[28:31], s69 offen lds
    s_waitcnt lgkmcnt(0)
    v_mfma_f32_32x32x16_bf16 v[128:143], v[72:75], v[40:43], v[128:143]
    ds_read_b128 v[56:59], v32 offset:16384
    ds_read_b128 v[60:63], v32 offset:20480
    ds_read_b64_tr_b16 v[88:89], v33 offset:45056
    s_lshl_b32 s94, s94, 7
    s_add_u32 s95, s95, s94
    v_mfma_f32_32x32x16_bf16 v[144:159], v[76:79], v[40:43], v[144:159]
    ds_read_b64_tr_b16 v[90:91], v33 offset:46080
    s_add_u32 m0, s84, 68608
    s_add_u32 s69, s83, 1810944
    buffer_load_dwordx4 v8, s[28:31], s69 offen lds
    v_mfma_f32_32x32x16_bf16 v[160:175], v[72:75], v[44:47], v[160:175]
    ds_read_b64_tr_b16 v[92:93], v34 offset:45056
    ds_read_b64_tr_b16 v[94:95], v34 offset:46080
    s_add_u32 s95, s95, 8192
    s_and_b32 s94, s92, 3
    s_lshl_b32 s94, s94, 2
    s_add_u32 s95, s95, s94
    v_mfma_f32_32x32x16_bf16 v[176:191], v[76:79], v[44:47], v[176:191]
    s_lshl_b32 s94, s92, 10
    s_add_u32 s94, s94, 75497472
    s_lshl_b32 s92, s92, 7
    s_add_u32 s92, s92, 78643200
    s_waitcnt vmcnt(20) lgkmcnt(0)
    s_barrier
    v_mfma_f32_32x32x16_bf16 v[128:143], v[88:91], v[56:59], v[128:143]
    ds_read_b128 v[40:43], v29 offset:32768
    ds_read_b128 v[44:47], v29 offset:36864
    s_cmp_eq_u32 s96, 0
    s_cselect_b32 s93, s94, s93
    s_cselect_b32 s95, s92, s95
    s_cselect_b32 s92, 2, 4
    v_mfma_f32_32x32x16_bf16 v[144:159], v[92:95], v[56:59], v[144:159]
    ds_read_b64_tr_b16 v[72:73], v33 offset:49152
    s_add_u32 m0, s84, 16384
    s_add_u32 s69, s82, 1024
    buffer_load_dwordx4 v4, s[24:27], s69 offen lds
    v_mfma_f32_32x32x16_bf16 v[160:175], v[88:91], v[60:63], v[160:175]
    ds_read_b64_tr_b16 v[74:75], v33 offset:50176
    ds_read_b64_tr_b16 v[76:77], v34 offset:49152
    ds_read_b64_tr_b16 v[78:79], v34 offset:50176
    v_and_b32 v118, 31, v0
    v_lshlrev_b32 v113, 4, v118
    v_mfma_f32_32x32x16_bf16 v[176:191], v[92:95], v[60:63], v[176:191]
    s_add_u32 m0, s84, 17408
    s_add_u32 s69, s82, 10240
    buffer_load_dwordx4 v5, s[24:27], s69 offen lds
    s_waitcnt lgkmcnt(0)
    v_mfma_f32_32x32x16_bf16 v[128:143], v[72:75], v[40:43], v[128:143]
    ds_read_b128 v[56:59], v30 offset:32768
    ds_read_b128 v[60:63], v30 offset:36864
    v_add_u32 v113, s93, v113
    v_lshlrev_b32 v115, s92, v118
    v_add_u32 v115, s95, v115
    v_mfma_f32_32x32x16_bf16 v[144:159], v[76:79], v[40:43], v[144:159]
    ds_read_b64_tr_b16 v[88:89], v33 offset:53248
    ds_read_b64_tr_b16 v[90:91], v33 offset:54272
    ds_read_b64_tr_b16 v[92:93], v34 offset:53248
    s_lshl_b32 s92, s55, 2
    s_lshl_b32 s93, s76, 1
    v_mfma_f32_32x32x16_bf16 v[160:175], v[72:75], v[44:47], v[160:175]
    ds_read_b64_tr_b16 v[94:95], v34 offset:54272
    s_add_u32 s92, s92, s93
    s_add_u32 s92, s92, 1
    s_lshr_b32 s95, s92, 3
    s_mul_i32 s95, s95, 18944
    s_add_u32 s95, s95, 79691776
    v_mfma_f32_32x32x16_bf16 v[176:191], v[76:79], v[44:47], v[176:191]
    s_add_u32 m0, s84, 18432
    s_add_u32 s69, s82, 19456
    buffer_load_dwordx4 v4, s[24:27], s69 offen lds
    s_waitcnt lgkmcnt(0)
    v_mfma_f32_32x32x16_bf16 v[128:143], v[88:91], v[56:59], v[128:143]
    ds_read_b128 v[40:43], v31 offset:32768
    ds_read_b128 v[44:47], v31 offset:36864
    ds_read_b64_tr_b16 v[72:73], v33 offset:57344
    s_and_b32 s93, s92, 7
    v_mfma_f32_32x32x16_bf16 v[144:159], v[92:95], v[56:59], v[144:159]
    ds_read_b64_tr_b16 v[74:75], v33 offset:58368
    ds_read_b64_tr_b16 v[76:77], v34 offset:57344
    s_lshl_b32 s93, s93, 10
    s_add_u32 s93, s93, s95
    v_mfma_f32_32x32x16_bf16 v[160:175], v[88:91], v[60:63], v[160:175]
    ds_read_b64_tr_b16 v[78:79], v34 offset:58368
    s_and_b32 s94, s92, 4
    s_lshl_b32 s94, s94, 7
    s_add_u32 s95, s95, s94
    v_mfma_f32_32x32x16_bf16 v[176:191], v[92:95], v[60:63], v[176:191]
    s_add_u32 m0, s84, 19456
    s_add_u32 s69, s82, 28672
    buffer_load_dwordx4 v5, s[24:27], s69 offen lds
    s_waitcnt lgkmcnt(0)
    v_mfma_f32_32x32x16_bf16 v[128:143], v[72:75], v[40:43], v[128:143]
    ds_read_b128 v[56:59], v32 offset:32768
    ds_read_b128 v[60:63], v32 offset:36864
    ds_read_b64_tr_b16 v[88:89], v33 offset:61440
    v_mfma_f32_32x32x16_bf16 v[144:159], v[76:79], v[40:43], v[144:159]
    ds_read_b64_tr_b16 v[90:91], v33 offset:62464
    s_add_u32 s95, s95, 8192
    s_and_b32 s94, s92, 3
    s_lshl_b32 s94, s94, 2
    s_add_u32 s95, s95, s94
    v_mfma_f32_32x32x16_bf16 v[160:175], v[72:75], v[44:47], v[160:175]
    ds_read_b64_tr_b16 v[92:93], v34 offset:61440
    ds_read_b64_tr_b16 v[94:95], v34 offset:62464
    s_lshl_b32 s94, s92, 10
    v_mfma_f32_32x32x16_bf16 v[176:191], v[76:79], v[44:47], v[176:191]
    s_add_u32 s94, s94, 75497472
    s_lshl_b32 s92, s92, 7
    s_add_u32 s92, s92, 78643200
    s_waitcnt vmcnt(12) lgkmcnt(0)
    s_barrier
    s_cmp_lg_u32 s68, 0
    s_cbranch_scc1 L_pj_tb0
    s_cmp_lg_u32 s67, 0
    s_cbranch_scc1 L_pj_tb0
    v_readfirstlane_b32 s65, v54
    s_nop 0
    s_cmp_ge_u32 s65, 16
    s_cbranch_scc0 L_pj_tb0_again
    buffer_inv sc1
    s_mov_b32 s67, 1
    s_branch L_pj_tb0
L_pj_tb0_again:
    buffer_load_dword v54, v53, s[32:35], s66 offen sc1
L_pj_tb0:
    v_mfma_f32_32x32x16_bf16 v[128:143], v[88:91], v[56:59], v[128:143]
    ds_read_b128 v[40:43], v29 offset:49152
    s_cmp_eq_u32 s96, 0
    s_cselect_b32 s93, s94, s93
    s_cselect_b32 s95, s92, s95
    s_cselect_b32 s92, 2, 4
    v_mfma_f32_32x32x16_bf16 v[144:159], v[92:95], v[56:59], v[144:159]
    ds_read_b128 v[44:47], v29 offset:53248
    ds_read_b64_tr_b16 v[72:73], v35 offset:0
    ds_read_b64_tr_b16 v[74:75], v35 offset:1024
    v_mfma_f32_32x32x16_bf16 v[160:175], v[88:91], v[60:63], v[160:175]
    ds_read_b64_tr_b16 v[76:77], v36 offset:0
    ds_read_b64_tr_b16 v[78:79], v36 offset:1024
    v_and_b32 v118, 31, v0
    v_mfma_f32_32x32x16_bf16 v[176:191], v[92:95], v[60:63], v[176:191]
    v_lshlrev_b32 v114, 4, v118
    v_add_u32 v114, s93, v114
    v_lshlrev_b32 v116, s92, v118
    v_add_u32 v116, s95, v116
    s_waitcnt lgkmcnt(0)
    v_mfma_f32_32x32x16_bf16 v[128:143], v[72:75], v[40:43], v[128:143]
    ds_read_b128 v[56:59], v30 offset:49152
    ds_read_b128 v[60:63], v30 offset:53248
    ds_read_b64_tr_b16 v[88:89], v35 offset:4096
    v_mfma_f32_32x32x16_bf16 v[144:159], v[76:79], v[40:43], v[144:159]
    ds_read_b64_tr_b16 v[90:91], v35 offset:5120
    v_lshrrev_b32 v117, 5, v0
    v_lshlrev_b32 v117, 3, v117
    v_add_u32 v118, 0, v117
    v_mfma_f32_32x32x16_bf16 v[160:175], v[72:75], v[44:47], v[160:175]
    ds_read_b64_tr_b16 v[92:93], v36 offset:4096
    ds_read_b64_tr_b16 v[94:95], v36 offset:5120
    ds_bpermute_b32 v120, v118, v112
    v_mfma_f32_32x32x16_bf16 v[176:191], v[76:79], v[44:47], v[176:191]
    v_add_u32 v118, 4, v117
    ds_bpermute_b32 v121, v118, v112
    v_add_u32 v118, 16, v117
    s_waitcnt lgkmcnt(0)
    v_mfma_f32_32x32x16_bf16 v[128:143], v[88:91], v[56:59], v[128:143]
    ds_read_b128 v[40:43], v31 offset:49152
    ds_read_b128 v[44:47], v31 offset:53248
    ds_bpermute_b32 v122, v118, v112
    v_mfma_f32_32x32x16_bf16 v[144:159], v[92:95], v[56:59], v[144:159]
    ds_read_b64_tr_b16 v[72:73], v35 offset:8192
    ds_read_b64_tr_b16 v[74:75], v35 offset:9216
    ds_read_b64_tr_b16 v[76:77], v36 offset:8192
    v_mfma_f32_32x32x16_bf16 v[160:175], v[88:91], v[60:63], v[160:175]
    ds_read_b64_tr_b16 v[78:79], v36 offset:9216
    v_add_u32 v118, 20, v117
    ds_bpermute_b32 v123, v118, v112
    v_mfma_f32_32x32x16_bf16 v[176:191], v[92:95], v[60:63], v[176:191]
    v_add_u32 v118, 32, v117
    ds_bpermute_b32 v124, v118, v112
    v_add_u32 v118, 36, v117
    s_waitcnt lgkmcnt(0)
    v_mfma_f32_32x32x16_bf16 v[128:143], v[72:75], v[40:43], v[128:143]
    ds_bpermute_b32 v125, v118, v112
    v_add_u32 v118, 48, v117
    ds_bpermute_b32 v126, v118, v112
    v_add_u32 v118, 52, v117
    v_mfma_f32_32x32x16_bf16 v[144:159], v[76:79], v[40:43], v[144:159]
    ds_read_b128 v[56:59], v32 offset:49152
    ds_read_b128 v[60:63], v32 offset:53248
    ds_read_b64_tr_b16 v[88:89], v35 offset:12288
    v_mfma_f32_32x32x16_bf16 v[160:175], v[72:75], v[44:47], v[160:175]
    ds_read_b64_tr_b16 v[90:91], v35 offset:13312
    ds_read_b64_tr_b16 v[92:93], v36 offset:12288
    ds_read_b64_tr_b16 v[94:95], v36 offset:13312
    v_mfma_f32_32x32x16_bf16 v[176:191], v[76:79], v[44:47], v[176:191]
    ds_bpermute_b32 v127, v118, v112
    v_add_u32 v118, 64, v117
    s_waitcnt vmcnt(8) lgkmcnt(0)
    s_barrier
    v_mfma_f32_32x32x16_bf16 v[128:143], v[88:91], v[56:59], v[128:143]
    ds_read_b128 v[40:43], v29 offset:0
    ds_read_b128 v[44:47], v29 offset:4096
    ds_read_b64_tr_b16 v[72:73], v35 offset:16384
    v_mfma_f32_32x32x16_bf16 v[144:159], v[92:95], v[56:59], v[144:159]
    ds_read_b64_tr_b16 v[74:75], v35 offset:17408
    ds_bpermute_b32 v232, v118, v112
    v_add_u32 v118, 68, v117
    ds_bpermute_b32 v233, v118, v112
    v_mfma_f32_32x32x16_bf16 v[160:175], v[88:91], v[60:63], v[160:175]
    ds_read_b64_tr_b16 v[76:77], v36 offset:16384
    ds_read_b64_tr_b16 v[78:79], v36 offset:17408
    v_add_u32 v118, 80, v117
    ds_bpermute_b32 v234, v118, v112
    v_mfma_f32_32x32x16_bf16 v[176:191], v[92:95], v[60:63], v[176:191]
    v_add_u32 v118, 84, v117
    ds_bpermute_b32 v235, v118, v112
    v_add_u32 v118, 96, v117
    s_waitcnt lgkmcnt(0)
    v_mfma_f32_32x32x16_bf16 v[128:143], v[72:75], v[40:43], v[128:143]
    ds_read_b128 v[56:59], v30 offset:0
    ds_bpermute_b32 v236, v118, v112
    v_add_u32 v118, 100, v117
    ds_bpermute_b32 v237, v118, v112
    v_mfma_f32_32x32x16_bf16 v[144:159], v[76:79], v[40:43], v[144:159]
    ds_read_b128 v[60:63], v30 offset:4096
    ds_read_b64_tr_b16 v[88:89], v35 offset:20480
    ds_read_b64_tr_b16 v[90:91], v35 offset:21504
    v_add_u32 v118, 112, v117
    v_mfma_f32_32x32x16_bf16 v[160:175], v[72:75], v[44:47], v[160:175]
    ds_read_b64_tr_b16 v[92:93], v36 offset:20480
    ds_read_b64_tr_b16 v[94:95], v36 offset:21504
    ds_bpermute_b32 v238, v118, v112
    v_mfma_f32_32x32x16_bf16 v[176:191], v[76:79], v[44:47], v[176:191]
    v_add_u32 v118, 116, v117
    ds_bpermute_b32 v239, v118, v112
    s_waitcnt lgkmcnt(0)
    s_waitcnt lgkmcnt(0)
    v_mfma_f32_32x32x16_bf16 v[128:143], v[88:91], v[56:59], v[128:143]
    v_cmp_gt_i32 vcc, 0, v120
    v_and_b32 v120, 0x7fffffff, v120
    s_nop 0
    v_cndmask_b32 v192, v113, v115, vcc
    v_cndmask_b32 v208, v114, v116, vcc
    v_add_u32 v192, v192, v120
    v_add_u32 v208, v208, v120
    v_mfma_f32_32x32x16_bf16 v[144:159], v[92:95], v[56:59], v[144:159]
    ds_read_b128 v[40:43], v31 offset:0
    ds_read_b128 v[44:47], v31 offset:4096
    v_cmp_gt_i32 vcc, 0, v121
    v_and_b32 v121, 0x7fffffff, v121
    s_nop 0
    v_cndmask_b32 v193, v113, v115, vcc
    v_cndmask_b32 v209, v114, v116, vcc
    v_mfma_f32_32x32x16_bf16 v[160:175], v[88:91], v[60:63], v[160:175]
    ds_read_b64_tr_b16 v[72:73], v35 offset:24576
    ds_read_b64_tr_b16 v[74:75], v35 offset:25600
    ds_read_b64_tr_b16 v[76:77], v36 offset:24576
    ds_read_b64_tr_b16 v[78:79], v36 offset:25600
    v_add_u32 v193, v193, v121
    v_mfma_f32_32x32x16_bf16 v[176:191], v[92:95], v[60:63], v[176:191]
    v_add_u32 v209, v209, v121
    v_cmp_gt_i32 vcc, 0, v122
    v_and_b32 v122, 0x7fffffff, v122
    s_nop 0
    v_cndmask_b32 v194, v113, v115, vcc
    v_cndmask_b32 v210, v114, v116, vcc
    s_waitcnt lgkmcnt(0)
    v_mfma_f32_32x32x16_bf16 v[128:143], v[72:75], v[40:43], v[128:143]
    ds_read_b128 v[56:59], v32 offset:0
    ds_read_b128 v[60:63], v32 offset:4096
    ds_read_b64_tr_b16 v[88:89], v35 offset:28672
    v_add_u32 v194, v194, v122
    v_mfma_f32_32x32x16_bf16 v[144:159], v[76:79], v[40:43], v[144:159]
    v_add_u32 v210, v210, v122
    v_cmp_gt_i32 vcc, 0, v123
    v_and_b32 v123, 0x7fffffff, v123
    s_nop 0
    v_cndmask_b32 v195, v113, v115, vcc
    v_cndmask_b32 v211, v114, v116, vcc
    v_mfma_f32_32x32x16_bf16 v[160:175], v[72:75], v[44:47], v[160:175]
    ds_read_b64_tr_b16 v[90:91], v35 offset:29696
    ds_read_b64_tr_b16 v[92:93], v36 offset:28672
    ds_read_b64_tr_b16 v[94:95], v36 offset:29696
    v_add_u32 v195, v195, v123
    v_add_u32 v211, v211, v123
    v_mfma_f32_32x32x16_bf16 v[176:191], v[76:79], v[44:47], v[176:191]
    v_cmp_gt_i32 vcc, 0, v124
    v_and_b32 v124, 0x7fffffff, v124
    s_nop 0
    v_cndmask_b32 v196, v113, v115, vcc
    v_cndmask_b32 v212, v114, v116, vcc
    s_waitcnt vmcnt(0) lgkmcnt(0)
    s_barrier
    v_mfma_f32_32x32x16_bf16 v[128:143], v[88:91], v[56:59], v[128:143]
    v_add_u32 v196, v196, v124
    v_add_u32 v212, v212, v124
    v_cmp_gt_i32 vcc, 0, v125
    v_and_b32 v125, 0x7fffffff, v125
    s_nop 0
    v_cndmask_b32 v197, v113, v115, vcc
    v_cndmask_b32 v213, v114, v116, vcc
    v_mfma_f32_32x32x16_bf16 v[144:159], v[92:95], v[56:59], v[144:159]
    ds_read_b128 v[40:43], v29 offset:16384
    ds_read_b128 v[44:47], v29 offset:20480
    ds_read_b64_tr_b16 v[72:73], v33 offset:0
    ds_read_b64_tr_b16 v[74:75], v33 offset:1024
    v_add_u32 v197, v197, v125
    v_add_u32 v213, v213, v125
    v_mfma_f32_32x32x16_bf16 v[160:175], v[88:91], v[60:63], v[160:175]
    ds_read_b64_tr_b16 v[76:77], v34 offset:0
    ds_read_b64_tr_b16 v[78:79], v34 offset:1024
    v_cmp_gt_i32 vcc, 0, v126
    v_and_b32 v126, 0x7fffffff, v126
    s_nop 0
    v_cndmask_b32 v198, v113, v115, vcc
    v_cndmask_b32 v214, v114, v116, vcc
    v_mfma_f32_32x32x16_bf16 v[176:191], v[92:95], v[60:63], v[176:191]
    v_add_u32 v198, v198, v126
    v_add_u32 v214, v214, v126
    v_cmp_gt_i32 vcc, 0, v127
    v_and_b32 v127, 0x7fffffff, v127
    s_nop 0
    v_cndmask_b32 v199, v113, v115, vcc
    v_cndmask_b32 v215, v114, v116, vcc
    s_waitcnt lgkmcnt(0)
    v_mfma_f32_32x32x16_bf16 v[128:143], v[72:75], v[40:43], v[128:143]
    ds_read_b128 v[56:59], v30 offset:16384
    ds_read_b128 v[60:63], v30 offset:20480
    v_add_u32 v199, v199, v127
    v_add_u32 v215, v215, v127
    v_mfma_f32_32x32x16_bf16 v[144:159], v[76:79], v[40:43], v[144:159]
    ds_read_b64_tr_b16 v[88:89], v33 offset:4096
    ds_read_b64_tr_b16 v[90:91], v33 offset:5120
    ds_read_b64_tr_b16 v[92:93], v34 offset:4096
    ds_read_b64_tr_b16 v[94:95], v34 offset:5120
    v_mfma_f32_32x32x16_bf16 v[160:175], v[72:75], v[44:47], v[160:175]
    v_cmp_gt_i32 vcc, 0, v232
    v_and_b32 v232, 0x7fffffff, v232
    s_nop 0
    v_cndmask_b32 v200, v113, v115, vcc
    v_cndmask_b32 v216, v114, v116, vcc
    v_add_u32 v200, v200, v232
    v_add_u32 v216, v216, v232
    v_mfma_f32_32x32x16_bf16 v[176:191], v[76:79], v[44:47], v[176:191]
    v_cmp_gt_i32 vcc, 0, v233
    v_and_b32 v233, 0x7fffffff, v233
    s_nop 0
    v_cndmask_b32 v201, v113, v115, vcc
    v_cndmask_b32 v217, v114, v116, vcc
    s_waitcnt lgkmcnt(0)
    v_mfma_f32_32x32x16_bf16 v[128:143], v[88:91], v[56:59], v[128:143]
    ds_read_b128 v[40:43], v31 offset:16384
    ds_read_b128 v[44:47], v31 offset:20480
    ds_read_b64_tr_b16 v[72:73], v33 offset:8192
    v_add_u32 v201, v201, v233
    v_mfma_f32_32x32x16_bf16 v[144:159], v[92:95], v[56:59], v[144:159]
    v_add_u32 v217, v217, v233
    v_cmp_gt_i32 vcc, 0, v234
    v_and_b32 v234, 0x7fffffff, v234
    s_nop 0
    v_cndmask_b32 v202, v113, v115, vcc
    v_cndmask_b32 v218, v114, v116, vcc
    v_mfma_f32_32x32x16_bf16 v[160:175], v[88:91], v[60:63], v[160:175]
    ds_read_b64_tr_b16 v[74:75], v33 offset:9216
    ds_read_b64_tr_b16 v[76:77], v34 offset:8192
    ds_read_b64_tr_b16 v[78:79], v34 offset:9216
    v_add_u32 v202, v202, v234
    v_add_u32 v218, v218, v234
    v_mfma_f32_32x32x16_bf16 v[176:191], v[92:95], v[60:63], v[176:191]
    v_cmp_gt_i32 vcc, 0, v235
    v_and_b32 v235, 0x7fffffff, v235
    s_nop 0
    v_cndmask_b32 v203, v113, v115, vcc
    v_cndmask_b32 v219, v114, v116, vcc
    v_add_u32 v203, v203, v235
    s_waitcnt lgkmcnt(0)
    v_mfma_f32_32x32x16_bf16 v[128:143], v[72:75], v[40:43], v[128:143]
    ds_read_b128 v[56:59], v32 offset:16384
    ds_read_b128 v[60:63], v32 offset:20480
    ds_read_b64_tr_b16 v[88:89], v33 offset:12288
    ds_read_b64_tr_b16 v[90:91], v33 offset:13312
    ds_read_b64_tr_b16 v[92:93], v34 offset:12288
    v_mfma_f32_32x32x16_bf16 v[144:159], v[76:79], v[40:43], v[144:159]
    v_add_u32 v219, v219, v235
    v_cmp_gt_i32 vcc, 0, v236
    v_and_b32 v236, 0x7fffffff, v236
    s_nop 0
    v_cndmask_b32 v204, v113, v115, vcc
    v_cndmask_b32 v220, v114, v116, vcc
    v_add_u32 v204, v204, v236
    v_mfma_f32_32x32x16_bf16 v[160:175], v[72:75], v[44:47], v[160:175]
    ds_read_b64_tr_b16 v[94:95], v34 offset:13312
    v_add_u32 v220, v220, v236
    v_cmp_gt_i32 vcc, 0, v237
    v_and_b32 v237, 0x7fffffff, v237
    s_nop 0
    v_cndmask_b32 v205, v113, v115, vcc
    v_cndmask_b32 v221, v114, v116, vcc
    v_mfma_f32_32x32x16_bf16 v[176:191], v[76:79], v[44:47], v[176:191]
    v_add_u32 v205, v205, v237
    v_add_u32 v221, v221, v237
    s_waitcnt lgkmcnt(0)
    s_barrier
    v_mfma_f32_32x32x16_bf16 v[128:143], v[88:91], v[56:59], v[128:143]
    v_cmp_gt_i32 vcc, 0, v238
    v_and_b32 v238, 0x7fffffff, v238
    s_nop 0
    v_cndmask_b32 v206, v113, v115, vcc
    v_cndmask_b32 v222, v114, v116, vcc
    v_mfma_f32_32x32x16_bf16 v[144:159], v[92:95], v[56:59], v[144:159]
    v_add_u32 v206, v206, v238
    v_add_u32 v222, v222, v238
    v_mfma_f32_32x32x16_bf16 v[160:175], v[88:91], v[60:63], v[160:175]
    v_cmp_gt_i32 vcc, 0, v239
    v_and_b32 v239, 0x7fffffff, v239
    s_nop 0
    v_cndmask_b32 v207, v113, v115, vcc
    v_cndmask_b32 v223, v114, v116, vcc
    v_mfma_f32_32x32x16_bf16 v[176:191], v[92:95], v[60:63], v[176:191]
    v_add_u32 v207, v207, v239
    v_add_u32 v223, v223, v239
    s_waitcnt lgkmcnt(0)
    s_branch L_pj_H
L_pj_BV:
    v_mfma_f32_32x32x16_bf16 v[128:143], v[40:43], v[72:75], 0
    ds_read_b128 v[56:59], v30 offset:16384
    ds_read_b128 v[60:63], v30 offset:20480
    v_mul_f32 v192, s53, v192
    v_mul_f32 v193, s53, v193
    s_add_u32 m0, s84, 98304
    s_add_u32 s69, s83, 884736
    buffer_load_dwordx4 v8, s[28:31], s69 offen lds
    v_mfma_f32_32x32x16_bf16 v[144:159], v[40:43], v[76:79], 0
    ds_read_b64_tr_b16 v[88:89], v35 offset:4096
    ds_read_b64_tr_b16 v[90:91], v35 offset:5120
    ds_read_b64_tr_b16 v[92:93], v36 offset:4096
    s_add_u32 m0, s84, 99328
    s_add_u32 s69, s83, 898560
    buffer_load_dwordx4 v8, s[28:31], s69 offen lds
    v_mfma_f32_32x32x16_bf16 v[160:175], v[44:47], v[72:75], 0
    ds_read_b64_tr_b16 v[94:95], v36 offset:5120
    v_mul_f32 v194, s53, v194
    v_mul_f32 v195, s53, v195
    v_mul_f32 v196, s53, v196
    v_mul_f32 v197, s53, v197
    v_mul_f32 v198, s53, v198
    v_mul_f32 v199, s53, v199
    v_mul_f32 v200, s53, v200
    v_mul_f32 v201, s53, v201
    v_mfma_f32_32x32x16_bf16 v[176:191], v[44:47], v[76:79], 0
    v_mul_f32 v202, s53, v202
    v_mul_f32 v203, s53, v203
    v_mul_f32 v204, s53, v204
    s_add_u32 m0, s84, 100352
    s_add_u32 s69, s83, 912384
    buffer_load_dwordx4 v8, s[28:31], s69 offen lds
    s_waitcnt lgkmcnt(0)
    v_mfma_f32_32x32x16_bf16 v[128:143], v[56:59], v[88:91], v[128:143]
    ds_read_b128 v[40:43], v31 offset:16384
    v_mul_f32 v205, s53, v205
    v_mul_f32 v206, s53, v206
    v_mul_f32 v207, s53, v207
    s_add_u32 m0, s84, 101376
    s_add_u32 s69, s83, 926208
    buffer_load_dwordx4 v8, s[28:31], s69 offen lds
    v_mfma_f32_32x32x16_bf16 v[144:159], v[56:59], v[92:95], v[144:159]
    ds_read_b128 v[44:47], v31 offset:20480
    ds_read_b64_tr_b16 v[72:73], v35 offset:8192
    v_cvt_pk_bf16_f32 v192, v192, v193
    s_add_u32 m0, s84, 114688
    s_add_u32 s69, s83, 1105920
    buffer_load_dwordx4 v8, s[28:31], s69 offen lds
    v_mfma_f32_32x32x16_bf16 v[160:175], v[60:63], v[88:91], v[160:175]
    ds_read_b64_tr_b16 v[74:75], v35 offset:9216
    ds_read_b64_tr_b16 v[76:77], v36 offset:8192
    ds_read_b64_tr_b16 v[78:79], v36 offset:9216
    v_cvt_pk_bf16_f32 v193, v194, v195
    v_cvt_pk_bf16_f32 v194, v196, v197
    v_cvt_pk_bf16_f32 v195, v198, v199
    v_cvt_pk_bf16_f32 v196, v200, v201
    v_cvt_pk_bf16_f32 v197, v202, v203
    v_mfma_f32_32x32x16_bf16 v[176:191], v[60:63], v[92:95], v[176:191]
    v_cvt_pk_bf16_f32 v198, v204, v205
    v_cvt_pk_bf16_f32 v199, v206, v207
    v_accvgpr_write_b32 a160, v192
    s_add_u32 m0, s84, 115712
    s_add_u32 s69, s83, 1119744
    buffer_load_dwordx4 v8, s[28:31], s69 offen lds
    s_waitcnt lgkmcnt(0)
    v_mfma_f32_32x32x16_bf16 v[128:143], v[40:43], v[72:75], v[128:143]
    v_accvgpr_write_b32 a161, v193
    v_accvgpr_write_b32 a162, v194
    v_accvgpr_write_b32 a163, v195
    v_accvgpr_write_b32 a164, v196
    s_add_u32 m0, s84, 116736
    s_add_u32 s69, s83, 1133568
    buffer_load_dwordx4 v8, s[28:31], s69 offen lds
    v_mfma_f32_32x32x16_bf16 v[144:159], v[40:43], v[76:79], v[144:159]
    ds_read_b128 v[56:59], v32 offset:16384
    v_accvgpr_write_b32 a165, v197
    v_accvgpr_write_b32 a166, v198
    s_add_u32 m0, s84, 117760
    s_add_u32 s69, s83, 1147392
    buffer_load_dwordx4 v8, s[28:31], s69 offen lds
    v_mfma_f32_32x32x16_bf16 v[160:175], v[44:47], v[72:75], v[160:175]
    ds_read_b128 v[60:63], v32 offset:20480
    ds_read_b64_tr_b16 v[88:89], v35 offset:12288
    ds_read_b64_tr_b16 v[90:91], v35 offset:13312
    ds_read_b64_tr_b16 v[92:93], v36 offset:12288
    ds_read_b64_tr_b16 v[94:95], v36 offset:13312
    v_accvgpr_write_b32 a167, v199
    v_mfma_f32_32x32x16_bf16 v[176:191], v[44:47], v[76:79], v[176:191]
    v_mul_f32 v208, s53, v208
    v_mul_f32 v209, s53, v209
    v_mul_f32 v210, s53, v210
    v_mul_f32 v211, s53, v211
    v_mul_f32 v212, s53, v212
    v_mul_f32 v213, s53, v213
    s_waitcnt vmcnt(24) lgkmcnt(0)
    s_barrier
    v_mfma_f32_32x32x16_bf16 v[128:143], v[56:59], v[88:91], v[128:143]
    ds_read_b128 v[40:43], v29 offset:32768
    v_mul_f32 v214, s53, v214
    s_add_u32 m0, s84, 16384
    s_add_u32 s69, s82, 512
    buffer_load_dwordx4 v4, s[24:27], s69 offen lds
    v_mfma_f32_32x32x16_bf16 v[144:159], v[56:59], v[92:95], v[144:159]
    ds_read_b128 v[44:47], v29 offset:36864
    ds_read_b64_tr_b16 v[72:73], v35 offset:16384
    ds_read_b64_tr_b16 v[74:75], v35 offset:17408
    ds_read_b64_tr_b16 v[76:77], v36 offset:16384
    v_mul_f32 v215, s53, v215
    v_mfma_f32_32x32x16_bf16 v[160:175], v[60:63], v[88:91], v[160:175]
    ds_read_b64_tr_b16 v[78:79], v36 offset:17408
    v_mul_f32 v216, s53, v216
    v_mul_f32 v217, s53, v217
    v_mul_f32 v218, s53, v218
    v_mul_f32 v219, s53, v219
    v_mul_f32 v220, s53, v220
    v_mul_f32 v221, s53, v221
    v_mfma_f32_32x32x16_bf16 v[176:191], v[60:63], v[92:95], v[176:191]
    v_mul_f32 v222, s53, v222
    s_add_u32 m0, s84, 17408
    s_add_u32 s69, s82, 9728
    buffer_load_dwordx4 v5, s[24:27], s69 offen lds
    s_waitcnt lgkmcnt(0)
    v_mfma_f32_32x32x16_bf16 v[128:143], v[40:43], v[72:75], v[128:143]
    ds_read_b128 v[56:59], v30 offset:32768
    ds_read_b128 v[60:63], v30 offset:36864
    v_mul_f32 v223, s53, v223
    v_cvt_pk_bf16_f32 v208, v208, v209
    v_cvt_pk_bf16_f32 v209, v210, v211
    v_cvt_pk_bf16_f32 v210, v212, v213
    v_cvt_pk_bf16_f32 v211, v214, v215
    v_mfma_f32_32x32x16_bf16 v[144:159], v[40:43], v[76:79], v[144:159]
    ds_read_b64_tr_b16 v[88:89], v35 offset:20480
    ds_read_b64_tr_b16 v[90:91], v35 offset:21504
    ds_read_b64_tr_b16 v[92:93], v36 offset:20480
    v_cvt_pk_bf16_f32 v212, v216, v217
    v_cvt_pk_bf16_f32 v213, v218, v219
    v_cvt_pk_bf16_f32 v214, v220, v221
    v_mfma_f32_32x32x16_bf16 v[160:175], v[44:47], v[72:75], v[160:175]
    ds_read_b64_tr_b16 v[94:95], v36 offset:21504
    v_cvt_pk_bf16_f32 v215, v222, v223
    v_accvgpr_write_b32 a168, v208
    v_accvgpr_write_b32 a169, v209
    v_accvgpr_write_b32 a170, v210
    v_accvgpr_write_b32 a171, v211
    v_accvgpr_write_b32 a172, v212
    v_mfma_f32_32x32x16_bf16 v[176:191], v[44:47], v[76:79], v[176:191]
    v_accvgpr_write_b32 a173, v213
    s_add_u32 m0, s84, 18432
    s_add_u32 s69, s82, 18944
    buffer_load_dwordx4 v4, s[24:27], s69 offen lds
    s_waitcnt lgkmcnt(0)
    v_mfma_f32_32x32x16_bf16 v[128:143], v[56:59], v[88:91], v[128:143]
    ds_read_b128 v[40:43], v31 offset:32768
    ds_read_b128 v[44:47], v31 offset:36864
    v_accvgpr_write_b32 a174, v214
    v_accvgpr_write_b32 a175, v215
    v_mul_f32 v224, s53, v224
    v_mul_f32 v225, s53, v225
    v_mfma_f32_32x32x16_bf16 v[144:159], v[56:59], v[92:95], v[144:159]
    ds_read_b64_tr_b16 v[72:73], v35 offset:24576
    ds_read_b64_tr_b16 v[74:75], v35 offset:25600
    ds_read_b64_tr_b16 v[76:77], v36 offset:24576
    v_mul_f32 v226, s53, v226
    v_mul_f32 v227, s53, v227
    v_mfma_f32_32x32x16_bf16 v[160:175], v[60:63], v[88:91], v[160:175]
    ds_read_b64_tr_b16 v[78:79], v36 offset:25600
    v_mul_f32 v228, s53, v228
    v_mul_f32 v229, s53, v229
    v_mul_f32 v230, s53, v230
    v_mul_f32 v231, s53, v231
    v_mul_f32 v232, s53, v232
    v_mul_f32 v233, s53, v233
    v_mfma_f32_32x32x16_bf16 v[176:191], v[60:63], v[92:95], v[176:191]
    v_mul_f32 v234, s53, v234
    s_add_u32 m0, s84, 19456
    s_add_u32 s69, s82, 28160
    buffer_load_dwordx4 v5, s[24:27], s69 offen lds
    s_waitcnt lgkmcnt(0)
    v_mfma_f32_32x32x16_bf16 v[128:143], v[40:43], v[72:75], v[128:143]
    ds_read_b128 v[56:59], v32 offset:32768
    v_mul_f32 v235, s53, v235
    v_mul_f32 v236, s53, v236
    v_mul_f32 v237, s53, v237
    v_mul_f32 v238, s53, v238
    v_mul_f32 v239, s53, v239
    v_mfma_f32_32x32x16_bf16 v[144:159], v[40:43], v[76:79], v[144:159]
    ds_read_b128 v[60:63], v32 offset:36864
    ds_read_b64_tr_b16 v[88:89], v35 offset:28672
    ds_read_b64_tr_b16 v[90:91], v35 offset:29696
    v_cvt_pk_bf16_f32 v224, v224, v225
    v_cvt_pk_bf16_f32 v225, v226, v227
    v_mfma_f32_32x32x16_bf16 v[160:175], v[44:47], v[72:75], v[160:175]
    ds_read_b64_tr_b16 v[92:93], v36 offset:28672
    ds_read_b64_tr_b16 v[94:95], v36 offset:29696
    v_cvt_pk_bf16_f32 v226, v228, v229
    v_cvt_pk_bf16_f32 v227, v230, v231
    v_cvt_pk_bf16_f32 v228, v232, v233
    v_cvt_pk_bf16_f32 v229, v234, v235
    v_mfma_f32_32x32x16_bf16 v[176:191], v[44:47], v[76:79], v[176:191]
    v_cvt_pk_bf16_f32 v230, v236, v237
    v_cvt_pk_bf16_f32 v231, v238, v239
    v_accvgpr_write_b32 a176, v224
    v_accvgpr_write_b32 a177, v225
    v_accvgpr_write_b32 a178, v226
    s_waitcnt vmcnt(16) lgkmcnt(0)
    s_barrier
    v_mfma_f32_32x32x16_bf16 v[128:143], v[56:59], v[88:91], v[128:143]
    ds_read_b128 v[40:43], v29 offset:49152
    ds_read_b128 v[44:47], v29 offset:53248
    ds_read_b64_tr_b16 v[72:73], v33 offset:0
    s_add_u32 m0, s84, 32768
    s_add_u32 s69, s82, 640
    buffer_load_dwordx4 v4, s[24:27], s69 offen lds
    v_mfma_f32_32x32x16_bf16 v[144:159], v[56:59], v[92:95], v[144:159]
    ds_read_b64_tr_b16 v[74:75], v33 offset:1024
    v_accvgpr_write_b32 a179, v227
    v_accvgpr_write_b32 a180, v228
    v_accvgpr_write_b32 a181, v229
    s_add_u32 m0, s84, 33792
    s_add_u32 s69, s82, 9856
    buffer_load_dwordx4 v5, s[24:27], s69 offen lds
    v_mfma_f32_32x32x16_bf16 v[160:175], v[60:63], v[88:91], v[160:175]
    ds_read_b64_tr_b16 v[76:77], v34 offset:0
    ds_read_b64_tr_b16 v[78:79], v34 offset:1024
    v_accvgpr_write_b32 a182, v230
    v_accvgpr_write_b32 a183, v231
    s_add_u32 m0, s84, 34816
    s_add_u32 s69, s82, 19072
    buffer_load_dwordx4 v4, s[24:27], s69 offen lds
    v_mfma_f32_32x32x16_bf16 v[176:191], v[60:63], v[92:95], v[176:191]
    v_mul_f32 v240, s53, v240
    v_mul_f32 v241, s53, v241
    v_mul_f32 v242, s53, v242
    s_add_u32 m0, s84, 35840
    s_add_u32 s69, s82, 28288
    buffer_load_dwordx4 v5, s[24:27], s69 offen lds
    s_waitcnt lgkmcnt(0)
    v_mfma_f32_32x32x16_bf16 v[128:143], v[40:43], v[72:75], v[128:143]
    ds_read_b128 v[56:59], v30 offset:49152
    ds_read_b128 v[60:63], v30 offset:53248
    v_mul_f32 v243, s53, v243
    v_mul_f32 v244, s53, v244
    v_mul_f32 v245, s53, v245
    v_mul_f32 v246, s53, v246
    v_mul_f32 v247, s53, v247
    v_mul_f32 v248, s53, v248
    v_mfma_f32_32x32x16_bf16 v[144:159], v[40:43], v[76:79], v[144:159]
    ds_read_b64_tr_b16 v[88:89], v33 offset:4096
    ds_read_b64_tr_b16 v[90:91], v33 offset:5120
    v_mul_f32 v249, s53, v249
    s_add_u32 m0, s84, 131072
    s_add_u32 s69, s83, 1327104
    buffer_load_dwordx4 v8, s[28:31], s69 offen lds
    v_mfma_f32_32x32x16_bf16 v[160:175], v[44:47], v[72:75], v[160:175]
    ds_read_b64_tr_b16 v[92:93], v34 offset:4096
    ds_read_b64_tr_b16 v[94:95], v34 offset:5120
    v_mul_f32 v250, s53, v250
    s_add_u32 m0, s84, 132096
    s_add_u32 s69, s83, 1340928
    buffer_load_dwordx4 v8, s[28:31], s69 offen lds
    v_mfma_f32_32x32x16_bf16 v[176:191], v[44:47], v[76:79], v[176:191]
    v_mul_f32 v251, s53, v251
    v_mul_f32 v252, s53, v252
    v_mul_f32 v253, s53, v253
    v_mul_f32 v254, s53, v254
    s_add_u32 m0, s84, 133120
    s_add_u32 s69, s83, 1354752
    buffer_load_dwordx4 v8, s[28:31], s69 offen lds
    s_waitcnt lgkmcnt(0)
    v_mfma_f32_32x32x16_bf16 v[128:143], v[56:59], v[88:91], v[128:143]
    ds_read_b128 v[40:43], v31 offset:49152
    ds_read_b128 v[44:47], v31 offset:53248
    v_mul_f32 v255, s53, v255
    v_cvt_pk_bf16_f32 v240, v240, v241
    s_add_u32 m0, s84, 134144
    s_add_u32 s69, s83, 1368576
    buffer_load_dwordx4 v8, s[28:31], s69 offen lds
    v_mfma_f32_32x32x16_bf16 v[144:159], v[56:59], v[92:95], v[144:159]
    ds_read_b64_tr_b16 v[72:73], v33 offset:8192
    ds_read_b64_tr_b16 v[74:75], v33 offset:9216
    v_cvt_pk_bf16_f32 v241, v242, v243
    v_cvt_pk_bf16_f32 v242, v244, v245
    v_cvt_pk_bf16_f32 v243, v246, v247
    v_cvt_pk_bf16_f32 v244, v248, v249
    v_cvt_pk_bf16_f32 v245, v250, v251
    v_cvt_pk_bf16_f32 v246, v252, v253
    v_mfma_f32_32x32x16_bf16 v[160:175], v[60:63], v[88:91], v[160:175]
    ds_read_b64_tr_b16 v[76:77], v34 offset:8192
    ds_read_b64_tr_b16 v[78:79], v34 offset:9216
    v_cvt_pk_bf16_f32 v247, v254, v255
    s_add_u32 m0, s84, 147456
    s_add_u32 s69, s83, 1548288
    buffer_load_dwordx4 v8, s[28:31], s69 offen lds
    v_mfma_f32_32x32x16_bf16 v[176:191], v[60:63], v[92:95], v[176:191]
    v_accvgpr_write_b32 a184, v240
    v_accvgpr_write_b32 a185, v241
    v_accvgpr_write_b32 a186, v242
    s_add_u32 m0, s84, 148480
    s_add_u32 s69, s83, 1562112
    buffer_load_dwordx4 v8, s[28:31], s69 offen lds
    s_waitcnt lgkmcnt(0)
    v_mfma_f32_32x32x16_bf16 v[128:143], v[40:43], v[72:75], v[128:143]
    v_accvgpr_write_b32 a187, v243
    v_accvgpr_write_b32 a188, v244
    v_accvgpr_write_b32 a189, v245
    v_accvgpr_write_b32 a190, v246
    v_accvgpr_write_b32 a191, v247
    s_add_u32 m0, s84, 149504
    s_add_u32 s69, s83, 1575936
    buffer_load_dwordx4 v8, s[28:31], s69 offen lds
    v_mfma_f32_32x32x16_bf16 v[144:159], v[40:43], v[76:79], v[144:159]
    ds_read_b128 v[56:59], v32 offset:49152
    s_add_u32 m0, s84, 150528
    s_add_u32 s69, s83, 1589760
    buffer_load_dwordx4 v8, s[28:31], s69 offen lds
    v_mfma_f32_32x32x16_bf16 v[160:175], v[44:47], v[72:75], v[160:175]
    ds_read_b128 v[60:63], v32 offset:53248
    ds_read_b64_tr_b16 v[88:89], v33 offset:12288
    ds_read_b64_tr_b16 v[90:91], v33 offset:13312
    ds_read_b64_tr_b16 v[92:93], v34 offset:12288
    ds_read_b64_tr_b16 v[94:95], v34 offset:13312
    v_mfma_f32_32x32x16_bf16 v[176:191], v[44:47], v[76:79], v[176:191]
    s_waitcnt vmcnt(24) lgkmcnt(0)
    s_barrier
    s_cmp_lg_u32 s68, 0
    s_cbranch_scc1 L_pj_ta1
    s_cmp_lg_u32 s67, 0
    s_cbranch_scc1 L_pj_ta1
    v_readfirstlane_b32 s65, v54
    s_nop 0
    s_cmp_ge_u32 s65, 16
    s_cbranch_scc0 L_pj_ta1_again
    buffer_inv sc1
    s_mov_b32 s67, 1
    s_branch L_pj_ta1
L_pj_ta1_again:
    buffer_load_dword v54, v53, s[32:35], s66 offen sc1
L_pj_ta1:
    v_mfma_f32_32x32x16_bf16 v[128:143], v[56:59], v[88:91], v[128:143]
    ds_read_b128 v[40:43], v29 offset:0
    s_add_u32 m0, s84, 49152
    s_add_u32 s69, s82, 768
    buffer_load_dwordx4 v4, s[24:27], s69 offen lds
    v_mfma_f32_32x32x16_bf16 v[144:159], v[56:59], v[92:95], v[144:159]
    ds_read_b128 v[44:47], v29 offset:4096
    ds_read_b64_tr_b16 v[72:73], v33 offset:16384
    v_mov_b32 v226, 0x3f803f80
    v_mov_b32 v227, 0x3f803f80
    v_mov_b32 v228, 0x3f803f80
    v_mov_b32 v229, 0x3f803f80
    v_mfma_f32_32x32x16_bf16 v[160:175], v[60:63], v[88:91], v[160:175]
    ds_read_b64_tr_b16 v[74:75], v33 offset:17408
    ds_read_b64_tr_b16 v[76:77], v34 offset:16384
    ds_read_b64_tr_b16 v[78:79], v34 offset:17408
    s_mov_b32 s57, 0x3f800000
    s_lshl_b32 s92, s55, 3
    v_mfma_f32_32x32x16_bf16 v[176:191], v[60:63], v[92:95], v[176:191]
    s_add_u32 m0, s84, 50176
    s_add_u32 s69, s82, 9984
    buffer_load_dwordx4 v5, s[24:27], s69 offen lds
    s_waitcnt lgkmcnt(0)
    v_mfma_f32_32x32x16_bf16 v[128:143], v[40:43], v[72:75], v[128:143]
    ds_read_b128 v[56:59], v30 offset:0
    ds_read_b128 v[60:63], v30 offset:4096
    ds_read_b64_tr_b16 v[88:89], v33 offset:20480
    s_lshl_b32 s93, s76, 2
    v_mfma_f32_32x32x16_bf16 v[144:159], v[40:43], v[76:79], v[144:159]
    ds_read_b64_tr_b16 v[90:91], v33 offset:21504
    s_add_u32 s92, s92, s93
    s_add_u32 s92, s92, 0
    s_lshr_b32 s93, s92, 4
    s_mul_i32 s93, s93, 18944
    v_mfma_f32_32x32x16_bf16 v[160:175], v[44:47], v[72:75], v[160:175]
    ds_read_b64_tr_b16 v[92:93], v34 offset:20480
    ds_read_b64_tr_b16 v[94:95], v34 offset:21504
    s_and_b32 s92, s92, 15
    s_mul_i32 s92, s92, 608
    v_mfma_f32_32x32x16_bf16 v[176:191], v[44:47], v[76:79], v[176:191]
    s_add_u32 m0, s84, 51200
    s_add_u32 s69, s82, 19200
    buffer_load_dwordx4 v4, s[24:27], s69 offen lds
    s_waitcnt lgkmcnt(0)
    v_mfma_f32_32x32x16_bf16 v[128:143], v[56:59], v[88:91], v[128:143]
    ds_read_b128 v[40:43], v31 offset:0
    ds_read_b128 v[44:47], v31 offset:4096
    ds_read_b64_tr_b16 v[72:73], v33 offset:24576
    v_mfma_f32_32x32x16_bf16 v[144:159], v[56:59], v[92:95], v[144:159]
    ds_read_b64_tr_b16 v[74:75], v33 offset:25600
    ds_read_b64_tr_b16 v[76:77], v34 offset:24576
    s_add_u32 s92, s92, s93
    s_add_u32 s4, s92, 79700992
    v_mfma_f32_32x32x16_bf16 v[160:175], v[60:63], v[88:91], v[160:175]
    ds_read_b64_tr_b16 v[78:79], v34 offset:25600
    s_lshl_b32 s92, s55, 3
    s_lshl_b32 s93, s76, 2
    s_add_u32 s92, s92, s93
    v_mfma_f32_32x32x16_bf16 v[176:191], v[60:63], v[92:95], v[176:191]
    s_add_u32 m0, s84, 52224
    s_add_u32 s69, s82, 28416
    buffer_load_dwordx4 v5, s[24:27], s69 offen lds
    s_waitcnt lgkmcnt(0)
    v_mfma_f32_32x32x16_bf16 v[128:143], v[40:43], v[72:75], v[128:143]
    ds_read_b128 v[56:59], v32 offset:0
    ds_read_b128 v[60:63], v32 offset:4096
    s_add_u32 s92, s92, 1
    s_lshr_b32 s93, s92, 4
    v_mfma_f32_32x32x16_bf16 v[144:159], v[40:43], v[76:79], v[144:159]
    ds_read_b64_tr_b16 v[88:89], v33 offset:28672
    ds_read_b64_tr_b16 v[90:91], v33 offset:29696
    ds_read_b64_tr_b16 v[92:93], v34 offset:28672
    s_mul_i32 s93, s93, 18944
    v_mfma_f32_32x32x16_bf16 v[160:175], v[44:47], v[72:75], v[160:175]
    ds_read_b64_tr_b16 v[94:95], v34 offset:29696
    s_and_b32 s92, s92, 15
    s_mul_i32 s92, s92, 608
    s_add_u32 s92, s92, s93
    s_add_u32 s5, s92, 79700992
    v_mfma_f32_32x32x16_bf16 v[176:191], v[44:47], v[76:79], v[176:191]
    s_lshl_b32 s92, s55, 3
    s_lshl_b32 s93, s76, 2
    s_add_u32 s92, s92, s93
    s_waitcnt vmcnt(16) lgkmcnt(0)
    s_barrier
    v_mfma_f32_32x32x16_bf16 v[128:143], v[56:59], v[88:91], v[128:143]
    ds_read_b128 v[40:43], v29 offset:16384
    s_add_u32 m0, s84, 0
    s_add_u32 s69, s82, 896
    buffer_load_dwordx4 v4, s[24:27], s69 offen lds
    v_mfma_f32_32x32x16_bf16 v[144:159], v[56:59], v[92:95], v[144:159]
    ds_read_b128 v[44:47], v29 offset:20480
    s_add_u32 m0, s84, 1024
    s_add_u32 s69, s82, 10112
    buffer_load_dwordx4 v5, s[24:27], s69 offen lds
    v_mfma_f32_32x32x16_bf16 v[160:175], v[60:63], v[88:91], v[160:175]
    ds_read_b64_tr_b16 v[72:73], v33 offset:32768
    ds_read_b64_tr_b16 v[74:75], v33 offset:33792
    ds_read_b64_tr_b16 v[76:77], v34 offset:32768
    ds_read_b64_tr_b16 v[78:79], v34 offset:33792
    s_add_u32 s92, s92, 2
    v_mfma_f32_32x32x16_bf16 v[176:191], v[60:63], v[92:95], v[176:191]
    s_lshr_b32 s93, s92, 4
    s_add_u32 m0, s84, 2048
    s_add_u32 s69, s82, 19328
    buffer_load_dwordx4 v4, s[24:27], s69 offen lds
    s_waitcnt lgkmcnt(0)
    v_mfma_f32_32x32x16_bf16 v[128:143], v[40:43], v[72:75], v[128:143]
    ds_read_b128 v[56:59], v30 offset:16384
    ds_read_b128 v[60:63], v30 offset:20480
    s_mul_i32 s93, s93, 18944
    s_and_b32 s92, s92, 15
    s_mul_i32 s92, s92, 608
    s_add_u32 s92, s92, s93
    v_mfma_f32_32x32x16_bf16 v[144:159], v[40:43], v[76:79], v[144:159]
    ds_read_b64_tr_b16 v[88:89], v33 offset:36864
    s_add_u32 m0, s84, 3072
    s_add_u32 s69, s82, 28544
    buffer_load_dwordx4 v5, s[24:27], s69 offen lds
    v_mfma_f32_32x32x16_bf16 v[160:175], v[44:47], v[72:75], v[160:175]
    ds_read_b64_tr_b16 v[90:91], v33 offset:37888
    ds_read_b64_tr_b16 v[92:93], v34 offset:36864
    ds_read_b64_tr_b16 v[94:95], v34 offset:37888
    s_add_u32 s6, s92, 79700992
    s_lshl_b32 s92, s55, 3
    v_mfma_f32_32x32x16_bf16 v[176:191], v[44:47], v[76:79], v[176:191]
    s_add_u32 m0, s84, 65536
    s_add_u32 s69, s83, 1769472
    buffer_load_dwordx4 v8, s[28:31], s69 offen lds
    s_waitcnt lgkmcnt(0)
    v_mfma_f32_32x32x16_bf16 v[128:143], v[56:59], v[88:91], v[128:143]
    ds_read_b128 v[40:43], v31 offset:16384
    ds_read_b128 v[44:47], v31 offset:20480
    s_lshl_b32 s93, s76, 2
    s_add_u32 s92, s92, s93
    s_add_u32 s92, s92, 3
    s_lshr_b32 s93, s92, 4
    v_mfma_f32_32x32x16_bf16 v[144:159], v[56:59], v[92:95], v[144:159]
    ds_read_b64_tr_b16 v[72:73], v33 offset:40960
    s_add_u32 m0, s84, 66560
    s_add_u32 s69, s83, 1783296
    buffer_load_dwordx4 v8, s[28:31], s69 offen lds
    v_mfma_f32_32x32x16_bf16 v[160:175], v[60:63], v[88:91], v[160:175]
    ds_read_b64_tr_b16 v[74:75], v33 offset:41984
    ds_read_b64_tr_b16 v[76:77], v34 offset:40960
    ds_read_b64_tr_b16 v[78:79], v34 offset:41984
    s_mul_i32 s93, s93, 18944
    s_and_b32 s92, s92, 15
    v_mfma_f32_32x32x16_bf16 v[176:191], v[60:63], v[92:95], v[176:191]
    s_add_u32 m0, s84, 67584
    s_add_u32 s69, s83, 1797120
    buffer_load_dwordx4 v8, s[28:31], s69 offen lds
    s_waitcnt lgkmcnt(0)
    v_mfma_f32_32x32x16_bf16 v[128:143], v[40:43], v[72:75], v[128:143]
    ds_read_b128 v[56:59], v32 offset:16384
    ds_read_b128 v[60:63], v32 offset:20480
    ds_read_b64_tr_b16 v[88:89], v33 offset:45056
    s_mul_i32 s92, s92, 608
    s_add_u32 s92, s92, s93
    v_mfma_f32_32x32x16_bf16 v[144:159], v[40:43], v[76:79], v[144:159]
    s_add_u32 s7, s92, 79700992
    s_add_u32 m0, s84, 68608
    s_add_u32 s69, s83, 1810944
    buffer_load_dwordx4 v8, s[28:31], s69 offen lds
    v_mfma_f32_32x32x16_bf16 v[160:175], v[44:47], v[72:75], v[160:175]
    ds_read_b64_tr_b16 v[90:91], v33 offset:46080
    ds_read_b64_tr_b16 v[92:93], v34 offset:45056
    ds_read_b64_tr_b16 v[94:95], v34 offset:46080
    s_lshl_b32 s92, s54, 7
    v_mfma_f32_32x32x16_bf16 v[176:191], v[44:47], v[76:79], v[176:191]
    s_lshl_b32 s93, s77, 6
    s_add_u32 s92, s92, s93
    s_add_u32 s92, s92, 0
    s_sub_u32 s92, s92, 1152
    s_waitcnt vmcnt(20) lgkmcnt(0)
    s_barrier
    v_mfma_f32_32x32x16_bf16 v[128:143], v[56:59], v[88:91], v[128:143]
    ds_read_b128 v[40:43], v29 offset:32768
    ds_read_b128 v[44:47], v29 offset:36864
    s_cmp_eq_u32 s75, 2
    s_cselect_b32 s92, 4096, s92
    v_and_b32 v118, 31, v0
    v_mfma_f32_32x32x16_bf16 v[144:159], v[56:59], v[92:95], v[144:159]
    v_add_u32 v118, s92, v118
    s_add_u32 m0, s84, 16384
    s_add_u32 s69, s82, 1024
    buffer_load_dwordx4 v4, s[24:27], s69 offen lds
    v_mfma_f32_32x32x16_bf16 v[160:175], v[60:63], v[88:91], v[160:175]
    ds_read_b64_tr_b16 v[72:73], v33 offset:49152
    ds_read_b64_tr_b16 v[74:75], v33 offset:50176
    ds_read_b64_tr_b16 v[76:77], v34 offset:49152
    ds_read_b64_tr_b16 v[78:79], v34 offset:50176
    v_mfma_f32_32x32x16_bf16 v[176:191], v[60:63], v[92:95], v[176:191]
    s_add_u32 m0, s84, 17408
    s_add_u32 s69, s82, 10240
    buffer_load_dwordx4 v5, s[24:27], s69 offen lds
    s_waitcnt lgkmcnt(0)
    v_mfma_f32_32x32x16_bf16 v[128:143], v[40:43], v[72:75], v[128:143]
    ds_read_b128 v[56:59], v30 offset:32768
    ds_read_b128 v[60:63], v30 offset:36864
    v_mul_u32_u24 v119, 3641, v118
    v_lshrrev_b32 v119, 16, v119
    v_mul_u32_u24 v104, 18, v119
    v_mfma_f32_32x32x16_bf16 v[144:159], v[40:43], v[76:79], v[144:159]
    ds_read_b64_tr_b16 v[88:89], v33 offset:53248
    ds_read_b64_tr_b16 v[90:91], v33 offset:54272
    v_sub_u32 v104, v118, v104
    s_mov_b32 s93, 151552
    v_mul_lo_u32 v119, v119, s93
    v_mfma_f32_32x32x16_bf16 v[160:175], v[44:47], v[72:75], v[160:175]
    ds_read_b64_tr_b16 v[92:93], v34 offset:53248
    ds_read_b64_tr_b16 v[94:95], v34 offset:54272
    v_lshl_add_u32 v119, v104, 4, v119
    v_lshrrev_b32 v105, 5, v0
    v_mul_u32_u24 v105, 304, v105
    v_mfma_f32_32x32x16_bf16 v[176:191], v[44:47], v[76:79], v[176:191]
    s_add_u32 m0, s84, 18432
    s_add_u32 s69, s82, 19456
    buffer_load_dwordx4 v4, s[24:27], s69 offen lds
    s_waitcnt lgkmcnt(0)
    v_mfma_f32_32x32x16_bf16 v[128:143], v[56:59], v[88:91], v[128:143]
    ds_read_b128 v[40:43], v31 offset:32768
    ds_read_b128 v[44:47], v31 offset:36864
    ds_read_b64_tr_b16 v[72:73], v33 offset:57344
    v_add_u32 v119, v119, v105
    v_mov_b32 v106, 0xf0000000
    v_mfma_f32_32x32x16_bf16 v[144:159], v[56:59], v[92:95], v[144:159]
    ds_read_b64_tr_b16 v[74:75], v33 offset:58368
    ds_read_b64_tr_b16 v[76:77], v34 offset:57344
    v_cmp_gt_u32 vcc, 576, v118
    s_nop 1
    v_cndmask_b32 v107, v106, v119, vcc
    v_mfma_f32_32x32x16_bf16 v[160:175], v[60:63], v[88:91], v[160:175]
    ds_read_b64_tr_b16 v[78:79], v34 offset:58368
    v_add_u32 v119, 16, v107
    v_cmp_eq_u32 vcc, 17, v104
    s_nop 1
    v_cndmask_b32 v224, v106, v119, vcc
    v_mfma_f32_32x32x16_bf16 v[176:191], v[60:63], v[92:95], v[176:191]
    s_add_u32 m0, s84, 19456
    s_add_u32 s69, s82, 28672
    buffer_load_dwordx4 v5, s[24:27], s69 offen lds
    s_waitcnt lgkmcnt(0)
    v_mfma_f32_32x32x16_bf16 v[128:143], v[40:43], v[72:75], v[128:143]
    ds_read_b128 v[56:59], v32 offset:32768
    ds_read_b128 v[60:63], v32 offset:36864
    ds_read_b64_tr_b16 v[88:89], v33 offset:61440
    v_mfma_f32_32x32x16_bf16 v[144:159], v[40:43], v[76:79], v[144:159]
    ds_read_b64_tr_b16 v[90:91], v33 offset:62464
    s_add_u32 s92, s4, 0
    v_add_u32 v192, s92, v107
    s_add_u32 s92, s4, 4
    v_mfma_f32_32x32x16_bf16 v[160:175], v[44:47], v[72:75], v[160:175]
    ds_read_b64_tr_b16 v[92:93], v34 offset:61440
    ds_read_b64_tr_b16 v[94:95], v34 offset:62464
    v_add_u32 v193, s92, v107
    v_mfma_f32_32x32x16_bf16 v[176:191], v[44:47], v[76:79], v[176:191]
    s_add_u32 s92, s4, 8
    v_add_u32 v194, s92, v107
    s_waitcnt vmcnt(12) lgkmcnt(0)
    s_barrier
    s_cmp_lg_u32 s68, 0
    s_cbranch_scc1 L_pj_tb1
    s_cmp_lg_u32 s67, 0
    s_cbranch_scc1 L_pj_tb1
    v_readfirstlane_b32 s65, v54
    s_nop 0
    s_cmp_ge_u32 s65, 16
    s_cbranch_scc0 L_pj_tb1_again
    buffer_inv sc1
    s_mov_b32 s67, 1
    s_branch L_pj_tb1
L_pj_tb1_again:
    buffer_load_dword v54, v53, s[32:35], s66 offen sc1
L_pj_tb1:
    v_mfma_f32_32x32x16_bf16 v[128:143], v[56:59], v[88:91], v[128:143]
    ds_read_b128 v[40:43], v29 offset:49152
    ds_read_b128 v[44:47], v29 offset:53248
    ds_read_b64_tr_b16 v[72:73], v35 offset:0
    v_mfma_f32_32x32x16_bf16 v[144:159], v[56:59], v[92:95], v[144:159]
    ds_read_b64_tr_b16 v[74:75], v35 offset:1024
    ds_read_b64_tr_b16 v[76:77], v36 offset:0
    s_add_u32 s92, s4, 12
    v_mfma_f32_32x32x16_bf16 v[160:175], v[60:63], v[88:91], v[160:175]
    ds_read_b64_tr_b16 v[78:79], v36 offset:1024
    v_add_u32 v195, s92, v107
    s_add_u32 s92, s5, 0
    v_add_u32 v196, s92, v107
    v_mfma_f32_32x32x16_bf16 v[176:191], v[60:63], v[92:95], v[176:191]
    s_add_u32 s92, s5, 4
    v_add_u32 v197, s92, v107
    s_add_u32 s92, s5, 8
    s_waitcnt lgkmcnt(0)
    v_mfma_f32_32x32x16_bf16 v[128:143], v[40:43], v[72:75], v[128:143]
    ds_read_b128 v[56:59], v30 offset:49152
    v_add_u32 v198, s92, v107
    s_add_u32 s92, s5, 12
    v_mfma_f32_32x32x16_bf16 v[144:159], v[40:43], v[76:79], v[144:159]
    ds_read_b128 v[60:63], v30 offset:53248
    ds_read_b64_tr_b16 v[88:89], v35 offset:4096
    v_add_u32 v199, s92, v107
    v_mfma_f32_32x32x16_bf16 v[160:175], v[44:47], v[72:75], v[160:175]
    ds_read_b64_tr_b16 v[90:91], v35 offset:5120
    ds_read_b64_tr_b16 v[92:93], v36 offset:4096
    ds_read_b64_tr_b16 v[94:95], v36 offset:5120
    v_mfma_f32_32x32x16_bf16 v[176:191], v[44:47], v[76:79], v[176:191]
    s_add_u32 s92, s6, 0
    v_add_u32 v208, s92, v107
    s_add_u32 s92, s6, 4
    s_waitcnt lgkmcnt(0)
    v_mfma_f32_32x32x16_bf16 v[128:143], v[56:59], v[88:91], v[128:143]
    ds_read_b128 v[40:43], v31 offset:49152
    v_add_u32 v209, s92, v107
    s_add_u32 s92, s6, 8
    v_mfma_f32_32x32x16_bf16 v[144:159], v[56:59], v[92:95], v[144:159]
    ds_read_b128 v[44:47], v31 offset:53248
    ds_read_b64_tr_b16 v[72:73], v35 offset:8192
    v_add_u32 v210, s92, v107
    v_mfma_f32_32x32x16_bf16 v[160:175], v[60:63], v[88:91], v[160:175]
    ds_read_b64_tr_b16 v[74:75], v35 offset:9216
    ds_read_b64_tr_b16 v[76:77], v36 offset:8192
    ds_read_b64_tr_b16 v[78:79], v36 offset:9216
    v_mfma_f32_32x32x16_bf16 v[176:191], v[60:63], v[92:95], v[176:191]
    s_add_u32 s92, s6, 12
    v_add_u32 v211, s92, v107
    s_add_u32 s92, s7, 0
    s_waitcnt lgkmcnt(0)
    v_mfma_f32_32x32x16_bf16 v[128:143], v[40:43], v[72:75], v[128:143]
    ds_read_b128 v[56:59], v32 offset:49152
    ds_read_b128 v[60:63], v32 offset:53248
    ds_read_b64_tr_b16 v[88:89], v35 offset:12288
    v_mfma_f32_32x32x16_bf16 v[144:159], v[40:43], v[76:79], v[144:159]
    v_add_u32 v212, s92, v107
    s_add_u32 s92, s7, 4
    v_add_u32 v213, s92, v107
    s_add_u32 s92, s7, 8
    v_mfma_f32_32x32x16_bf16 v[160:175], v[44:47], v[72:75], v[160:175]
    ds_read_b64_tr_b16 v[90:91], v35 offset:13312
    ds_read_b64_tr_b16 v[92:93], v36 offset:12288
    ds_read_b64_tr_b16 v[94:95], v36 offset:13312
    v_mfma_f32_32x32x16_bf16 v[176:191], v[44:47], v[76:79], v[176:191]
    v_add_u32 v214, s92, v107
    s_add_u32 s92, s7, 12
    s_waitcnt vmcnt(8) lgkmcnt(0)
    s_barrier
    v_mfma_f32_32x32x16_bf16 v[128:143], v[56:59], v[88:91], v[128:143]
    ds_read_b128 v[40:43], v29 offset:0
    ds_read_b128 v[44:47], v29 offset:4096
    ds_read_b64_tr_b16 v[72:73], v35 offset:16384
    v_mfma_f32_32x32x16_bf16 v[144:159], v[56:59], v[92:95], v[144:159]
    v_add_u32 v215, s92, v107
    s_lshl_b32 s92, s54, 7
    s_lshl_b32 s93, s77, 6
    s_add_u32 s92, s92, s93
    s_add_u32 s92, s92, 32
    v_mfma_f32_32x32x16_bf16 v[160:175], v[60:63], v[88:91], v[160:175]
    ds_read_b64_tr_b16 v[74:75], v35 offset:17408
    ds_read_b64_tr_b16 v[76:77], v36 offset:16384
    ds_read_b64_tr_b16 v[78:79], v36 offset:17408
    v_mfma_f32_32x32x16_bf16 v[176:191], v[60:63], v[92:95], v[176:191]
    s_sub_u32 s92, s92, 1152
    s_cmp_eq_u32 s75, 2
    s_cselect_b32 s92, 4096, s92
    v_and_b32 v118, 31, v0
    s_waitcnt lgkmcnt(0)
    v_mfma_f32_32x32x16_bf16 v[128:143], v[40:43], v[72:75], v[128:143]
    ds_read_b128 v[56:59], v30 offset:0
    ds_read_b128 v[60:63], v30 offset:4096
    v_add_u32 v118, s92, v118
    v_mfma_f32_32x32x16_bf16 v[144:159], v[40:43], v[76:79], v[144:159]
    ds_read_b64_tr_b16 v[88:89], v35 offset:20480
    ds_read_b64_tr_b16 v[90:91], v35 offset:21504
    ds_read_b64_tr_b16 v[92:93], v36 offset:20480
    v_mfma_f32_32x32x16_bf16 v[160:175], v[44:47], v[72:75], v[160:175]
    ds_read_b64_tr_b16 v[94:95], v36 offset:21504
    v_mul_u32_u24 v119, 3641, v118
    v_lshrrev_b32 v119, 16, v119
    v_mfma_f32_32x32x16_bf16 v[176:191], v[44:47], v[76:79], v[176:191]
    v_mul_u32_u24 v104, 18, v119
    v_sub_u32 v104, v118, v104
    s_mov_b32 s93, 151552
    s_waitcnt lgkmcnt(0)
    v_mfma_f32_32x32x16_bf16 v[128:143], v[56:59], v[88:91], v[128:143]
    ds_read_b128 v[40:43], v31 offset:0
    ds_read_b128 v[44:47], v31 offset:4096
    v_mul_lo_u32 v119, v119, s93
    v_mfma_f32_32x32x16_bf16 v[144:159], v[56:59], v[92:95], v[144:159]
    ds_read_b64_tr_b16 v[72:73], v35 offset:24576
    ds_read_b64_tr_b16 v[74:75], v35 offset:25600
    v_lshl_add_u32 v119, v104, 4, v119
    v_mfma_f32_32x32x16_bf16 v[160:175], v[60:63], v[88:91], v[160:175]
    ds_read_b64_tr_b16 v[76:77], v36 offset:24576
    ds_read_b64_tr_b16 v[78:79], v36 offset:25600
    v_lshrrev_b32 v105, 5, v0
    v_mfma_f32_32x32x16_bf16 v[176:191], v[60:63], v[92:95], v[176:191]
    v_mul_u32_u24 v105, 304, v105
    v_add_u32 v119, v119, v105
    v_mov_b32 v106, 0xf0000000
    s_waitcnt lgkmcnt(0)
    v_mfma_f32_32x32x16_bf16 v[128:143], v[40:43], v[72:75], v[128:143]
    ds_read_b128 v[56:59], v32 offset:0
    ds_read_b128 v[60:63], v32 offset:4096
    ds_read_b64_tr_b16 v[88:89], v35 offset:28672
    v_mfma_f32_32x32x16_bf16 v[144:159], v[40:43], v[76:79], v[144:159]
    v_cmp_gt_u32 vcc, 576, v118
    s_nop 1
    v_cndmask_b32 v107, v106, v119, vcc
    v_add_u32 v119, 16, v107
    v_mfma_f32_32x32x16_bf16 v[160:175], v[44:47], v[72:75], v[160:175]
    ds_read_b64_tr_b16 v[90:91], v35 offset:29696
    ds_read_b64_tr_b16 v[92:93], v36 offset:28672
    ds_read_b64_tr_b16 v[94:95], v36 offset:29696
    v_mfma_f32_32x32x16_bf16 v[176:191], v[44:47], v[76:79], v[176:191]
    v_cmp_eq_u32 vcc, 17, v104
    s_nop 1
    v_cndmask_b32 v225, v106, v119, vcc
    s_waitcnt vmcnt(0) lgkmcnt(0)
    s_barrier
    v_mfma_f32_32x32x16_bf16 v[128:143], v[56:59], v[88:91], v[128:143]
    ds_read_b128 v[40:43], v29 offset:16384
    ds_read_b128 v[44:47], v29 offset:20480
    ds_read_b64_tr_b16 v[72:73], v33 offset:0
    v_mfma_f32_32x32x16_bf16 v[144:159], v[56:59], v[92:95], v[144:159]
    ds_read_b64_tr_b16 v[74:75], v33 offset:1024
    s_add_u32 s92, s4, 0
    v_add_u32 v200, s92, v107
    v_mfma_f32_32x32x16_bf16 v[160:175], v[60:63], v[88:91], v[160:175]
    ds_read_b64_tr_b16 v[76:77], v34 offset:0
    ds_read_b64_tr_b16 v[78:79], v34 offset:1024
    s_add_u32 s92, s4, 4
    v_mfma_f32_32x32x16_bf16 v[176:191], v[60:63], v[92:95], v[176:191]
    v_add_u32 v201, s92, v107
    s_add_u32 s92, s4, 8
    v_add_u32 v202, s92, v107
    s_waitcnt lgkmcnt(0)
    v_mfma_f32_32x32x16_bf16 v[128:143], v[40:43], v[72:75], v[128:143]
    ds_read_b128 v[56:59], v30 offset:16384
    ds_read_b128 v[60:63], v30 offset:20480
    s_add_u32 s92, s4, 12
    v_mfma_f32_32x32x16_bf16 v[144:159], v[40:43], v[76:79], v[144:159]
    ds_read_b64_tr_b16 v[88:89], v33 offset:4096
    ds_read_b64_tr_b16 v[90:91], v33 offset:5120
    ds_read_b64_tr_b16 v[92:93], v34 offset:4096
    v_mfma_f32_32x32x16_bf16 v[160:175], v[44:47], v[72:75], v[160:175]
    ds_read_b64_tr_b16 v[94:95], v34 offset:5120
    v_add_u32 v203, s92, v107
    s_add_u32 s92, s5, 0
    v_add_u32 v204, s92, v107
    v_mfma_f32_32x32x16_bf16 v[176:191], v[44:47], v[76:79], v[176:191]
    s_add_u32 s92, s5, 4
    v_add_u32 v205, s92, v107
    s_add_u32 s92, s5, 8
    s_waitcnt lgkmcnt(0)
    v_mfma_f32_32x32x16_bf16 v[128:143], v[56:59], v[88:91], v[128:143]
    ds_read_b128 v[40:43], v31 offset:16384
    v_add_u32 v206, s92, v107
    s_add_u32 s92, s5, 12
    v_mfma_f32_32x32x16_bf16 v[144:159], v[56:59], v[92:95], v[144:159]
    ds_read_b128 v[44:47], v31 offset:20480
    ds_read_b64_tr_b16 v[72:73], v33 offset:8192
    ds_read_b64_tr_b16 v[74:75], v33 offset:9216
    v_mfma_f32_32x32x16_bf16 v[160:175], v[60:63], v[88:91], v[160:175]
    ds_read_b64_tr_b16 v[76:77], v34 offset:8192
    ds_read_b64_tr_b16 v[78:79], v34 offset:9216
    v_mfma_f32_32x32x16_bf16 v[176:191], v[60:63], v[92:95], v[176:191]
    v_add_u32 v207, s92, v107
    s_add_u32 s92, s6, 0
    v_add_u32 v216, s92, v107
    s_waitcnt lgkmcnt(0)
    v_mfma_f32_32x32x16_bf16 v[128:143], v[40:43], v[72:75], v[128:143]
    ds_read_b128 v[56:59], v32 offset:16384
    ds_read_b128 v[60:63], v32 offset:20480
    ds_read_b64_tr_b16 v[88:89], v33 offset:12288
    v_mfma_f32_32x32x16_bf16 v[144:159], v[40:43], v[76:79], v[144:159]
    ds_read_b64_tr_b16 v[90:91], v33 offset:13312
    s_add_u32 s92, s6, 4
    v_add_u32 v217, s92, v107
    v_mfma_f32_32x32x16_bf16 v[160:175], v[44:47], v[72:75], v[160:175]
    ds_read_b64_tr_b16 v[92:93], v34 offset:12288
    ds_read_b64_tr_b16 v[94:95], v34 offset:13312
    v_mfma_f32_32x32x16_bf16 v[176:191], v[44:47], v[76:79], v[176:191]
    s_add_u32 s92, s6, 8
    s_waitcnt lgkmcnt(0)
    s_barrier
    v_mfma_f32_32x32x16_bf16 v[128:143], v[56:59], v[88:91], v[128:143]
    v_add_u32 v218, s92, v107
    s_add_u32 s92, s6, 12
    v_add_u32 v219, s92, v107
    v_mfma_f32_32x32x16_bf16 v[144:159], v[56:59], v[92:95], v[144:159]
    s_add_u32 s92, s7, 0
    v_add_u32 v220, s92, v107
    s_add_u32 s92, s7, 4
    v_mfma_f32_32x32x16_bf16 v[160:175], v[60:63], v[88:91], v[160:175]
    v_add_u32 v221, s92, v107
    s_add_u32 s92, s7, 8
    v_add_u32 v222, s92, v107
    v_mfma_f32_32x32x16_bf16 v[176:191], v[60:63], v[92:95], v[176:191]
    s_add_u32 s92, s7, 12
    v_add_u32 v223, s92, v107
    s_waitcnt lgkmcnt(0)
    s_branch L_pj_H
L_pj_BN:
    v_mul_f32 v192, s53, v192
    v_mul_f32 v193, s53, v193
    v_mul_f32 v194, s53, v194
    v_mul_f32 v195, s53, v195
    v_mul_f32 v196, s53, v196
    v_mul_f32 v197, s53, v197
    v_mul_f32 v198, s53, v198
    v_mul_f32 v199, s53, v199
    v_mul_f32 v200, s53, v200
    v_mul_f32 v201, s53, v201
    v_mul_f32 v202, s53, v202
    v_mul_f32 v203, s53, v203
    v_mul_f32 v204, s53, v204
    v_mul_f32 v205, s53, v205
    v_mul_f32 v206, s53, v206
    v_mul_f32 v207, s53, v207
    v_cvt_pk_bf16_f32 v192, v192, v193
    v_cvt_pk_bf16_f32 v193, v194, v195
    v_cvt_pk_bf16_f32 v194, v196, v197
    v_cvt_pk_bf16_f32 v195, v198, v199
    v_cvt_pk_bf16_f32 v196, v200, v201
    v_cvt_pk_bf16_f32 v197, v202, v203
    v_cvt_pk_bf16_f32 v198, v204, v205
    v_cvt_pk_bf16_f32 v199, v206, v207
    v_accvgpr_write_b32 a160, v192
    v_accvgpr_write_b32 a161, v193
    v_accvgpr_write_b32 a162, v194
    v_accvgpr_write_b32 a163, v195
    v_accvgpr_write_b32 a164, v196
    v_accvgpr_write_b32 a165, v197
    v_accvgpr_write_b32 a166, v198
    v_accvgpr_write_b32 a167, v199
    v_mul_f32 v208, s53, v208
    v_mul_f32 v209, s53, v209
    v_mul_f32 v210, s53, v210
    v_mul_f32 v211, s53, v211
    v_mul_f32 v212, s53, v212
    v_mul_f32 v213, s53, v213
    v_mul_f32 v214, s53, v214
    v_mul_f32 v215, s53, v215
    v_mul_f32 v216, s53, v216
    v_mul_f32 v217, s53, v217
    v_mul_f32 v218, s53, v218
    v_mul_f32 v219, s53, v219
    v_mul_f32 v220, s53, v220
    v_mul_f32 v221, s53, v221
    v_mul_f32 v222, s53, v222
    v_mul_f32 v223, s53, v223
    v_cvt_pk_bf16_f32 v208, v208, v209
    v_cvt_pk_bf16_f32 v209, v210, v211
    v_cvt_pk_bf16_f32 v210, v212, v213
    v_cvt_pk_bf16_f32 v211, v214, v215
    v_cvt_pk_bf16_f32 v212, v216, v217
    v_cvt_pk_bf16_f32 v213, v218, v219
    v_cvt_pk_bf16_f32 v214, v220, v221
    v_cvt_pk_bf16_f32 v215, v222, v223
    v_accvgpr_write_b32 a168, v208
    v_accvgpr_write_b32 a169, v209
    v_accvgpr_write_b32 a170, v210
    v_accvgpr_write_b32 a171, v211
    v_accvgpr_write_b32 a172, v212
    v_accvgpr_write_b32 a173, v213
    v_accvgpr_write_b32 a174, v214
    v_accvgpr_write_b32 a175, v215
    v_mul_f32 v224, s53, v224
    v_mul_f32 v225, s53, v225
    v_mul_f32 v226, s53, v226
    v_mul_f32 v227, s53, v227
    v_mul_f32 v228, s53, v228
    v_mul_f32 v229, s53, v229
    v_mul_f32 v230, s53, v230
    v_mul_f32 v231, s53, v231
    v_mul_f32 v232, s53, v232
    v_mul_f32 v233, s53, v233
    v_mul_f32 v234, s53, v234
    v_mul_f32 v235, s53, v235
    v_mul_f32 v236, s53, v236
    v_mul_f32 v237, s53, v237
    v_mul_f32 v238, s53, v238
    v_mul_f32 v239, s53, v239
    v_cvt_pk_bf16_f32 v224, v224, v225
    v_cvt_pk_bf16_f32 v225, v226, v227
    v_cvt_pk_bf16_f32 v226, v228, v229
    v_cvt_pk_bf16_f32 v227, v230, v231
    v_cvt_pk_bf16_f32 v228, v232, v233
    v_cvt_pk_bf16_f32 v229, v234, v235
    v_cvt_pk_bf16_f32 v230, v236, v237
    v_cvt_pk_bf16_f32 v231, v238, v239
    v_accvgpr_write_b32 a176, v224
    v_accvgpr_write_b32 a177, v225
    v_accvgpr_write_b32 a178, v226
    v_accvgpr_write_b32 a179, v227
    v_accvgpr_write_b32 a180, v228
    v_accvgpr_write_b32 a181, v229
    v_accvgpr_write_b32 a182, v230
    v_accvgpr_write_b32 a183, v231
    v_mul_f32 v240, s53, v240
    v_mul_f32 v241, s53, v241
    v_mul_f32 v242, s53, v242
    v_mul_f32 v243, s53, v243
    v_mul_f32 v244, s53, v244
    v_mul_f32 v245, s53, v245
    v_mul_f32 v246, s53, v246
    v_mul_f32 v247, s53, v247
    v_mul_f32 v248, s53, v248
    v_mul_f32 v249, s53, v249
    v_mul_f32 v250, s53, v250
    v_mul_f32 v251, s53, v251
    v_mul_f32 v252, s53, v252
    v_mul_f32 v253, s53, v253
    v_mul_f32 v254, s53, v254
    v_mul_f32 v255, s53, v255
    v_cvt_pk_bf16_f32 v240, v240, v241
    v_cvt_pk_bf16_f32 v241, v242, v243
    v_cvt_pk_bf16_f32 v242, v244, v245
    v_cvt_pk_bf16_f32 v243, v246, v247
    v_cvt_pk_bf16_f32 v244, v248, v249
    v_cvt_pk_bf16_f32 v245, v250, v251
    v_cvt_pk_bf16_f32 v246, v252, v253
    v_cvt_pk_bf16_f32 v247, v254, v255
    v_accvgpr_write_b32 a184, v240
    v_accvgpr_write_b32 a185, v241
    v_accvgpr_write_b32 a186, v242
    v_accvgpr_write_b32 a187, v243
    v_accvgpr_write_b32 a188, v244
    v_accvgpr_write_b32 a189, v245
    v_accvgpr_write_b32 a190, v246
    v_accvgpr_write_b32 a191, v247
    s_waitcnt vmcnt(0)
L_pj_H:
    s_mov_b32 s44, s32
    s_mov_b32 s45, s33
    s_mov_b32 s46, s34
    s_mov_b32 s47, s35
    s_mov_b32 s48, s4
    s_mov_b32 s49, s5
    s_mov_b32 s50, s6
    s_mov_b32 s51, s7
    s_mov_b32 s18, s68
    s_mov_b32 s16, s58
    s_mov_b32 s17, s59
    s_mov_b32 s76, s53
    s_mov_b32 s77, s53
    s_mov_b32 s4, s32
    s_mov_b32 s5, s33
    s_mov_b32 s6, s34
    s_mov_b32 s7, s35
    v_lshlrev_b32 v1, 4, v0
    s_lshl_b32 s19, s17, 1
    s_sub_u32 s26, 32, s19
    s_lshl_b32 s19, s16, 19
    s_lshl_b32 s20, s18, 12
    s_add_u32 s22, s19, s20
    s_add_u32 s23, s22, 16777216
    s_mov_b32 s24, s20
    s_add_u32 s25, s20, 65536
    s_lshl_b32 s32, s17, 2
    s_add_u32 s32, s32, s18
    s_lshl_b32 s19, s17, 2
    s_sub_u32 s33, 60, s19
    s_add_u32 s33, s33, s18
    s_cmp_lg_u32 s68, 0
    s_cbranch_scc1 L_pj_polled_all
    s_cmp_lg_u32 s67, 0
    s_cbranch_scc1 L_pj_polled
    s_mov_b32 s64, 0x20000
L_pj_poll:
    s_waitcnt vmcnt(0)
    v_readfirstlane_b32 s65, v54
    s_sub_u32 s64, s64, 1
    s_cmp_ge_u32 s65, 16
    s_cbranch_scc1 L_pj_acq
    s_cmp_eq_u32 s64, 0
    s_cbranch_scc1 L_pj_acq
    s_sleep 4
    buffer_load_dword v54, v53, s[44:47], s66 offen sc1
    s_branch L_pj_poll
L_pj_acq:
    buffer_inv sc1
L_pj_polled:
    s_waitcnt vmcnt(0)
L_pj_polled_all:
    s_barrier
    s_add_u32 m0, s24, 0
    s_nop 0
    buffer_load_dwordx4 v1, s[4:7], s22 offen lds
    buffer_load_dwordx4 v1, s[4:7], s22 offen offset:1024 lds
    buffer_load_dwordx4 v1, s[4:7], s22 offen offset:2048 lds
    buffer_load_dwordx4 v1, s[4:7], s22 offen offset:3072 lds
    s_add_u32 s22, s22, 16384
    s_add_u32 m0, s25, 0
    s_nop 0
    buffer_load_dwordx4 v1, s[4:7], s23 offen lds
    buffer_load_dwordx4 v1, s[4:7], s23 offen offset:1024 lds
    buffer_load_dwordx4 v1, s[4:7], s23 offen offset:2048 lds
    buffer_load_dwordx4 v1, s[4:7], s23 offen offset:3072 lds
    s_add_u32 s23, s23, 16384
    s_add_u32 m0, s24, 16384
    s_nop 0
    buffer_load_dwordx4 v1, s[4:7], s22 offen lds
    buffer_load_dwordx4 v1, s[4:7], s22 offen offset:1024 lds
    buffer_load_dwordx4 v1, s[4:7], s22 offen offset:2048 lds
    buffer_load_dwordx4 v1, s[4:7], s22 offen offset:3072 lds
    s_add_u32 s22, s22, 16384
    s_add_u32 m0, s24, 32768
    s_nop 0
    buffer_load_dwordx4 v1, s[4:7], s22 offen lds
    buffer_load_dwordx4 v1, s[4:7], s22 offen offset:1024 lds
    buffer_load_dwordx4 v1, s[4:7], s22 offen offset:2048 lds
    buffer_load_dwordx4 v1, s[4:7], s22 offen offset:3072 lds
    s_add_u32 s22, s22, 16384
    s_nop 7
    s_cmp_eq_u32 s75, 2
    s_cbranch_scc1 L_pj_Ed
    s_cmp_lg_u32 s75, 0
    s_cbranch_scc1 L_pj_Ev
    v_mul_f32 v128, s57, v128
    v_mul_f32 v129, s57, v129
    v_cvt_pk_bf16_f32 v232, v128, v129
    buffer_store_dword v232, v192, s[44:47], 0 offen
    v_mul_f32 v130, s57, v130
    v_mul_f32 v131, s57, v131
    v_cvt_pk_bf16_f32 v233, v130, v131
    buffer_store_dword v233, v193, s[44:47], 0 offen
    v_mul_f32 v132, s57, v132
    v_mul_f32 v133, s57, v133
    v_cvt_pk_bf16_f32 v234, v132, v133
    buffer_store_dword v234, v194, s[44:47], 0 offen
    v_mul_f32 v134, s57, v134
    v_mul_f32 v135, s57, v135
    v_cvt_pk_bf16_f32 v235, v134, v135
    buffer_store_dword v235, v195, s[44:47], 0 offen
    v_mul_f32 v136, s57, v136
    v_mul_f32 v137, s57, v137
    v_cvt_pk_bf16_f32 v236, v136, v137
    buffer_store_dword v236, v196, s[44:47], 0 offen
    v_mul_f32 v138, s57, v138
    v_mul_f32 v139, s57, v139
    v_cvt_pk_bf16_f32 v237, v138, v139
    buffer_store_dword v237, v197, s[44:47], 0 offen
    v_mul_f32 v140, s57, v140
    v_mul_f32 v141, s57, v141
    v_cvt_pk_bf16_f32 v238, v140, v141
    buffer_store_dword v238, v198, s[44:47], 0 offen
    v_mul_f32 v142, s57, v142
    v_mul_f32 v143, s57, v143
    v_cvt_pk_bf16_f32 v239, v142, v143
    buffer_store_dword v239, v199, s[44:47], 0 offen
    v_mul_f32 v144, s57, v144
    v_mul_f32 v145, s57, v145
    v_cvt_pk_bf16_f32 v232, v144, v145
    buffer_store_dword v232, v200, s[44:47], 0 offen
    v_mul_f32 v146, s57, v146
    v_mul_f32 v147, s57, v147
    v_cvt_pk_bf16_f32 v233, v146, v147
    buffer_store_dword v233, v201, s[44:47], 0 offen
    v_mul_f32 v148, s57, v148
    v_mul_f32 v149, s57, v149
    v_cvt_pk_bf16_f32 v234, v148, v149
    buffer_store_dword v234, v202, s[44:47], 0 offen
    v_mul_f32 v150, s57, v150
    v_mul_f32 v151, s57, v151
    v_cvt_pk_bf16_f32 v235, v150, v151
    buffer_store_dword v235, v203, s[44:47], 0 offen
    v_mul_f32 v152, s57, v152
    v_mul_f32 v153, s57, v153
    v_cvt_pk_bf16_f32 v236, v152, v153
    buffer_store_dword v236, v204, s[44:47], 0 offen
    v_mul_f32 v154, s57, v154
    v_mul_f32 v155, s57, v155
    v_cvt_pk_bf16_f32 v237, v154, v155
    buffer_store_dword v237, v205, s[44:47], 0 offen
    v_mul_f32 v156, s57, v156
    v_mul_f32 v157, s57, v157
    v_cvt_pk_bf16_f32 v238, v156, v157
    buffer_store_dword v238, v206, s[44:47], 0 offen
    v_mul_f32 v158, s57, v158
    v_mul_f32 v159, s57, v159
    v_cvt_pk_bf16_f32 v239, v158, v159
    buffer_store_dword v239, v207, s[44:47], 0 offen
    v_mul_f32 v160, s57, v160
    v_mul_f32 v161, s57, v161
    v_cvt_pk_bf16_f32 v232, v160, v161
    buffer_store_dword v232, v208, s[44:47], 0 offen
    v_mul_f32 v162, s57, v162
    v_mul_f32 v163, s57, v163
    v_cvt_pk_bf16_f32 v233, v162, v163
    buffer_store_dword v233, v209, s[44:47], 0 offen
    v_mul_f32 v164, s57, v164
    v_mul_f32 v165, s57, v165
    v_cvt_pk_bf16_f32 v234, v164, v165
    buffer_store_dword v234, v210, s[44:47], 0 offen
    v_mul_f32 v166, s57, v166
    v_mul_f32 v167, s57, v167
    v_cvt_pk_bf16_f32 v235, v166, v167
    buffer_store_dword v235, v211, s[44:47], 0 offen
    v_mul_f32 v168, s57, v168
    v_mul_f32 v169, s57, v169
    v_cvt_pk_bf16_f32 v236, v168, v169
    buffer_store_dword v236, v212, s[44:47], 0 offen
    v_mul_f32 v170, s57, v170
    v_mul_f32 v171, s57, v171
    v_cvt_pk_bf16_f32 v237, v170, v171
    buffer_store_dword v237, v213, s[44:47], 0 offen
    v_mul_f32 v172, s57, v172
    v_mul_f32 v173, s57, v173
    v_cvt_pk_bf16_f32 v238, v172, v173
    buffer_store_dword v238, v214, s[44:47], 0 offen
    v_mul_f32 v174, s57, v174
    v_mul_f32 v175, s57, v175
    v_cvt_pk_bf16_f32 v239, v174, v175
    buffer_store_dword v239, v215, s[44:47], 0 offen
    v_mul_f32 v176, s57, v176
    v_mul_f32 v177, s57, v177
    v_cvt_pk_bf16_f32 v232, v176, v177
    buffer_store_dword v232, v216, s[44:47], 0 offen
    v_mul_f32 v178, s57, v178
    v_mul_f32 v179, s57, v179
    v_cvt_pk_bf16_f32 v233, v178, v179
    buffer_store_dword v233, v217, s[44:47], 0 offen
    v_mul_f32 v180, s57, v180
    v_mul_f32 v181, s57, v181
    v_cvt_pk_bf16_f32 v234, v180, v181
    buffer_store_dword v234, v218, s[44:47], 0 offen
    v_mul_f32 v182, s57, v182
    v_mul_f32 v183, s57, v183
    v_cvt_pk_bf16_f32 v235, v182, v183
    buffer_store_dword v235, v219, s[44:47], 0 offen
    v_mul_f32 v184, s57, v184
    v_mul_f32 v185, s57, v185
    v_cvt_pk_bf16_f32 v236, v184, v185
    buffer_store_dword v236, v220, s[44:47], 0 offen
    v_mul_f32 v186, s57, v186
    v_mul_f32 v187, s57, v187
    v_cvt_pk_bf16_f32 v237, v186, v187
    buffer_store_dword v237, v221, s[44:47], 0 offen
    v_mul_f32 v188, s57, v188
    v_mul_f32 v189, s57, v189
    v_cvt_pk_bf16_f32 v238, v188, v189
    buffer_store_dword v238, v222, s[44:47], 0 offen
    v_mul_f32 v190, s57, v190
    v_mul_f32 v191, s57, v191
    v_cvt_pk_bf16_f32 v239, v190, v191
    buffer_store_dword v239, v223, s[44:47], 0 offen
    s_branch L_pj_Ed
L_pj_Ev:
    v_cvt_pk_bf16_f32 v232, v128, v129
    v_cvt_pk_bf16_f32 v233, v130, v131
    v_cvt_pk_bf16_f32 v234, v132, v133
    v_cvt_pk_bf16_f32 v235, v134, v135
    v_cvt_pk_bf16_f32 v236, v136, v137
    v_cvt_pk_bf16_f32 v237, v138, v139
    v_cvt_pk_bf16_f32 v238, v140, v141
    v_cvt_pk_bf16_f32 v239, v142, v143
    buffer_store_dwordx4 v[232:235], v192, s[44:47], 0 offen
    buffer_store_dwordx4 v[236:239], v196, s[44:47], 0 offen
    v_cvt_pk_bf16_f32 v104, v144, v145
    v_cvt_pk_bf16_f32 v105, v146, v147
    v_cvt_pk_bf16_f32 v106, v148, v149
    v_cvt_pk_bf16_f32 v107, v150, v151
    v_cvt_pk_bf16_f32 v108, v152, v153
    v_cvt_pk_bf16_f32 v109, v154, v155
    v_cvt_pk_bf16_f32 v110, v156, v157
    v_cvt_pk_bf16_f32 v111, v158, v159
    buffer_store_dwordx4 v[104:107], v200, s[44:47], 0 offen
    buffer_store_dwordx4 v[108:111], v204, s[44:47], 0 offen
    v_cvt_pk_bf16_f32 v232, v160, v161
    v_cvt_pk_bf16_f32 v233, v162, v163
    v_cvt_pk_bf16_f32 v234, v164, v165
    v_cvt_pk_bf16_f32 v235, v166, v167
    v_cvt_pk_bf16_f32 v236, v168, v169
    v_cvt_pk_bf16_f32 v237, v170, v171
    v_cvt_pk_bf16_f32 v238, v172, v173
    v_cvt_pk_bf16_f32 v239, v174, v175
    buffer_store_dwordx4 v[232:235], v208, s[44:47], 0 offen
    buffer_store_dwordx4 v[236:239], v212, s[44:47], 0 offen
    v_cvt_pk_bf16_f32 v104, v176, v177
    v_cvt_pk_bf16_f32 v105, v178, v179
    v_cvt_pk_bf16_f32 v106, v180, v181
    v_cvt_pk_bf16_f32 v107, v182, v183
    v_cvt_pk_bf16_f32 v108, v184, v185
    v_cvt_pk_bf16_f32 v109, v186, v187
    v_cvt_pk_bf16_f32 v110, v188, v189
    v_cvt_pk_bf16_f32 v111, v190, v191
    buffer_store_dwordx4 v[104:107], v216, s[44:47], 0 offen
    buffer_store_dwordx4 v[108:111], v220, s[44:47], 0 offen
    buffer_store_dwordx4 v[226:229], v224, s[44:47], s48 offen
    buffer_store_dwordx4 v[226:229], v225, s[44:47], s48 offen
    buffer_store_dwordx4 v[226:229], v224, s[44:47], s49 offen
    buffer_store_dwordx4 v[226:229], v225, s[44:47], s49 offen
    buffer_store_dwordx4 v[226:229], v224, s[44:47], s50 offen
    buffer_store_dwordx4 v[226:229], v225, s[44:47], s50 offen
    buffer_store_dwordx4 v[226:229], v224, s[44:47], s51 offen
    buffer_store_dwordx4 v[226:229], v225, s[44:47], s51 offen
L_pj_Ed:
    s_mul_i32 s51, s2, 18432
    s_lshl_b32 s52, s18, 10
    s_add_u32 s51, s51, s52
    s_add_u32 s52, s52, 131072
    s_add_u32 m0, s52, 0
    s_add_u32 s54, s51, 0
    buffer_load_dwordx4 v1, s[36:39], s54 offen lds
    s_add_u32 m0, s52, 4096
    s_add_u32 s54, s51, 4096
    buffer_load_dwordx4 v1, s[36:39], s54 offen lds
    s_add_u32 m0, s52, 8192
    s_add_u32 s54, s51, 8192
    buffer_load_dwordx4 v1, s[36:39], s54 offen lds
    s_add_u32 m0, s52, 12288
    s_add_u32 s54, s51, 12288
    buffer_load_dwordx4 v1, s[36:39], s54 offen lds
    s_add_u32 m0, s52, 16384
    s_add_u32 s54, s51, 16384
    buffer_load_dwordx4 v1, s[36:39], s54 offen lds
    s_add_u32 m0, s25, 16384
    s_nop 0
    buffer_load_dwordx4 v1, s[4:7], s23 offen lds
    buffer_load_dwordx4 v1, s[4:7], s23 offen offset:1024 lds
    buffer_load_dwordx4 v1, s[4:7], s23 offen offset:2048 lds
    buffer_load_dwordx4 v1, s[4:7], s23 offen offset:3072 lds
    s_add_u32 s23, s23, 16384
    s_add_u32 m0, s24, 49152
    s_nop 0
    buffer_load_dwordx4 v1, s[4:7], s22 offen lds
    buffer_load_dwordx4 v1, s[4:7], s22 offen offset:1024 lds
    buffer_load_dwordx4 v1, s[4:7], s22 offen offset:2048 lds
    buffer_load_dwordx4 v1, s[4:7], s22 offen offset:3072 lds
    s_add_u32 s22, s22, 16384
    v_and_b32 v2, 31, v0
    v_lshrrev_b32 v3, 5, v0
    v_lshlrev_b32 v3, 2, v3
    v_sub_u32 v2, v2, v3
    s_lshl_b32 s19, s32, 5
    v_add_u32 v9, s19, v2
    v_cvt_f32_i32 v9, v9
    s_lshl_b32 s19, s33, 5
    v_add_u32 v10, s19, v2
    v_cvt_f32_i32 v10, v10
    v_mov_b32 v12, 0
    v_mov_b32 v13, 0
    s_mov_b32 s31, 1602224128
    s_mov_b32 s28, 0
    s_mov_b32 s29, 0x8000
    s_mov_b32 s27, 0
    v_add_u32 v7, 16384, v1
    v_add_u32 v15, 65536, v1
    v_mov_b32 v8, v15
    s_cmp_eq_u32 s75, 0
    s_cbranch_scc1 L_A_wq
    s_cmp_eq_u32 s75, 1
    s_cbranch_scc1 L_A_wv
    s_waitcnt vmcnt(25)
L_A_wv:
    s_waitcnt vmcnt(41)
L_A_wq:
    s_waitcnt vmcnt(57)
    s_barrier
    ds_read_b128 v[128:131], v1 offset:0
    ds_read_b128 v[132:135], v1 offset:1024
    ds_read_b128 v[136:139], v1 offset:2048
    ds_read_b128 v[140:143], v1 offset:3072
    ds_read_b128 v[144:147], v1 offset:4096
    ds_read_b128 v[148:151], v1 offset:5120
    ds_read_b128 v[152:155], v1 offset:6144
    ds_read_b128 v[156:159], v1 offset:7168
    s_cmp_lg_u32 s17, 0
    s_cbranch_scc1 L_A_nomask0
    v_mov_b32 v192, 0
    v_mul_f32 v11, 0x7149f2ca, v9
    v_add_f32 v80, 0x70c9f2ca, v11
    v_add_f32 v81, 0xf0c9f2ca, v11
    v_add_f32 v82, 0xf1977617, v11
    v_add_f32 v83, 0xf1fc6f7c, v11
    v_add_f32 v84, 0xf2bd539d, v11
    v_add_f32 v85, 0xf2d691f6, v11
    v_add_f32 v86, 0xf2efd050, v11
    v_add_f32 v87, 0xf3048754, v11
    v_add_f32 v88, 0xf343a333, v11
    v_add_f32 v89, 0xf3504260, v11
    v_add_f32 v90, 0xf35ce18d, v11
    v_add_f32 v91, 0xf36980b9, v11
    v_add_f32 v92, 0xf3944e4c, v11
    v_add_f32 v93, 0xf39a9de3, v11
    v_add_f32 v94, 0xf3a0ed79, v11
    v_add_f32 v95, 0xf3a73d0f, v11
    v_min_f32 v80, v192, v80
    v_min_f32 v81, v192, v81
    v_min_f32 v82, v192, v82
    v_min_f32 v83, v192, v83
    v_min_f32 v84, v192, v84
    v_min_f32 v85, v192, v85
    v_min_f32 v86, v192, v86
    v_min_f32 v87, v192, v87
    v_min_f32 v88, v192, v88
    v_min_f32 v89, v192, v89
    v_min_f32 v90, v192, v90
    v_min_f32 v91, v192, v91
    v_min_f32 v92, v192, v92
    v_min_f32 v93, v192, v93
    v_min_f32 v94, v192, v94
    v_min_f32 v95, v192, v95
    v_add_f32 v9, 0xc2000000, v9
    s_waitcnt lgkmcnt(0)
    v_mfma_f32_32x32x16_bf16 v[16:31], v[128:131], a[128:131], v[80:95]
    v_mfma_f32_32x32x16_bf16 v[16:31], v[132:135], a[132:135], v[16:31]
    v_mfma_f32_32x32x16_bf16 v[16:31], v[136:139], a[136:139], v[16:31]
    v_mfma_f32_32x32x16_bf16 v[16:31], v[140:143], a[140:143], v[16:31]
    v_mfma_f32_32x32x16_bf16 v[16:31], v[144:147], a[144:147], v[16:31]
    v_mfma_f32_32x32x16_bf16 v[16:31], v[148:151], a[148:151], v[16:31]
    v_mfma_f32_32x32x16_bf16 v[16:31], v[152:155], a[152:155], v[16:31]
    v_mfma_f32_32x32x16_bf16 v[16:31], v[156:159], a[156:159], v[16:31]
    s_branch L_A_m0done
L_A_nomask0:
    v_add_f32 v9, 0xc2000000, v9
    s_waitcnt lgkmcnt(0)
    v_mfma_f32_32x32x16_bf16 v[16:31], v[128:131], a[128:131], 0
    v_mfma_f32_32x32x16_bf16 v[16:31], v[132:135], a[132:135], v[16:31]
    v_mfma_f32_32x32x16_bf16 v[16:31], v[136:139], a[136:139], v[16:31]
    v_mfma_f32_32x32x16_bf16 v[16:31], v[140:143], a[140:143], v[16:31]
    v_mfma_f32_32x32x16_bf16 v[16:31], v[144:147], a[144:147], v[16:31]
    v_mfma_f32_32x32x16_bf16 v[16:31], v[148:151], a[148:151], v[16:31]
    v_mfma_f32_32x32x16_bf16 v[16:31], v[152:155], a[152:155], v[16:31]
    v_mfma_f32_32x32x16_bf16 v[16:31], v[156:159], a[156:159], v[16:31]
L_A_m0done:
    v_add_f32 v10, 0xc2000000, v10
    s_nop 0
    v_mfma_f32_32x32x16_bf16 v[32:47], v[128:131], a[160:163], 0
    v_mfma_f32_32x32x16_bf16 v[32:47], v[132:135], a[164:167], v[32:47]
    v_mfma_f32_32x32x16_bf16 v[32:47], v[136:139], a[168:171], v[32:47]
    v_max3_f32 v2, v16, v17, v18
    v_max3_f32 v2, v2, v19, v20
    v_max3_f32 v2, v2, v21, v22
    v_max3_f32 v2, v2, v23, v24
    v_max3_f32 v2, v2, v25, v26
    v_mfma_f32_32x32x16_bf16 v[32:47], v[140:143], a[172:175], v[32:47]
    v_max3_f32 v2, v2, v27, v28
    v_max3_f32 v2, v2, v29, v30
    v_max_f32 v2, v2, v31
    v_mov_b32 v3, v2
    s_nop 1
    v_mfma_f32_32x32x16_bf16 v[32:47], v[144:147], a[176:179], v[32:47]
    v_permlane32_swap_b32 v2, v3
    s_nop 1
    v_max_f32 v2, v2, v3
    v_add_f32 v2, 0x42c00000, v2
    v_sub_f32 v48, 0, v2
    v_mfma_f32_32x32x16_bf16 v[32:47], v[148:151], a[180:183], v[32:47]
    v_sub_f32 v49, 0, v2
    v_sub_f32 v50, 0, v2
    v_sub_f32 v51, 0, v2
    v_sub_f32 v52, 0, v2
    v_sub_f32 v53, 0, v2
    v_mfma_f32_32x32x16_bf16 v[32:47], v[152:155], a[184:187], v[32:47]
    v_sub_f32 v54, 0, v2
    v_sub_f32 v55, 0, v2
    v_sub_f32 v56, 0, v2
    v_sub_f32 v57, 0, v2
    v_sub_f32 v58, 0, v2
    v_mfma_f32_32x32x16_bf16 v[32:47], v[156:159], a[188:191], v[32:47]
    v_sub_f32 v59, 0, v2
    v_sub_f32 v60, 0, v2
    v_sub_f32 v61, 0, v2
    v_sub_f32 v62, 0, v2
    v_sub_f32 v63, 0, v2
    ds_read_b128 v[128:131], v1 offset:8192
    ds_read_b128 v[132:135], v1 offset:9216
    ds_read_b128 v[136:139], v1 offset:10240
    ds_read_b128 v[140:143], v1 offset:11264
    ds_read_b128 v[144:147], v1 offset:12288
    ds_read_b128 v[148:151], v1 offset:13312
    ds_read_b128 v[152:155], v1 offset:14336
    ds_read_b128 v[156:159], v1 offset:15360
    v_sub_f32 v16, v16, v2
    v_sub_f32 v17, v17, v2
    v_sub_f32 v18, v18, v2
    v_sub_f32 v19, v19, v2
    v_sub_f32 v20, v20, v2
    v_sub_f32 v21, v21, v2
    v_sub_f32 v22, v22, v2
    v_sub_f32 v23, v23, v2
    v_sub_f32 v24, v24, v2
    v_sub_f32 v25, v25, v2
    v_sub_f32 v26, v26, v2
    v_sub_f32 v27, v27, v2
    v_sub_f32 v28, v28, v2
    v_sub_f32 v29, v29, v2
    v_sub_f32 v30, v30, v2
    v_sub_f32 v31, v31, v2
    v_exp_f32 v16, v16
    v_exp_f32 v17, v17
    v_exp_f32 v18, v18
    v_add_f32 v12, v12, v16
    v_exp_f32 v19, v19
    v_add_f32 v12, v12, v17
    v_exp_f32 v20, v20
    v_add_f32 v12, v12, v18
    v_max3_f32 v4, v32, v33, v34
    v_max3_f32 v4, v4, v35, v36
    v_max3_f32 v4, v4, v37, v38
    v_max3_f32 v4, v4, v39, v40
    v_max3_f32 v4, v4, v41, v42
    v_max3_f32 v4, v4, v43, v44
    v_max3_f32 v4, v4, v45, v46
    v_max_f32 v4, v4, v47
    v_mov_b32 v5, v4
    s_nop 1
    v_permlane32_swap_b32 v4, v5
    s_nop 1
    v_max_f32 v4, v4, v5
    v_add_f32 v4, 0x42c00000, v4
    v_sub_f32 v64, 0, v4
    v_sub_f32 v65, 0, v4
    v_sub_f32 v66, 0, v4
    v_sub_f32 v67, 0, v4
    v_sub_f32 v68, 0, v4
    v_sub_f32 v69, 0, v4
    v_sub_f32 v70, 0, v4
    v_sub_f32 v71, 0, v4
    v_sub_f32 v72, 0, v4
    v_sub_f32 v73, 0, v4
    v_sub_f32 v74, 0, v4
    v_sub_f32 v75, 0, v4
    v_sub_f32 v76, 0, v4
    v_sub_f32 v77, 0, v4
    v_sub_f32 v78, 0, v4
    v_sub_f32 v79, 0, v4
    v_sub_f32 v32, v32, v4
    v_sub_f32 v33, v33, v4
    v_sub_f32 v34, v34, v4
    v_sub_f32 v35, v35, v4
    v_sub_f32 v36, v36, v4
    v_sub_f32 v37, v37, v4
    v_sub_f32 v38, v38, v4
    v_sub_f32 v39, v39, v4
    v_sub_f32 v40, v40, v4
    v_sub_f32 v41, v41, v4
    v_sub_f32 v42, v42, v4
    v_sub_f32 v43, v43, v4
    v_sub_f32 v44, v44, v4
    v_sub_f32 v45, v45, v4
    v_sub_f32 v46, v46, v4
    v_sub_f32 v47, v47, v4
    v_exp_f32 v21, v21
    v_add_f32 v12, v12, v19
    v_exp_f32 v22, v22
    v_add_f32 v12, v12, v20
    v_exp_f32 v23, v23
    v_add_f32 v12, v12, v21
    v_exp_f32 v24, v24
    v_add_f32 v12, v12, v22
    v_exp_f32 v25, v25
    v_add_f32 v12, v12, v23
    v_exp_f32 v26, v26
    v_add_f32 v12, v12, v24
    v_exp_f32 v27, v27
    v_add_f32 v12, v12, v25
    v_exp_f32 v28, v28
    v_add_f32 v12, v12, v26
    v_exp_f32 v29, v29
    v_add_f32 v12, v12, v27
    v_exp_f32 v30, v30
    v_add_f32 v12, v12, v28
    v_exp_f32 v31, v31
    v_add_f32 v12, v12, v29
    v_add_f32 v12, v12, v30
    v_add_f32 v12, v12, v31
    s_nop 0
    v_cvt_pk_bf16_f32 v112, v16, v17
    v_cvt_pk_bf16_f32 v113, v18, v19
    v_cvt_pk_bf16_f32 v114, v20, v21
    v_cvt_pk_bf16_f32 v115, v22, v23
    v_cvt_pk_bf16_f32 v116, v24, v25
    v_cvt_pk_bf16_f32 v117, v26, v27
    v_cvt_pk_bf16_f32 v118, v28, v29
    v_cvt_pk_bf16_f32 v119, v30, v31
    v_exp_f32 v32, v32
    v_exp_f32 v33, v33
    v_exp_f32 v34, v34
    v_add_f32 v13, v13, v32
    v_exp_f32 v35, v35
    v_add_f32 v13, v13, v33
    v_exp_f32 v36, v36
    v_add_f32 v13, v13, v34
    v_exp_f32 v37, v37
    v_add_f32 v13, v13, v35
    v_exp_f32 v38, v38
    v_add_f32 v13, v13, v36
    v_exp_f32 v39, v39
    v_add_f32 v13, v13, v37
    s_waitcnt lgkmcnt(0)
    s_lshl_b32 s34, s17, 1
    s_sub_u32 s34, s34, 1
    s_cmp_lt_i32 s34, 1
    s_cbranch_scc1 L_A_p1m_enter
L_A_p1:
    v_mfma_f32_32x32x16_bf16 v[16:31], v[128:131], a[128:131], v[48:63]
    v_exp_f32 v40, v40
    v_add_f32 v13, v13, v38
    v_exp_f32 v41, v41
    v_mfma_f32_32x32x16_bf16 v[16:31], v[132:135], a[132:135], v[16:31]
    v_mov_b32 v6, v7
    v_add_u32 v7, s29, v1
    v_add_f32 v13, v13, v39
    v_exp_f32 v42, v42
    v_add_f32 v13, v13, v40
    v_mfma_f32_32x32x16_bf16 v[16:31], v[136:139], a[136:139], v[16:31]
    v_exp_f32 v43, v43
    v_add_f32 v13, v13, v41
    v_exp_f32 v44, v44
    v_mfma_f32_32x32x16_bf16 v[16:31], v[140:143], a[140:143], v[16:31]
    v_add_f32 v13, v13, v42
    v_exp_f32 v45, v45
    v_add_f32 v13, v13, v43
    s_waitcnt lgkmcnt(0)
    v_mfma_f32_32x32x16_bf16 v[16:31], v[144:147], a[144:147], v[16:31]
    v_exp_f32 v46, v46
    v_add_f32 v13, v13, v44
    v_exp_f32 v47, v47
    v_mfma_f32_32x32x16_bf16 v[16:31], v[148:151], a[148:151], v[16:31]
    v_add_f32 v13, v13, v45
    v_add_f32 v13, v13, v46
    v_add_f32 v13, v13, v47
    v_cvt_pk_bf16_f32 v120, v32, v33
    v_mfma_f32_32x32x16_bf16 v[16:31], v[152:155], a[152:155], v[16:31]
    v_cvt_pk_bf16_f32 v121, v34, v35
    v_cvt_pk_bf16_f32 v122, v36, v37
    v_cvt_pk_bf16_f32 v123, v38, v39
    v_cvt_pk_bf16_f32 v124, v40, v41
    v_cvt_pk_bf16_f32 v125, v42, v43
    v_mfma_f32_32x32x16_bf16 v[16:31], v[156:159], a[156:159], v[16:31]
    s_waitcnt vmcnt(8)
    s_barrier
    v_cvt_pk_bf16_f32 v126, v44, v45
    v_cvt_pk_bf16_f32 v127, v46, v47
    v_mfma_f32_32x32x16_bf16 v[32:47], v[128:131], a[160:163], v[64:79]
    s_or_b32 m0, s28, s24
    v_max_f32 v2, v12, v13
    v_cmp_lt_f32 vcc, s31, v2
    s_cbranch_vccnz L_A_rare_p1
L_A_ret_p1:
    ds_read_b128 v[160:163], v8 offset:0
    v_mfma_f32_32x32x16_bf16 v[32:47], v[132:135], a[164:167], v[32:47]
    ds_read_b128 v[164:167], v8 offset:1024
    v_exp_f32 v16, v16
    v_exp_f32 v17, v17
    v_mfma_f32_32x32x16_bf16 v[32:47], v[136:139], a[168:171], v[32:47]
    buffer_load_dwordx4 v1, s[4:7], s22 offen lds
    ds_read_b128 v[168:171], v8 offset:2048
    v_exp_f32 v18, v18
    v_mfma_f32_32x32x16_bf16 v[32:47], v[140:143], a[172:175], v[32:47]
    ds_read_b128 v[172:175], v8 offset:3072
    v_add_f32 v12, v12, v16
    v_exp_f32 v19, v19
    v_add_f32 v12, v12, v17
    v_mfma_f32_32x32x16_bf16 v[32:47], v[144:147], a[176:179], v[32:47]
    buffer_load_dwordx4 v1, s[4:7], s22 offen offset:1024 lds
    ds_read_b128 v[176:179], v8 offset:4096
    v_exp_f32 v20, v20
    v_mfma_f32_32x32x16_bf16 v[32:47], v[148:151], a[180:183], v[32:47]
    ds_read_b128 v[180:183], v8 offset:5120
    v_add_f32 v12, v12, v18
    v_exp_f32 v21, v21
    v_add_f32 v12, v12, v19
    v_mfma_f32_32x32x16_bf16 v[32:47], v[152:155], a[184:187], v[32:47]
    buffer_load_dwordx4 v1, s[4:7], s22 offen offset:2048 lds
    ds_read_b128 v[184:187], v8 offset:6144
    v_exp_f32 v22, v22
    v_mfma_f32_32x32x16_bf16 v[32:47], v[156:159], a[188:191], v[32:47]
    ds_read_b128 v[188:191], v8 offset:7168
    v_add_f32 v12, v12, v20
    v_exp_f32 v23, v23
    s_waitcnt lgkmcnt(4)
    v_mfma_f32_32x32x16_bf16 a[0:15], v[160:163], v[112:115], a[0:15]
    buffer_load_dwordx4 v1, s[4:7], s22 offen offset:3072 lds
    v_add_f32 v12, v12, v21
    v_exp_f32 v24, v24
    v_mfma_f32_32x32x16_bf16 a[16:31], v[164:167], v[112:115], a[16:31]
    s_add_u32 s22, s22, 16384
    s_add_u32 m0, s29, s25
    v_add_f32 v12, v12, v22
    v_exp_f32 v25, v25
    v_mfma_f32_32x32x16_bf16 a[32:47], v[168:171], v[112:115], a[32:47]
    buffer_load_dwordx4 v1, s[4:7], s23 offen lds
    v_add_f32 v12, v12, v23
    v_exp_f32 v26, v26
    v_add_f32 v12, v12, v24
    v_mfma_f32_32x32x16_bf16 a[48:63], v[172:175], v[112:115], a[48:63]
    v_exp_f32 v27, v27
    v_add_f32 v12, v12, v25
    v_exp_f32 v28, v28
    s_waitcnt lgkmcnt(0)
    v_mfma_f32_32x32x16_bf16 a[0:15], v[176:179], v[116:119], a[0:15]
    buffer_load_dwordx4 v1, s[4:7], s23 offen offset:1024 lds
    v_add_f32 v12, v12, v26
    v_exp_f32 v29, v29
    v_add_f32 v12, v12, v27
    v_mfma_f32_32x32x16_bf16 a[16:31], v[180:183], v[116:119], a[16:31]
    v_exp_f32 v30, v30
    v_add_f32 v12, v12, v28
    v_exp_f32 v31, v31
    v_add_f32 v12, v12, v29
    v_mfma_f32_32x32x16_bf16 a[32:47], v[184:187], v[116:119], a[32:47]
    buffer_load_dwordx4 v1, s[4:7], s23 offen offset:2048 lds
    v_add_f32 v12, v12, v30
    v_add_f32 v12, v12, v31
    v_cvt_pk_bf16_f32 v112, v16, v17
    v_cvt_pk_bf16_f32 v113, v18, v19
    v_mfma_f32_32x32x16_bf16 a[48:63], v[188:191], v[116:119], a[48:63]
    v_cvt_pk_bf16_f32 v114, v20, v21
    v_cvt_pk_bf16_f32 v115, v22, v23
    v_cvt_pk_bf16_f32 v116, v24, v25
    v_cvt_pk_bf16_f32 v117, v26, v27
    v_cvt_pk_bf16_f32 v118, v28, v29
    v_cvt_pk_bf16_f32 v119, v30, v31
    v_mfma_f32_32x32x16_bf16 a[64:79], v[160:163], v[120:123], a[64:79]
    buffer_load_dwordx4 v1, s[4:7], s23 offen offset:3072 lds
    ds_read_b128 v[128:131], v6 offset:0
    v_exp_f32 v32, v32
    v_mfma_f32_32x32x16_bf16 a[80:95], v[164:167], v[120:123], a[80:95]
    s_add_u32 s23, s23, 16384
    ds_read_b128 v[132:135], v6 offset:1024
    v_exp_f32 v33, v33
    v_mfma_f32_32x32x16_bf16 a[96:111], v[168:171], v[120:123], a[96:111]
    ds_read_b128 v[136:139], v6 offset:2048
    v_exp_f32 v34, v34
    v_add_f32 v13, v13, v32
    v_mfma_f32_32x32x16_bf16 a[112:127], v[172:175], v[120:123], a[112:127]
    ds_read_b128 v[140:143], v6 offset:3072
    v_exp_f32 v35, v35
    v_add_f32 v13, v13, v33
    v_mfma_f32_32x32x16_bf16 a[64:79], v[176:179], v[124:127], a[64:79]
    ds_read_b128 v[144:147], v6 offset:4096
    v_exp_f32 v36, v36
    v_add_f32 v13, v13, v34
    v_mfma_f32_32x32x16_bf16 a[80:95], v[180:183], v[124:127], a[80:95]
    ds_read_b128 v[148:151], v6 offset:5120
    v_exp_f32 v37, v37
    v_add_f32 v13, v13, v35
    v_mfma_f32_32x32x16_bf16 a[96:111], v[184:187], v[124:127], a[96:111]
    ds_read_b128 v[152:155], v6 offset:6144
    v_exp_f32 v38, v38
    v_add_f32 v13, v13, v36
    v_mfma_f32_32x32x16_bf16 a[112:127], v[188:191], v[124:127], a[112:127]
    ds_read_b128 v[156:159], v6 offset:7168
    v_exp_f32 v39, v39
    v_add_f32 v13, v13, v37
    s_waitcnt lgkmcnt(4)
    v_mfma_f32_32x32x16_bf16 v[16:31], v[128:131], a[128:131], v[48:63]
    v_exp_f32 v40, v40
    v_add_f32 v13, v13, v38
    v_exp_f32 v41, v41
    v_mfma_f32_32x32x16_bf16 v[16:31], v[132:135], a[132:135], v[16:31]
    v_add_f32 v13, v13, v39
    v_exp_f32 v42, v42
    v_add_f32 v13, v13, v40
    v_mfma_f32_32x32x16_bf16 v[16:31], v[136:139], a[136:139], v[16:31]
    v_exp_f32 v43, v43
    v_add_f32 v13, v13, v41
    v_exp_f32 v44, v44
    v_mfma_f32_32x32x16_bf16 v[16:31], v[140:143], a[140:143], v[16:31]
    v_add_f32 v13, v13, v42
    v_exp_f32 v45, v45
    s_waitcnt lgkmcnt(0)
    v_mfma_f32_32x32x16_bf16 v[16:31], v[144:147], a[144:147], v[16:31]
    v_add_f32 v13, v13, v43
    v_exp_f32 v46, v46
    v_add_f32 v13, v13, v44
    v_mfma_f32_32x32x16_bf16 v[16:31], v[148:151], a[148:151], v[16:31]
    v_exp_f32 v47, v47
    v_add_f32 v13, v13, v45
    v_add_f32 v13, v13, v46
    v_add_f32 v13, v13, v47
    v_mfma_f32_32x32x16_bf16 v[16:31], v[152:155], a[152:155], v[16:31]
    v_cvt_pk_bf16_f32 v120, v32, v33
    v_cvt_pk_bf16_f32 v121, v34, v35
    v_cvt_pk_bf16_f32 v122, v36, v37
    v_cvt_pk_bf16_f32 v123, v38, v39
    v_mfma_f32_32x32x16_bf16 v[16:31], v[156:159], a[156:159], v[16:31]
    v_cvt_pk_bf16_f32 v124, v40, v41
    v_cvt_pk_bf16_f32 v125, v42, v43
    v_cvt_pk_bf16_f32 v126, v44, v45
    v_cvt_pk_bf16_f32 v127, v46, v47
    v_mfma_f32_32x32x16_bf16 v[32:47], v[128:131], a[160:163], v[64:79]
    ds_read_b128 v[160:163], v8 offset:8192
    v_mfma_f32_32x32x16_bf16 v[32:47], v[132:135], a[164:167], v[32:47]
    ds_read_b128 v[164:167], v8 offset:9216
    v_exp_f32 v16, v16
    v_exp_f32 v17, v17
    v_mfma_f32_32x32x16_bf16 v[32:47], v[136:139], a[168:171], v[32:47]
    ds_read_b128 v[168:171], v8 offset:10240
    v_exp_f32 v18, v18
    v_add_f32 v12, v12, v16
    v_mfma_f32_32x32x16_bf16 v[32:47], v[140:143], a[172:175], v[32:47]
    ds_read_b128 v[172:175], v8 offset:11264
    v_exp_f32 v19, v19
    v_add_f32 v12, v12, v17
    v_mfma_f32_32x32x16_bf16 v[32:47], v[144:147], a[176:179], v[32:47]
    ds_read_b128 v[176:179], v8 offset:12288
    v_exp_f32 v20, v20
    v_add_f32 v12, v12, v18
    v_mfma_f32_32x32x16_bf16 v[32:47], v[148:151], a[180:183], v[32:47]
    ds_read_b128 v[180:183], v8 offset:13312
    v_exp_f32 v21, v21
    v_add_f32 v12, v12, v19
    v_mfma_f32_32x32x16_bf16 v[32:47], v[152:155], a[184:187], v[32:47]
    ds_read_b128 v[184:187], v8 offset:14336
    v_exp_f32 v22, v22
    v_add_f32 v12, v12, v20
    v_mfma_f32_32x32x16_bf16 v[32:47], v[156:159], a[188:191], v[32:47]
    ds_read_b128 v[188:191], v8 offset:15360
    v_exp_f32 v23, v23
    s_waitcnt lgkmcnt(4)
    v_mfma_f32_32x32x16_bf16 a[0:15], v[160:163], v[112:115], a[0:15]
    v_add_f32 v12, v12, v21
    v_exp_f32 v24, v24
    v_add_f32 v12, v12, v22
    v_exp_f32 v25, v25
    v_mfma_f32_32x32x16_bf16 a[16:31], v[164:167], v[112:115], a[16:31]
    v_add_f32 v12, v12, v23
    v_exp_f32 v26, v26
    v_add_f32 v12, v12, v24
    v_mfma_f32_32x32x16_bf16 a[32:47], v[168:171], v[112:115], a[32:47]
    v_exp_f32 v27, v27
    v_add_f32 v12, v12, v25
    v_exp_f32 v28, v28
    v_mfma_f32_32x32x16_bf16 a[48:63], v[172:175], v[112:115], a[48:63]
    v_add_f32 v12, v12, v26
    v_exp_f32 v29, v29
    s_waitcnt lgkmcnt(0)
    v_mfma_f32_32x32x16_bf16 a[0:15], v[176:179], v[116:119], a[0:15]
    v_add_f32 v12, v12, v27
    v_exp_f32 v32, v32
    v_exp_f32 v33, v33
    v_mfma_f32_32x32x16_bf16 a[16:31], v[180:183], v[116:119], a[16:31]
    v_exp_f32 v34, v34
    v_add_f32 v13, v13, v32
    v_exp_f32 v35, v35
    v_mfma_f32_32x32x16_bf16 a[32:47], v[184:187], v[116:119], a[32:47]
    v_exp_f32 v30, v30
    v_add_f32 v12, v12, v28
    v_exp_f32 v31, v31
    v_mfma_f32_32x32x16_bf16 a[48:63], v[188:191], v[116:119], a[48:63]
    v_add_f32 v12, v12, v29
    v_add_f32 v12, v12, v30
    v_add_f32 v13, v13, v33
    v_exp_f32 v36, v36
    v_mfma_f32_32x32x16_bf16 a[64:79], v[160:163], v[120:123], a[64:79]
    ds_read_b128 v[128:131], v6 offset:8192
    v_add_f32 v13, v13, v34
    v_exp_f32 v37, v37
    v_mfma_f32_32x32x16_bf16 a[80:95], v[164:167], v[120:123], a[80:95]
    ds_read_b128 v[132:135], v6 offset:9216
    v_add_f32 v12, v12, v31
    v_cvt_pk_bf16_f32 v112, v16, v17
    v_cvt_pk_bf16_f32 v113, v18, v19
    v_mfma_f32_32x32x16_bf16 a[96:111], v[168:171], v[120:123], a[96:111]
    s_add_u32 s28, s28, 16384
    s_add_u32 s27, s27, 1
    ds_read_b128 v[136:139], v6 offset:10240
    v_add_f32 v13, v13, v35
    v_mfma_f32_32x32x16_bf16 a[112:127], v[172:175], v[120:123], a[112:127]
    s_and_b32 s28, s28, 0xffff
    ds_read_b128 v[140:143], v6 offset:11264
    v_exp_f32 v38, v38
    v_mfma_f32_32x32x16_bf16 a[64:79], v[176:179], v[124:127], a[64:79]
    s_xor_b32 s29, s28, 0x8000
    v_add_u32 v8, s28, v15
    ds_read_b128 v[144:147], v6 offset:12288
    v_add_f32 v13, v13, v36
    v_mfma_f32_32x32x16_bf16 a[80:95], v[180:183], v[124:127], a[80:95]
    ds_read_b128 v[148:151], v6 offset:13312
    v_cvt_pk_bf16_f32 v114, v20, v21
    v_cvt_pk_bf16_f32 v115, v22, v23
    v_cvt_pk_bf16_f32 v116, v24, v25
    v_mfma_f32_32x32x16_bf16 a[96:111], v[184:187], v[124:127], a[96:111]
    ds_read_b128 v[152:155], v6 offset:14336
    v_cvt_pk_bf16_f32 v117, v26, v27
    v_cvt_pk_bf16_f32 v118, v28, v29
    v_cvt_pk_bf16_f32 v119, v30, v31
    v_mfma_f32_32x32x16_bf16 a[112:127], v[188:191], v[124:127], a[112:127]
    ds_read_b128 v[156:159], v6 offset:15360
    v_exp_f32 v39, v39
    v_add_f32 v13, v13, v37
    s_waitcnt lgkmcnt(4)
    s_cmp_lt_i32 s27, s34
    s_cbranch_scc1 L_A_p1
L_A_p1m_enter:
    s_lshl_b32 s19, s27, 6
    v_cvt_f32_u32 v2, s19
    v_sub_f32 v9, v9, v2
    v_mul_f32 v11, 0x7149f2ca, v9
    v_add_f32 v80, 0x70c9f2ca, v11
    v_add_f32 v81, 0xf0c9f2ca, v11
    v_add_f32 v82, 0xf1977617, v11
    v_add_f32 v83, 0xf1fc6f7c, v11
    v_add_f32 v84, 0xf2bd539d, v11
    v_add_f32 v85, 0xf2d691f6, v11
    v_add_f32 v86, 0xf2efd050, v11
    v_add_f32 v87, 0xf3048754, v11
    v_add_f32 v88, 0xf343a333, v11
    v_add_f32 v89, 0xf3504260, v11
    v_add_f32 v90, 0xf35ce18d, v11
    v_add_f32 v91, 0xf36980b9, v11
    v_add_f32 v92, 0xf3944e4c, v11
    v_add_f32 v93, 0xf39a9de3, v11
    v_add_f32 v94, 0xf3a0ed79, v11
    v_add_f32 v95, 0xf3a73d0f, v11
    v_min_f32 v80, v48, v80
    v_min_f32 v81, v48, v81
    v_min_f32 v82, v48, v82
    v_min_f32 v83, v48, v83
    v_min_f32 v84, v48, v84
    v_min_f32 v85, v48, v85
    v_min_f32 v86, v48, v86
    v_min_f32 v87, v48, v87
    v_min_f32 v88, v48, v88
    v_min_f32 v89, v48, v89
    v_min_f32 v90, v48, v90
    v_min_f32 v91, v48, v91
    v_min_f32 v92, v48, v92
    v_min_f32 v93, v48, v93
    v_min_f32 v94, v48, v94
    v_min_f32 v95, v48, v95
    v_add_f32 v9, 0xc2000000, v9
    s_lshl_b32 s34, s17, 1
    s_add_u32 s34, s34, 1
L_A_p1m:
    v_mfma_f32_32x32x16_bf16 v[16:31], v[128:131], a[128:131], v[80:95]
    v_exp_f32 v40, v40
    v_add_f32 v13, v13, v38
    v_exp_f32 v41, v41
    v_mfma_f32_32x32x16_bf16 v[16:31], v[132:135], a[132:135], v[16:31]
    v_mov_b32 v6, v7
    v_add_u32 v7, s29, v1
    v_add_f32 v13, v13, v39
    v_exp_f32 v42, v42
    v_mfma_f32_32x32x16_bf16 v[16:31], v[136:139], a[136:139], v[16:31]
    v_add_f32 v13, v13, v40
    v_exp_f32 v43, v43
    v_add_f32 v13, v13, v41
    v_mfma_f32_32x32x16_bf16 v[16:31], v[140:143], a[140:143], v[16:31]
    v_exp_f32 v44, v44
    v_add_f32 v13, v13, v42
    s_waitcnt lgkmcnt(0)
    v_mfma_f32_32x32x16_bf16 v[16:31], v[144:147], a[144:147], v[16:31]
    v_exp_f32 v45, v45
    v_add_f32 v13, v13, v43
    v_exp_f32 v46, v46
    v_mfma_f32_32x32x16_bf16 v[16:31], v[148:151], a[148:151], v[16:31]
    v_add_f32 v13, v13, v44
    v_exp_f32 v47, v47
    v_add_f32 v13, v13, v45
    v_add_f32 v13, v13, v46
    v_add_f32 v13, v13, v47
    v_mfma_f32_32x32x16_bf16 v[16:31], v[152:155], a[152:155], v[16:31]
    v_cvt_pk_bf16_f32 v120, v32, v33
    v_cvt_pk_bf16_f32 v121, v34, v35
    v_cvt_pk_bf16_f32 v122, v36, v37
    v_cvt_pk_bf16_f32 v123, v38, v39
    v_cvt_pk_bf16_f32 v124, v40, v41
    v_mfma_f32_32x32x16_bf16 v[16:31], v[156:159], a[156:159], v[16:31]
    s_waitcnt vmcnt(8)
    s_barrier
    v_cvt_pk_bf16_f32 v125, v42, v43
    v_cvt_pk_bf16_f32 v126, v44, v45
    v_cvt_pk_bf16_f32 v127, v46, v47
    v_mfma_f32_32x32x16_bf16 v[32:47], v[128:131], a[160:163], v[64:79]
    s_or_b32 m0, s28, s24
    v_max_f32 v2, v12, v13
    v_cmp_lt_f32 vcc, s31, v2
    s_cbranch_vccnz L_A_rare_p1m
L_A_ret_p1m:
    ds_read_b128 v[160:163], v8 offset:0
    v_mfma_f32_32x32x16_bf16 v[32:47], v[132:135], a[164:167], v[32:47]
    ds_read_b128 v[164:167], v8 offset:1024
    v_exp_f32 v16, v16
    v_exp_f32 v17, v17
    v_exp_f32 v18, v18
    v_mfma_f32_32x32x16_bf16 v[32:47], v[136:139], a[168:171], v[32:47]
    buffer_load_dwordx4 v1, s[4:7], s22 offen lds
    ds_read_b128 v[168:171], v8 offset:2048
    v_add_f32 v12, v12, v16
    v_exp_f32 v19, v19
    v_add_f32 v12, v12, v17
    v_mfma_f32_32x32x16_bf16 v[32:47], v[140:143], a[172:175], v[32:47]
    ds_read_b128 v[172:175], v8 offset:3072
    v_exp_f32 v20, v20
    v_add_f32 v12, v12, v18
    v_exp_f32 v21, v21
    v_add_f32 v12, v12, v19
    v_mfma_f32_32x32x16_bf16 v[32:47], v[144:147], a[176:179], v[32:47]
    buffer_load_dwordx4 v1, s[4:7], s22 offen offset:1024 lds
    ds_read_b128 v[176:179], v8 offset:4096
    v_exp_f32 v22, v22
    v_add_f32 v12, v12, v20
    v_mul_f32 v11, 0x7149f2ca, v9
    v_mfma_f32_32x32x16_bf16 v[32:47], v[148:151], a[180:183], v[32:47]
    ds_read_b128 v[180:183], v8 offset:5120
    v_exp_f32 v23, v23
    v_add_f32 v12, v12, v21
    v_exp_f32 v24, v24
    v_add_f32 v12, v12, v22
    v_mfma_f32_32x32x16_bf16 v[32:47], v[152:155], a[184:187], v[32:47]
    buffer_load_dwordx4 v1, s[4:7], s22 offen offset:2048 lds
    ds_read_b128 v[184:187], v8 offset:6144
    v_exp_f32 v25, v25
    v_add_f32 v12, v12, v23
    v_add_f32 v80, 0x70c9f2ca, v11
    v_mfma_f32_32x32x16_bf16 v[32:47], v[156:159], a[188:191], v[32:47]
    ds_read_b128 v[188:191], v8 offset:7168
    v_exp_f32 v26, v26
    v_add_f32 v12, v12, v24
    v_exp_f32 v27, v27
    s_waitcnt lgkmcnt(4)
    v_mfma_f32_32x32x16_bf16 a[0:15], v[160:163], v[112:115], a[0:15]
    buffer_load_dwordx4 v1, s[4:7], s22 offen offset:3072 lds
    v_add_f32 v12, v12, v25
    v_exp_f32 v28, v28
    v_add_f32 v12, v12, v26
    v_exp_f32 v29, v29
    v_mfma_f32_32x32x16_bf16 a[16:31], v[164:167], v[112:115], a[16:31]
    s_add_u32 s22, s22, 16384
    s_add_u32 m0, s29, s25
    v_add_f32 v12, v12, v27
    v_exp_f32 v30, v30
    v_add_f32 v12, v12, v28
    v_exp_f32 v31, v31
    v_mfma_f32_32x32x16_bf16 a[32:47], v[168:171], v[112:115], a[32:47]
    buffer_load_dwordx4 v1, s[4:7], s23 offen lds
    v_add_f32 v12, v12, v29
    v_add_f32 v12, v12, v30
    v_add_f32 v12, v12, v31
    v_exp_f32 v32, v32
    v_mfma_f32_32x32x16_bf16 a[48:63], v[172:175], v[112:115], a[48:63]
    v_cvt_pk_bf16_f32 v112, v16, v17
    v_cvt_pk_bf16_f32 v113, v18, v19
    v_cvt_pk_bf16_f32 v114, v20, v21
    v_exp_f32 v33, v33
    v_add_f32 v81, 0xf0c9f2ca, v11
    s_waitcnt lgkmcnt(0)
    v_mfma_f32_32x32x16_bf16 a[0:15], v[176:179], v[116:119], a[0:15]
    buffer_load_dwordx4 v1, s[4:7], s23 offen offset:1024 lds
    v_exp_f32 v34, v34
    v_add_f32 v13, v13, v32
    v_exp_f32 v35, v35
    v_mfma_f32_32x32x16_bf16 a[16:31], v[180:183], v[116:119], a[16:31]
    v_add_f32 v13, v13, v33
    v_exp_f32 v36, v36
    v_add_f32 v13, v13, v34
    v_exp_f32 v37, v37
    v_add_f32 v13, v13, v35
    v_mfma_f32_32x32x16_bf16 a[32:47], v[184:187], v[116:119], a[32:47]
    buffer_load_dwordx4 v1, s[4:7], s23 offen offset:2048 lds
    v_cvt_pk_bf16_f32 v115, v22, v23
    v_exp_f32 v38, v38
    v_add_f32 v82, 0xf1977617, v11
    v_add_f32 v83, 0xf1fc6f7c, v11
    v_mfma_f32_32x32x16_bf16 a[48:63], v[188:191], v[116:119], a[48:63]
    v_cvt_pk_bf16_f32 v116, v24, v25
    v_cvt_pk_bf16_f32 v117, v26, v27
    v_add_f32 v13, v13, v36
    v_add_f32 v84, 0xf2bd539d, v11
    v_add_f32 v85, 0xf2d691f6, v11
    v_add_f32 v86, 0xf2efd050, v11
    v_add_f32 v87, 0xf3048754, v11
    v_mfma_f32_32x32x16_bf16 a[64:79], v[160:163], v[120:123], a[64:79]
    buffer_load_dwordx4 v1, s[4:7], s23 offen offset:3072 lds
    ds_read_b128 v[128:131], v6 offset:0
    v_cvt_pk_bf16_f32 v118, v28, v29
    v_exp_f32 v39, v39
    v_mfma_f32_32x32x16_bf16 a[80:95], v[164:167], v[120:123], a[80:95]
    s_add_u32 s23, s23, 16384
    ds_read_b128 v[132:135], v6 offset:1024
    v_add_f32 v88, 0xf343a333, v11
    v_add_f32 v89, 0xf3504260, v11
    v_add_f32 v90, 0xf35ce18d, v11
    v_mfma_f32_32x32x16_bf16 a[96:111], v[168:171], v[120:123], a[96:111]
    ds_read_b128 v[136:139], v6 offset:2048
    v_add_f32 v91, 0xf36980b9, v11
    v_add_f32 v92, 0xf3944e4c, v11
    v_add_f32 v93, 0xf39a9de3, v11
    v_add_f32 v94, 0xf3a0ed79, v11
    v_mfma_f32_32x32x16_bf16 a[112:127], v[172:175], v[120:123], a[112:127]
    ds_read_b128 v[140:143], v6 offset:3072
    v_add_f32 v95, 0xf3a73d0f, v11
    v_min_f32 v80, v48, v80
    v_min_f32 v81, v48, v81
    v_min_f32 v82, v48, v82
    v_mfma_f32_32x32x16_bf16 a[64:79], v[176:179], v[124:127], a[64:79]
    ds_read_b128 v[144:147], v6 offset:4096
    v_cvt_pk_bf16_f32 v119, v30, v31
    v_add_f32 v13, v13, v37
    v_min_f32 v83, v48, v83
    v_min_f32 v84, v48, v84
    v_min_f32 v85, v48, v85
    v_mfma_f32_32x32x16_bf16 a[80:95], v[180:183], v[124:127], a[80:95]
    ds_read_b128 v[148:151], v6 offset:5120
    v_min_f32 v86, v48, v86
    v_min_f32 v87, v48, v87
    v_min_f32 v88, v48, v88
    v_min_f32 v89, v48, v89
    v_mfma_f32_32x32x16_bf16 a[96:111], v[184:187], v[124:127], a[96:111]
    ds_read_b128 v[152:155], v6 offset:6144
    v_min_f32 v90, v48, v90
    v_min_f32 v91, v48, v91
    v_min_f32 v92, v48, v92
    v_min_f32 v93, v48, v93
    v_mfma_f32_32x32x16_bf16 a[112:127], v[188:191], v[124:127], a[112:127]
    ds_read_b128 v[156:159], v6 offset:7168
    v_min_f32 v94, v48, v94
    v_min_f32 v95, v48, v95
    v_add_f32 v9, 0xc2000000, v9
    s_waitcnt lgkmcnt(4)
    v_mfma_f32_32x32x16_bf16 v[16:31], v[128:131], a[128:131], v[80:95]
    v_exp_f32 v40, v40
    v_add_f32 v13, v13, v38
    v_exp_f32 v41, v41
    v_mfma_f32_32x32x16_bf16 v[16:31], v[132:135], a[132:135], v[16:31]
    v_add_f32 v13, v13, v39
    v_exp_f32 v42, v42
    v_add_f32 v13, v13, v40
    v_mfma_f32_32x32x16_bf16 v[16:31], v[136:139], a[136:139], v[16:31]
    v_exp_f32 v43, v43
    v_add_f32 v13, v13, v41
    v_exp_f32 v44, v44
    v_mfma_f32_32x32x16_bf16 v[16:31], v[140:143], a[140:143], v[16:31]
    v_add_f32 v13, v13, v42
    v_exp_f32 v45, v45
    s_waitcnt lgkmcnt(0)
    v_mfma_f32_32x32x16_bf16 v[16:31], v[144:147], a[144:147], v[16:31]
    v_add_f32 v13, v13, v43
    v_exp_f32 v46, v46
    v_add_f32 v13, v13, v44
    v_mfma_f32_32x32x16_bf16 v[16:31], v[148:151], a[148:151], v[16:31]
    v_exp_f32 v47, v47
    v_add_f32 v13, v13, v45
    v_add_f32 v13, v13, v46
    v_mfma_f32_32x32x16_bf16 v[16:31], v[152:155], a[152:155], v[16:31]
    v_add_f32 v13, v13, v47
    v_cvt_pk_bf16_f32 v120, v32, v33
    v_cvt_pk_bf16_f32 v121, v34, v35
    v_cvt_pk_bf16_f32 v122, v36, v37
    v_cvt_pk_bf16_f32 v123, v38, v39
    v_mfma_f32_32x32x16_bf16 v[16:31], v[156:159], a[156:159], v[16:31]
    v_cvt_pk_bf16_f32 v124, v40, v41
    v_cvt_pk_bf16_f32 v125, v42, v43
    v_cvt_pk_bf16_f32 v126, v44, v45
    v_cvt_pk_bf16_f32 v127, v46, v47
    v_mfma_f32_32x32x16_bf16 v[32:47], v[128:131], a[160:163], v[64:79]
    ds_read_b128 v[160:163], v8 offset:8192
    v_mfma_f32_32x32x16_bf16 v[32:47], v[132:135], a[164:167], v[32:47]
    ds_read_b128 v[164:167], v8 offset:9216
    v_exp_f32 v16, v16
    v_exp_f32 v17, v17
    v_mfma_f32_32x32x16_bf16 v[32:47], v[136:139], a[168:171], v[32:47]
    ds_read_b128 v[168:171], v8 offset:10240
    v_exp_f32 v18, v18
    v_add_f32 v12, v12, v16
    v_exp_f32 v19, v19
    v_mfma_f32_32x32x16_bf16 v[32:47], v[140:143], a[172:175], v[32:47]
    ds_read_b128 v[172:175], v8 offset:11264
    v_add_f32 v12, v12, v17
    v_exp_f32 v20, v20
    v_add_f32 v12, v12, v18
    v_mul_f32 v11, 0x7149f2ca, v9
    v_mfma_f32_32x32x16_bf16 v[32:47], v[144:147], a[176:179], v[32:47]
    ds_read_b128 v[176:179], v8 offset:12288
    v_exp_f32 v21, v21
    v_add_f32 v12, v12, v19
    v_exp_f32 v22, v22
    v_mfma_f32_32x32x16_bf16 v[32:47], v[148:151], a[180:183], v[32:47]
    ds_read_b128 v[180:183], v8 offset:13312
    v_add_f32 v12, v12, v20
    v_exp_f32 v23, v23
    v_add_f32 v12, v12, v21
    v_add_f32 v80, 0x70c9f2ca, v11
    v_mfma_f32_32x32x16_bf16 v[32:47], v[152:155], a[184:187], v[32:47]
    ds_read_b128 v[184:187], v8 offset:14336
    v_exp_f32 v24, v24
    v_add_f32 v12, v12, v22
    v_exp_f32 v25, v25
    v_mfma_f32_32x32x16_bf16 v[32:47], v[156:159], a[188:191], v[32:47]
    ds_read_b128 v[188:191], v8 offset:15360
    v_add_f32 v12, v12, v23
    v_exp_f32 v26, v26
    s_waitcnt lgkmcnt(4)
    v_mfma_f32_32x32x16_bf16 a[0:15], v[160:163], v[112:115], a[0:15]
    v_add_f32 v12, v12, v24
    v_exp_f32 v27, v27
    v_add_f32 v12, v12, v25
    v_exp_f32 v28, v28
    v_add_f32 v12, v12, v26
    v_mfma_f32_32x32x16_bf16 a[16:31], v[164:167], v[112:115], a[16:31]
    v_exp_f32 v29, v29
    v_add_f32 v12, v12, v27
    v_exp_f32 v30, v30
    v_add_f32 v81, 0xf0c9f2ca, v11
    v_mfma_f32_32x32x16_bf16 a[32:47], v[168:171], v[112:115], a[32:47]
    v_add_f32 v12, v12, v28
    v_exp_f32 v31, v31
    v_add_f32 v12, v12, v29
    v_add_f32 v12, v12, v30
    v_exp_f32 v32, v32
    v_mfma_f32_32x32x16_bf16 a[48:63], v[172:175], v[112:115], a[48:63]
    v_add_f32 v12, v12, v31
    v_cvt_pk_bf16_f32 v112, v16, v17
    v_cvt_pk_bf16_f32 v113, v18, v19
    v_exp_f32 v33, v33
    s_waitcnt lgkmcnt(0)
    v_mfma_f32_32x32x16_bf16 a[0:15], v[176:179], v[116:119], a[0:15]
    v_exp_f32 v34, v34
    v_add_f32 v13, v13, v32
    v_exp_f32 v35, v35
    v_add_f32 v13, v13, v33
    v_mfma_f32_32x32x16_bf16 a[16:31], v[180:183], v[116:119], a[16:31]
    v_cvt_pk_bf16_f32 v114, v20, v21
    v_exp_f32 v36, v36
    v_add_f32 v13, v13, v34
    v_exp_f32 v37, v37
    v_mfma_f32_32x32x16_bf16 a[32:47], v[184:187], v[116:119], a[32:47]
    v_add_f32 v13, v13, v35
    v_exp_f32 v38, v38
    v_add_f32 v13, v13, v36
    v_exp_f32 v39, v39
    v_add_f32 v82, 0xf1977617, v11
    v_mfma_f32_32x32x16_bf16 a[48:63], v[188:191], v[116:119], a[48:63]
    v_cvt_pk_bf16_f32 v115, v22, v23
    v_cvt_pk_bf16_f32 v116, v24, v25
    v_add_f32 v83, 0xf1fc6f7c, v11
    v_add_f32 v84, 0xf2bd539d, v11
    v_add_f32 v85, 0xf2d691f6, v11
    v_add_f32 v86, 0xf2efd050, v11
    v_mfma_f32_32x32x16_bf16 a[64:79], v[160:163], v[120:123], a[64:79]
    ds_read_b128 v[128:131], v6 offset:8192
    v_add_f32 v87, 0xf3048754, v11
    v_add_f32 v88, 0xf343a333, v11
    v_add_f32 v89, 0xf3504260, v11
    v_add_f32 v90, 0xf35ce18d, v11
    v_add_f32 v91, 0xf36980b9, v11
    v_mfma_f32_32x32x16_bf16 a[80:95], v[164:167], v[120:123], a[80:95]
    ds_read_b128 v[132:135], v6 offset:9216
    v_cvt_pk_bf16_f32 v117, v26, v27
    v_add_f32 v13, v13, v37
    v_add_f32 v92, 0xf3944e4c, v11
    v_add_f32 v93, 0xf39a9de3, v11
    v_mfma_f32_32x32x16_bf16 a[96:111], v[168:171], v[120:123], a[96:111]
    s_add_u32 s28, s28, 16384
    s_add_u32 s27, s27, 1
    ds_read_b128 v[136:139], v6 offset:10240
    v_add_f32 v94, 0xf3a0ed79, v11
    v_add_f32 v95, 0xf3a73d0f, v11
    v_min_f32 v80, v48, v80
    v_mfma_f32_32x32x16_bf16 a[112:127], v[172:175], v[120:123], a[112:127]
    s_and_b32 s28, s28, 0xffff
    ds_read_b128 v[140:143], v6 offset:11264
    v_cvt_pk_bf16_f32 v118, v28, v29
    v_cvt_pk_bf16_f32 v119, v30, v31
    v_min_f32 v81, v48, v81
    v_mfma_f32_32x32x16_bf16 a[64:79], v[176:179], v[124:127], a[64:79]
    s_xor_b32 s29, s28, 0x8000
    v_add_u32 v8, s28, v15
    ds_read_b128 v[144:147], v6 offset:12288
    v_min_f32 v82, v48, v82
    v_min_f32 v83, v48, v83
    v_min_f32 v84, v48, v84
    v_mfma_f32_32x32x16_bf16 a[80:95], v[180:183], v[124:127], a[80:95]
    ds_read_b128 v[148:151], v6 offset:13312
    v_min_f32 v85, v48, v85
    v_min_f32 v86, v48, v86
    v_min_f32 v87, v48, v87
    v_min_f32 v88, v48, v88
    v_mfma_f32_32x32x16_bf16 a[96:111], v[184:187], v[124:127], a[96:111]
    ds_read_b128 v[152:155], v6 offset:14336
    v_min_f32 v89, v48, v89
    v_min_f32 v90, v48, v90
    v_min_f32 v91, v48, v91
    v_min_f32 v92, v48, v92
    v_mfma_f32_32x32x16_bf16 a[112:127], v[188:191], v[124:127], a[112:127]
    ds_read_b128 v[156:159], v6 offset:15360
    v_min_f32 v93, v48, v93
    v_min_f32 v94, v48, v94
    v_min_f32 v95, v48, v95
    v_add_f32 v9, 0xc2000000, v9
    s_waitcnt lgkmcnt(4)
    s_cmp_lt_u32 s27, s34
    s_cbranch_scc1 L_A_p1m
    s_lshl_b32 s19, s27, 6
    s_add_u32 s19, s19, 32
    v_cvt_f32_u32 v2, s19
    v_sub_f32 v10, v10, v2
    v_mfma_f32_32x32x16_bf16 v[16:31], v[128:131], a[128:131], v[80:95]
    v_exp_f32 v40, v40
    v_add_f32 v13, v13, v38
    v_exp_f32 v41, v41
    v_mfma_f32_32x32x16_bf16 v[16:31], v[132:135], a[132:135], v[16:31]
    v_mov_b32 v6, v7
    v_add_u32 v7, s29, v1
    v_add_f32 v13, v13, v39
    v_exp_f32 v42, v42
    v_add_f32 v13, v13, v40
    v_mfma_f32_32x32x16_bf16 v[16:31], v[136:139], a[136:139], v[16:31]
    v_exp_f32 v43, v43
    v_add_f32 v13, v13, v41
    v_exp_f32 v44, v44
    v_mfma_f32_32x32x16_bf16 v[16:31], v[140:143], a[140:143], v[16:31]
    v_add_f32 v13, v13, v42
    v_exp_f32 v45, v45
    v_add_f32 v13, v13, v43
    s_waitcnt lgkmcnt(0)
    v_mfma_f32_32x32x16_bf16 v[16:31], v[144:147], a[144:147], v[16:31]
    v_exp_f32 v46, v46
    v_add_f32 v13, v13, v44
    v_exp_f32 v47, v47
    v_mfma_f32_32x32x16_bf16 v[16:31], v[148:151], a[148:151], v[16:31]
    v_add_f32 v13, v13, v45
    v_add_f32 v13, v13, v46
    v_add_f32 v13, v13, v47
    v_cvt_pk_bf16_f32 v120, v32, v33
    v_mfma_f32_32x32x16_bf16 v[16:31], v[152:155], a[152:155], v[16:31]
    v_cvt_pk_bf16_f32 v121, v34, v35
    v_cvt_pk_bf16_f32 v122, v36, v37
    v_cvt_pk_bf16_f32 v123, v38, v39
    v_cvt_pk_bf16_f32 v124, v40, v41
    v_cvt_pk_bf16_f32 v125, v42, v43
    v_mfma_f32_32x32x16_bf16 v[16:31], v[156:159], a[156:159], v[16:31]
    s_waitcnt vmcnt(8)
    s_barrier
    v_cvt_pk_bf16_f32 v126, v44, v45
    v_cvt_pk_bf16_f32 v127, v46, v47
    v_mfma_f32_32x32x16_bf16 v[32:47], v[128:131], a[160:163], v[64:79]
    s_or_b32 m0, s28, s24
    v_max_f32 v2, v12, v13
    v_cmp_lt_f32 vcc, s31, v2
    s_cbranch_vccnz L_A_rare_p1lm
L_A_ret_p1lm:
    ds_read_b128 v[160:163], v8 offset:0
    v_mfma_f32_32x32x16_bf16 v[32:47], v[132:135], a[164:167], v[32:47]
    ds_read_b128 v[164:167], v8 offset:1024
    v_exp_f32 v16, v16
    v_exp_f32 v17, v17
    v_mfma_f32_32x32x16_bf16 v[32:47], v[136:139], a[168:171], v[32:47]
    buffer_load_dwordx4 v1, s[4:7], s22 offen lds
    ds_read_b128 v[168:171], v8 offset:2048
    v_exp_f32 v18, v18
    v_mfma_f32_32x32x16_bf16 v[32:47], v[140:143], a[172:175], v[32:47]
    ds_read_b128 v[172:175], v8 offset:3072
    v_add_f32 v12, v12, v16
    v_exp_f32 v19, v19
    v_add_f32 v12, v12, v17
    v_mfma_f32_32x32x16_bf16 v[32:47], v[144:147], a[176:179], v[32:47]
    buffer_load_dwordx4 v1, s[4:7], s22 offen offset:1024 lds
    ds_read_b128 v[176:179], v8 offset:4096
    v_exp_f32 v20, v20
    v_mfma_f32_32x32x16_bf16 v[32:47], v[148:151], a[180:183], v[32:47]
    ds_read_b128 v[180:183], v8 offset:5120
    v_add_f32 v12, v12, v18
    v_exp_f32 v21, v21
    v_add_f32 v12, v12, v19
    v_mfma_f32_32x32x16_bf16 v[32:47], v[152:155], a[184:187], v[32:47]
    buffer_load_dwordx4 v1, s[4:7], s22 offen offset:2048 lds
    ds_read_b128 v[184:187], v8 offset:6144
    v_exp_f32 v22, v22
    v_mfma_f32_32x32x16_bf16 v[32:47], v[156:159], a[188:191], v[32:47]
    ds_read_b128 v[188:191], v8 offset:7168
    v_add_f32 v12, v12, v20
    v_exp_f32 v23, v23
    s_waitcnt lgkmcnt(4)
    v_mfma_f32_32x32x16_bf16 a[0:15], v[160:163], v[112:115], a[0:15]
    buffer_load_dwordx4 v1, s[4:7], s22 offen offset:3072 lds
    v_add_f32 v12, v12, v21
    v_exp_f32 v24, v24
    v_mfma_f32_32x32x16_bf16 a[16:31], v[164:167], v[112:115], a[16:31]
    s_add_u32 s22, s22, 16384
    s_add_u32 m0, s29, s25
    v_add_f32 v12, v12, v22
    v_exp_f32 v25, v25
    v_mfma_f32_32x32x16_bf16 a[32:47], v[168:171], v[112:115], a[32:47]
    buffer_load_dwordx4 v1, s[4:7], s23 offen lds
    v_add_f32 v12, v12, v23
    v_exp_f32 v26, v26
    v_add_f32 v12, v12, v24
    v_mfma_f32_32x32x16_bf16 a[48:63], v[172:175], v[112:115], a[48:63]
    v_exp_f32 v27, v27
    v_add_f32 v12, v12, v25
    v_exp_f32 v28, v28
    s_waitcnt lgkmcnt(0)
    v_mfma_f32_32x32x16_bf16 a[0:15], v[176:179], v[116:119], a[0:15]
    buffer_load_dwordx4 v1, s[4:7], s23 offen offset:1024 lds
    v_add_f32 v12, v12, v26
    v_exp_f32 v29, v29
    v_add_f32 v12, v12, v27
    v_mfma_f32_32x32x16_bf16 a[16:31], v[180:183], v[116:119], a[16:31]
    v_exp_f32 v30, v30
    v_add_f32 v12, v12, v28
    v_exp_f32 v31, v31
    v_add_f32 v12, v12, v29
    v_mfma_f32_32x32x16_bf16 a[32:47], v[184:187], v[116:119], a[32:47]
    buffer_load_dwordx4 v1, s[4:7], s23 offen offset:2048 lds
    v_add_f32 v12, v12, v30
    v_add_f32 v12, v12, v31
    v_cvt_pk_bf16_f32 v112, v16, v17
    v_cvt_pk_bf16_f32 v113, v18, v19
    v_mfma_f32_32x32x16_bf16 a[48:63], v[188:191], v[116:119], a[48:63]
    v_cvt_pk_bf16_f32 v114, v20, v21
    v_cvt_pk_bf16_f32 v115, v22, v23
    v_cvt_pk_bf16_f32 v116, v24, v25
    v_cvt_pk_bf16_f32 v117, v26, v27
    v_cvt_pk_bf16_f32 v118, v28, v29
    v_cvt_pk_bf16_f32 v119, v30, v31
    v_mfma_f32_32x32x16_bf16 a[64:79], v[160:163], v[120:123], a[64:79]
    buffer_load_dwordx4 v1, s[4:7], s23 offen offset:3072 lds
    ds_read_b128 v[128:131], v6 offset:0
    v_exp_f32 v32, v32
    v_mfma_f32_32x32x16_bf16 a[80:95], v[164:167], v[120:123], a[80:95]
    s_add_u32 s23, s23, 16384
    ds_read_b128 v[132:135], v6 offset:1024
    v_exp_f32 v33, v33
    v_mfma_f32_32x32x16_bf16 a[96:111], v[168:171], v[120:123], a[96:111]
    ds_read_b128 v[136:139], v6 offset:2048
    v_exp_f32 v34, v34
    v_add_f32 v13, v13, v32
    v_mfma_f32_32x32x16_bf16 a[112:127], v[172:175], v[120:123], a[112:127]
    ds_read_b128 v[140:143], v6 offset:3072
    v_exp_f32 v35, v35
    v_add_f32 v13, v13, v33
    v_mfma_f32_32x32x16_bf16 a[64:79], v[176:179], v[124:127], a[64:79]
    ds_read_b128 v[144:147], v6 offset:4096
    v_exp_f32 v36, v36
    v_add_f32 v13, v13, v34
    v_mfma_f32_32x32x16_bf16 a[80:95], v[180:183], v[124:127], a[80:95]
    ds_read_b128 v[148:151], v6 offset:5120
    v_exp_f32 v37, v37
    v_add_f32 v13, v13, v35
    v_mfma_f32_32x32x16_bf16 a[96:111], v[184:187], v[124:127], a[96:111]
    ds_read_b128 v[152:155], v6 offset:6144
    v_exp_f32 v38, v38
    v_add_f32 v13, v13, v36
    v_mfma_f32_32x32x16_bf16 a[112:127], v[188:191], v[124:127], a[112:127]
    ds_read_b128 v[156:159], v6 offset:7168
    v_exp_f32 v39, v39
    v_add_f32 v13, v13, v37
    s_waitcnt lgkmcnt(4)
    v_mul_f32 v11, 0x7149f2ca, v10
    v_add_f32 v80, 0x70c9f2ca, v11
    v_add_f32 v81, 0xf0c9f2ca, v11
    v_add_f32 v82, 0xf1977617, v11
    v_add_f32 v83, 0xf1fc6f7c, v11
    v_add_f32 v84, 0xf2bd539d, v11
    v_add_f32 v85, 0xf2d691f6, v11
    v_add_f32 v86, 0xf2efd050, v11
    v_add_f32 v87, 0xf3048754, v11
    v_add_f32 v88, 0xf343a333, v11
    v_add_f32 v89, 0xf3504260, v11
    v_add_f32 v90, 0xf35ce18d, v11
    v_add_f32 v91, 0xf36980b9, v11
    v_add_f32 v92, 0xf3944e4c, v11
    v_add_f32 v93, 0xf39a9de3, v11
    v_add_f32 v94, 0xf3a0ed79, v11
    v_add_f32 v95, 0xf3a73d0f, v11
    v_min_f32 v80, v64, v80
    v_min_f32 v81, v64, v81
    v_min_f32 v82, v64, v82
    v_min_f32 v83, v64, v83
    v_min_f32 v84, v64, v84
    v_min_f32 v85, v64, v85
    v_min_f32 v86, v64, v86
    v_min_f32 v87, v64, v87
    v_min_f32 v88, v64, v88
    v_min_f32 v89, v64, v89
    v_min_f32 v90, v64, v90
    v_min_f32 v91, v64, v91
    v_min_f32 v92, v64, v92
    v_min_f32 v93, v64, v93
    v_min_f32 v94, v64, v94
    v_min_f32 v95, v64, v95
    v_add_f32 v10, 0xc2000000, v10
    v_mul_f32 v11, 0x7149f2ca, v10
    v_add_f32 v96, 0x70c9f2ca, v11
    v_add_f32 v97, 0xf0c9f2ca, v11
    v_add_f32 v98, 0xf1977617, v11
    v_add_f32 v99, 0xf1fc6f7c, v11
    v_add_f32 v100, 0xf2bd539d, v11
    v_add_f32 v101, 0xf2d691f6, v11
    v_add_f32 v102, 0xf2efd050, v11
    v_add_f32 v103, 0xf3048754, v11
    v_add_f32 v104, 0xf343a333, v11
    v_add_f32 v105, 0xf3504260, v11
    v_add_f32 v106, 0xf35ce18d, v11
    v_add_f32 v107, 0xf36980b9, v11
    v_add_f32 v108, 0xf3944e4c, v11
    v_add_f32 v109, 0xf39a9de3, v11
    v_add_f32 v110, 0xf3a0ed79, v11
    v_add_f32 v111, 0xf3a73d0f, v11
    v_min_f32 v96, v64, v96
    v_min_f32 v97, v64, v97
    v_min_f32 v98, v64, v98
    v_min_f32 v99, v64, v99
    v_min_f32 v100, v64, v100
    v_min_f32 v101, v64, v101
    v_min_f32 v102, v64, v102
    v_min_f32 v103, v64, v103
    v_min_f32 v104, v64, v104
    v_min_f32 v105, v64, v105
    v_min_f32 v106, v64, v106
    v_min_f32 v107, v64, v107
    v_min_f32 v108, v64, v108
    v_min_f32 v109, v64, v109
    v_min_f32 v110, v64, v110
    v_min_f32 v111, v64, v111
    v_add_f32 v10, 0xc2000000, v10
    v_mov_b32 v14, v12
    v_mov_b32 v12, 0
    v_mfma_f32_32x32x16_bf16 v[16:31], v[128:131], a[160:163], v[80:95]
    ds_read_b128 v[128:131], v6 offset:8192
    v_exp_f32 v40, v40
    v_add_f32 v13, v13, v38
    v_exp_f32 v41, v41
    v_mfma_f32_32x32x16_bf16 v[16:31], v[132:135], a[164:167], v[16:31]
    ds_read_b128 v[132:135], v6 offset:9216
    v_add_f32 v13, v13, v39
    v_exp_f32 v42, v42
    v_add_f32 v13, v13, v40
    v_mfma_f32_32x32x16_bf16 v[16:31], v[136:139], a[168:171], v[16:31]
    ds_read_b128 v[136:139], v6 offset:10240
    v_exp_f32 v43, v43
    v_add_f32 v13, v13, v41
    v_exp_f32 v44, v44
    v_mfma_f32_32x32x16_bf16 v[16:31], v[140:143], a[172:175], v[16:31]
    ds_read_b128 v[140:143], v6 offset:11264
    v_add_f32 v13, v13, v42
    v_exp_f32 v45, v45
    v_add_f32 v13, v13, v43
    s_waitcnt lgkmcnt(4)
    v_mfma_f32_32x32x16_bf16 v[16:31], v[144:147], a[176:179], v[16:31]
    ds_read_b128 v[144:147], v6 offset:12288
    v_exp_f32 v46, v46
    v_add_f32 v13, v13, v44
    v_exp_f32 v47, v47
    v_mfma_f32_32x32x16_bf16 v[16:31], v[148:151], a[180:183], v[16:31]
    ds_read_b128 v[148:151], v6 offset:13312
    v_add_f32 v13, v13, v45
    v_add_f32 v13, v13, v46
    v_add_f32 v13, v13, v47
    v_cvt_pk_bf16_f32 v120, v32, v33
    v_mfma_f32_32x32x16_bf16 v[16:31], v[152:155], a[184:187], v[16:31]
    ds_read_b128 v[152:155], v6 offset:14336
    v_cvt_pk_bf16_f32 v121, v34, v35
    v_cvt_pk_bf16_f32 v122, v36, v37
    v_cvt_pk_bf16_f32 v123, v38, v39
    v_cvt_pk_bf16_f32 v124, v40, v41
    v_mfma_f32_32x32x16_bf16 v[16:31], v[156:159], a[188:191], v[16:31]
    ds_read_b128 v[156:159], v6 offset:15360
    v_cvt_pk_bf16_f32 v125, v42, v43
    v_cvt_pk_bf16_f32 v126, v44, v45
    v_cvt_pk_bf16_f32 v127, v46, v47
    s_waitcnt lgkmcnt(4)
    v_mfma_f32_32x32x16_bf16 v[32:47], v[128:131], a[160:163], v[96:111]
    ds_read_b128 v[160:163], v8 offset:8192
    v_mfma_f32_32x32x16_bf16 v[32:47], v[132:135], a[164:167], v[32:47]
    ds_read_b128 v[164:167], v8 offset:9216
    v_exp_f32 v16, v16
    v_exp_f32 v17, v17
    v_mfma_f32_32x32x16_bf16 v[32:47], v[136:139], a[168:171], v[32:47]
    ds_read_b128 v[168:171], v8 offset:10240
    v_exp_f32 v18, v18
    v_add_f32 v12, v12, v16
    v_mfma_f32_32x32x16_bf16 v[32:47], v[140:143], a[172:175], v[32:47]
    ds_read_b128 v[172:175], v8 offset:11264
    v_exp_f32 v19, v19
    s_waitcnt lgkmcnt(4)
    v_mfma_f32_32x32x16_bf16 v[32:47], v[144:147], a[176:179], v[32:47]
    v_mov_b32 v6, v7
    ds_read_b128 v[176:179], v8 offset:12288
    v_add_f32 v12, v12, v17
    v_exp_f32 v20, v20
    v_mfma_f32_32x32x16_bf16 v[32:47], v[148:151], a[180:183], v[32:47]
    ds_read_b128 v[180:183], v8 offset:13312
    v_add_f32 v12, v12, v18
    v_exp_f32 v21, v21
    v_mfma_f32_32x32x16_bf16 v[32:47], v[152:155], a[184:187], v[32:47]
    ds_read_b128 v[184:187], v8 offset:14336
    v_add_f32 v12, v12, v19
    v_exp_f32 v22, v22
    v_add_f32 v12, v12, v20
    v_mfma_f32_32x32x16_bf16 v[32:47], v[156:159], a[188:191], v[32:47]
    ds_read_b128 v[188:191], v8 offset:15360
    v_exp_f32 v23, v23
    v_add_f32 v12, v12, v21
    s_waitcnt lgkmcnt(4)
    v_mfma_f32_32x32x16_bf16 a[0:15], v[160:163], v[112:115], a[0:15]
    v_exp_f32 v24, v24
    v_add_f32 v12, v12, v22
    v_exp_f32 v25, v25
    v_mfma_f32_32x32x16_bf16 a[16:31], v[164:167], v[112:115], a[16:31]
    v_add_f32 v12, v12, v23
    v_exp_f32 v26, v26
    v_exp_f32 v32, v32
    v_mfma_f32_32x32x16_bf16 a[32:47], v[168:171], v[112:115], a[32:47]
    v_add_f32 v12, v12, v24
    v_exp_f32 v27, v27
    v_exp_f32 v33, v33
    v_mfma_f32_32x32x16_bf16 a[48:63], v[172:175], v[112:115], a[48:63]
    v_add_f32 v12, v12, v25
    v_exp_f32 v28, v28
    v_add_f32 v12, v12, v26
    s_waitcnt lgkmcnt(0)
    v_mfma_f32_32x32x16_bf16 a[0:15], v[176:179], v[116:119], a[0:15]
    v_exp_f32 v29, v29
    v_add_f32 v12, v12, v27
    v_exp_f32 v34, v34
    v_mfma_f32_32x32x16_bf16 a[16:31], v[180:183], v[116:119], a[16:31]
    v_exp_f32 v30, v30
    v_add_f32 v12, v12, v28
    v_exp_f32 v31, v31
    v_mfma_f32_32x32x16_bf16 a[32:47], v[184:187], v[116:119], a[32:47]
    v_add_f32 v12, v12, v29
    v_add_f32 v13, v13, v32
    v_exp_f32 v35, v35
    v_add_f32 v13, v13, v33
    v_mfma_f32_32x32x16_bf16 a[48:63], v[188:191], v[116:119], a[48:63]
    v_add_f32 v12, v12, v30
    v_add_f32 v12, v12, v31
    v_cvt_pk_bf16_f32 v112, v16, v17
    v_exp_f32 v36, v36
    v_mfma_f32_32x32x16_bf16 a[64:79], v[160:163], v[120:123], a[64:79]
    ds_read_b128 v[128:131], v7 offset:0
    v_add_f32 v13, v13, v34
    v_exp_f32 v37, v37
    v_mfma_f32_32x32x16_bf16 a[80:95], v[164:167], v[120:123], a[80:95]
    ds_read_b128 v[132:135], v7 offset:1024
    v_add_f32 v13, v13, v35
    v_exp_f32 v38, v38
    v_mfma_f32_32x32x16_bf16 a[96:111], v[168:171], v[120:123], a[96:111]
    s_add_u32 s28, s28, 16384
    s_add_u32 s27, s27, 1
    ds_read_b128 v[136:139], v7 offset:2048
    v_cvt_pk_bf16_f32 v113, v18, v19
    v_mfma_f32_32x32x16_bf16 a[112:127], v[172:175], v[120:123], a[112:127]
    s_and_b32 s28, s28, 0xffff
    ds_read_b128 v[140:143], v7 offset:3072
    v_cvt_pk_bf16_f32 v114, v20, v21
    v_add_f32 v13, v13, v36
    v_mfma_f32_32x32x16_bf16 a[64:79], v[176:179], v[124:127], a[64:79]
    s_xor_b32 s29, s28, 0x8000
    v_add_u32 v8, s28, v15
    ds_read_b128 v[144:147], v7 offset:4096
    v_cvt_pk_bf16_f32 v115, v22, v23
    v_mfma_f32_32x32x16_bf16 a[80:95], v[180:183], v[124:127], a[80:95]
    ds_read_b128 v[148:151], v7 offset:5120
    v_cvt_pk_bf16_f32 v116, v24, v25
    v_cvt_pk_bf16_f32 v117, v26, v27
    v_cvt_pk_bf16_f32 v118, v28, v29
    v_mfma_f32_32x32x16_bf16 a[96:111], v[184:187], v[124:127], a[96:111]
    ds_read_b128 v[152:155], v7 offset:6144
    v_cvt_pk_bf16_f32 v119, v30, v31
    v_exp_f32 v39, v39
    v_mfma_f32_32x32x16_bf16 a[112:127], v[188:191], v[124:127], a[112:127]
    ds_read_b128 v[156:159], v7 offset:7168
    v_add_f32 v13, v13, v37
    s_waitcnt lgkmcnt(4)
    s_sub_u32 s34, s26, 3
    s_cmp_ge_u32 s27, s34
    s_cbranch_scc1 L_A_p2m_enter
L_A_p2:
    v_mfma_f32_32x32x16_bf16 v[16:31], v[128:131], a[160:163], v[64:79]
    ds_read_b128 v[128:131], v6 offset:8192
    v_exp_f32 v40, v40
    v_add_f32 v13, v13, v38
    v_exp_f32 v41, v41
    v_mfma_f32_32x32x16_bf16 v[16:31], v[132:135], a[164:167], v[16:31]
    v_add_u32 v7, s29, v1
    ds_read_b128 v[132:135], v6 offset:9216
    v_add_f32 v13, v13, v39
    v_exp_f32 v42, v42
    v_add_f32 v13, v13, v40
    v_mfma_f32_32x32x16_bf16 v[16:31], v[136:139], a[168:171], v[16:31]
    ds_read_b128 v[136:139], v6 offset:10240
    v_exp_f32 v43, v43
    v_add_f32 v13, v13, v41
    v_exp_f32 v44, v44
    v_mfma_f32_32x32x16_bf16 v[16:31], v[140:143], a[172:175], v[16:31]
    ds_read_b128 v[140:143], v6 offset:11264
    v_add_f32 v13, v13, v42
    v_exp_f32 v45, v45
    v_add_f32 v13, v13, v43
    s_waitcnt lgkmcnt(4)
    v_mfma_f32_32x32x16_bf16 v[16:31], v[144:147], a[176:179], v[16:31]
    ds_read_b128 v[144:147], v6 offset:12288
    v_exp_f32 v46, v46
    v_add_f32 v13, v13, v44
    v_exp_f32 v47, v47
    v_mfma_f32_32x32x16_bf16 v[16:31], v[148:151], a[180:183], v[16:31]
    ds_read_b128 v[148:151], v6 offset:13312
    v_add_f32 v13, v13, v45
    v_add_f32 v13, v13, v46
    v_add_f32 v13, v13, v47
    v_cvt_pk_bf16_f32 v120, v32, v33
    v_mfma_f32_32x32x16_bf16 v[16:31], v[152:155], a[184:187], v[16:31]
    ds_read_b128 v[152:155], v6 offset:14336
    v_cvt_pk_bf16_f32 v121, v34, v35
    v_cvt_pk_bf16_f32 v122, v36, v37
    v_cvt_pk_bf16_f32 v123, v38, v39
    v_cvt_pk_bf16_f32 v124, v40, v41
    v_cvt_pk_bf16_f32 v125, v42, v43
    v_mfma_f32_32x32x16_bf16 v[16:31], v[156:159], a[188:191], v[16:31]
    s_waitcnt vmcnt(8)
    s_barrier
    ds_read_b128 v[156:159], v6 offset:15360
    v_cvt_pk_bf16_f32 v126, v44, v45
    v_cvt_pk_bf16_f32 v127, v46, v47
    s_waitcnt lgkmcnt(4)
    v_mfma_f32_32x32x16_bf16 v[32:47], v[128:131], a[160:163], v[64:79]
    s_or_b32 m0, s28, s24
    v_max_f32 v2, v12, v13
    v_cmp_lt_f32 vcc, s31, v2
    s_cbranch_vccnz L_A_rare_p2
L_A_ret_p2:
    ds_read_b128 v[160:163], v8 offset:0
    v_mfma_f32_32x32x16_bf16 v[32:47], v[132:135], a[164:167], v[32:47]
    ds_read_b128 v[164:167], v8 offset:1024
    v_exp_f32 v16, v16
    v_exp_f32 v17, v17
    v_exp_f32 v18, v18
    v_mfma_f32_32x32x16_bf16 v[32:47], v[136:139], a[168:171], v[32:47]
    buffer_load_dwordx4 v1, s[4:7], s22 offen lds
    ds_read_b128 v[168:171], v8 offset:2048
    v_add_f32 v12, v12, v16
    v_exp_f32 v19, v19
    v_add_f32 v12, v12, v17
    v_mfma_f32_32x32x16_bf16 v[32:47], v[140:143], a[172:175], v[32:47]
    ds_read_b128 v[172:175], v8 offset:3072
    v_exp_f32 v20, v20
    v_add_f32 v12, v12, v18
    v_exp_f32 v21, v21
    s_waitcnt lgkmcnt(4)
    v_mfma_f32_32x32x16_bf16 v[32:47], v[144:147], a[176:179], v[32:47]
    buffer_load_dwordx4 v1, s[4:7], s22 offen offset:1024 lds
    v_mov_b32 v6, v7
    ds_read_b128 v[176:179], v8 offset:4096
    v_add_f32 v12, v12, v19
    v_exp_f32 v22, v22
    v_mfma_f32_32x32x16_bf16 v[32:47], v[148:151], a[180:183], v[32:47]
    ds_read_b128 v[180:183], v8 offset:5120
    v_add_f32 v12, v12, v20
    v_exp_f32 v23, v23
    v_add_f32 v12, v12, v21
    v_exp_f32 v24, v24
    v_mfma_f32_32x32x16_bf16 v[32:47], v[152:155], a[184:187], v[32:47]
    buffer_load_dwordx4 v1, s[4:7], s22 offen offset:2048 lds
    ds_read_b128 v[184:187], v8 offset:6144
    v_add_f32 v12, v12, v22
    v_exp_f32 v25, v25
    v_add_f32 v12, v12, v23
    v_mfma_f32_32x32x16_bf16 v[32:47], v[156:159], a[188:191], v[32:47]
    ds_read_b128 v[188:191], v8 offset:7168
    v_exp_f32 v26, v26
    v_add_f32 v12, v12, v24
    v_exp_f32 v27, v27
    s_waitcnt lgkmcnt(4)
    v_mfma_f32_32x32x16_bf16 a[64:79], v[160:163], v[112:115], a[64:79]
    buffer_load_dwordx4 v1, s[4:7], s22 offen offset:3072 lds
    ds_read_b128 v[160:163], v8 offset:8192
    v_add_f32 v12, v12, v25
    v_exp_f32 v28, v28
    v_mfma_f32_32x32x16_bf16 a[80:95], v[164:167], v[112:115], a[80:95]
    s_add_u32 s22, s22, 16384
    s_add_u32 m0, s29, s25
    ds_read_b128 v[164:167], v8 offset:9216
    v_add_f32 v12, v12, v26
    v_exp_f32 v29, v29
    v_mfma_f32_32x32x16_bf16 a[96:111], v[168:171], v[112:115], a[96:111]
    buffer_load_dwordx4 v1, s[4:7], s23 offen lds
    ds_read_b128 v[168:171], v8 offset:10240
    v_add_f32 v12, v12, v27
    v_exp_f32 v30, v30
    v_mfma_f32_32x32x16_bf16 a[112:127], v[172:175], v[112:115], a[112:127]
    ds_read_b128 v[172:175], v8 offset:11264
    v_add_f32 v12, v12, v28
    v_exp_f32 v31, v31
    s_waitcnt lgkmcnt(4)
    v_mfma_f32_32x32x16_bf16 a[64:79], v[176:179], v[116:119], a[64:79]
    buffer_load_dwordx4 v1, s[4:7], s23 offen offset:1024 lds
    ds_read_b128 v[176:179], v8 offset:12288
    v_add_f32 v12, v12, v29
    v_add_f32 v12, v12, v30
    v_mfma_f32_32x32x16_bf16 a[80:95], v[180:183], v[116:119], a[80:95]
    ds_read_b128 v[180:183], v8 offset:13312
    v_exp_f32 v32, v32
    v_exp_f32 v33, v33
    v_mfma_f32_32x32x16_bf16 a[96:111], v[184:187], v[116:119], a[96:111]
    buffer_load_dwordx4 v1, s[4:7], s23 offen offset:2048 lds
    ds_read_b128 v[184:187], v8 offset:14336
    v_exp_f32 v34, v34
    v_mfma_f32_32x32x16_bf16 a[112:127], v[188:191], v[116:119], a[112:127]
    ds_read_b128 v[188:191], v8 offset:15360
    v_add_f32 v13, v13, v32
    v_exp_f32 v35, v35
    s_waitcnt lgkmcnt(4)
    v_mfma_f32_32x32x16_bf16 a[64:79], v[160:163], v[120:123], a[64:79]
    buffer_load_dwordx4 v1, s[4:7], s23 offen offset:3072 lds
    ds_read_b128 v[128:131], v7 offset:0
    v_add_f32 v12, v12, v31
    v_cvt_pk_bf16_f32 v112, v16, v17
    v_mfma_f32_32x32x16_bf16 a[80:95], v[164:167], v[120:123], a[80:95]
    s_add_u32 s23, s23, 16384
    ds_read_b128 v[132:135], v7 offset:1024
    v_cvt_pk_bf16_f32 v113, v18, v19
    v_cvt_pk_bf16_f32 v114, v20, v21
    v_add_f32 v13, v13, v33
    v_mfma_f32_32x32x16_bf16 a[96:111], v[168:171], v[120:123], a[96:111]
    s_add_u32 s28, s28, 16384
    s_add_u32 s27, s27, 1
    ds_read_b128 v[136:139], v7 offset:2048
    v_cvt_pk_bf16_f32 v115, v22, v23
    v_cvt_pk_bf16_f32 v116, v24, v25
    v_mfma_f32_32x32x16_bf16 a[112:127], v[172:175], v[120:123], a[112:127]
    s_and_b32 s28, s28, 0xffff
    ds_read_b128 v[140:143], v7 offset:3072
    v_cvt_pk_bf16_f32 v117, v26, v27
    v_cvt_pk_bf16_f32 v118, v28, v29
    s_waitcnt lgkmcnt(4)
    v_mfma_f32_32x32x16_bf16 a[64:79], v[176:179], v[124:127], a[64:79]
    s_xor_b32 s29, s28, 0x8000
    v_add_u32 v8, s28, v15
    ds_read_b128 v[144:147], v7 offset:4096
    v_exp_f32 v36, v36
    v_mfma_f32_32x32x16_bf16 a[80:95], v[180:183], v[124:127], a[80:95]
    ds_read_b128 v[148:151], v7 offset:5120
    v_cvt_pk_bf16_f32 v119, v30, v31
    v_add_f32 v13, v13, v34
    v_exp_f32 v37, v37
    v_mfma_f32_32x32x16_bf16 a[96:111], v[184:187], v[124:127], a[96:111]
    ds_read_b128 v[152:155], v7 offset:6144
    v_add_f32 v13, v13, v35
    v_exp_f32 v38, v38
    v_add_f32 v13, v13, v36
    v_mfma_f32_32x32x16_bf16 a[112:127], v[188:191], v[124:127], a[112:127]
    ds_read_b128 v[156:159], v7 offset:7168
    v_exp_f32 v39, v39
    v_add_f32 v13, v13, v37
    s_waitcnt lgkmcnt(4)
    s_cmp_lt_u32 s27, s34
    s_cbranch_scc1 L_A_p2
L_A_p2m_enter:
    v_and_b32 v2, 31, v0
    v_lshrrev_b32 v3, 5, v0
    v_lshlrev_b32 v3, 2, v3
    v_sub_u32 v2, v2, v3
    s_lshl_b32 s19, s33, 5
    s_lshl_b32 s20, s27, 6
    s_add_u32 s20, s20, 64
    s_sub_i32 s19, s19, s20
    v_add_u32 v10, s19, v2
    v_cvt_f32_i32 v10, v10
    s_sub_u32 s34, s26, 1
L_A_p2m:
    v_mul_f32 v11, 0x7149f2ca, v10
    v_add_f32 v80, 0x70c9f2ca, v11
    v_add_f32 v81, 0xf0c9f2ca, v11
    v_add_f32 v82, 0xf1977617, v11
    v_add_f32 v83, 0xf1fc6f7c, v11
    v_add_f32 v84, 0xf2bd539d, v11
    v_add_f32 v85, 0xf2d691f6, v11
    v_add_f32 v86, 0xf2efd050, v11
    v_add_f32 v87, 0xf3048754, v11
    v_add_f32 v88, 0xf343a333, v11
    v_add_f32 v89, 0xf3504260, v11
    v_add_f32 v90, 0xf35ce18d, v11
    v_add_f32 v91, 0xf36980b9, v11
    v_add_f32 v92, 0xf3944e4c, v11
    v_add_f32 v93, 0xf39a9de3, v11
    v_add_f32 v94, 0xf3a0ed79, v11
    v_add_f32 v95, 0xf3a73d0f, v11
    v_min_f32 v80, v64, v80
    v_min_f32 v81, v64, v81
    v_min_f32 v82, v64, v82
    v_min_f32 v83, v64, v83
    v_min_f32 v84, v64, v84
    v_min_f32 v85, v64, v85
    v_min_f32 v86, v64, v86
    v_min_f32 v87, v64, v87
    v_min_f32 v88, v64, v88
    v_min_f32 v89, v64, v89
    v_min_f32 v90, v64, v90
    v_min_f32 v91, v64, v91
    v_min_f32 v92, v64, v92
    v_min_f32 v93, v64, v93
    v_min_f32 v94, v64, v94
    v_min_f32 v95, v64, v95
    v_add_f32 v10, 0xc2000000, v10
    v_mul_f32 v11, 0x7149f2ca, v10
    v_add_f32 v96, 0x70c9f2ca, v11
    v_add_f32 v97, 0xf0c9f2ca, v11
    v_add_f32 v98, 0xf1977617, v11
    v_add_f32 v99, 0xf1fc6f7c, v11
    v_add_f32 v100, 0xf2bd539d, v11
    v_add_f32 v101, 0xf2d691f6, v11
    v_add_f32 v102, 0xf2efd050, v11
    v_add_f32 v103, 0xf3048754, v11
    v_add_f32 v104, 0xf343a333, v11
    v_add_f32 v105, 0xf3504260, v11
    v_add_f32 v106, 0xf35ce18d, v11
    v_add_f32 v107, 0xf36980b9, v11
    v_add_f32 v108, 0xf3944e4c, v11
    v_add_f32 v109, 0xf39a9de3, v11
    v_add_f32 v110, 0xf3a0ed79, v11
    v_add_f32 v111, 0xf3a73d0f, v11
    v_min_f32 v96, v64, v96
    v_min_f32 v97, v64, v97
    v_min_f32 v98, v64, v98
    v_min_f32 v99, v64, v99
    v_min_f32 v100, v64, v100
    v_min_f32 v101, v64, v101
    v_min_f32 v102, v64, v102
    v_min_f32 v103, v64, v103
    v_min_f32 v104, v64, v104
    v_min_f32 v105, v64, v105
    v_min_f32 v106, v64, v106
    v_min_f32 v107, v64, v107
    v_min_f32 v108, v64, v108
    v_min_f32 v109, v64, v109
    v_min_f32 v110, v64, v110
    v_min_f32 v111, v64, v111
    v_add_f32 v10, 0xc2000000, v10
    v_mfma_f32_32x32x16_bf16 v[16:31], v[128:131], a[160:163], v[80:95]
    ds_read_b128 v[128:131], v6 offset:8192
    v_exp_f32 v40, v40
    v_add_f32 v13, v13, v38
    v_exp_f32 v41, v41
    v_mfma_f32_32x32x16_bf16 v[16:31], v[132:135], a[164:167], v[16:31]
    v_add_u32 v7, s29, v1
    ds_read_b128 v[132:135], v6 offset:9216
    v_add_f32 v13, v13, v39
    v_exp_f32 v42, v42
    v_add_f32 v13, v13, v40
    v_mfma_f32_32x32x16_bf16 v[16:31], v[136:139], a[168:171], v[16:31]
    ds_read_b128 v[136:139], v6 offset:10240
    v_exp_f32 v43, v43
    v_add_f32 v13, v13, v41
    v_exp_f32 v44, v44
    v_mfma_f32_32x32x16_bf16 v[16:31], v[140:143], a[172:175], v[16:31]
    ds_read_b128 v[140:143], v6 offset:11264
    v_add_f32 v13, v13, v42
    v_exp_f32 v45, v45
    v_add_f32 v13, v13, v43
    s_waitcnt lgkmcnt(4)
    v_mfma_f32_32x32x16_bf16 v[16:31], v[144:147], a[176:179], v[16:31]
    ds_read_b128 v[144:147], v6 offset:12288
    v_exp_f32 v46, v46
    v_add_f32 v13, v13, v44
    v_exp_f32 v47, v47
    v_mfma_f32_32x32x16_bf16 v[16:31], v[148:151], a[180:183], v[16:31]
    ds_read_b128 v[148:151], v6 offset:13312
    v_add_f32 v13, v13, v45
    v_add_f32 v13, v13, v46
    v_add_f32 v13, v13, v47
    v_cvt_pk_bf16_f32 v120, v32, v33
    v_cvt_pk_bf16_f32 v121, v34, v35
    v_mfma_f32_32x32x16_bf16 v[16:31], v[152:155], a[184:187], v[16:31]
    ds_read_b128 v[152:155], v6 offset:14336
    v_cvt_pk_bf16_f32 v122, v36, v37
    v_cvt_pk_bf16_f32 v123, v38, v39
    v_cvt_pk_bf16_f32 v124, v40, v41
    v_cvt_pk_bf16_f32 v125, v42, v43
    v_mfma_f32_32x32x16_bf16 v[16:31], v[156:159], a[188:191], v[16:31]
    s_waitcnt vmcnt(4)
    s_barrier
    ds_read_b128 v[156:159], v6 offset:15360
    v_cvt_pk_bf16_f32 v126, v44, v45
    v_cvt_pk_bf16_f32 v127, v46, v47
    s_waitcnt lgkmcnt(4)
    v_mfma_f32_32x32x16_bf16 v[32:47], v[128:131], a[160:163], v[96:111]
    v_max_f32 v2, v12, v13
    v_cmp_lt_f32 vcc, s31, v2
    s_cbranch_vccnz L_A_rare_p2m
L_A_ret_p2m:
    ds_read_b128 v[160:163], v8 offset:0
    v_mfma_f32_32x32x16_bf16 v[32:47], v[132:135], a[164:167], v[32:47]
    ds_read_b128 v[164:167], v8 offset:1024
    v_exp_f32 v16, v16
    v_exp_f32 v17, v17
    v_mfma_f32_32x32x16_bf16 v[32:47], v[136:139], a[168:171], v[32:47]
    ds_read_b128 v[168:171], v8 offset:2048
    v_exp_f32 v18, v18
    v_add_f32 v12, v12, v16
    v_exp_f32 v19, v19
    v_mfma_f32_32x32x16_bf16 v[32:47], v[140:143], a[172:175], v[32:47]
    ds_read_b128 v[172:175], v8 offset:3072
    v_add_f32 v12, v12, v17
    v_exp_f32 v20, v20
    s_waitcnt lgkmcnt(4)
    v_mfma_f32_32x32x16_bf16 v[32:47], v[144:147], a[176:179], v[32:47]
    v_mov_b32 v6, v7
    ds_read_b128 v[176:179], v8 offset:4096
    v_add_f32 v12, v12, v18
    v_exp_f32 v21, v21
    v_add_f32 v12, v12, v19
    v_mfma_f32_32x32x16_bf16 v[32:47], v[148:151], a[180:183], v[32:47]
    ds_read_b128 v[180:183], v8 offset:5120
    v_exp_f32 v22, v22
    v_add_f32 v12, v12, v20
    v_exp_f32 v23, v23
    v_mfma_f32_32x32x16_bf16 v[32:47], v[152:155], a[184:187], v[32:47]
    ds_read_b128 v[184:187], v8 offset:6144
    v_add_f32 v12, v12, v21
    v_exp_f32 v24, v24
    v_add_f32 v12, v12, v22
    v_mfma_f32_32x32x16_bf16 v[32:47], v[156:159], a[188:191], v[32:47]
    ds_read_b128 v[188:191], v8 offset:7168
    v_exp_f32 v25, v25
    v_add_f32 v12, v12, v23
    s_waitcnt lgkmcnt(4)
    v_mfma_f32_32x32x16_bf16 a[64:79], v[160:163], v[112:115], a[64:79]
    ds_read_b128 v[160:163], v8 offset:8192
    v_exp_f32 v26, v26
    v_add_f32 v12, v12, v24
    v_exp_f32 v27, v27
    v_mfma_f32_32x32x16_bf16 a[80:95], v[164:167], v[112:115], a[80:95]
    s_add_u32 m0, s29, s25
    ds_read_b128 v[164:167], v8 offset:9216
    v_add_f32 v12, v12, v25
    v_exp_f32 v28, v28
    v_add_f32 v12, v12, v26
    v_mfma_f32_32x32x16_bf16 a[96:111], v[168:171], v[112:115], a[96:111]
    buffer_load_dwordx4 v1, s[4:7], s23 offen lds
    ds_read_b128 v[168:171], v8 offset:10240
    v_exp_f32 v29, v29
    v_mfma_f32_32x32x16_bf16 a[112:127], v[172:175], v[112:115], a[112:127]
    ds_read_b128 v[172:175], v8 offset:11264
    v_add_f32 v12, v12, v27
    v_exp_f32 v30, v30
    v_add_f32 v12, v12, v28
    s_waitcnt lgkmcnt(4)
    v_mfma_f32_32x32x16_bf16 a[64:79], v[176:179], v[116:119], a[64:79]
    buffer_load_dwordx4 v1, s[4:7], s23 offen offset:1024 lds
    ds_read_b128 v[176:179], v8 offset:12288
    v_exp_f32 v31, v31
    v_mfma_f32_32x32x16_bf16 a[80:95], v[180:183], v[116:119], a[80:95]
    ds_read_b128 v[180:183], v8 offset:13312
    v_add_f32 v12, v12, v29
    v_add_f32 v12, v12, v30
    v_add_f32 v12, v12, v31
    v_cvt_pk_bf16_f32 v112, v16, v17
    v_mfma_f32_32x32x16_bf16 a[96:111], v[184:187], v[116:119], a[96:111]
    buffer_load_dwordx4 v1, s[4:7], s23 offen offset:2048 lds
    ds_read_b128 v[184:187], v8 offset:14336
    v_cvt_pk_bf16_f32 v113, v18, v19
    v_exp_f32 v32, v32
    v_mfma_f32_32x32x16_bf16 a[112:127], v[188:191], v[116:119], a[112:127]
    ds_read_b128 v[188:191], v8 offset:15360
    v_cvt_pk_bf16_f32 v114, v20, v21
    v_cvt_pk_bf16_f32 v115, v22, v23
    v_cvt_pk_bf16_f32 v116, v24, v25
    v_cvt_pk_bf16_f32 v117, v26, v27
    s_waitcnt lgkmcnt(4)
    v_mfma_f32_32x32x16_bf16 a[64:79], v[160:163], v[120:123], a[64:79]
    buffer_load_dwordx4 v1, s[4:7], s23 offen offset:3072 lds
    ds_read_b128 v[128:131], v7 offset:0
    v_exp_f32 v33, v33
    v_mfma_f32_32x32x16_bf16 a[80:95], v[164:167], v[120:123], a[80:95]
    s_add_u32 s23, s23, 16384
    ds_read_b128 v[132:135], v7 offset:1024
    v_exp_f32 v34, v34
    v_add_f32 v13, v13, v32
    v_mfma_f32_32x32x16_bf16 a[96:111], v[168:171], v[120:123], a[96:111]
    s_add_u32 s28, s28, 16384
    s_add_u32 s27, s27, 1
    ds_read_b128 v[136:139], v7 offset:2048
    v_exp_f32 v35, v35
    v_mfma_f32_32x32x16_bf16 a[112:127], v[172:175], v[120:123], a[112:127]
    s_and_b32 s28, s28, 0xffff
    ds_read_b128 v[140:143], v7 offset:3072
    v_cvt_pk_bf16_f32 v118, v28, v29
    v_add_f32 v13, v13, v33
    s_waitcnt lgkmcnt(4)
    v_mfma_f32_32x32x16_bf16 a[64:79], v[176:179], v[124:127], a[64:79]
    s_xor_b32 s29, s28, 0x8000
    v_add_u32 v8, s28, v15
    ds_read_b128 v[144:147], v7 offset:4096
    v_exp_f32 v36, v36
    v_mfma_f32_32x32x16_bf16 a[80:95], v[180:183], v[124:127], a[80:95]
    ds_read_b128 v[148:151], v7 offset:5120
    v_cvt_pk_bf16_f32 v119, v30, v31
    v_add_f32 v13, v13, v34
    v_exp_f32 v37, v37
    v_mfma_f32_32x32x16_bf16 a[96:111], v[184:187], v[124:127], a[96:111]
    ds_read_b128 v[152:155], v7 offset:6144
    v_add_f32 v13, v13, v35
    v_exp_f32 v38, v38
    v_add_f32 v13, v13, v36
    v_mfma_f32_32x32x16_bf16 a[112:127], v[188:191], v[124:127], a[112:127]
    ds_read_b128 v[156:159], v7 offset:7168
    v_exp_f32 v39, v39
    v_add_f32 v13, v13, v37
    s_waitcnt lgkmcnt(4)
    s_cmp_lt_u32 s27, s34
    s_cbranch_scc1 L_A_p2m
    v_exp_f32 v40, v40
    v_add_f32 v13, v13, v38
    v_exp_f32 v41, v41
    v_add_f32 v13, v13, v39
    v_exp_f32 v42, v42
    v_add_f32 v13, v13, v40
    v_exp_f32 v43, v43
    v_add_f32 v13, v13, v41
    v_exp_f32 v44, v44
    v_add_f32 v13, v13, v42
    v_exp_f32 v45, v45
    v_add_f32 v13, v13, v43
    v_exp_f32 v46, v46
    v_add_f32 v13, v13, v44
    v_exp_f32 v47, v47
    v_add_f32 v13, v13, v45
    v_add_f32 v13, v13, v46
    v_add_f32 v13, v13, v47
    v_cvt_pk_bf16_f32 v120, v32, v33
    v_cvt_pk_bf16_f32 v121, v34, v35
    v_cvt_pk_bf16_f32 v122, v36, v37
    v_cvt_pk_bf16_f32 v123, v38, v39
    v_cvt_pk_bf16_f32 v124, v40, v41
    v_cvt_pk_bf16_f32 v125, v42, v43
    s_waitcnt vmcnt(4)
    s_barrier
    v_cvt_pk_bf16_f32 v126, v44, v45
    v_cvt_pk_bf16_f32 v127, v46, v47
    ds_read_b128 v[160:163], v8 offset:0
    ds_read_b128 v[164:167], v8 offset:1024
    ds_read_b128 v[168:171], v8 offset:2048
    ds_read_b128 v[172:175], v8 offset:3072
    ds_read_b128 v[176:179], v8 offset:4096
    ds_read_b128 v[180:183], v8 offset:5120
    ds_read_b128 v[184:187], v8 offset:6144
    ds_read_b128 v[188:191], v8 offset:7168
    s_waitcnt lgkmcnt(4)
    v_mfma_f32_32x32x16_bf16 a[64:79], v[160:163], v[112:115], a[64:79]
    ds_read_b128 v[160:163], v8 offset:8192
    v_mfma_f32_32x32x16_bf16 a[80:95], v[164:167], v[112:115], a[80:95]
    ds_read_b128 v[164:167], v8 offset:9216
    v_mfma_f32_32x32x16_bf16 a[96:111], v[168:171], v[112:115], a[96:111]
    ds_read_b128 v[168:171], v8 offset:10240
    v_mfma_f32_32x32x16_bf16 a[112:127], v[172:175], v[112:115], a[112:127]
    ds_read_b128 v[172:175], v8 offset:11264
    s_waitcnt lgkmcnt(4)
    v_mfma_f32_32x32x16_bf16 a[64:79], v[176:179], v[116:119], a[64:79]
    ds_read_b128 v[176:179], v8 offset:12288
    v_mfma_f32_32x32x16_bf16 a[80:95], v[180:183], v[116:119], a[80:95]
    ds_read_b128 v[180:183], v8 offset:13312
    v_mfma_f32_32x32x16_bf16 a[96:111], v[184:187], v[116:119], a[96:111]
    ds_read_b128 v[184:187], v8 offset:14336
    v_mfma_f32_32x32x16_bf16 a[112:127], v[188:191], v[116:119], a[112:127]
    ds_read_b128 v[188:191], v8 offset:15360
    s_waitcnt lgkmcnt(4)
    v_mfma_f32_32x32x16_bf16 a[64:79], v[160:163], v[120:123], a[64:79]
    v_mfma_f32_32x32x16_bf16 a[80:95], v[164:167], v[120:123], a[80:95]
    v_mfma_f32_32x32x16_bf16 a[96:111], v[168:171], v[120:123], a[96:111]
    v_mfma_f32_32x32x16_bf16 a[112:127], v[172:175], v[120:123], a[112:127]
    s_waitcnt lgkmcnt(0)
    v_mfma_f32_32x32x16_bf16 a[64:79], v[176:179], v[124:127], a[64:79]
    v_mfma_f32_32x32x16_bf16 a[80:95], v[180:183], v[124:127], a[80:95]
    v_mfma_f32_32x32x16_bf16 a[96:111], v[184:187], v[124:127], a[96:111]
    v_mfma_f32_32x32x16_bf16 a[112:127], v[188:191], v[124:127], a[112:127]
    s_nop 7
    s_nop 7
    v_add_f32 v12, v12, v13
    v_mov_b32 v16, 0
    v_mov_b32 v17, 0
    v_mov_b32 v18, 0
    v_mov_b32 v19, 0
    v_mov_b32 v2, v14
    v_mov_b32 v3, v14
    s_nop 1
    v_permlane32_swap_b32 v2, v3
    s_nop 1
    v_add_f32 v2, v2, v3
    v_mul_f32 v11, 0, v2
    v_rcp_f32 v2, v2
    s_lshl_b32 s19, s32, 18
    s_lshl_b32 s20, s16, 13
    s_add_u32 s19, s19, s20
    s_add_u32 s19, s19, 50331648
    s_add_u32 s20, s19, 4096
    v_accvgpr_read_b32 v128, a0
    v_accvgpr_read_b32 v129, a1
    v_accvgpr_read_b32 v130, a2
    v_accvgpr_read_b32 v131, a3
    v_accvgpr_read_b32 v132, a4
    v_accvgpr_read_b32 v133, a5
    v_accvgpr_read_b32 v134, a6
    v_accvgpr_read_b32 v135, a7
    v_mul_f32 v128, v2, v128
    v_mul_f32 v129, v2, v129
    v_mul_f32 v130, v2, v130
    v_mul_f32 v131, v2, v131
    v_mul_f32 v132, v2, v132
    v_mul_f32 v133, v2, v133
    v_mul_f32 v134, v2, v134
    v_mul_f32 v135, v2, v135
    v_cvt_pk_bf16_f32 v136, v128, v129
    v_cvt_pk_bf16_f32 v137, v130, v131
    v_cvt_pk_bf16_f32 v138, v132, v133
    v_cvt_pk_bf16_f32 v139, v134, v135
    buffer_store_dwordx4 v[136:139], v1, s[4:7], s19 offen offset:0 sc1
    s_nop 0
    v_mfma_f32_32x32x16_bf16 v[32:47], v[16:19], v[136:139], 0
    v_accvgpr_read_b32 v140, a8
    v_accvgpr_read_b32 v141, a9
    v_accvgpr_read_b32 v142, a10
    v_accvgpr_read_b32 v143, a11
    v_accvgpr_read_b32 v144, a12
    v_accvgpr_read_b32 v145, a13
    v_accvgpr_read_b32 v146, a14
    v_accvgpr_read_b32 v147, a15
    v_mul_f32 v140, v2, v140
    v_mul_f32 v141, v2, v141
    v_mul_f32 v142, v2, v142
    v_mul_f32 v143, v2, v143
    v_mul_f32 v144, v2, v144
    v_mul_f32 v145, v2, v145
    v_mul_f32 v146, v2, v146
    v_mul_f32 v147, v2, v147
    v_cvt_pk_bf16_f32 v148, v140, v141
    v_cvt_pk_bf16_f32 v149, v142, v143
    v_cvt_pk_bf16_f32 v150, v144, v145
    v_cvt_pk_bf16_f32 v151, v146, v147
    buffer_store_dwordx4 v[148:151], v1, s[4:7], s19 offen offset:1024 sc1
    s_nop 0
    v_mfma_f32_32x32x16_bf16 v[32:47], v[16:19], v[148:151], v[32:47]
    v_accvgpr_read_b32 v152, a16
    v_accvgpr_read_b32 v153, a17
    v_accvgpr_read_b32 v154, a18
    v_accvgpr_read_b32 v155, a19
    v_accvgpr_read_b32 v156, a20
    v_accvgpr_read_b32 v157, a21
    v_accvgpr_read_b32 v158, a22
    v_accvgpr_read_b32 v159, a23
    v_mul_f32 v152, v2, v152
    v_mul_f32 v153, v2, v153
    v_mul_f32 v154, v2, v154
    v_mul_f32 v155, v2, v155
    v_mul_f32 v156, v2, v156
    v_mul_f32 v157, v2, v157
    v_mul_f32 v158, v2, v158
    v_mul_f32 v159, v2, v159
    v_cvt_pk_bf16_f32 v160, v152, v153
    v_cvt_pk_bf16_f32 v161, v154, v155
    v_cvt_pk_bf16_f32 v162, v156, v157
    v_cvt_pk_bf16_f32 v163, v158, v159
    buffer_store_dwordx4 v[160:163], v1, s[4:7], s19 offen offset:2048 sc1
    s_nop 0
    v_mfma_f32_32x32x16_bf16 v[32:47], v[16:19], v[160:163], v[32:47]
    v_accvgpr_read_b32 v164, a24
    v_accvgpr_read_b32 v165, a25
    v_accvgpr_read_b32 v166, a26
    v_accvgpr_read_b32 v167, a27
    v_accvgpr_read_b32 v168, a28
    v_accvgpr_read_b32 v169, a29
    v_accvgpr_read_b32 v170, a30
    v_accvgpr_read_b32 v171, a31
    v_mul_f32 v164, v2, v164
    v_mul_f32 v165, v2, v165
    v_mul_f32 v166, v2, v166
    v_mul_f32 v167, v2, v167
    v_mul_f32 v168, v2, v168
    v_mul_f32 v169, v2, v169
    v_mul_f32 v170, v2, v170
    v_mul_f32 v171, v2, v171
    v_cvt_pk_bf16_f32 v172, v164, v165
    v_cvt_pk_bf16_f32 v173, v166, v167
    v_cvt_pk_bf16_f32 v174, v168, v169
    v_cvt_pk_bf16_f32 v175, v170, v171
    buffer_store_dwordx4 v[172:175], v1, s[4:7], s19 offen offset:3072 sc1
    s_nop 0
    v_mfma_f32_32x32x16_bf16 v[32:47], v[16:19], v[172:175], v[32:47]
    v_accvgpr_read_b32 v128, a32
    v_accvgpr_read_b32 v129, a33
    v_accvgpr_read_b32 v130, a34
    v_accvgpr_read_b32 v131, a35
    v_accvgpr_read_b32 v132, a36
    v_accvgpr_read_b32 v133, a37
    v_accvgpr_read_b32 v134, a38
    v_accvgpr_read_b32 v135, a39
    v_mul_f32 v128, v2, v128
    v_mul_f32 v129, v2, v129
    v_mul_f32 v130, v2, v130
    v_mul_f32 v131, v2, v131
    v_mul_f32 v132, v2, v132
    v_mul_f32 v133, v2, v133
    v_mul_f32 v134, v2, v134
    v_mul_f32 v135, v2, v135
    v_cvt_pk_bf16_f32 v136, v128, v129
    v_cvt_pk_bf16_f32 v137, v130, v131
    v_cvt_pk_bf16_f32 v138, v132, v133
    v_cvt_pk_bf16_f32 v139, v134, v135
    buffer_store_dwordx4 v[136:139], v1, s[4:7], s20 offen offset:0 sc1
    s_nop 0
    v_mfma_f32_32x32x16_bf16 v[32:47], v[16:19], v[136:139], v[32:47]
    v_accvgpr_read_b32 v140, a40
    v_accvgpr_read_b32 v141, a41
    v_accvgpr_read_b32 v142, a42
    v_accvgpr_read_b32 v143, a43
    v_accvgpr_read_b32 v144, a44
    v_accvgpr_read_b32 v145, a45
    v_accvgpr_read_b32 v146, a46
    v_accvgpr_read_b32 v147, a47
    v_mul_f32 v140, v2, v140
    v_mul_f32 v141, v2, v141
    v_mul_f32 v142, v2, v142
    v_mul_f32 v143, v2, v143
    v_mul_f32 v144, v2, v144
    v_mul_f32 v145, v2, v145
    v_mul_f32 v146, v2, v146
    v_mul_f32 v147, v2, v147
    v_cvt_pk_bf16_f32 v148, v140, v141
    v_cvt_pk_bf16_f32 v149, v142, v143
    v_cvt_pk_bf16_f32 v150, v144, v145
    v_cvt_pk_bf16_f32 v151, v146, v147
    buffer_store_dwordx4 v[148:151], v1, s[4:7], s20 offen offset:1024 sc1
    s_nop 0
    v_mfma_f32_32x32x16_bf16 v[32:47], v[16:19], v[148:151], v[32:47]
    v_accvgpr_read_b32 v152, a48
    v_accvgpr_read_b32 v153, a49
    v_accvgpr_read_b32 v154, a50
    v_accvgpr_read_b32 v155, a51
    v_accvgpr_read_b32 v156, a52
    v_accvgpr_read_b32 v157, a53
    v_accvgpr_read_b32 v158, a54
    v_accvgpr_read_b32 v159, a55
    v_mul_f32 v152, v2, v152
    v_mul_f32 v153, v2, v153
    v_mul_f32 v154, v2, v154
    v_mul_f32 v155, v2, v155
    v_mul_f32 v156, v2, v156
    v_mul_f32 v157, v2, v157
    v_mul_f32 v158, v2, v158
    v_mul_f32 v159, v2, v159
    v_cvt_pk_bf16_f32 v160, v152, v153
    v_cvt_pk_bf16_f32 v161, v154, v155
    v_cvt_pk_bf16_f32 v162, v156, v157
    v_cvt_pk_bf16_f32 v163, v158, v159
    buffer_store_dwordx4 v[160:163], v1, s[4:7], s20 offen offset:2048 sc1
    s_nop 0
    v_mfma_f32_32x32x16_bf16 v[32:47], v[16:19], v[160:163], v[32:47]
    v_accvgpr_read_b32 v164, a56
    v_accvgpr_read_b32 v165, a57
    v_accvgpr_read_b32 v166, a58
    v_accvgpr_read_b32 v167, a59
    v_accvgpr_read_b32 v168, a60
    v_accvgpr_read_b32 v169, a61
    v_accvgpr_read_b32 v170, a62
    v_accvgpr_read_b32 v171, a63
    v_mul_f32 v164, v2, v164
    v_mul_f32 v165, v2, v165
    v_mul_f32 v166, v2, v166
    v_mul_f32 v167, v2, v167
    v_mul_f32 v168, v2, v168
    v_mul_f32 v169, v2, v169
    v_mul_f32 v170, v2, v170
    v_mul_f32 v171, v2, v171
    v_cvt_pk_bf16_f32 v172, v164, v165
    v_cvt_pk_bf16_f32 v173, v166, v167
    v_cvt_pk_bf16_f32 v174, v168, v169
    v_cvt_pk_bf16_f32 v175, v170, v171
    buffer_store_dwordx4 v[172:175], v1, s[4:7], s20 offen offset:3072 sc1
    s_nop 0
    v_mfma_f32_32x32x16_bf16 v[32:47], v[16:19], v[172:175], v[32:47]
    v_mov_b32 v2, v12
    v_mov_b32 v3, v12
    s_nop 1
    v_permlane32_swap_b32 v2, v3
    s_nop 1
    v_add_f32 v2, v2, v3
    v_fma_f32 v11, v2, 0, v11
    v_rcp_f32 v2, v2
    s_lshl_b32 s19, s33, 18
    s_lshl_b32 s20, s16, 13
    s_add_u32 s19, s19, s20
    s_add_u32 s19, s19, 50331648
    s_add_u32 s20, s19, 4096
    v_accvgpr_read_b32 v128, a64
    v_accvgpr_read_b32 v129, a65
    v_accvgpr_read_b32 v130, a66
    v_accvgpr_read_b32 v131, a67
    v_accvgpr_read_b32 v132, a68
    v_accvgpr_read_b32 v133, a69
    v_accvgpr_read_b32 v134, a70
    v_accvgpr_read_b32 v135, a71
    v_mul_f32 v128, v2, v128
    v_mul_f32 v129, v2, v129
    v_mul_f32 v130, v2, v130
    v_mul_f32 v131, v2, v131
    v_mul_f32 v132, v2, v132
    v_mul_f32 v133, v2, v133
    v_mul_f32 v134, v2, v134
    v_mul_f32 v135, v2, v135
    v_cvt_pk_bf16_f32 v136, v128, v129
    v_cvt_pk_bf16_f32 v137, v130, v131
    v_cvt_pk_bf16_f32 v138, v132, v133
    v_cvt_pk_bf16_f32 v139, v134, v135
    buffer_store_dwordx4 v[136:139], v1, s[4:7], s19 offen offset:0 sc1
    s_nop 0
    v_mfma_f32_32x32x16_bf16 v[32:47], v[16:19], v[136:139], v[32:47]
    v_accvgpr_read_b32 v140, a72
    v_accvgpr_read_b32 v141, a73
    v_accvgpr_read_b32 v142, a74
    v_accvgpr_read_b32 v143, a75
    v_accvgpr_read_b32 v144, a76
    v_accvgpr_read_b32 v145, a77
    v_accvgpr_read_b32 v146, a78
    v_accvgpr_read_b32 v147, a79
    v_mul_f32 v140, v2, v140
    v_mul_f32 v141, v2, v141
    v_mul_f32 v142, v2, v142
    v_mul_f32 v143, v2, v143
    v_mul_f32 v144, v2, v144
    v_mul_f32 v145, v2, v145
    v_mul_f32 v146, v2, v146
    v_mul_f32 v147, v2, v147
    v_cvt_pk_bf16_f32 v148, v140, v141
    v_cvt_pk_bf16_f32 v149, v142, v143
    v_cvt_pk_bf16_f32 v150, v144, v145
    v_cvt_pk_bf16_f32 v151, v146, v147
    buffer_store_dwordx4 v[148:151], v1, s[4:7], s19 offen offset:1024 sc1
    s_nop 0
    v_mfma_f32_32x32x16_bf16 v[32:47], v[16:19], v[148:151], v[32:47]
    v_accvgpr_read_b32 v152, a80
    v_accvgpr_read_b32 v153, a81
    v_accvgpr_read_b32 v154, a82
    v_accvgpr_read_b32 v155, a83
    v_accvgpr_read_b32 v156, a84
    v_accvgpr_read_b32 v157, a85
    v_accvgpr_read_b32 v158, a86
    v_accvgpr_read_b32 v159, a87
    v_mul_f32 v152, v2, v152
    v_mul_f32 v153, v2, v153
    v_mul_f32 v154, v2, v154
    v_mul_f32 v155, v2, v155
    v_mul_f32 v156, v2, v156
    v_mul_f32 v157, v2, v157
    v_mul_f32 v158, v2, v158
    v_mul_f32 v159, v2, v159
    v_cvt_pk_bf16_f32 v160, v152, v153
    v_cvt_pk_bf16_f32 v161, v154, v155
    v_cvt_pk_bf16_f32 v162, v156, v157
    v_cvt_pk_bf16_f32 v163, v158, v159
    buffer_store_dwordx4 v[160:163], v1, s[4:7], s19 offen offset:2048 sc1
    s_nop 0
    v_mfma_f32_32x32x16_bf16 v[32:47], v[16:19], v[160:163], v[32:47]
    v_accvgpr_read_b32 v164, a88
    v_accvgpr_read_b32 v165, a89
    v_accvgpr_read_b32 v166, a90
    v_accvgpr_read_b32 v167, a91
    v_accvgpr_read_b32 v168, a92
    v_accvgpr_read_b32 v169, a93
    v_accvgpr_read_b32 v170, a94
    v_accvgpr_read_b32 v171, a95
    v_mul_f32 v164, v2, v164
    v_mul_f32 v165, v2, v165
    v_mul_f32 v166, v2, v166
    v_mul_f32 v167, v2, v167
    v_mul_f32 v168, v2, v168
    v_mul_f32 v169, v2, v169
    v_mul_f32 v170, v2, v170
    v_mul_f32 v171, v2, v171
    v_cvt_pk_bf16_f32 v172, v164, v165
    v_cvt_pk_bf16_f32 v173, v166, v167
    v_cvt_pk_bf16_f32 v174, v168, v169
    v_cvt_pk_bf16_f32 v175, v170, v171
    buffer_store_dwordx4 v[172:175], v1, s[4:7], s19 offen offset:3072 sc1
    s_nop 0
    v_mfma_f32_32x32x16_bf16 v[32:47], v[16:19], v[172:175], v[32:47]
    v_accvgpr_read_b32 v128, a96
    v_accvgpr_read_b32 v129, a97
    v_accvgpr_read_b32 v130, a98
    v_accvgpr_read_b32 v131, a99
    v_accvgpr_read_b32 v132, a100
    v_accvgpr_read_b32 v133, a101
    v_accvgpr_read_b32 v134, a102
    v_accvgpr_read_b32 v135, a103
    v_mul_f32 v128, v2, v128
    v_mul_f32 v129, v2, v129
    v_mul_f32 v130, v2, v130
    v_mul_f32 v131, v2, v131
    v_mul_f32 v132, v2, v132
    v_mul_f32 v133, v2, v133
    v_mul_f32 v134, v2, v134
    v_mul_f32 v135, v2, v135
    v_cvt_pk_bf16_f32 v136, v128, v129
    v_cvt_pk_bf16_f32 v137, v130, v131
    v_cvt_pk_bf16_f32 v138, v132, v133
    v_cvt_pk_bf16_f32 v139, v134, v135
    buffer_store_dwordx4 v[136:139], v1, s[4:7], s20 offen offset:0 sc1
    s_nop 0
    v_mfma_f32_32x32x16_bf16 v[32:47], v[16:19], v[136:139], v[32:47]
    v_accvgpr_read_b32 v140, a104
    v_accvgpr_read_b32 v141, a105
    v_accvgpr_read_b32 v142, a106
    v_accvgpr_read_b32 v143, a107
    v_accvgpr_read_b32 v144, a108
    v_accvgpr_read_b32 v145, a109
    v_accvgpr_read_b32 v146, a110
    v_accvgpr_read_b32 v147, a111
    v_mul_f32 v140, v2, v140
    v_mul_f32 v141, v2, v141
    v_mul_f32 v142, v2, v142
    v_mul_f32 v143, v2, v143
    v_mul_f32 v144, v2, v144
    v_mul_f32 v145, v2, v145
    v_mul_f32 v146, v2, v146
    v_mul_f32 v147, v2, v147
    v_cvt_pk_bf16_f32 v148, v140, v141
    v_cvt_pk_bf16_f32 v149, v142, v143
    v_cvt_pk_bf16_f32 v150, v144, v145
    v_cvt_pk_bf16_f32 v151, v146, v147
    buffer_store_dwordx4 v[148:151], v1, s[4:7], s20 offen offset:1024 sc1
    s_nop 0
    v_mfma_f32_32x32x16_bf16 v[32:47], v[16:19], v[148:151], v[32:47]
    v_accvgpr_read_b32 v152, a112
    v_accvgpr_read_b32 v153, a113
    v_accvgpr_read_b32 v154, a114
    v_accvgpr_read_b32 v155, a115
    v_accvgpr_read_b32 v156, a116
    v_accvgpr_read_b32 v157, a117
    v_accvgpr_read_b32 v158, a118
    v_accvgpr_read_b32 v159, a119
    v_mul_f32 v152, v2, v152
    v_mul_f32 v153, v2, v153
    v_mul_f32 v154, v2, v154
    v_mul_f32 v155, v2, v155
    v_mul_f32 v156, v2, v156
    v_mul_f32 v157, v2, v157
    v_mul_f32 v158, v2, v158
    v_mul_f32 v159, v2, v159
    v_cvt_pk_bf16_f32 v160, v152, v153
    v_cvt_pk_bf16_f32 v161, v154, v155
    v_cvt_pk_bf16_f32 v162, v156, v157
    v_cvt_pk_bf16_f32 v163, v158, v159
    buffer_store_dwordx4 v[160:163], v1, s[4:7], s20 offen offset:2048 sc1
    s_nop 0
    v_mfma_f32_32x32x16_bf16 v[32:47], v[16:19], v[160:163], v[32:47]
    v_accvgpr_read_b32 v164, a120
    v_accvgpr_read_b32 v165, a121
    v_accvgpr_read_b32 v166, a122
    v_accvgpr_read_b32 v167, a123
    v_accvgpr_read_b32 v168, a124
    v_accvgpr_read_b32 v169, a125
    v_accvgpr_read_b32 v170, a126
    v_accvgpr_read_b32 v171, a127
    v_mul_f32 v164, v2, v164
    v_mul_f32 v165, v2, v165
    v_mul_f32 v166, v2, v166
    v_mul_f32 v167, v2, v167
    v_mul_f32 v168, v2, v168
    v_mul_f32 v169, v2, v169
    v_mul_f32 v170, v2, v170
    v_mul_f32 v171, v2, v171
    v_cvt_pk_bf16_f32 v172, v164, v165
    v_cvt_pk_bf16_f32 v173, v166, v167
    v_cvt_pk_bf16_f32 v174, v168, v169
    v_cvt_pk_bf16_f32 v175, v170, v171
    buffer_store_dwordx4 v[172:175], v1, s[4:7], s20 offen offset:3072 sc1
    s_nop 0
    v_mfma_f32_32x32x16_bf16 v[32:47], v[16:19], v[172:175], v[32:47]
    s_nop 7
    s_nop 7
    v_add_f32 v11, v11, v32
    s_nop 0
    v_cmp_u_f32 vcc, v11, v11
    s_cbranch_vccnz L_A_slow
L_A_tail:
    v_lshrrev_b32 v16, 5, v0
    v_lshlrev_b32 v16, 2, v16
    v_and_b32 v17, 15, v0
    v_lshrrev_b32 v17, 2, v17
    v_add_u32 v16, v16, v17
    v_mul_u32_u24 v16, 1152, v16
    v_lshrrev_b32 v17, 4, v0
    v_and_b32 v17, 1, v17
    v_lshl_add_u32 v16, v17, 5, v16
    v_and_b32 v17, 3, v0
    v_lshl_add_u32 v16, v17, 3, v16
    s_lshl_b32 s54, s18, 6
    s_add_u32 s54, s54, 131072
    v_add_u32 v16, s54, v16
    s_mul_i32 s53, s2, 18432
    s_lshl_b32 s54, s18, 10
    s_add_u32 s53, s53, s54
    s_add_u32 s53, s53, 67108864
    ds_read_b64_tr_b16 v[24:25], v16 offset:0
    ds_read_b64_tr_b16 v[26:27], v16 offset:9216
    ds_read_b64_tr_b16 v[28:29], v16 offset:256
    ds_read_b64_tr_b16 v[30:31], v16 offset:9472
    ds_read_b64_tr_b16 v[32:33], v16 offset:512
    ds_read_b64_tr_b16 v[34:35], v16 offset:9728
    ds_read_b64_tr_b16 v[36:37], v16 offset:768
    ds_read_b64_tr_b16 v[38:39], v16 offset:9984
    ds_read_b64_tr_b16 v[40:41], v16 offset:1024
    ds_read_b64_tr_b16 v[42:43], v16 offset:10240
    s_waitcnt lgkmcnt(0)
    s_add_u32 s54, s53, 0
    buffer_store_dwordx4 v[24:27], v1, s[4:7], s54 offen
    s_add_u32 s54, s53, 4096
    buffer_store_dwordx4 v[28:31], v1, s[4:7], s54 offen
    s_add_u32 s54, s53, 8192
    buffer_store_dwordx4 v[32:35], v1, s[4:7], s54 offen
    s_add_u32 s54, s53, 12288
    buffer_store_dwordx4 v[36:39], v1, s[4:7], s54 offen
    s_cmp_ge_u32 s18, 2
    s_cbranch_scc1 L_rl_done
    s_add_u32 s54, s53, 16384
    buffer_store_dwordx4 v[40:43], v1, s[4:7], s54 offen
L_rl_done:
    s_endpgm
L_A_rare_p1:
    s_nop 7
    s_nop 7
    v_mov_b32 v2, v12
    v_mov_b32 v3, v2
    s_nop 1
    v_permlane32_swap_b32 v2, v3
    s_nop 1
    v_add_f32 v2, v2, v3
    v_frexp_exp_i32_f32 v192, v2
    v_add_u32 v192, 0x60, v192
    v_max_i32 v192, 0, v192
    v_cvt_f32_i32 v194, v192
    v_sub_u32 v193, 0, v192
    v_ldexp_f32 v12, v12, v193
    v_accvgpr_read_b32 v196, a0
    v_ldexp_f32 v196, v196, v193
    v_accvgpr_write_b32 a0, v196
    v_accvgpr_read_b32 v197, a1
    v_ldexp_f32 v197, v197, v193
    v_accvgpr_write_b32 a1, v197
    v_accvgpr_read_b32 v198, a2
    v_ldexp_f32 v198, v198, v193
    v_accvgpr_write_b32 a2, v198
    v_accvgpr_read_b32 v199, a3
    v_ldexp_f32 v199, v199, v193
    v_accvgpr_write_b32 a3, v199
    v_accvgpr_read_b32 v196, a4
    v_ldexp_f32 v196, v196, v193
    v_accvgpr_write_b32 a4, v196
    v_accvgpr_read_b32 v197, a5
    v_ldexp_f32 v197, v197, v193
    v_accvgpr_write_b32 a5, v197
    v_accvgpr_read_b32 v198, a6
    v_ldexp_f32 v198, v198, v193
    v_accvgpr_write_b32 a6, v198
    v_accvgpr_read_b32 v199, a7
    v_ldexp_f32 v199, v199, v193
    v_accvgpr_write_b32 a7, v199
    v_accvgpr_read_b32 v196, a8
    v_ldexp_f32 v196, v196, v193
    v_accvgpr_write_b32 a8, v196
    v_accvgpr_read_b32 v197, a9
    v_ldexp_f32 v197, v197, v193
    v_accvgpr_write_b32 a9, v197
    v_accvgpr_read_b32 v198, a10
    v_ldexp_f32 v198, v198, v193
    v_accvgpr_write_b32 a10, v198
    v_accvgpr_read_b32 v199, a11
    v_ldexp_f32 v199, v199, v193
    v_accvgpr_write_b32 a11, v199
    v_accvgpr_read_b32 v196, a12
    v_ldexp_f32 v196, v196, v193
    v_accvgpr_write_b32 a12, v196
    v_accvgpr_read_b32 v197, a13
    v_ldexp_f32 v197, v197, v193
    v_accvgpr_write_b32 a13, v197
    v_accvgpr_read_b32 v198, a14
    v_ldexp_f32 v198, v198, v193
    v_accvgpr_write_b32 a14, v198
    v_accvgpr_read_b32 v199, a15
    v_ldexp_f32 v199, v199, v193
    v_accvgpr_write_b32 a15, v199
    v_accvgpr_read_b32 v196, a16
    v_ldexp_f32 v196, v196, v193
    v_accvgpr_write_b32 a16, v196
    v_accvgpr_read_b32 v197, a17
    v_ldexp_f32 v197, v197, v193
    v_accvgpr_write_b32 a17, v197
    v_accvgpr_read_b32 v198, a18
    v_ldexp_f32 v198, v198, v193
    v_accvgpr_write_b32 a18, v198
    v_accvgpr_read_b32 v199, a19
    v_ldexp_f32 v199, v199, v193
    v_accvgpr_write_b32 a19, v199
    v_accvgpr_read_b32 v196, a20
    v_ldexp_f32 v196, v196, v193
    v_accvgpr_write_b32 a20, v196
    v_accvgpr_read_b32 v197, a21
    v_ldexp_f32 v197, v197, v193
    v_accvgpr_write_b32 a21, v197
    v_accvgpr_read_b32 v198, a22
    v_ldexp_f32 v198, v198, v193
    v_accvgpr_write_b32 a22, v198
    v_accvgpr_read_b32 v199, a23
    v_ldexp_f32 v199, v199, v193
    v_accvgpr_write_b32 a23, v199
    v_accvgpr_read_b32 v196, a24
    v_ldexp_f32 v196, v196, v193
    v_accvgpr_write_b32 a24, v196
    v_accvgpr_read_b32 v197, a25
    v_ldexp_f32 v197, v197, v193
    v_accvgpr_write_b32 a25, v197
    v_accvgpr_read_b32 v198, a26
    v_ldexp_f32 v198, v198, v193
    v_accvgpr_write_b32 a26, v198
    v_accvgpr_read_b32 v199, a27
    v_ldexp_f32 v199, v199, v193
    v_accvgpr_write_b32 a27, v199
    v_accvgpr_read_b32 v196, a28
    v_ldexp_f32 v196, v196, v193
    v_accvgpr_write_b32 a28, v196
    v_accvgpr_read_b32 v197, a29
    v_ldexp_f32 v197, v197, v193
    v_accvgpr_write_b32 a29, v197
    v_accvgpr_read_b32 v198, a30
    v_ldexp_f32 v198, v198, v193
    v_accvgpr_write_b32 a30, v198
    v_accvgpr_read_b32 v199, a31
    v_ldexp_f32 v199, v199, v193
    v_accvgpr_write_b32 a31, v199
    v_accvgpr_read_b32 v196, a32
    v_ldexp_f32 v196, v196, v193
    v_accvgpr_write_b32 a32, v196
    v_accvgpr_read_b32 v197, a33
    v_ldexp_f32 v197, v197, v193
    v_accvgpr_write_b32 a33, v197
    v_accvgpr_read_b32 v198, a34
    v_ldexp_f32 v198, v198, v193
    v_accvgpr_write_b32 a34, v198
    v_accvgpr_read_b32 v199, a35
    v_ldexp_f32 v199, v199, v193
    v_accvgpr_write_b32 a35, v199
    v_accvgpr_read_b32 v196, a36
    v_ldexp_f32 v196, v196, v193
    v_accvgpr_write_b32 a36, v196
    v_accvgpr_read_b32 v197, a37
    v_ldexp_f32 v197, v197, v193
    v_accvgpr_write_b32 a37, v197
    v_accvgpr_read_b32 v198, a38
    v_ldexp_f32 v198, v198, v193
    v_accvgpr_write_b32 a38, v198
    v_accvgpr_read_b32 v199, a39
    v_ldexp_f32 v199, v199, v193
    v_accvgpr_write_b32 a39, v199
    v_accvgpr_read_b32 v196, a40
    v_ldexp_f32 v196, v196, v193
    v_accvgpr_write_b32 a40, v196
    v_accvgpr_read_b32 v197, a41
    v_ldexp_f32 v197, v197, v193
    v_accvgpr_write_b32 a41, v197
    v_accvgpr_read_b32 v198, a42
    v_ldexp_f32 v198, v198, v193
    v_accvgpr_write_b32 a42, v198
    v_accvgpr_read_b32 v199, a43
    v_ldexp_f32 v199, v199, v193
    v_accvgpr_write_b32 a43, v199
    v_accvgpr_read_b32 v196, a44
    v_ldexp_f32 v196, v196, v193
    v_accvgpr_write_b32 a44, v196
    v_accvgpr_read_b32 v197, a45
    v_ldexp_f32 v197, v197, v193
    v_accvgpr_write_b32 a45, v197
    v_accvgpr_read_b32 v198, a46
    v_ldexp_f32 v198, v198, v193
    v_accvgpr_write_b32 a46, v198
    v_accvgpr_read_b32 v199, a47
    v_ldexp_f32 v199, v199, v193
    v_accvgpr_write_b32 a47, v199
    v_accvgpr_read_b32 v196, a48
    v_ldexp_f32 v196, v196, v193
    v_accvgpr_write_b32 a48, v196
    v_accvgpr_read_b32 v197, a49
    v_ldexp_f32 v197, v197, v193
    v_accvgpr_write_b32 a49, v197
    v_accvgpr_read_b32 v198, a50
    v_ldexp_f32 v198, v198, v193
    v_accvgpr_write_b32 a50, v198
    v_accvgpr_read_b32 v199, a51
    v_ldexp_f32 v199, v199, v193
    v_accvgpr_write_b32 a51, v199
    v_accvgpr_read_b32 v196, a52
    v_ldexp_f32 v196, v196, v193
    v_accvgpr_write_b32 a52, v196
    v_accvgpr_read_b32 v197, a53
    v_ldexp_f32 v197, v197, v193
    v_accvgpr_write_b32 a53, v197
    v_accvgpr_read_b32 v198, a54
    v_ldexp_f32 v198, v198, v193
    v_accvgpr_write_b32 a54, v198
    v_accvgpr_read_b32 v199, a55
    v_ldexp_f32 v199, v199, v193
    v_accvgpr_write_b32 a55, v199
    v_accvgpr_read_b32 v196, a56
    v_ldexp_f32 v196, v196, v193
    v_accvgpr_write_b32 a56, v196
    v_accvgpr_read_b32 v197, a57
    v_ldexp_f32 v197, v197, v193
    v_accvgpr_write_b32 a57, v197
    v_accvgpr_read_b32 v198, a58
    v_ldexp_f32 v198, v198, v193
    v_accvgpr_write_b32 a58, v198
    v_accvgpr_read_b32 v199, a59
    v_ldexp_f32 v199, v199, v193
    v_accvgpr_write_b32 a59, v199
    v_accvgpr_read_b32 v196, a60
    v_ldexp_f32 v196, v196, v193
    v_accvgpr_write_b32 a60, v196
    v_accvgpr_read_b32 v197, a61
    v_ldexp_f32 v197, v197, v193
    v_accvgpr_write_b32 a61, v197
    v_accvgpr_read_b32 v198, a62
    v_ldexp_f32 v198, v198, v193
    v_accvgpr_write_b32 a62, v198
    v_accvgpr_read_b32 v199, a63
    v_ldexp_f32 v199, v199, v193
    v_accvgpr_write_b32 a63, v199
    v_lshlrev_b32 v4, 16, v112
    v_and_b32 v5, 0xffff0000, v112
    v_ldexp_f32 v4, v4, v193
    v_ldexp_f32 v5, v5, v193
    v_cvt_pk_bf16_f32 v112, v4, v5
    v_lshlrev_b32 v4, 16, v113
    v_and_b32 v5, 0xffff0000, v113
    v_ldexp_f32 v4, v4, v193
    v_ldexp_f32 v5, v5, v193
    v_cvt_pk_bf16_f32 v113, v4, v5
    v_lshlrev_b32 v4, 16, v114
    v_and_b32 v5, 0xffff0000, v114
    v_ldexp_f32 v4, v4, v193
    v_ldexp_f32 v5, v5, v193
    v_cvt_pk_bf16_f32 v114, v4, v5
    v_lshlrev_b32 v4, 16, v115
    v_and_b32 v5, 0xffff0000, v115
    v_ldexp_f32 v4, v4, v193
    v_ldexp_f32 v5, v5, v193
    v_cvt_pk_bf16_f32 v115, v4, v5
    v_lshlrev_b32 v4, 16, v116
    v_and_b32 v5, 0xffff0000, v116
    v_ldexp_f32 v4, v4, v193
    v_ldexp_f32 v5, v5, v193
    v_cvt_pk_bf16_f32 v116, v4, v5
    v_lshlrev_b32 v4, 16, v117
    v_and_b32 v5, 0xffff0000, v117
    v_ldexp_f32 v4, v4, v193
    v_ldexp_f32 v5, v5, v193
    v_cvt_pk_bf16_f32 v117, v4, v5
    v_lshlrev_b32 v4, 16, v118
    v_and_b32 v5, 0xffff0000, v118
    v_ldexp_f32 v4, v4, v193
    v_ldexp_f32 v5, v5, v193
    v_cvt_pk_bf16_f32 v118, v4, v5
    v_lshlrev_b32 v4, 16, v119
    v_and_b32 v5, 0xffff0000, v119
    v_ldexp_f32 v4, v4, v193
    v_ldexp_f32 v5, v5, v193
    v_cvt_pk_bf16_f32 v119, v4, v5
    v_sub_f32 v16, v16, v194
    v_sub_f32 v17, v17, v194
    v_sub_f32 v18, v18, v194
    v_sub_f32 v19, v19, v194
    v_sub_f32 v20, v20, v194
    v_sub_f32 v21, v21, v194
    v_sub_f32 v22, v22, v194
    v_sub_f32 v23, v23, v194
    v_sub_f32 v24, v24, v194
    v_sub_f32 v25, v25, v194
    v_sub_f32 v26, v26, v194
    v_sub_f32 v27, v27, v194
    v_sub_f32 v28, v28, v194
    v_sub_f32 v29, v29, v194
    v_sub_f32 v30, v30, v194
    v_sub_f32 v31, v31, v194
    v_sub_f32 v48, v48, v194
    v_sub_f32 v49, v49, v194
    v_sub_f32 v50, v50, v194
    v_sub_f32 v51, v51, v194
    v_sub_f32 v52, v52, v194
    v_sub_f32 v53, v53, v194
    v_sub_f32 v54, v54, v194
    v_sub_f32 v55, v55, v194
    v_sub_f32 v56, v56, v194
    v_sub_f32 v57, v57, v194
    v_sub_f32 v58, v58, v194
    v_sub_f32 v59, v59, v194
    v_sub_f32 v60, v60, v194
    v_sub_f32 v61, v61, v194
    v_sub_f32 v62, v62, v194
    v_sub_f32 v63, v63, v194
    v_mov_b32 v2, v13
    v_mov_b32 v3, v2
    s_nop 1
    v_permlane32_swap_b32 v2, v3
    s_nop 1
    v_add_f32 v2, v2, v3
    v_frexp_exp_i32_f32 v192, v2
    v_add_u32 v192, 0x60, v192
    v_max_i32 v192, 0, v192
    v_cvt_f32_i32 v194, v192
    v_sub_u32 v193, 0, v192
    v_ldexp_f32 v13, v13, v193
    v_accvgpr_read_b32 v196, a64
    v_ldexp_f32 v196, v196, v193
    v_accvgpr_write_b32 a64, v196
    v_accvgpr_read_b32 v197, a65
    v_ldexp_f32 v197, v197, v193
    v_accvgpr_write_b32 a65, v197
    v_accvgpr_read_b32 v198, a66
    v_ldexp_f32 v198, v198, v193
    v_accvgpr_write_b32 a66, v198
    v_accvgpr_read_b32 v199, a67
    v_ldexp_f32 v199, v199, v193
    v_accvgpr_write_b32 a67, v199
    v_accvgpr_read_b32 v196, a68
    v_ldexp_f32 v196, v196, v193
    v_accvgpr_write_b32 a68, v196
    v_accvgpr_read_b32 v197, a69
    v_ldexp_f32 v197, v197, v193
    v_accvgpr_write_b32 a69, v197
    v_accvgpr_read_b32 v198, a70
    v_ldexp_f32 v198, v198, v193
    v_accvgpr_write_b32 a70, v198
    v_accvgpr_read_b32 v199, a71
    v_ldexp_f32 v199, v199, v193
    v_accvgpr_write_b32 a71, v199
    v_accvgpr_read_b32 v196, a72
    v_ldexp_f32 v196, v196, v193
    v_accvgpr_write_b32 a72, v196
    v_accvgpr_read_b32 v197, a73
    v_ldexp_f32 v197, v197, v193
    v_accvgpr_write_b32 a73, v197
    v_accvgpr_read_b32 v198, a74
    v_ldexp_f32 v198, v198, v193
    v_accvgpr_write_b32 a74, v198
    v_accvgpr_read_b32 v199, a75
    v_ldexp_f32 v199, v199, v193
    v_accvgpr_write_b32 a75, v199
    v_accvgpr_read_b32 v196, a76
    v_ldexp_f32 v196, v196, v193
    v_accvgpr_write_b32 a76, v196
    v_accvgpr_read_b32 v197, a77
    v_ldexp_f32 v197, v197, v193
    v_accvgpr_write_b32 a77, v197
    v_accvgpr_read_b32 v198, a78
    v_ldexp_f32 v198, v198, v193
    v_accvgpr_write_b32 a78, v198
    v_accvgpr_read_b32 v199, a79
    v_ldexp_f32 v199, v199, v193
    v_accvgpr_write_b32 a79, v199
    v_accvgpr_read_b32 v196, a80
    v_ldexp_f32 v196, v196, v193
    v_accvgpr_write_b32 a80, v196
    v_accvgpr_read_b32 v197, a81
    v_ldexp_f32 v197, v197, v193
    v_accvgpr_write_b32 a81, v197
    v_accvgpr_read_b32 v198, a82
    v_ldexp_f32 v198, v198, v193
    v_accvgpr_write_b32 a82, v198
    v_accvgpr_read_b32 v199, a83
    v_ldexp_f32 v199, v199, v193
    v_accvgpr_write_b32 a83, v199
    v_accvgpr_read_b32 v196, a84
    v_ldexp_f32 v196, v196, v193
    v_accvgpr_write_b32 a84, v196
    v_accvgpr_read_b32 v197, a85
    v_ldexp_f32 v197, v197, v193
    v_accvgpr_write_b32 a85, v197
    v_accvgpr_read_b32 v198, a86
    v_ldexp_f32 v198, v198, v193
    v_accvgpr_write_b32 a86, v198
    v_accvgpr_read_b32 v199, a87
    v_ldexp_f32 v199, v199, v193
    v_accvgpr_write_b32 a87, v199
    v_accvgpr_read_b32 v196, a88
    v_ldexp_f32 v196, v196, v193
    v_accvgpr_write_b32 a88, v196
    v_accvgpr_read_b32 v197, a89
    v_ldexp_f32 v197, v197, v193
    v_accvgpr_write_b32 a89, v197
    v_accvgpr_read_b32 v198, a90
    v_ldexp_f32 v198, v198, v193
    v_accvgpr_write_b32 a90, v198
    v_accvgpr_read_b32 v199, a91
    v_ldexp_f32 v199, v199, v193
    v_accvgpr_write_b32 a91, v199
    v_accvgpr_read_b32 v196, a92
    v_ldexp_f32 v196, v196, v193
    v_accvgpr_write_b32 a92, v196
    v_accvgpr_read_b32 v197, a93
    v_ldexp_f32 v197, v197, v193
    v_accvgpr_write_b32 a93, v197
    v_accvgpr_read_b32 v198, a94
    v_ldexp_f32 v198, v198, v193
    v_accvgpr_write_b32 a94, v198
    v_accvgpr_read_b32 v199, a95
    v_ldexp_f32 v199, v199, v193
    v_accvgpr_write_b32 a95, v199
    v_accvgpr_read_b32 v196, a96
    v_ldexp_f32 v196, v196, v193
    v_accvgpr_write_b32 a96, v196
    v_accvgpr_read_b32 v197, a97
    v_ldexp_f32 v197, v197, v193
    v_accvgpr_write_b32 a97, v197
    v_accvgpr_read_b32 v198, a98
    v_ldexp_f32 v198, v198, v193
    v_accvgpr_write_b32 a98, v198
    v_accvgpr_read_b32 v199, a99
    v_ldexp_f32 v199, v199, v193
    v_accvgpr_write_b32 a99, v199
    v_accvgpr_read_b32 v196, a100
    v_ldexp_f32 v196, v196, v193
    v_accvgpr_write_b32 a100, v196
    v_accvgpr_read_b32 v197, a101
    v_ldexp_f32 v197, v197, v193
    v_accvgpr_write_b32 a101, v197
    v_accvgpr_read_b32 v198, a102
    v_ldexp_f32 v198, v198, v193
    v_accvgpr_write_b32 a102, v198
    v_accvgpr_read_b32 v199, a103
    v_ldexp_f32 v199, v199, v193
    v_accvgpr_write_b32 a103, v199
    v_accvgpr_read_b32 v196, a104
    v_ldexp_f32 v196, v196, v193
    v_accvgpr_write_b32 a104, v196
    v_accvgpr_read_b32 v197, a105
    v_ldexp_f32 v197, v197, v193
    v_accvgpr_write_b32 a105, v197
    v_accvgpr_read_b32 v198, a106
    v_ldexp_f32 v198, v198, v193
    v_accvgpr_write_b32 a106, v198
    v_accvgpr_read_b32 v199, a107
    v_ldexp_f32 v199, v199, v193
    v_accvgpr_write_b32 a107, v199
    v_accvgpr_read_b32 v196, a108
    v_ldexp_f32 v196, v196, v193
    v_accvgpr_write_b32 a108, v196
    v_accvgpr_read_b32 v197, a109
    v_ldexp_f32 v197, v197, v193
    v_accvgpr_write_b32 a109, v197
    v_accvgpr_read_b32 v198, a110
    v_ldexp_f32 v198, v198, v193
    v_accvgpr_write_b32 a110, v198
    v_accvgpr_read_b32 v199, a111
    v_ldexp_f32 v199, v199, v193
    v_accvgpr_write_b32 a111, v199
    v_accvgpr_read_b32 v196, a112
    v_ldexp_f32 v196, v196, v193
    v_accvgpr_write_b32 a112, v196
    v_accvgpr_read_b32 v197, a113
    v_ldexp_f32 v197, v197, v193
    v_accvgpr_write_b32 a113, v197
    v_accvgpr_read_b32 v198, a114
    v_ldexp_f32 v198, v198, v193
    v_accvgpr_write_b32 a114, v198
    v_accvgpr_read_b32 v199, a115
    v_ldexp_f32 v199, v199, v193
    v_accvgpr_write_b32 a115, v199
    v_accvgpr_read_b32 v196, a116
    v_ldexp_f32 v196, v196, v193
    v_accvgpr_write_b32 a116, v196
    v_accvgpr_read_b32 v197, a117
    v_ldexp_f32 v197, v197, v193
    v_accvgpr_write_b32 a117, v197
    v_accvgpr_read_b32 v198, a118
    v_ldexp_f32 v198, v198, v193
    v_accvgpr_write_b32 a118, v198
    v_accvgpr_read_b32 v199, a119
    v_ldexp_f32 v199, v199, v193
    v_accvgpr_write_b32 a119, v199
    v_accvgpr_read_b32 v196, a120
    v_ldexp_f32 v196, v196, v193
    v_accvgpr_write_b32 a120, v196
    v_accvgpr_read_b32 v197, a121
    v_ldexp_f32 v197, v197, v193
    v_accvgpr_write_b32 a121, v197
    v_accvgpr_read_b32 v198, a122
    v_ldexp_f32 v198, v198, v193
    v_accvgpr_write_b32 a122, v198
    v_accvgpr_read_b32 v199, a123
    v_ldexp_f32 v199, v199, v193
    v_accvgpr_write_b32 a123, v199
    v_accvgpr_read_b32 v196, a124
    v_ldexp_f32 v196, v196, v193
    v_accvgpr_write_b32 a124, v196
    v_accvgpr_read_b32 v197, a125
    v_ldexp_f32 v197, v197, v193
    v_accvgpr_write_b32 a125, v197
    v_accvgpr_read_b32 v198, a126
    v_ldexp_f32 v198, v198, v193
    v_accvgpr_write_b32 a126, v198
    v_accvgpr_read_b32 v199, a127
    v_ldexp_f32 v199, v199, v193
    v_accvgpr_write_b32 a127, v199
    v_lshlrev_b32 v4, 16, v120
    v_and_b32 v5, 0xffff0000, v120
    v_ldexp_f32 v4, v4, v193
    v_ldexp_f32 v5, v5, v193
    v_cvt_pk_bf16_f32 v120, v4, v5
    v_lshlrev_b32 v4, 16, v121
    v_and_b32 v5, 0xffff0000, v121
    v_ldexp_f32 v4, v4, v193
    v_ldexp_f32 v5, v5, v193
    v_cvt_pk_bf16_f32 v121, v4, v5
    v_lshlrev_b32 v4, 16, v122
    v_and_b32 v5, 0xffff0000, v122
    v_ldexp_f32 v4, v4, v193
    v_ldexp_f32 v5, v5, v193
    v_cvt_pk_bf16_f32 v122, v4, v5
    v_lshlrev_b32 v4, 16, v123
    v_and_b32 v5, 0xffff0000, v123
    v_ldexp_f32 v4, v4, v193
    v_ldexp_f32 v5, v5, v193
    v_cvt_pk_bf16_f32 v123, v4, v5
    v_lshlrev_b32 v4, 16, v124
    v_and_b32 v5, 0xffff0000, v124
    v_ldexp_f32 v4, v4, v193
    v_ldexp_f32 v5, v5, v193
    v_cvt_pk_bf16_f32 v124, v4, v5
    v_lshlrev_b32 v4, 16, v125
    v_and_b32 v5, 0xffff0000, v125
    v_ldexp_f32 v4, v4, v193
    v_ldexp_f32 v5, v5, v193
    v_cvt_pk_bf16_f32 v125, v4, v5
    v_lshlrev_b32 v4, 16, v126
    v_and_b32 v5, 0xffff0000, v126
    v_ldexp_f32 v4, v4, v193
    v_ldexp_f32 v5, v5, v193
    v_cvt_pk_bf16_f32 v126, v4, v5
    v_lshlrev_b32 v4, 16, v127
    v_and_b32 v5, 0xffff0000, v127
    v_ldexp_f32 v4, v4, v193
    v_ldexp_f32 v5, v5, v193
    v_cvt_pk_bf16_f32 v127, v4, v5
    v_sub_f32 v32, v32, v194
    v_sub_f32 v33, v33, v194
    v_sub_f32 v34, v34, v194
    v_sub_f32 v35, v35, v194
    v_sub_f32 v36, v36, v194
    v_sub_f32 v37, v37, v194
    v_sub_f32 v38, v38, v194
    v_sub_f32 v39, v39, v194
    v_sub_f32 v40, v40, v194
    v_sub_f32 v41, v41, v194
    v_sub_f32 v42, v42, v194
    v_sub_f32 v43, v43, v194
    v_sub_f32 v44, v44, v194
    v_sub_f32 v45, v45, v194
    v_sub_f32 v46, v46, v194
    v_sub_f32 v47, v47, v194
    v_sub_f32 v64, v64, v194
    v_sub_f32 v65, v65, v194
    v_sub_f32 v66, v66, v194
    v_sub_f32 v67, v67, v194
    v_sub_f32 v68, v68, v194
    v_sub_f32 v69, v69, v194
    v_sub_f32 v70, v70, v194
    v_sub_f32 v71, v71, v194
    v_sub_f32 v72, v72, v194
    v_sub_f32 v73, v73, v194
    v_sub_f32 v74, v74, v194
    v_sub_f32 v75, v75, v194
    v_sub_f32 v76, v76, v194
    v_sub_f32 v77, v77, v194
    v_sub_f32 v78, v78, v194
    v_sub_f32 v79, v79, v194
    s_nop 1
    s_branch L_A_ret_p1
L_A_rare_p1m:
    s_nop 7
    s_nop 7
    v_mov_b32 v2, v12
    v_mov_b32 v3, v2
    s_nop 1
    v_permlane32_swap_b32 v2, v3
    s_nop 1
    v_add_f32 v2, v2, v3
    v_frexp_exp_i32_f32 v192, v2
    v_add_u32 v192, 0x60, v192
    v_max_i32 v192, 0, v192
    v_cvt_f32_i32 v194, v192
    v_sub_u32 v193, 0, v192
    v_ldexp_f32 v12, v12, v193
    v_accvgpr_read_b32 v196, a0
    v_ldexp_f32 v196, v196, v193
    v_accvgpr_write_b32 a0, v196
    v_accvgpr_read_b32 v197, a1
    v_ldexp_f32 v197, v197, v193
    v_accvgpr_write_b32 a1, v197
    v_accvgpr_read_b32 v198, a2
    v_ldexp_f32 v198, v198, v193
    v_accvgpr_write_b32 a2, v198
    v_accvgpr_read_b32 v199, a3
    v_ldexp_f32 v199, v199, v193
    v_accvgpr_write_b32 a3, v199
    v_accvgpr_read_b32 v196, a4
    v_ldexp_f32 v196, v196, v193
    v_accvgpr_write_b32 a4, v196
    v_accvgpr_read_b32 v197, a5
    v_ldexp_f32 v197, v197, v193
    v_accvgpr_write_b32 a5, v197
    v_accvgpr_read_b32 v198, a6
    v_ldexp_f32 v198, v198, v193
    v_accvgpr_write_b32 a6, v198
    v_accvgpr_read_b32 v199, a7
    v_ldexp_f32 v199, v199, v193
    v_accvgpr_write_b32 a7, v199
    v_accvgpr_read_b32 v196, a8
    v_ldexp_f32 v196, v196, v193
    v_accvgpr_write_b32 a8, v196
    v_accvgpr_read_b32 v197, a9
    v_ldexp_f32 v197, v197, v193
    v_accvgpr_write_b32 a9, v197
    v_accvgpr_read_b32 v198, a10
    v_ldexp_f32 v198, v198, v193
    v_accvgpr_write_b32 a10, v198
    v_accvgpr_read_b32 v199, a11
    v_ldexp_f32 v199, v199, v193
    v_accvgpr_write_b32 a11, v199
    v_accvgpr_read_b32 v196, a12
    v_ldexp_f32 v196, v196, v193
    v_accvgpr_write_b32 a12, v196
    v_accvgpr_read_b32 v197, a13
    v_ldexp_f32 v197, v197, v193
    v_accvgpr_write_b32 a13, v197
    v_accvgpr_read_b32 v198, a14
    v_ldexp_f32 v198, v198, v193
    v_accvgpr_write_b32 a14, v198
    v_accvgpr_read_b32 v199, a15
    v_ldexp_f32 v199, v199, v193
    v_accvgpr_write_b32 a15, v199
    v_accvgpr_read_b32 v196, a16
    v_ldexp_f32 v196, v196, v193
    v_accvgpr_write_b32 a16, v196
    v_accvgpr_read_b32 v197, a17
    v_ldexp_f32 v197, v197, v193
    v_accvgpr_write_b32 a17, v197
    v_accvgpr_read_b32 v198, a18
    v_ldexp_f32 v198, v198, v193
    v_accvgpr_write_b32 a18, v198
    v_accvgpr_read_b32 v199, a19
    v_ldexp_f32 v199, v199, v193
    v_accvgpr_write_b32 a19, v199
    v_accvgpr_read_b32 v196, a20
    v_ldexp_f32 v196, v196, v193
    v_accvgpr_write_b32 a20, v196
    v_accvgpr_read_b32 v197, a21
    v_ldexp_f32 v197, v197, v193
    v_accvgpr_write_b32 a21, v197
    v_accvgpr_read_b32 v198, a22
    v_ldexp_f32 v198, v198, v193
    v_accvgpr_write_b32 a22, v198
    v_accvgpr_read_b32 v199, a23
    v_ldexp_f32 v199, v199, v193
    v_accvgpr_write_b32 a23, v199
    v_accvgpr_read_b32 v196, a24
    v_ldexp_f32 v196, v196, v193
    v_accvgpr_write_b32 a24, v196
    v_accvgpr_read_b32 v197, a25
    v_ldexp_f32 v197, v197, v193
    v_accvgpr_write_b32 a25, v197
    v_accvgpr_read_b32 v198, a26
    v_ldexp_f32 v198, v198, v193
    v_accvgpr_write_b32 a26, v198
    v_accvgpr_read_b32 v199, a27
    v_ldexp_f32 v199, v199, v193
    v_accvgpr_write_b32 a27, v199
    v_accvgpr_read_b32 v196, a28
    v_ldexp_f32 v196, v196, v193
    v_accvgpr_write_b32 a28, v196
    v_accvgpr_read_b32 v197, a29
    v_ldexp_f32 v197, v197, v193
    v_accvgpr_write_b32 a29, v197
    v_accvgpr_read_b32 v198, a30
    v_ldexp_f32 v198, v198, v193
    v_accvgpr_write_b32 a30, v198
    v_accvgpr_read_b32 v199, a31
    v_ldexp_f32 v199, v199, v193
    v_accvgpr_write_b32 a31, v199
    v_accvgpr_read_b32 v196, a32
    v_ldexp_f32 v196, v196, v193
    v_accvgpr_write_b32 a32, v196
    v_accvgpr_read_b32 v197, a33
    v_ldexp_f32 v197, v197, v193
    v_accvgpr_write_b32 a33, v197
    v_accvgpr_read_b32 v198, a34
    v_ldexp_f32 v198, v198, v193
    v_accvgpr_write_b32 a34, v198
    v_accvgpr_read_b32 v199, a35
    v_ldexp_f32 v199, v199, v193
    v_accvgpr_write_b32 a35, v199
    v_accvgpr_read_b32 v196, a36
    v_ldexp_f32 v196, v196, v193
    v_accvgpr_write_b32 a36, v196
    v_accvgpr_read_b32 v197, a37
    v_ldexp_f32 v197, v197, v193
    v_accvgpr_write_b32 a37, v197
    v_accvgpr_read_b32 v198, a38
    v_ldexp_f32 v198, v198, v193
    v_accvgpr_write_b32 a38, v198
    v_accvgpr_read_b32 v199, a39
    v_ldexp_f32 v199, v199, v193
    v_accvgpr_write_b32 a39, v199
    v_accvgpr_read_b32 v196, a40
    v_ldexp_f32 v196, v196, v193
    v_accvgpr_write_b32 a40, v196
    v_accvgpr_read_b32 v197, a41
    v_ldexp_f32 v197, v197, v193
    v_accvgpr_write_b32 a41, v197
    v_accvgpr_read_b32 v198, a42
    v_ldexp_f32 v198, v198, v193
    v_accvgpr_write_b32 a42, v198
    v_accvgpr_read_b32 v199, a43
    v_ldexp_f32 v199, v199, v193
    v_accvgpr_write_b32 a43, v199
    v_accvgpr_read_b32 v196, a44
    v_ldexp_f32 v196, v196, v193
    v_accvgpr_write_b32 a44, v196
    v_accvgpr_read_b32 v197, a45
    v_ldexp_f32 v197, v197, v193
    v_accvgpr_write_b32 a45, v197
    v_accvgpr_read_b32 v198, a46
    v_ldexp_f32 v198, v198, v193
    v_accvgpr_write_b32 a46, v198
    v_accvgpr_read_b32 v199, a47
    v_ldexp_f32 v199, v199, v193
    v_accvgpr_write_b32 a47, v199
    v_accvgpr_read_b32 v196, a48
    v_ldexp_f32 v196, v196, v193
    v_accvgpr_write_b32 a48, v196
    v_accvgpr_read_b32 v197, a49
    v_ldexp_f32 v197, v197, v193
    v_accvgpr_write_b32 a49, v197
    v_accvgpr_read_b32 v198, a50
    v_ldexp_f32 v198, v198, v193
    v_accvgpr_write_b32 a50, v198
    v_accvgpr_read_b32 v199, a51
    v_ldexp_f32 v199, v199, v193
    v_accvgpr_write_b32 a51, v199
    v_accvgpr_read_b32 v196, a52
    v_ldexp_f32 v196, v196, v193
    v_accvgpr_write_b32 a52, v196
    v_accvgpr_read_b32 v197, a53
    v_ldexp_f32 v197, v197, v193
    v_accvgpr_write_b32 a53, v197
    v_accvgpr_read_b32 v198, a54
    v_ldexp_f32 v198, v198, v193
    v_accvgpr_write_b32 a54, v198
    v_accvgpr_read_b32 v199, a55
    v_ldexp_f32 v199, v199, v193
    v_accvgpr_write_b32 a55, v199
    v_accvgpr_read_b32 v196, a56
    v_ldexp_f32 v196, v196, v193
    v_accvgpr_write_b32 a56, v196
    v_accvgpr_read_b32 v197, a57
    v_ldexp_f32 v197, v197, v193
    v_accvgpr_write_b32 a57, v197
    v_accvgpr_read_b32 v198, a58
    v_ldexp_f32 v198, v198, v193
    v_accvgpr_write_b32 a58, v198
    v_accvgpr_read_b32 v199, a59
    v_ldexp_f32 v199, v199, v193
    v_accvgpr_write_b32 a59, v199
    v_accvgpr_read_b32 v196, a60
    v_ldexp_f32 v196, v196, v193
    v_accvgpr_write_b32 a60, v196
    v_accvgpr_read_b32 v197, a61
    v_ldexp_f32 v197, v197, v193
    v_accvgpr_write_b32 a61, v197
    v_accvgpr_read_b32 v198, a62
    v_ldexp_f32 v198, v198, v193
    v_accvgpr_write_b32 a62, v198
    v_accvgpr_read_b32 v199, a63
    v_ldexp_f32 v199, v199, v193
    v_accvgpr_write_b32 a63, v199
    v_lshlrev_b32 v4, 16, v112
    v_and_b32 v5, 0xffff0000, v112
    v_ldexp_f32 v4, v4, v193
    v_ldexp_f32 v5, v5, v193
    v_cvt_pk_bf16_f32 v112, v4, v5
    v_lshlrev_b32 v4, 16, v113
    v_and_b32 v5, 0xffff0000, v113
    v_ldexp_f32 v4, v4, v193
    v_ldexp_f32 v5, v5, v193
    v_cvt_pk_bf16_f32 v113, v4, v5
    v_lshlrev_b32 v4, 16, v114
    v_and_b32 v5, 0xffff0000, v114
    v_ldexp_f32 v4, v4, v193
    v_ldexp_f32 v5, v5, v193
    v_cvt_pk_bf16_f32 v114, v4, v5
    v_lshlrev_b32 v4, 16, v115
    v_and_b32 v5, 0xffff0000, v115
    v_ldexp_f32 v4, v4, v193
    v_ldexp_f32 v5, v5, v193
    v_cvt_pk_bf16_f32 v115, v4, v5
    v_lshlrev_b32 v4, 16, v116
    v_and_b32 v5, 0xffff0000, v116
    v_ldexp_f32 v4, v4, v193
    v_ldexp_f32 v5, v5, v193
    v_cvt_pk_bf16_f32 v116, v4, v5
    v_lshlrev_b32 v4, 16, v117
    v_and_b32 v5, 0xffff0000, v117
    v_ldexp_f32 v4, v4, v193
    v_ldexp_f32 v5, v5, v193
    v_cvt_pk_bf16_f32 v117, v4, v5
    v_lshlrev_b32 v4, 16, v118
    v_and_b32 v5, 0xffff0000, v118
    v_ldexp_f32 v4, v4, v193
    v_ldexp_f32 v5, v5, v193
    v_cvt_pk_bf16_f32 v118, v4, v5
    v_lshlrev_b32 v4, 16, v119
    v_and_b32 v5, 0xffff0000, v119
    v_ldexp_f32 v4, v4, v193
    v_ldexp_f32 v5, v5, v193
    v_cvt_pk_bf16_f32 v119, v4, v5
    v_sub_f32 v16, v16, v194
    v_sub_f32 v17, v17, v194
    v_sub_f32 v18, v18, v194
    v_sub_f32 v19, v19, v194
    v_sub_f32 v20, v20, v194
    v_sub_f32 v21, v21, v194
    v_sub_f32 v22, v22, v194
    v_sub_f32 v23, v23, v194
    v_sub_f32 v24, v24, v194
    v_sub_f32 v25, v25, v194
    v_sub_f32 v26, v26, v194
    v_sub_f32 v27, v27, v194
    v_sub_f32 v28, v28, v194
    v_sub_f32 v29, v29, v194
    v_sub_f32 v30, v30, v194
    v_sub_f32 v31, v31, v194
    v_sub_f32 v48, v48, v194
    v_sub_f32 v49, v49, v194
    v_sub_f32 v50, v50, v194
    v_sub_f32 v51, v51, v194
    v_sub_f32 v52, v52, v194
    v_sub_f32 v53, v53, v194
    v_sub_f32 v54, v54, v194
    v_sub_f32 v55, v55, v194
    v_sub_f32 v56, v56, v194
    v_sub_f32 v57, v57, v194
    v_sub_f32 v58, v58, v194
    v_sub_f32 v59, v59, v194
    v_sub_f32 v60, v60, v194
    v_sub_f32 v61, v61, v194
    v_sub_f32 v62, v62, v194
    v_sub_f32 v63, v63, v194
    v_mov_b32 v2, v13
    v_mov_b32 v3, v2
    s_nop 1
    v_permlane32_swap_b32 v2, v3
    s_nop 1
    v_add_f32 v2, v2, v3
    v_frexp_exp_i32_f32 v192, v2
    v_add_u32 v192, 0x60, v192
    v_max_i32 v192, 0, v192
    v_cvt_f32_i32 v194, v192
    v_sub_u32 v193, 0, v192
    v_ldexp_f32 v13, v13, v193
    v_accvgpr_read_b32 v196, a64
    v_ldexp_f32 v196, v196, v193
    v_accvgpr_write_b32 a64, v196
    v_accvgpr_read_b32 v197, a65
    v_ldexp_f32 v197, v197, v193
    v_accvgpr_write_b32 a65, v197
    v_accvgpr_read_b32 v198, a66
    v_ldexp_f32 v198, v198, v193
    v_accvgpr_write_b32 a66, v198
    v_accvgpr_read_b32 v199, a67
    v_ldexp_f32 v199, v199, v193
    v_accvgpr_write_b32 a67, v199
    v_accvgpr_read_b32 v196, a68
    v_ldexp_f32 v196, v196, v193
    v_accvgpr_write_b32 a68, v196
    v_accvgpr_read_b32 v197, a69
    v_ldexp_f32 v197, v197, v193
    v_accvgpr_write_b32 a69, v197
    v_accvgpr_read_b32 v198, a70
    v_ldexp_f32 v198, v198, v193
    v_accvgpr_write_b32 a70, v198
    v_accvgpr_read_b32 v199, a71
    v_ldexp_f32 v199, v199, v193
    v_accvgpr_write_b32 a71, v199
    v_accvgpr_read_b32 v196, a72
    v_ldexp_f32 v196, v196, v193
    v_accvgpr_write_b32 a72, v196
    v_accvgpr_read_b32 v197, a73
    v_ldexp_f32 v197, v197, v193
    v_accvgpr_write_b32 a73, v197
    v_accvgpr_read_b32 v198, a74
    v_ldexp_f32 v198, v198, v193
    v_accvgpr_write_b32 a74, v198
    v_accvgpr_read_b32 v199, a75
    v_ldexp_f32 v199, v199, v193
    v_accvgpr_write_b32 a75, v199
    v_accvgpr_read_b32 v196, a76
    v_ldexp_f32 v196, v196, v193
    v_accvgpr_write_b32 a76, v196
    v_accvgpr_read_b32 v197, a77
    v_ldexp_f32 v197, v197, v193
    v_accvgpr_write_b32 a77, v197
    v_accvgpr_read_b32 v198, a78
    v_ldexp_f32 v198, v198, v193
    v_accvgpr_write_b32 a78, v198
    v_accvgpr_read_b32 v199, a79
    v_ldexp_f32 v199, v199, v193
    v_accvgpr_write_b32 a79, v199
    v_accvgpr_read_b32 v196, a80
    v_ldexp_f32 v196, v196, v193
    v_accvgpr_write_b32 a80, v196
    v_accvgpr_read_b32 v197, a81
    v_ldexp_f32 v197, v197, v193
    v_accvgpr_write_b32 a81, v197
    v_accvgpr_read_b32 v198, a82
    v_ldexp_f32 v198, v198, v193
    v_accvgpr_write_b32 a82, v198
    v_accvgpr_read_b32 v199, a83
    v_ldexp_f32 v199, v199, v193
    v_accvgpr_write_b32 a83, v199
    v_accvgpr_read_b32 v196, a84
    v_ldexp_f32 v196, v196, v193
    v_accvgpr_write_b32 a84, v196
    v_accvgpr_read_b32 v197, a85
    v_ldexp_f32 v197, v197, v193
    v_accvgpr_write_b32 a85, v197
    v_accvgpr_read_b32 v198, a86
    v_ldexp_f32 v198, v198, v193
    v_accvgpr_write_b32 a86, v198
    v_accvgpr_read_b32 v199, a87
    v_ldexp_f32 v199, v199, v193
    v_accvgpr_write_b32 a87, v199
    v_accvgpr_read_b32 v196, a88
    v_ldexp_f32 v196, v196, v193
    v_accvgpr_write_b32 a88, v196
    v_accvgpr_read_b32 v197, a89
    v_ldexp_f32 v197, v197, v193
    v_accvgpr_write_b32 a89, v197
    v_accvgpr_read_b32 v198, a90
    v_ldexp_f32 v198, v198, v193
    v_accvgpr_write_b32 a90, v198
    v_accvgpr_read_b32 v199, a91
    v_ldexp_f32 v199, v199, v193
    v_accvgpr_write_b32 a91, v199
    v_accvgpr_read_b32 v196, a92
    v_ldexp_f32 v196, v196, v193
    v_accvgpr_write_b32 a92, v196
    v_accvgpr_read_b32 v197, a93
    v_ldexp_f32 v197, v197, v193
    v_accvgpr_write_b32 a93, v197
    v_accvgpr_read_b32 v198, a94
    v_ldexp_f32 v198, v198, v193
    v_accvgpr_write_b32 a94, v198
    v_accvgpr_read_b32 v199, a95
    v_ldexp_f32 v199, v199, v193
    v_accvgpr_write_b32 a95, v199
    v_accvgpr_read_b32 v196, a96
    v_ldexp_f32 v196, v196, v193
    v_accvgpr_write_b32 a96, v196
    v_accvgpr_read_b32 v197, a97
    v_ldexp_f32 v197, v197, v193
    v_accvgpr_write_b32 a97, v197
    v_accvgpr_read_b32 v198, a98
    v_ldexp_f32 v198, v198, v193
    v_accvgpr_write_b32 a98, v198
    v_accvgpr_read_b32 v199, a99
    v_ldexp_f32 v199, v199, v193
    v_accvgpr_write_b32 a99, v199
    v_accvgpr_read_b32 v196, a100
    v_ldexp_f32 v196, v196, v193
    v_accvgpr_write_b32 a100, v196
    v_accvgpr_read_b32 v197, a101
    v_ldexp_f32 v197, v197, v193
    v_accvgpr_write_b32 a101, v197
    v_accvgpr_read_b32 v198, a102
    v_ldexp_f32 v198, v198, v193
    v_accvgpr_write_b32 a102, v198
    v_accvgpr_read_b32 v199, a103
    v_ldexp_f32 v199, v199, v193
    v_accvgpr_write_b32 a103, v199
    v_accvgpr_read_b32 v196, a104
    v_ldexp_f32 v196, v196, v193
    v_accvgpr_write_b32 a104, v196
    v_accvgpr_read_b32 v197, a105
    v_ldexp_f32 v197, v197, v193
    v_accvgpr_write_b32 a105, v197
    v_accvgpr_read_b32 v198, a106
    v_ldexp_f32 v198, v198, v193
    v_accvgpr_write_b32 a106, v198
    v_accvgpr_read_b32 v199, a107
    v_ldexp_f32 v199, v199, v193
    v_accvgpr_write_b32 a107, v199
    v_accvgpr_read_b32 v196, a108
    v_ldexp_f32 v196, v196, v193
    v_accvgpr_write_b32 a108, v196
    v_accvgpr_read_b32 v197, a109
    v_ldexp_f32 v197, v197, v193
    v_accvgpr_write_b32 a109, v197
    v_accvgpr_read_b32 v198, a110
    v_ldexp_f32 v198, v198, v193
    v_accvgpr_write_b32 a110, v198
    v_accvgpr_read_b32 v199, a111
    v_ldexp_f32 v199, v199, v193
    v_accvgpr_write_b32 a111, v199
    v_accvgpr_read_b32 v196, a112
    v_ldexp_f32 v196, v196, v193
    v_accvgpr_write_b32 a112, v196
    v_accvgpr_read_b32 v197, a113
    v_ldexp_f32 v197, v197, v193
    v_accvgpr_write_b32 a113, v197
    v_accvgpr_read_b32 v198, a114
    v_ldexp_f32 v198, v198, v193
    v_accvgpr_write_b32 a114, v198
    v_accvgpr_read_b32 v199, a115
    v_ldexp_f32 v199, v199, v193
    v_accvgpr_write_b32 a115, v199
    v_accvgpr_read_b32 v196, a116
    v_ldexp_f32 v196, v196, v193
    v_accvgpr_write_b32 a116, v196
    v_accvgpr_read_b32 v197, a117
    v_ldexp_f32 v197, v197, v193
    v_accvgpr_write_b32 a117, v197
    v_accvgpr_read_b32 v198, a118
    v_ldexp_f32 v198, v198, v193
    v_accvgpr_write_b32 a118, v198
    v_accvgpr_read_b32 v199, a119
    v_ldexp_f32 v199, v199, v193
    v_accvgpr_write_b32 a119, v199
    v_accvgpr_read_b32 v196, a120
    v_ldexp_f32 v196, v196, v193
    v_accvgpr_write_b32 a120, v196
    v_accvgpr_read_b32 v197, a121
    v_ldexp_f32 v197, v197, v193
    v_accvgpr_write_b32 a121, v197
    v_accvgpr_read_b32 v198, a122
    v_ldexp_f32 v198, v198, v193
    v_accvgpr_write_b32 a122, v198
    v_accvgpr_read_b32 v199, a123
    v_ldexp_f32 v199, v199, v193
    v_accvgpr_write_b32 a123, v199
    v_accvgpr_read_b32 v196, a124
    v_ldexp_f32 v196, v196, v193
    v_accvgpr_write_b32 a124, v196
    v_accvgpr_read_b32 v197, a125
    v_ldexp_f32 v197, v197, v193
    v_accvgpr_write_b32 a125, v197
    v_accvgpr_read_b32 v198, a126
    v_ldexp_f32 v198, v198, v193
    v_accvgpr_write_b32 a126, v198
    v_accvgpr_read_b32 v199, a127
    v_ldexp_f32 v199, v199, v193
    v_accvgpr_write_b32 a127, v199
    v_lshlrev_b32 v4, 16, v120
    v_and_b32 v5, 0xffff0000, v120
    v_ldexp_f32 v4, v4, v193
    v_ldexp_f32 v5, v5, v193
    v_cvt_pk_bf16_f32 v120, v4, v5
    v_lshlrev_b32 v4, 16, v121
    v_and_b32 v5, 0xffff0000, v121
    v_ldexp_f32 v4, v4, v193
    v_ldexp_f32 v5, v5, v193
    v_cvt_pk_bf16_f32 v121, v4, v5
    v_lshlrev_b32 v4, 16, v122
    v_and_b32 v5, 0xffff0000, v122
    v_ldexp_f32 v4, v4, v193
    v_ldexp_f32 v5, v5, v193
    v_cvt_pk_bf16_f32 v122, v4, v5
    v_lshlrev_b32 v4, 16, v123
    v_and_b32 v5, 0xffff0000, v123
    v_ldexp_f32 v4, v4, v193
    v_ldexp_f32 v5, v5, v193
    v_cvt_pk_bf16_f32 v123, v4, v5
    v_lshlrev_b32 v4, 16, v124
    v_and_b32 v5, 0xffff0000, v124
    v_ldexp_f32 v4, v4, v193
    v_ldexp_f32 v5, v5, v193
    v_cvt_pk_bf16_f32 v124, v4, v5
    v_lshlrev_b32 v4, 16, v125
    v_and_b32 v5, 0xffff0000, v125
    v_ldexp_f32 v4, v4, v193
    v_ldexp_f32 v5, v5, v193
    v_cvt_pk_bf16_f32 v125, v4, v5
    v_lshlrev_b32 v4, 16, v126
    v_and_b32 v5, 0xffff0000, v126
    v_ldexp_f32 v4, v4, v193
    v_ldexp_f32 v5, v5, v193
    v_cvt_pk_bf16_f32 v126, v4, v5
    v_lshlrev_b32 v4, 16, v127
    v_and_b32 v5, 0xffff0000, v127
    v_ldexp_f32 v4, v4, v193
    v_ldexp_f32 v5, v5, v193
    v_cvt_pk_bf16_f32 v127, v4, v5
    v_sub_f32 v32, v32, v194
    v_sub_f32 v33, v33, v194
    v_sub_f32 v34, v34, v194
    v_sub_f32 v35, v35, v194
    v_sub_f32 v36, v36, v194
    v_sub_f32 v37, v37, v194
    v_sub_f32 v38, v38, v194
    v_sub_f32 v39, v39, v194
    v_sub_f32 v40, v40, v194
    v_sub_f32 v41, v41, v194
    v_sub_f32 v42, v42, v194
    v_sub_f32 v43, v43, v194
    v_sub_f32 v44, v44, v194
    v_sub_f32 v45, v45, v194
    v_sub_f32 v46, v46, v194
    v_sub_f32 v47, v47, v194
    v_sub_f32 v64, v64, v194
    v_sub_f32 v65, v65, v194
    v_sub_f32 v66, v66, v194
    v_sub_f32 v67, v67, v194
    v_sub_f32 v68, v68, v194
    v_sub_f32 v69, v69, v194
    v_sub_f32 v70, v70, v194
    v_sub_f32 v71, v71, v194
    v_sub_f32 v72, v72, v194
    v_sub_f32 v73, v73, v194
    v_sub_f32 v74, v74, v194
    v_sub_f32 v75, v75, v194
    v_sub_f32 v76, v76, v194
    v_sub_f32 v77, v77, v194
    v_sub_f32 v78, v78, v194
    v_sub_f32 v79, v79, v194
    s_nop 1
    s_branch L_A_ret_p1m
L_A_rare_p1lm:
    s_nop 7
    s_nop 7
    v_mov_b32 v2, v12
    v_mov_b32 v3, v2
    s_nop 1
    v_permlane32_swap_b32 v2, v3
    s_nop 1
    v_add_f32 v2, v2, v3
    v_frexp_exp_i32_f32 v192, v2
    v_add_u32 v192, 0x60, v192
    v_max_i32 v192, 0, v192
    v_cvt_f32_i32 v194, v192
    v_sub_u32 v193, 0, v192
    v_ldexp_f32 v12, v12, v193
    v_accvgpr_read_b32 v196, a0
    v_ldexp_f32 v196, v196, v193
    v_accvgpr_write_b32 a0, v196
    v_accvgpr_read_b32 v197, a1
    v_ldexp_f32 v197, v197, v193
    v_accvgpr_write_b32 a1, v197
    v_accvgpr_read_b32 v198, a2
    v_ldexp_f32 v198, v198, v193
    v_accvgpr_write_b32 a2, v198
    v_accvgpr_read_b32 v199, a3
    v_ldexp_f32 v199, v199, v193
    v_accvgpr_write_b32 a3, v199
    v_accvgpr_read_b32 v196, a4
    v_ldexp_f32 v196, v196, v193
    v_accvgpr_write_b32 a4, v196
    v_accvgpr_read_b32 v197, a5
    v_ldexp_f32 v197, v197, v193
    v_accvgpr_write_b32 a5, v197
    v_accvgpr_read_b32 v198, a6
    v_ldexp_f32 v198, v198, v193
    v_accvgpr_write_b32 a6, v198
    v_accvgpr_read_b32 v199, a7
    v_ldexp_f32 v199, v199, v193
    v_accvgpr_write_b32 a7, v199
    v_accvgpr_read_b32 v196, a8
    v_ldexp_f32 v196, v196, v193
    v_accvgpr_write_b32 a8, v196
    v_accvgpr_read_b32 v197, a9
    v_ldexp_f32 v197, v197, v193
    v_accvgpr_write_b32 a9, v197
    v_accvgpr_read_b32 v198, a10
    v_ldexp_f32 v198, v198, v193
    v_accvgpr_write_b32 a10, v198
    v_accvgpr_read_b32 v199, a11
    v_ldexp_f32 v199, v199, v193
    v_accvgpr_write_b32 a11, v199
    v_accvgpr_read_b32 v196, a12
    v_ldexp_f32 v196, v196, v193
    v_accvgpr_write_b32 a12, v196
    v_accvgpr_read_b32 v197, a13
    v_ldexp_f32 v197, v197, v193
    v_accvgpr_write_b32 a13, v197
    v_accvgpr_read_b32 v198, a14
    v_ldexp_f32 v198, v198, v193
    v_accvgpr_write_b32 a14, v198
    v_accvgpr_read_b32 v199, a15
    v_ldexp_f32 v199, v199, v193
    v_accvgpr_write_b32 a15, v199
    v_accvgpr_read_b32 v196, a16
    v_ldexp_f32 v196, v196, v193
    v_accvgpr_write_b32 a16, v196
    v_accvgpr_read_b32 v197, a17
    v_ldexp_f32 v197, v197, v193
    v_accvgpr_write_b32 a17, v197
    v_accvgpr_read_b32 v198, a18
    v_ldexp_f32 v198, v198, v193
    v_accvgpr_write_b32 a18, v198
    v_accvgpr_read_b32 v199, a19
    v_ldexp_f32 v199, v199, v193
    v_accvgpr_write_b32 a19, v199
    v_accvgpr_read_b32 v196, a20
    v_ldexp_f32 v196, v196, v193
    v_accvgpr_write_b32 a20, v196
    v_accvgpr_read_b32 v197, a21
    v_ldexp_f32 v197, v197, v193
    v_accvgpr_write_b32 a21, v197
    v_accvgpr_read_b32 v198, a22
    v_ldexp_f32 v198, v198, v193
    v_accvgpr_write_b32 a22, v198
    v_accvgpr_read_b32 v199, a23
    v_ldexp_f32 v199, v199, v193
    v_accvgpr_write_b32 a23, v199
    v_accvgpr_read_b32 v196, a24
    v_ldexp_f32 v196, v196, v193
    v_accvgpr_write_b32 a24, v196
    v_accvgpr_read_b32 v197, a25
    v_ldexp_f32 v197, v197, v193
    v_accvgpr_write_b32 a25, v197
    v_accvgpr_read_b32 v198, a26
    v_ldexp_f32 v198, v198, v193
    v_accvgpr_write_b32 a26, v198
    v_accvgpr_read_b32 v199, a27
    v_ldexp_f32 v199, v199, v193
    v_accvgpr_write_b32 a27, v199
    v_accvgpr_read_b32 v196, a28
    v_ldexp_f32 v196, v196, v193
    v_accvgpr_write_b32 a28, v196
    v_accvgpr_read_b32 v197, a29
    v_ldexp_f32 v197, v197, v193
    v_accvgpr_write_b32 a29, v197
    v_accvgpr_read_b32 v198, a30
    v_ldexp_f32 v198, v198, v193
    v_accvgpr_write_b32 a30, v198
    v_accvgpr_read_b32 v199, a31
    v_ldexp_f32 v199, v199, v193
    v_accvgpr_write_b32 a31, v199
    v_accvgpr_read_b32 v196, a32
    v_ldexp_f32 v196, v196, v193
    v_accvgpr_write_b32 a32, v196
    v_accvgpr_read_b32 v197, a33
    v_ldexp_f32 v197, v197, v193
    v_accvgpr_write_b32 a33, v197
    v_accvgpr_read_b32 v198, a34
    v_ldexp_f32 v198, v198, v193
    v_accvgpr_write_b32 a34, v198
    v_accvgpr_read_b32 v199, a35
    v_ldexp_f32 v199, v199, v193
    v_accvgpr_write_b32 a35, v199
    v_accvgpr_read_b32 v196, a36
    v_ldexp_f32 v196, v196, v193
    v_accvgpr_write_b32 a36, v196
    v_accvgpr_read_b32 v197, a37
    v_ldexp_f32 v197, v197, v193
    v_accvgpr_write_b32 a37, v197
    v_accvgpr_read_b32 v198, a38
    v_ldexp_f32 v198, v198, v193
    v_accvgpr_write_b32 a38, v198
    v_accvgpr_read_b32 v199, a39
    v_ldexp_f32 v199, v199, v193
    v_accvgpr_write_b32 a39, v199
    v_accvgpr_read_b32 v196, a40
    v_ldexp_f32 v196, v196, v193
    v_accvgpr_write_b32 a40, v196
    v_accvgpr_read_b32 v197, a41
    v_ldexp_f32 v197, v197, v193
    v_accvgpr_write_b32 a41, v197
    v_accvgpr_read_b32 v198, a42
    v_ldexp_f32 v198, v198, v193
    v_accvgpr_write_b32 a42, v198
    v_accvgpr_read_b32 v199, a43
    v_ldexp_f32 v199, v199, v193
    v_accvgpr_write_b32 a43, v199
    v_accvgpr_read_b32 v196, a44
    v_ldexp_f32 v196, v196, v193
    v_accvgpr_write_b32 a44, v196
    v_accvgpr_read_b32 v197, a45
    v_ldexp_f32 v197, v197, v193
    v_accvgpr_write_b32 a45, v197
    v_accvgpr_read_b32 v198, a46
    v_ldexp_f32 v198, v198, v193
    v_accvgpr_write_b32 a46, v198
    v_accvgpr_read_b32 v199, a47
    v_ldexp_f32 v199, v199, v193
    v_accvgpr_write_b32 a47, v199
    v_accvgpr_read_b32 v196, a48
    v_ldexp_f32 v196, v196, v193
    v_accvgpr_write_b32 a48, v196
    v_accvgpr_read_b32 v197, a49
    v_ldexp_f32 v197, v197, v193
    v_accvgpr_write_b32 a49, v197
    v_accvgpr_read_b32 v198, a50
    v_ldexp_f32 v198, v198, v193
    v_accvgpr_write_b32 a50, v198
    v_accvgpr_read_b32 v199, a51
    v_ldexp_f32 v199, v199, v193
    v_accvgpr_write_b32 a51, v199
    v_accvgpr_read_b32 v196, a52
    v_ldexp_f32 v196, v196, v193
    v_accvgpr_write_b32 a52, v196
    v_accvgpr_read_b32 v197, a53
    v_ldexp_f32 v197, v197, v193
    v_accvgpr_write_b32 a53, v197
    v_accvgpr_read_b32 v198, a54
    v_ldexp_f32 v198, v198, v193
    v_accvgpr_write_b32 a54, v198
    v_accvgpr_read_b32 v199, a55
    v_ldexp_f32 v199, v199, v193
    v_accvgpr_write_b32 a55, v199
    v_accvgpr_read_b32 v196, a56
    v_ldexp_f32 v196, v196, v193
    v_accvgpr_write_b32 a56, v196
    v_accvgpr_read_b32 v197, a57
    v_ldexp_f32 v197, v197, v193
    v_accvgpr_write_b32 a57, v197
    v_accvgpr_read_b32 v198, a58
    v_ldexp_f32 v198, v198, v193
    v_accvgpr_write_b32 a58, v198
    v_accvgpr_read_b32 v199, a59
    v_ldexp_f32 v199, v199, v193
    v_accvgpr_write_b32 a59, v199
    v_accvgpr_read_b32 v196, a60
    v_ldexp_f32 v196, v196, v193
    v_accvgpr_write_b32 a60, v196
    v_accvgpr_read_b32 v197, a61
    v_ldexp_f32 v197, v197, v193
    v_accvgpr_write_b32 a61, v197
    v_accvgpr_read_b32 v198, a62
    v_ldexp_f32 v198, v198, v193
    v_accvgpr_write_b32 a62, v198
    v_accvgpr_read_b32 v199, a63
    v_ldexp_f32 v199, v199, v193
    v_accvgpr_write_b32 a63, v199
    v_lshlrev_b32 v4, 16, v112
    v_and_b32 v5, 0xffff0000, v112
    v_ldexp_f32 v4, v4, v193
    v_ldexp_f32 v5, v5, v193
    v_cvt_pk_bf16_f32 v112, v4, v5
    v_lshlrev_b32 v4, 16, v113
    v_and_b32 v5, 0xffff0000, v113
    v_ldexp_f32 v4, v4, v193
    v_ldexp_f32 v5, v5, v193
    v_cvt_pk_bf16_f32 v113, v4, v5
    v_lshlrev_b32 v4, 16, v114
    v_and_b32 v5, 0xffff0000, v114
    v_ldexp_f32 v4, v4, v193
    v_ldexp_f32 v5, v5, v193
    v_cvt_pk_bf16_f32 v114, v4, v5
    v_lshlrev_b32 v4, 16, v115
    v_and_b32 v5, 0xffff0000, v115
    v_ldexp_f32 v4, v4, v193
    v_ldexp_f32 v5, v5, v193
    v_cvt_pk_bf16_f32 v115, v4, v5
    v_lshlrev_b32 v4, 16, v116
    v_and_b32 v5, 0xffff0000, v116
    v_ldexp_f32 v4, v4, v193
    v_ldexp_f32 v5, v5, v193
    v_cvt_pk_bf16_f32 v116, v4, v5
    v_lshlrev_b32 v4, 16, v117
    v_and_b32 v5, 0xffff0000, v117
    v_ldexp_f32 v4, v4, v193
    v_ldexp_f32 v5, v5, v193
    v_cvt_pk_bf16_f32 v117, v4, v5
    v_lshlrev_b32 v4, 16, v118
    v_and_b32 v5, 0xffff0000, v118
    v_ldexp_f32 v4, v4, v193
    v_ldexp_f32 v5, v5, v193
    v_cvt_pk_bf16_f32 v118, v4, v5
    v_lshlrev_b32 v4, 16, v119
    v_and_b32 v5, 0xffff0000, v119
    v_ldexp_f32 v4, v4, v193
    v_ldexp_f32 v5, v5, v193
    v_cvt_pk_bf16_f32 v119, v4, v5
    v_sub_f32 v16, v16, v194
    v_sub_f32 v17, v17, v194
    v_sub_f32 v18, v18, v194
    v_sub_f32 v19, v19, v194
    v_sub_f32 v20, v20, v194
    v_sub_f32 v21, v21, v194
    v_sub_f32 v22, v22, v194
    v_sub_f32 v23, v23, v194
    v_sub_f32 v24, v24, v194
    v_sub_f32 v25, v25, v194
    v_sub_f32 v26, v26, v194
    v_sub_f32 v27, v27, v194
    v_sub_f32 v28, v28, v194
    v_sub_f32 v29, v29, v194
    v_sub_f32 v30, v30, v194
    v_sub_f32 v31, v31, v194
    v_sub_f32 v48, v48, v194
    v_sub_f32 v49, v49, v194
    v_sub_f32 v50, v50, v194
    v_sub_f32 v51, v51, v194
    v_sub_f32 v52, v52, v194
    v_sub_f32 v53, v53, v194
    v_sub_f32 v54, v54, v194
    v_sub_f32 v55, v55, v194
    v_sub_f32 v56, v56, v194
    v_sub_f32 v57, v57, v194
    v_sub_f32 v58, v58, v194
    v_sub_f32 v59, v59, v194
    v_sub_f32 v60, v60, v194
    v_sub_f32 v61, v61, v194
    v_sub_f32 v62, v62, v194
    v_sub_f32 v63, v63, v194
    v_mov_b32 v2, v13
    v_mov_b32 v3, v2
    s_nop 1
    v_permlane32_swap_b32 v2, v3
    s_nop 1
    v_add_f32 v2, v2, v3
    v_frexp_exp_i32_f32 v192, v2
    v_add_u32 v192, 0x60, v192
    v_max_i32 v192, 0, v192
    v_cvt_f32_i32 v194, v192
    v_sub_u32 v193, 0, v192
    v_ldexp_f32 v13, v13, v193
    v_accvgpr_read_b32 v196, a64
    v_ldexp_f32 v196, v196, v193
    v_accvgpr_write_b32 a64, v196
    v_accvgpr_read_b32 v197, a65
    v_ldexp_f32 v197, v197, v193
    v_accvgpr_write_b32 a65, v197
    v_accvgpr_read_b32 v198, a66
    v_ldexp_f32 v198, v198, v193
    v_accvgpr_write_b32 a66, v198
    v_accvgpr_read_b32 v199, a67
    v_ldexp_f32 v199, v199, v193
    v_accvgpr_write_b32 a67, v199
    v_accvgpr_read_b32 v196, a68
    v_ldexp_f32 v196, v196, v193
    v_accvgpr_write_b32 a68, v196
    v_accvgpr_read_b32 v197, a69
    v_ldexp_f32 v197, v197, v193
    v_accvgpr_write_b32 a69, v197
    v_accvgpr_read_b32 v198, a70
    v_ldexp_f32 v198, v198, v193
    v_accvgpr_write_b32 a70, v198
    v_accvgpr_read_b32 v199, a71
    v_ldexp_f32 v199, v199, v193
    v_accvgpr_write_b32 a71, v199
    v_accvgpr_read_b32 v196, a72
    v_ldexp_f32 v196, v196, v193
    v_accvgpr_write_b32 a72, v196
    v_accvgpr_read_b32 v197, a73
    v_ldexp_f32 v197, v197, v193
    v_accvgpr_write_b32 a73, v197
    v_accvgpr_read_b32 v198, a74
    v_ldexp_f32 v198, v198, v193
    v_accvgpr_write_b32 a74, v198
    v_accvgpr_read_b32 v199, a75
    v_ldexp_f32 v199, v199, v193
    v_accvgpr_write_b32 a75, v199
    v_accvgpr_read_b32 v196, a76
    v_ldexp_f32 v196, v196, v193
    v_accvgpr_write_b32 a76, v196
    v_accvgpr_read_b32 v197, a77
    v_ldexp_f32 v197, v197, v193
    v_accvgpr_write_b32 a77, v197
    v_accvgpr_read_b32 v198, a78
    v_ldexp_f32 v198, v198, v193
    v_accvgpr_write_b32 a78, v198
    v_accvgpr_read_b32 v199, a79
    v_ldexp_f32 v199, v199, v193
    v_accvgpr_write_b32 a79, v199
    v_accvgpr_read_b32 v196, a80
    v_ldexp_f32 v196, v196, v193
    v_accvgpr_write_b32 a80, v196
    v_accvgpr_read_b32 v197, a81
    v_ldexp_f32 v197, v197, v193
    v_accvgpr_write_b32 a81, v197
    v_accvgpr_read_b32 v198, a82
    v_ldexp_f32 v198, v198, v193
    v_accvgpr_write_b32 a82, v198
    v_accvgpr_read_b32 v199, a83
    v_ldexp_f32 v199, v199, v193
    v_accvgpr_write_b32 a83, v199
    v_accvgpr_read_b32 v196, a84
    v_ldexp_f32 v196, v196, v193
    v_accvgpr_write_b32 a84, v196
    v_accvgpr_read_b32 v197, a85
    v_ldexp_f32 v197, v197, v193
    v_accvgpr_write_b32 a85, v197
    v_accvgpr_read_b32 v198, a86
    v_ldexp_f32 v198, v198, v193
    v_accvgpr_write_b32 a86, v198
    v_accvgpr_read_b32 v199, a87
    v_ldexp_f32 v199, v199, v193
    v_accvgpr_write_b32 a87, v199
    v_accvgpr_read_b32 v196, a88
    v_ldexp_f32 v196, v196, v193
    v_accvgpr_write_b32 a88, v196
    v_accvgpr_read_b32 v197, a89
    v_ldexp_f32 v197, v197, v193
    v_accvgpr_write_b32 a89, v197
    v_accvgpr_read_b32 v198, a90
    v_ldexp_f32 v198, v198, v193
    v_accvgpr_write_b32 a90, v198
    v_accvgpr_read_b32 v199, a91
    v_ldexp_f32 v199, v199, v193
    v_accvgpr_write_b32 a91, v199
    v_accvgpr_read_b32 v196, a92
    v_ldexp_f32 v196, v196, v193
    v_accvgpr_write_b32 a92, v196
    v_accvgpr_read_b32 v197, a93
    v_ldexp_f32 v197, v197, v193
    v_accvgpr_write_b32 a93, v197
    v_accvgpr_read_b32 v198, a94
    v_ldexp_f32 v198, v198, v193
    v_accvgpr_write_b32 a94, v198
    v_accvgpr_read_b32 v199, a95
    v_ldexp_f32 v199, v199, v193
    v_accvgpr_write_b32 a95, v199
    v_accvgpr_read_b32 v196, a96
    v_ldexp_f32 v196, v196, v193
    v_accvgpr_write_b32 a96, v196
    v_accvgpr_read_b32 v197, a97
    v_ldexp_f32 v197, v197, v193
    v_accvgpr_write_b32 a97, v197
    v_accvgpr_read_b32 v198, a98
    v_ldexp_f32 v198, v198, v193
    v_accvgpr_write_b32 a98, v198
    v_accvgpr_read_b32 v199, a99
    v_ldexp_f32 v199, v199, v193
    v_accvgpr_write_b32 a99, v199
    v_accvgpr_read_b32 v196, a100
    v_ldexp_f32 v196, v196, v193
    v_accvgpr_write_b32 a100, v196
    v_accvgpr_read_b32 v197, a101
    v_ldexp_f32 v197, v197, v193
    v_accvgpr_write_b32 a101, v197
    v_accvgpr_read_b32 v198, a102
    v_ldexp_f32 v198, v198, v193
    v_accvgpr_write_b32 a102, v198
    v_accvgpr_read_b32 v199, a103
    v_ldexp_f32 v199, v199, v193
    v_accvgpr_write_b32 a103, v199
    v_accvgpr_read_b32 v196, a104
    v_ldexp_f32 v196, v196, v193
    v_accvgpr_write_b32 a104, v196
    v_accvgpr_read_b32 v197, a105
    v_ldexp_f32 v197, v197, v193
    v_accvgpr_write_b32 a105, v197
    v_accvgpr_read_b32 v198, a106
    v_ldexp_f32 v198, v198, v193
    v_accvgpr_write_b32 a106, v198
    v_accvgpr_read_b32 v199, a107
    v_ldexp_f32 v199, v199, v193
    v_accvgpr_write_b32 a107, v199
    v_accvgpr_read_b32 v196, a108
    v_ldexp_f32 v196, v196, v193
    v_accvgpr_write_b32 a108, v196
    v_accvgpr_read_b32 v197, a109
    v_ldexp_f32 v197, v197, v193
    v_accvgpr_write_b32 a109, v197
    v_accvgpr_read_b32 v198, a110
    v_ldexp_f32 v198, v198, v193
    v_accvgpr_write_b32 a110, v198
    v_accvgpr_read_b32 v199, a111
    v_ldexp_f32 v199, v199, v193
    v_accvgpr_write_b32 a111, v199
    v_accvgpr_read_b32 v196, a112
    v_ldexp_f32 v196, v196, v193
    v_accvgpr_write_b32 a112, v196
    v_accvgpr_read_b32 v197, a113
    v_ldexp_f32 v197, v197, v193
    v_accvgpr_write_b32 a113, v197
    v_accvgpr_read_b32 v198, a114
    v_ldexp_f32 v198, v198, v193
    v_accvgpr_write_b32 a114, v198
    v_accvgpr_read_b32 v199, a115
    v_ldexp_f32 v199, v199, v193
    v_accvgpr_write_b32 a115, v199
    v_accvgpr_read_b32 v196, a116
    v_ldexp_f32 v196, v196, v193
    v_accvgpr_write_b32 a116, v196
    v_accvgpr_read_b32 v197, a117
    v_ldexp_f32 v197, v197, v193
    v_accvgpr_write_b32 a117, v197
    v_accvgpr_read_b32 v198, a118
    v_ldexp_f32 v198, v198, v193
    v_accvgpr_write_b32 a118, v198
    v_accvgpr_read_b32 v199, a119
    v_ldexp_f32 v199, v199, v193
    v_accvgpr_write_b32 a119, v199
    v_accvgpr_read_b32 v196, a120
    v_ldexp_f32 v196, v196, v193
    v_accvgpr_write_b32 a120, v196
    v_accvgpr_read_b32 v197, a121
    v_ldexp_f32 v197, v197, v193
    v_accvgpr_write_b32 a121, v197
    v_accvgpr_read_b32 v198, a122
    v_ldexp_f32 v198, v198, v193
    v_accvgpr_write_b32 a122, v198
    v_accvgpr_read_b32 v199, a123
    v_ldexp_f32 v199, v199, v193
    v_accvgpr_write_b32 a123, v199
    v_accvgpr_read_b32 v196, a124
    v_ldexp_f32 v196, v196, v193
    v_accvgpr_write_b32 a124, v196
    v_accvgpr_read_b32 v197, a125
    v_ldexp_f32 v197, v197, v193
    v_accvgpr_write_b32 a125, v197
    v_accvgpr_read_b32 v198, a126
    v_ldexp_f32 v198, v198, v193
    v_accvgpr_write_b32 a126, v198
    v_accvgpr_read_b32 v199, a127
    v_ldexp_f32 v199, v199, v193
    v_accvgpr_write_b32 a127, v199
    v_lshlrev_b32 v4, 16, v120
    v_and_b32 v5, 0xffff0000, v120
    v_ldexp_f32 v4, v4, v193
    v_ldexp_f32 v5, v5, v193
    v_cvt_pk_bf16_f32 v120, v4, v5
    v_lshlrev_b32 v4, 16, v121
    v_and_b32 v5, 0xffff0000, v121
    v_ldexp_f32 v4, v4, v193
    v_ldexp_f32 v5, v5, v193
    v_cvt_pk_bf16_f32 v121, v4, v5
    v_lshlrev_b32 v4, 16, v122
    v_and_b32 v5, 0xffff0000, v122
    v_ldexp_f32 v4, v4, v193
    v_ldexp_f32 v5, v5, v193
    v_cvt_pk_bf16_f32 v122, v4, v5
    v_lshlrev_b32 v4, 16, v123
    v_and_b32 v5, 0xffff0000, v123
    v_ldexp_f32 v4, v4, v193
    v_ldexp_f32 v5, v5, v193
    v_cvt_pk_bf16_f32 v123, v4, v5
    v_lshlrev_b32 v4, 16, v124
    v_and_b32 v5, 0xffff0000, v124
    v_ldexp_f32 v4, v4, v193
    v_ldexp_f32 v5, v5, v193
    v_cvt_pk_bf16_f32 v124, v4, v5
    v_lshlrev_b32 v4, 16, v125
    v_and_b32 v5, 0xffff0000, v125
    v_ldexp_f32 v4, v4, v193
    v_ldexp_f32 v5, v5, v193
    v_cvt_pk_bf16_f32 v125, v4, v5
    v_lshlrev_b32 v4, 16, v126
    v_and_b32 v5, 0xffff0000, v126
    v_ldexp_f32 v4, v4, v193
    v_ldexp_f32 v5, v5, v193
    v_cvt_pk_bf16_f32 v126, v4, v5
    v_lshlrev_b32 v4, 16, v127
    v_and_b32 v5, 0xffff0000, v127
    v_ldexp_f32 v4, v4, v193
    v_ldexp_f32 v5, v5, v193
    v_cvt_pk_bf16_f32 v127, v4, v5
    v_sub_f32 v32, v32, v194
    v_sub_f32 v33, v33, v194
    v_sub_f32 v34, v34, v194
    v_sub_f32 v35, v35, v194
    v_sub_f32 v36, v36, v194
    v_sub_f32 v37, v37, v194
    v_sub_f32 v38, v38, v194
    v_sub_f32 v39, v39, v194
    v_sub_f32 v40, v40, v194
    v_sub_f32 v41, v41, v194
    v_sub_f32 v42, v42, v194
    v_sub_f32 v43, v43, v194
    v_sub_f32 v44, v44, v194
    v_sub_f32 v45, v45, v194
    v_sub_f32 v46, v46, v194
    v_sub_f32 v47, v47, v194
    v_sub_f32 v64, v64, v194
    v_sub_f32 v65, v65, v194
    v_sub_f32 v66, v66, v194
    v_sub_f32 v67, v67, v194
    v_sub_f32 v68, v68, v194
    v_sub_f32 v69, v69, v194
    v_sub_f32 v70, v70, v194
    v_sub_f32 v71, v71, v194
    v_sub_f32 v72, v72, v194
    v_sub_f32 v73, v73, v194
    v_sub_f32 v74, v74, v194
    v_sub_f32 v75, v75, v194
    v_sub_f32 v76, v76, v194
    v_sub_f32 v77, v77, v194
    v_sub_f32 v78, v78, v194
    v_sub_f32 v79, v79, v194
    s_nop 1
    s_branch L_A_ret_p1lm
L_A_rare_p2:
    s_nop 7
    s_nop 7
    v_mov_b32 v2, v12
    v_add_f32 v2, v2, v13
    v_mov_b32 v3, v2
    s_nop 1
    v_permlane32_swap_b32 v2, v3
    s_nop 1
    v_add_f32 v2, v2, v3
    v_frexp_exp_i32_f32 v192, v2
    v_add_u32 v192, 0x60, v192
    v_max_i32 v192, 0, v192
    v_cvt_f32_i32 v194, v192
    v_sub_u32 v193, 0, v192
    v_ldexp_f32 v12, v12, v193
    v_ldexp_f32 v13, v13, v193
    v_accvgpr_read_b32 v196, a64
    v_ldexp_f32 v196, v196, v193
    v_accvgpr_write_b32 a64, v196
    v_accvgpr_read_b32 v197, a65
    v_ldexp_f32 v197, v197, v193
    v_accvgpr_write_b32 a65, v197
    v_accvgpr_read_b32 v198, a66
    v_ldexp_f32 v198, v198, v193
    v_accvgpr_write_b32 a66, v198
    v_accvgpr_read_b32 v199, a67
    v_ldexp_f32 v199, v199, v193
    v_accvgpr_write_b32 a67, v199
    v_accvgpr_read_b32 v196, a68
    v_ldexp_f32 v196, v196, v193
    v_accvgpr_write_b32 a68, v196
    v_accvgpr_read_b32 v197, a69
    v_ldexp_f32 v197, v197, v193
    v_accvgpr_write_b32 a69, v197
    v_accvgpr_read_b32 v198, a70
    v_ldexp_f32 v198, v198, v193
    v_accvgpr_write_b32 a70, v198
    v_accvgpr_read_b32 v199, a71
    v_ldexp_f32 v199, v199, v193
    v_accvgpr_write_b32 a71, v199
    v_accvgpr_read_b32 v196, a72
    v_ldexp_f32 v196, v196, v193
    v_accvgpr_write_b32 a72, v196
    v_accvgpr_read_b32 v197, a73
    v_ldexp_f32 v197, v197, v193
    v_accvgpr_write_b32 a73, v197
    v_accvgpr_read_b32 v198, a74
    v_ldexp_f32 v198, v198, v193
    v_accvgpr_write_b32 a74, v198
    v_accvgpr_read_b32 v199, a75
    v_ldexp_f32 v199, v199, v193
    v_accvgpr_write_b32 a75, v199
    v_accvgpr_read_b32 v196, a76
    v_ldexp_f32 v196, v196, v193
    v_accvgpr_write_b32 a76, v196
    v_accvgpr_read_b32 v197, a77
    v_ldexp_f32 v197, v197, v193
    v_accvgpr_write_b32 a77, v197
    v_accvgpr_read_b32 v198, a78
    v_ldexp_f32 v198, v198, v193
    v_accvgpr_write_b32 a78, v198
    v_accvgpr_read_b32 v199, a79
    v_ldexp_f32 v199, v199, v193
    v_accvgpr_write_b32 a79, v199
    v_accvgpr_read_b32 v196, a80
    v_ldexp_f32 v196, v196, v193
    v_accvgpr_write_b32 a80, v196
    v_accvgpr_read_b32 v197, a81
    v_ldexp_f32 v197, v197, v193
    v_accvgpr_write_b32 a81, v197
    v_accvgpr_read_b32 v198, a82
    v_ldexp_f32 v198, v198, v193
    v_accvgpr_write_b32 a82, v198
    v_accvgpr_read_b32 v199, a83
    v_ldexp_f32 v199, v199, v193
    v_accvgpr_write_b32 a83, v199
    v_accvgpr_read_b32 v196, a84
    v_ldexp_f32 v196, v196, v193
    v_accvgpr_write_b32 a84, v196
    v_accvgpr_read_b32 v197, a85
    v_ldexp_f32 v197, v197, v193
    v_accvgpr_write_b32 a85, v197
    v_accvgpr_read_b32 v198, a86
    v_ldexp_f32 v198, v198, v193
    v_accvgpr_write_b32 a86, v198
    v_accvgpr_read_b32 v199, a87
    v_ldexp_f32 v199, v199, v193
    v_accvgpr_write_b32 a87, v199
    v_accvgpr_read_b32 v196, a88
    v_ldexp_f32 v196, v196, v193
    v_accvgpr_write_b32 a88, v196
    v_accvgpr_read_b32 v197, a89
    v_ldexp_f32 v197, v197, v193
    v_accvgpr_write_b32 a89, v197
    v_accvgpr_read_b32 v198, a90
    v_ldexp_f32 v198, v198, v193
    v_accvgpr_write_b32 a90, v198
    v_accvgpr_read_b32 v199, a91
    v_ldexp_f32 v199, v199, v193
    v_accvgpr_write_b32 a91, v199
    v_accvgpr_read_b32 v196, a92
    v_ldexp_f32 v196, v196, v193
    v_accvgpr_write_b32 a92, v196
    v_accvgpr_read_b32 v197, a93
    v_ldexp_f32 v197, v197, v193
    v_accvgpr_write_b32 a93, v197
    v_accvgpr_read_b32 v198, a94
    v_ldexp_f32 v198, v198, v193
    v_accvgpr_write_b32 a94, v198
    v_accvgpr_read_b32 v199, a95
    v_ldexp_f32 v199, v199, v193
    v_accvgpr_write_b32 a95, v199
    v_accvgpr_read_b32 v196, a96
    v_ldexp_f32 v196, v196, v193
    v_accvgpr_write_b32 a96, v196
    v_accvgpr_read_b32 v197, a97
    v_ldexp_f32 v197, v197, v193
    v_accvgpr_write_b32 a97, v197
    v_accvgpr_read_b32 v198, a98
    v_ldexp_f32 v198, v198, v193
    v_accvgpr_write_b32 a98, v198
    v_accvgpr_read_b32 v199, a99
    v_ldexp_f32 v199, v199, v193
    v_accvgpr_write_b32 a99, v199
    v_accvgpr_read_b32 v196, a100
    v_ldexp_f32 v196, v196, v193
    v_accvgpr_write_b32 a100, v196
    v_accvgpr_read_b32 v197, a101
    v_ldexp_f32 v197, v197, v193
    v_accvgpr_write_b32 a101, v197
    v_accvgpr_read_b32 v198, a102
    v_ldexp_f32 v198, v198, v193
    v_accvgpr_write_b32 a102, v198
    v_accvgpr_read_b32 v199, a103
    v_ldexp_f32 v199, v199, v193
    v_accvgpr_write_b32 a103, v199
    v_accvgpr_read_b32 v196, a104
    v_ldexp_f32 v196, v196, v193
    v_accvgpr_write_b32 a104, v196
    v_accvgpr_read_b32 v197, a105
    v_ldexp_f32 v197, v197, v193
    v_accvgpr_write_b32 a105, v197
    v_accvgpr_read_b32 v198, a106
    v_ldexp_f32 v198, v198, v193
    v_accvgpr_write_b32 a106, v198
    v_accvgpr_read_b32 v199, a107
    v_ldexp_f32 v199, v199, v193
    v_accvgpr_write_b32 a107, v199
    v_accvgpr_read_b32 v196, a108
    v_ldexp_f32 v196, v196, v193
    v_accvgpr_write_b32 a108, v196
    v_accvgpr_read_b32 v197, a109
    v_ldexp_f32 v197, v197, v193
    v_accvgpr_write_b32 a109, v197
    v_accvgpr_read_b32 v198, a110
    v_ldexp_f32 v198, v198, v193
    v_accvgpr_write_b32 a110, v198
    v_accvgpr_read_b32 v199, a111
    v_ldexp_f32 v199, v199, v193
    v_accvgpr_write_b32 a111, v199
    v_accvgpr_read_b32 v196, a112
    v_ldexp_f32 v196, v196, v193
    v_accvgpr_write_b32 a112, v196
    v_accvgpr_read_b32 v197, a113
    v_ldexp_f32 v197, v197, v193
    v_accvgpr_write_b32 a113, v197
    v_accvgpr_read_b32 v198, a114
    v_ldexp_f32 v198, v198, v193
    v_accvgpr_write_b32 a114, v198
    v_accvgpr_read_b32 v199, a115
    v_ldexp_f32 v199, v199, v193
    v_accvgpr_write_b32 a115, v199
    v_accvgpr_read_b32 v196, a116
    v_ldexp_f32 v196, v196, v193
    v_accvgpr_write_b32 a116, v196
    v_accvgpr_read_b32 v197, a117
    v_ldexp_f32 v197, v197, v193
    v_accvgpr_write_b32 a117, v197
    v_accvgpr_read_b32 v198, a118
    v_ldexp_f32 v198, v198, v193
    v_accvgpr_write_b32 a118, v198
    v_accvgpr_read_b32 v199, a119
    v_ldexp_f32 v199, v199, v193
    v_accvgpr_write_b32 a119, v199
    v_accvgpr_read_b32 v196, a120
    v_ldexp_f32 v196, v196, v193
    v_accvgpr_write_b32 a120, v196
    v_accvgpr_read_b32 v197, a121
    v_ldexp_f32 v197, v197, v193
    v_accvgpr_write_b32 a121, v197
    v_accvgpr_read_b32 v198, a122
    v_ldexp_f32 v198, v198, v193
    v_accvgpr_write_b32 a122, v198
    v_accvgpr_read_b32 v199, a123
    v_ldexp_f32 v199, v199, v193
    v_accvgpr_write_b32 a123, v199
    v_accvgpr_read_b32 v196, a124
    v_ldexp_f32 v196, v196, v193
    v_accvgpr_write_b32 a124, v196
    v_accvgpr_read_b32 v197, a125
    v_ldexp_f32 v197, v197, v193
    v_accvgpr_write_b32 a125, v197
    v_accvgpr_read_b32 v198, a126
    v_ldexp_f32 v198, v198, v193
    v_accvgpr_write_b32 a126, v198
    v_accvgpr_read_b32 v199, a127
    v_ldexp_f32 v199, v199, v193
    v_accvgpr_write_b32 a127, v199
    v_lshlrev_b32 v4, 16, v112
    v_and_b32 v5, 0xffff0000, v112
    v_ldexp_f32 v4, v4, v193
    v_ldexp_f32 v5, v5, v193
    v_cvt_pk_bf16_f32 v112, v4, v5
    v_lshlrev_b32 v4, 16, v113
    v_and_b32 v5, 0xffff0000, v113
    v_ldexp_f32 v4, v4, v193
    v_ldexp_f32 v5, v5, v193
    v_cvt_pk_bf16_f32 v113, v4, v5
    v_lshlrev_b32 v4, 16, v114
    v_and_b32 v5, 0xffff0000, v114
    v_ldexp_f32 v4, v4, v193
    v_ldexp_f32 v5, v5, v193
    v_cvt_pk_bf16_f32 v114, v4, v5
    v_lshlrev_b32 v4, 16, v115
    v_and_b32 v5, 0xffff0000, v115
    v_ldexp_f32 v4, v4, v193
    v_ldexp_f32 v5, v5, v193
    v_cvt_pk_bf16_f32 v115, v4, v5
    v_lshlrev_b32 v4, 16, v116
    v_and_b32 v5, 0xffff0000, v116
    v_ldexp_f32 v4, v4, v193
    v_ldexp_f32 v5, v5, v193
    v_cvt_pk_bf16_f32 v116, v4, v5
    v_lshlrev_b32 v4, 16, v117
    v_and_b32 v5, 0xffff0000, v117
    v_ldexp_f32 v4, v4, v193
    v_ldexp_f32 v5, v5, v193
    v_cvt_pk_bf16_f32 v117, v4, v5
    v_lshlrev_b32 v4, 16, v118
    v_and_b32 v5, 0xffff0000, v118
    v_ldexp_f32 v4, v4, v193
    v_ldexp_f32 v5, v5, v193
    v_cvt_pk_bf16_f32 v118, v4, v5
    v_lshlrev_b32 v4, 16, v119
    v_and_b32 v5, 0xffff0000, v119
    v_ldexp_f32 v4, v4, v193
    v_ldexp_f32 v5, v5, v193
    v_cvt_pk_bf16_f32 v119, v4, v5
    v_lshlrev_b32 v4, 16, v120
    v_and_b32 v5, 0xffff0000, v120
    v_ldexp_f32 v4, v4, v193
    v_ldexp_f32 v5, v5, v193
    v_cvt_pk_bf16_f32 v120, v4, v5
    v_lshlrev_b32 v4, 16, v121
    v_and_b32 v5, 0xffff0000, v121
    v_ldexp_f32 v4, v4, v193
    v_ldexp_f32 v5, v5, v193
    v_cvt_pk_bf16_f32 v121, v4, v5
    v_lshlrev_b32 v4, 16, v122
    v_and_b32 v5, 0xffff0000, v122
    v_ldexp_f32 v4, v4, v193
    v_ldexp_f32 v5, v5, v193
    v_cvt_pk_bf16_f32 v122, v4, v5
    v_lshlrev_b32 v4, 16, v123
    v_and_b32 v5, 0xffff0000, v123
    v_ldexp_f32 v4, v4, v193
    v_ldexp_f32 v5, v5, v193
    v_cvt_pk_bf16_f32 v123, v4, v5
    v_lshlrev_b32 v4, 16, v124
    v_and_b32 v5, 0xffff0000, v124
    v_ldexp_f32 v4, v4, v193
    v_ldexp_f32 v5, v5, v193
    v_cvt_pk_bf16_f32 v124, v4, v5
    v_lshlrev_b32 v4, 16, v125
    v_and_b32 v5, 0xffff0000, v125
    v_ldexp_f32 v4, v4, v193
    v_ldexp_f32 v5, v5, v193
    v_cvt_pk_bf16_f32 v125, v4, v5
    v_lshlrev_b32 v4, 16, v126
    v_and_b32 v5, 0xffff0000, v126
    v_ldexp_f32 v4, v4, v193
    v_ldexp_f32 v5, v5, v193
    v_cvt_pk_bf16_f32 v126, v4, v5
    v_lshlrev_b32 v4, 16, v127
    v_and_b32 v5, 0xffff0000, v127
    v_ldexp_f32 v4, v4, v193
    v_ldexp_f32 v5, v5, v193
    v_cvt_pk_bf16_f32 v127, v4, v5
    v_sub_f32 v16, v16, v194
    v_sub_f32 v17, v17, v194
    v_sub_f32 v18, v18, v194
    v_sub_f32 v19, v19, v194
    v_sub_f32 v20, v20, v194
    v_sub_f32 v21, v21, v194
    v_sub_f32 v22, v22, v194
    v_sub_f32 v23, v23, v194
    v_sub_f32 v24, v24, v194
    v_sub_f32 v25, v25, v194
    v_sub_f32 v26, v26, v194
    v_sub_f32 v27, v27, v194
    v_sub_f32 v28, v28, v194
    v_sub_f32 v29, v29, v194
    v_sub_f32 v30, v30, v194
    v_sub_f32 v31, v31, v194
    v_sub_f32 v32, v32, v194
    v_sub_f32 v33, v33, v194
    v_sub_f32 v34, v34, v194
    v_sub_f32 v35, v35, v194
    v_sub_f32 v36, v36, v194
    v_sub_f32 v37, v37, v194
    v_sub_f32 v38, v38, v194
    v_sub_f32 v39, v39, v194
    v_sub_f32 v40, v40, v194
    v_sub_f32 v41, v41, v194
    v_sub_f32 v42, v42, v194
    v_sub_f32 v43, v43, v194
    v_sub_f32 v44, v44, v194
    v_sub_f32 v45, v45, v194
    v_sub_f32 v46, v46, v194
    v_sub_f32 v47, v47, v194
    v_sub_f32 v64, v64, v194
    v_sub_f32 v65, v65, v194
    v_sub_f32 v66, v66, v194
    v_sub_f32 v67, v67, v194
    v_sub_f32 v68, v68, v194
    v_sub_f32 v69, v69, v194
    v_sub_f32 v70, v70, v194
    v_sub_f32 v71, v71, v194
    v_sub_f32 v72, v72, v194
    v_sub_f32 v73, v73, v194
    v_sub_f32 v74, v74, v194
    v_sub_f32 v75, v75, v194
    v_sub_f32 v76, v76, v194
    v_sub_f32 v77, v77, v194
    v_sub_f32 v78, v78, v194
    v_sub_f32 v79, v79, v194
    s_nop 1
    s_branch L_A_ret_p2
L_A_rare_p2m:
    s_nop 7
    s_nop 7
    v_mov_b32 v2, v12
    v_add_f32 v2, v2, v13
    v_mov_b32 v3, v2
    s_nop 1
    v_permlane32_swap_b32 v2, v3
    s_nop 1
    v_add_f32 v2, v2, v3
    v_frexp_exp_i32_f32 v192, v2
    v_add_u32 v192, 0x60, v192
    v_max_i32 v192, 0, v192
    v_cvt_f32_i32 v194, v192
    v_sub_u32 v193, 0, v192
    v_ldexp_f32 v12, v12, v193
    v_ldexp_f32 v13, v13, v193
    v_accvgpr_read_b32 v196, a64
    v_ldexp_f32 v196, v196, v193
    v_accvgpr_write_b32 a64, v196
    v_accvgpr_read_b32 v197, a65
    v_ldexp_f32 v197, v197, v193
    v_accvgpr_write_b32 a65, v197
    v_accvgpr_read_b32 v198, a66
    v_ldexp_f32 v198, v198, v193
    v_accvgpr_write_b32 a66, v198
    v_accvgpr_read_b32 v199, a67
    v_ldexp_f32 v199, v199, v193
    v_accvgpr_write_b32 a67, v199
    v_accvgpr_read_b32 v196, a68
    v_ldexp_f32 v196, v196, v193
    v_accvgpr_write_b32 a68, v196
    v_accvgpr_read_b32 v197, a69
    v_ldexp_f32 v197, v197, v193
    v_accvgpr_write_b32 a69, v197
    v_accvgpr_read_b32 v198, a70
    v_ldexp_f32 v198, v198, v193
    v_accvgpr_write_b32 a70, v198
    v_accvgpr_read_b32 v199, a71
    v_ldexp_f32 v199, v199, v193
    v_accvgpr_write_b32 a71, v199
    v_accvgpr_read_b32 v196, a72
    v_ldexp_f32 v196, v196, v193
    v_accvgpr_write_b32 a72, v196
    v_accvgpr_read_b32 v197, a73
    v_ldexp_f32 v197, v197, v193
    v_accvgpr_write_b32 a73, v197
    v_accvgpr_read_b32 v198, a74
    v_ldexp_f32 v198, v198, v193
    v_accvgpr_write_b32 a74, v198
    v_accvgpr_read_b32 v199, a75
    v_ldexp_f32 v199, v199, v193
    v_accvgpr_write_b32 a75, v199
    v_accvgpr_read_b32 v196, a76
    v_ldexp_f32 v196, v196, v193
    v_accvgpr_write_b32 a76, v196
    v_accvgpr_read_b32 v197, a77
    v_ldexp_f32 v197, v197, v193
    v_accvgpr_write_b32 a77, v197
    v_accvgpr_read_b32 v198, a78
    v_ldexp_f32 v198, v198, v193
    v_accvgpr_write_b32 a78, v198
    v_accvgpr_read_b32 v199, a79
    v_ldexp_f32 v199, v199, v193
    v_accvgpr_write_b32 a79, v199
    v_accvgpr_read_b32 v196, a80
    v_ldexp_f32 v196, v196, v193
    v_accvgpr_write_b32 a80, v196
    v_accvgpr_read_b32 v197, a81
    v_ldexp_f32 v197, v197, v193
    v_accvgpr_write_b32 a81, v197
    v_accvgpr_read_b32 v198, a82
    v_ldexp_f32 v198, v198, v193
    v_accvgpr_write_b32 a82, v198
    v_accvgpr_read_b32 v199, a83
    v_ldexp_f32 v199, v199, v193
    v_accvgpr_write_b32 a83, v199
    v_accvgpr_read_b32 v196, a84
    v_ldexp_f32 v196, v196, v193
    v_accvgpr_write_b32 a84, v196
    v_accvgpr_read_b32 v197, a85
    v_ldexp_f32 v197, v197, v193
    v_accvgpr_write_b32 a85, v197
    v_accvgpr_read_b32 v198, a86
    v_ldexp_f32 v198, v198, v193
    v_accvgpr_write_b32 a86, v198
    v_accvgpr_read_b32 v199, a87
    v_ldexp_f32 v199, v199, v193
    v_accvgpr_write_b32 a87, v199
    v_accvgpr_read_b32 v196, a88
    v_ldexp_f32 v196, v196, v193
    v_accvgpr_write_b32 a88, v196
    v_accvgpr_read_b32 v197, a89
    v_ldexp_f32 v197, v197, v193
    v_accvgpr_write_b32 a89, v197
    v_accvgpr_read_b32 v198, a90
    v_ldexp_f32 v198, v198, v193
    v_accvgpr_write_b32 a90, v198
    v_accvgpr_read_b32 v199, a91
    v_ldexp_f32 v199, v199, v193
    v_accvgpr_write_b32 a91, v199
    v_accvgpr_read_b32 v196, a92
    v_ldexp_f32 v196, v196, v193
    v_accvgpr_write_b32 a92, v196
    v_accvgpr_read_b32 v197, a93
    v_ldexp_f32 v197, v197, v193
    v_accvgpr_write_b32 a93, v197
    v_accvgpr_read_b32 v198, a94
    v_ldexp_f32 v198, v198, v193
    v_accvgpr_write_b32 a94, v198
    v_accvgpr_read_b32 v199, a95
    v_ldexp_f32 v199, v199, v193
    v_accvgpr_write_b32 a95, v199
    v_accvgpr_read_b32 v196, a96
    v_ldexp_f32 v196, v196, v193
    v_accvgpr_write_b32 a96, v196
    v_accvgpr_read_b32 v197, a97
    v_ldexp_f32 v197, v197, v193
    v_accvgpr_write_b32 a97, v197
    v_accvgpr_read_b32 v198, a98
    v_ldexp_f32 v198, v198, v193
    v_accvgpr_write_b32 a98, v198
    v_accvgpr_read_b32 v199, a99
    v_ldexp_f32 v199, v199, v193
    v_accvgpr_write_b32 a99, v199
    v_accvgpr_read_b32 v196, a100
    v_ldexp_f32 v196, v196, v193
    v_accvgpr_write_b32 a100, v196
    v_accvgpr_read_b32 v197, a101
    v_ldexp_f32 v197, v197, v193
    v_accvgpr_write_b32 a101, v197
    v_accvgpr_read_b32 v198, a102
    v_ldexp_f32 v198, v198, v193
    v_accvgpr_write_b32 a102, v198
    v_accvgpr_read_b32 v199, a103
    v_ldexp_f32 v199, v199, v193
    v_accvgpr_write_b32 a103, v199
    v_accvgpr_read_b32 v196, a104
    v_ldexp_f32 v196, v196, v193
    v_accvgpr_write_b32 a104, v196
    v_accvgpr_read_b32 v197, a105
    v_ldexp_f32 v197, v197, v193
    v_accvgpr_write_b32 a105, v197
    v_accvgpr_read_b32 v198, a106
    v_ldexp_f32 v198, v198, v193
    v_accvgpr_write_b32 a106, v198
    v_accvgpr_read_b32 v199, a107
    v_ldexp_f32 v199, v199, v193
    v_accvgpr_write_b32 a107, v199
    v_accvgpr_read_b32 v196, a108
    v_ldexp_f32 v196, v196, v193
    v_accvgpr_write_b32 a108, v196
    v_accvgpr_read_b32 v197, a109
    v_ldexp_f32 v197, v197, v193
    v_accvgpr_write_b32 a109, v197
    v_accvgpr_read_b32 v198, a110
    v_ldexp_f32 v198, v198, v193
    v_accvgpr_write_b32 a110, v198
    v_accvgpr_read_b32 v199, a111
    v_ldexp_f32 v199, v199, v193
    v_accvgpr_write_b32 a111, v199
    v_accvgpr_read_b32 v196, a112
    v_ldexp_f32 v196, v196, v193
    v_accvgpr_write_b32 a112, v196
    v_accvgpr_read_b32 v197, a113
    v_ldexp_f32 v197, v197, v193
    v_accvgpr_write_b32 a113, v197
    v_accvgpr_read_b32 v198, a114
    v_ldexp_f32 v198, v198, v193
    v_accvgpr_write_b32 a114, v198
    v_accvgpr_read_b32 v199, a115
    v_ldexp_f32 v199, v199, v193
    v_accvgpr_write_b32 a115, v199
    v_accvgpr_read_b32 v196, a116
    v_ldexp_f32 v196, v196, v193
    v_accvgpr_write_b32 a116, v196
    v_accvgpr_read_b32 v197, a117
    v_ldexp_f32 v197, v197, v193
    v_accvgpr_write_b32 a117, v197
    v_accvgpr_read_b32 v198, a118
    v_ldexp_f32 v198, v198, v193
    v_accvgpr_write_b32 a118, v198
    v_accvgpr_read_b32 v199, a119
    v_ldexp_f32 v199, v199, v193
    v_accvgpr_write_b32 a119, v199
    v_accvgpr_read_b32 v196, a120
    v_ldexp_f32 v196, v196, v193
    v_accvgpr_write_b32 a120, v196
    v_accvgpr_read_b32 v197, a121
    v_ldexp_f32 v197, v197, v193
    v_accvgpr_write_b32 a121, v197
    v_accvgpr_read_b32 v198, a122
    v_ldexp_f32 v198, v198, v193
    v_accvgpr_write_b32 a122, v198
    v_accvgpr_read_b32 v199, a123
    v_ldexp_f32 v199, v199, v193
    v_accvgpr_write_b32 a123, v199
    v_accvgpr_read_b32 v196, a124
    v_ldexp_f32 v196, v196, v193
    v_accvgpr_write_b32 a124, v196
    v_accvgpr_read_b32 v197, a125
    v_ldexp_f32 v197, v197, v193
    v_accvgpr_write_b32 a125, v197
    v_accvgpr_read_b32 v198, a126
    v_ldexp_f32 v198, v198, v193
    v_accvgpr_write_b32 a126, v198
    v_accvgpr_read_b32 v199, a127
    v_ldexp_f32 v199, v199, v193
    v_accvgpr_write_b32 a127, v199
    v_lshlrev_b32 v4, 16, v112
    v_and_b32 v5, 0xffff0000, v112
    v_ldexp_f32 v4, v4, v193
    v_ldexp_f32 v5, v5, v193
    v_cvt_pk_bf16_f32 v112, v4, v5
    v_lshlrev_b32 v4, 16, v113
    v_and_b32 v5, 0xffff0000, v113
    v_ldexp_f32 v4, v4, v193
    v_ldexp_f32 v5, v5, v193
    v_cvt_pk_bf16_f32 v113, v4, v5
    v_lshlrev_b32 v4, 16, v114
    v_and_b32 v5, 0xffff0000, v114
    v_ldexp_f32 v4, v4, v193
    v_ldexp_f32 v5, v5, v193
    v_cvt_pk_bf16_f32 v114, v4, v5
    v_lshlrev_b32 v4, 16, v115
    v_and_b32 v5, 0xffff0000, v115
    v_ldexp_f32 v4, v4, v193
    v_ldexp_f32 v5, v5, v193
    v_cvt_pk_bf16_f32 v115, v4, v5
    v_lshlrev_b32 v4, 16, v116
    v_and_b32 v5, 0xffff0000, v116
    v_ldexp_f32 v4, v4, v193
    v_ldexp_f32 v5, v5, v193
    v_cvt_pk_bf16_f32 v116, v4, v5
    v_lshlrev_b32 v4, 16, v117
    v_and_b32 v5, 0xffff0000, v117
    v_ldexp_f32 v4, v4, v193
    v_ldexp_f32 v5, v5, v193
    v_cvt_pk_bf16_f32 v117, v4, v5
    v_lshlrev_b32 v4, 16, v118
    v_and_b32 v5, 0xffff0000, v118
    v_ldexp_f32 v4, v4, v193
    v_ldexp_f32 v5, v5, v193
    v_cvt_pk_bf16_f32 v118, v4, v5
    v_lshlrev_b32 v4, 16, v119
    v_and_b32 v5, 0xffff0000, v119
    v_ldexp_f32 v4, v4, v193
    v_ldexp_f32 v5, v5, v193
    v_cvt_pk_bf16_f32 v119, v4, v5
    v_lshlrev_b32 v4, 16, v120
    v_and_b32 v5, 0xffff0000, v120
    v_ldexp_f32 v4, v4, v193
    v_ldexp_f32 v5, v5, v193
    v_cvt_pk_bf16_f32 v120, v4, v5
    v_lshlrev_b32 v4, 16, v121
    v_and_b32 v5, 0xffff0000, v121
    v_ldexp_f32 v4, v4, v193
    v_ldexp_f32 v5, v5, v193
    v_cvt_pk_bf16_f32 v121, v4, v5
    v_lshlrev_b32 v4, 16, v122
    v_and_b32 v5, 0xffff0000, v122
    v_ldexp_f32 v4, v4, v193
    v_ldexp_f32 v5, v5, v193
    v_cvt_pk_bf16_f32 v122, v4, v5
    v_lshlrev_b32 v4, 16, v123
    v_and_b32 v5, 0xffff0000, v123
    v_ldexp_f32 v4, v4, v193
    v_ldexp_f32 v5, v5, v193
    v_cvt_pk_bf16_f32 v123, v4, v5
    v_lshlrev_b32 v4, 16, v124
    v_and_b32 v5, 0xffff0000, v124
    v_ldexp_f32 v4, v4, v193
    v_ldexp_f32 v5, v5, v193
    v_cvt_pk_bf16_f32 v124, v4, v5
    v_lshlrev_b32 v4, 16, v125
    v_and_b32 v5, 0xffff0000, v125
    v_ldexp_f32 v4, v4, v193
    v_ldexp_f32 v5, v5, v193
    v_cvt_pk_bf16_f32 v125, v4, v5
    v_lshlrev_b32 v4, 16, v126
    v_and_b32 v5, 0xffff0000, v126
    v_ldexp_f32 v4, v4, v193
    v_ldexp_f32 v5, v5, v193
    v_cvt_pk_bf16_f32 v126, v4, v5
    v_lshlrev_b32 v4, 16, v127
    v_and_b32 v5, 0xffff0000, v127
    v_ldexp_f32 v4, v4, v193
    v_ldexp_f32 v5, v5, v193
    v_cvt_pk_bf16_f32 v127, v4, v5
    v_sub_f32 v16, v16, v194
    v_sub_f32 v17, v17, v194
    v_sub_f32 v18, v18, v194
    v_sub_f32 v19, v19, v194
    v_sub_f32 v20, v20, v194
    v_sub_f32 v21, v21, v194
    v_sub_f32 v22, v22, v194
    v_sub_f32 v23, v23, v194
    v_sub_f32 v24, v24, v194
    v_sub_f32 v25, v25, v194
    v_sub_f32 v26, v26, v194
    v_sub_f32 v27, v27, v194
    v_sub_f32 v28, v28, v194
    v_sub_f32 v29, v29, v194
    v_sub_f32 v30, v30, v194
    v_sub_f32 v31, v31, v194
    v_sub_f32 v32, v32, v194
    v_sub_f32 v33, v33, v194
    v_sub_f32 v34, v34, v194
    v_sub_f32 v35, v35, v194
    v_sub_f32 v36, v36, v194
    v_sub_f32 v37, v37, v194
    v_sub_f32 v38, v38, v194
    v_sub_f32 v39, v39, v194
    v_sub_f32 v40, v40, v194
    v_sub_f32 v41, v41, v194
    v_sub_f32 v42, v42, v194
    v_sub_f32 v43, v43, v194
    v_sub_f32 v44, v44, v194
    v_sub_f32 v45, v45, v194
    v_sub_f32 v46, v46, v194
    v_sub_f32 v47, v47, v194
    v_sub_f32 v64, v64, v194
    v_sub_f32 v65, v65, v194
    v_sub_f32 v66, v66, v194
    v_sub_f32 v67, v67, v194
    v_sub_f32 v68, v68, v194
    v_sub_f32 v69, v69, v194
    v_sub_f32 v70, v70, v194
    v_sub_f32 v71, v71, v194
    v_sub_f32 v72, v72, v194
    v_sub_f32 v73, v73, v194
    v_sub_f32 v74, v74, v194
    v_sub_f32 v75, v75, v194
    v_sub_f32 v76, v76, v194
    v_sub_f32 v77, v77, v194
    v_sub_f32 v78, v78, v194
    v_sub_f32 v79, v79, v194
    s_nop 1
    s_branch L_A_ret_p2m
L_A_slow:
    v_accvgpr_write_b32 a0, 0
    v_accvgpr_write_b32 a1, 0
    v_accvgpr_write_b32 a2, 0
    v_accvgpr_write_b32 a3, 0
    v_accvgpr_write_b32 a4, 0
    v_accvgpr_write_b32 a5, 0
    v_accvgpr_write_b32 a6, 0
    v_accvgpr_write_b32 a7, 0
    v_accvgpr_write_b32 a8, 0
    v_accvgpr_write_b32 a9, 0
    v_accvgpr_write_b32 a10, 0
    v_accvgpr_write_b32 a11, 0
    v_accvgpr_write_b32 a12, 0
    v_accvgpr_write_b32 a13, 0
    v_accvgpr_write_b32 a14, 0
    v_accvgpr_write_b32 a15, 0
    v_accvgpr_write_b32 a16, 0
    v_accvgpr_write_b32 a17, 0
    v_accvgpr_write_b32 a18, 0
    v_accvgpr_write_b32 a19, 0
    v_accvgpr_write_b32 a20, 0
    v_accvgpr_write_b32 a21, 0
    v_accvgpr_write_b32 a22, 0
    v_accvgpr_write_b32 a23, 0
    v_accvgpr_write_b32 a24, 0
    v_accvgpr_write_b32 a25, 0
    v_accvgpr_write_b32 a26, 0
    v_accvgpr_write_b32 a27, 0
    v_accvgpr_write_b32 a28, 0
    v_accvgpr_write_b32 a29, 0
    v_accvgpr_write_b32 a30, 0
    v_accvgpr_write_b32 a31, 0
    v_accvgpr_write_b32 a32, 0
    v_accvgpr_write_b32 a33, 0
    v_accvgpr_write_b32 a34, 0
    v_accvgpr_write_b32 a35, 0
    v_accvgpr_write_b32 a36, 0
    v_accvgpr_write_b32 a37, 0
    v_accvgpr_write_b32 a38, 0
    v_accvgpr_write_b32 a39, 0
    v_accvgpr_write_b32 a40, 0
    v_accvgpr_write_b32 a41, 0
    v_accvgpr_write_b32 a42, 0
    v_accvgpr_write_b32 a43, 0
    v_accvgpr_write_b32 a44, 0
    v_accvgpr_write_b32 a45, 0
    v_accvgpr_write_b32 a46, 0
    v_accvgpr_write_b32 a47, 0
    v_accvgpr_write_b32 a48, 0
    v_accvgpr_write_b32 a49, 0
    v_accvgpr_write_b32 a50, 0
    v_accvgpr_write_b32 a51, 0
    v_accvgpr_write_b32 a52, 0
    v_accvgpr_write_b32 a53, 0
    v_accvgpr_write_b32 a54, 0
    v_accvgpr_write_b32 a55, 0
    v_accvgpr_write_b32 a56, 0
    v_accvgpr_write_b32 a57, 0
    v_accvgpr_write_b32 a58, 0
    v_accvgpr_write_b32 a59, 0
    v_accvgpr_write_b32 a60, 0
    v_accvgpr_write_b32 a61, 0
    v_accvgpr_write_b32 a62, 0
    v_accvgpr_write_b32 a63, 0
    v_mov_b32 v14, 0
    v_mov_b32 v216, 0xff7fffff
    v_and_b32 v2, 31, v0
    v_lshrrev_b32 v3, 5, v0
    v_lshlrev_b32 v3, 2, v3
    v_sub_u32 v2, v2, v3
    s_lshl_b32 s19, s32, 5
    v_add_u32 v219, s19, v2
    v_cvt_f32_i32 v219, v219
    s_add_u32 s34, s32, 1
    s_mov_b32 s21, 0
    s_lshl_b32 s22, s16, 19
    s_add_u32 s23, s22, 16777216
L_A_slow_lo:
    s_add_u32 s19, s22, 4096
    s_add_u32 s20, s23, 4096
    buffer_load_dwordx4 v[128:131], v1, s[4:7], s22 offen offset:0
    buffer_load_dwordx4 v[132:135], v1, s[4:7], s22 offen offset:1024
    buffer_load_dwordx4 v[136:139], v1, s[4:7], s22 offen offset:2048
    buffer_load_dwordx4 v[140:143], v1, s[4:7], s22 offen offset:3072
    buffer_load_dwordx4 v[144:147], v1, s[4:7], s19 offen offset:0
    buffer_load_dwordx4 v[148:151], v1, s[4:7], s19 offen offset:1024
    buffer_load_dwordx4 v[152:155], v1, s[4:7], s19 offen offset:2048
    buffer_load_dwordx4 v[156:159], v1, s[4:7], s19 offen offset:3072
    buffer_load_dwordx4 v[160:163], v1, s[4:7], s23 offen offset:0
    buffer_load_dwordx4 v[164:167], v1, s[4:7], s23 offen offset:1024
    buffer_load_dwordx4 v[168:171], v1, s[4:7], s23 offen offset:2048
    buffer_load_dwordx4 v[172:175], v1, s[4:7], s23 offen offset:3072
    buffer_load_dwordx4 v[176:179], v1, s[4:7], s20 offen offset:0
    buffer_load_dwordx4 v[180:183], v1, s[4:7], s20 offen offset:1024
    buffer_load_dwordx4 v[184:187], v1, s[4:7], s20 offen offset:2048
    buffer_load_dwordx4 v[188:191], v1, s[4:7], s20 offen offset:3072
    v_mov_b32 v217, 0
    v_mul_f32 v11, 0x7149f2ca, v219
    v_add_f32 v80, 0x70c9f2ca, v11
    v_add_f32 v81, 0xf0c9f2ca, v11
    v_add_f32 v82, 0xf1977617, v11
    v_add_f32 v83, 0xf1fc6f7c, v11
    v_add_f32 v84, 0xf2bd539d, v11
    v_add_f32 v85, 0xf2d691f6, v11
    v_add_f32 v86, 0xf2efd050, v11
    v_add_f32 v87, 0xf3048754, v11
    v_add_f32 v88, 0xf343a333, v11
    v_add_f32 v89, 0xf3504260, v11
    v_add_f32 v90, 0xf35ce18d, v11
    v_add_f32 v91, 0xf36980b9, v11
    v_add_f32 v92, 0xf3944e4c, v11
    v_add_f32 v93, 0xf39a9de3, v11
    v_add_f32 v94, 0xf3a0ed79, v11
    v_add_f32 v95, 0xf3a73d0f, v11
    v_min_f32 v80, v217, v80
    v_min_f32 v81, v217, v81
    v_min_f32 v82, v217, v82
    v_min_f32 v83, v217, v83
    v_min_f32 v84, v217, v84
    v_min_f32 v85, v217, v85
    v_min_f32 v86, v217, v86
    v_min_f32 v87, v217, v87
    v_min_f32 v88, v217, v88
    v_min_f32 v89, v217, v89
    v_min_f32 v90, v217, v90
    v_min_f32 v91, v217, v91
    v_min_f32 v92, v217, v92
    v_min_f32 v93, v217, v93
    v_min_f32 v94, v217, v94
    v_min_f32 v95, v217, v95
    v_add_f32 v219, 0xc2000000, v219
    s_waitcnt vmcnt(0)
    v_mfma_f32_32x32x16_bf16 v[16:31], v[128:131], a[128:131], v[80:95]
    v_mfma_f32_32x32x16_bf16 v[16:31], v[132:135], a[132:135], v[16:31]
    v_mfma_f32_32x32x16_bf16 v[16:31], v[136:139], a[136:139], v[16:31]
    v_mfma_f32_32x32x16_bf16 v[16:31], v[140:143], a[140:143], v[16:31]
    v_mfma_f32_32x32x16_bf16 v[16:31], v[144:147], a[144:147], v[16:31]
    v_mfma_f32_32x32x16_bf16 v[16:31], v[148:151], a[148:151], v[16:31]
    v_mfma_f32_32x32x16_bf16 v[16:31], v[152:155], a[152:155], v[16:31]
    v_mfma_f32_32x32x16_bf16 v[16:31], v[156:159], a[156:159], v[16:31]
    s_nop 7
    s_nop 7
    v_max3_f32 v218, v16, v17, v18
    v_max3_f32 v218, v218, v19, v20
    v_max3_f32 v218, v218, v21, v22
    v_max3_f32 v218, v218, v23, v24
    v_max3_f32 v218, v218, v25, v26
    v_max3_f32 v218, v218, v27, v28
    v_max3_f32 v218, v218, v29, v30
    v_max3_f32 v218, v218, v31, v216
    v_mov_b32 v3, v218
    s_nop 1
    v_permlane32_swap_b32 v218, v3
    s_nop 1
    v_max_f32 v218, v218, v3
    v_sub_f32 v217, v216, v218
    v_exp_f32 v217, v217
    v_mov_b32 v216, v218
    v_sub_f32 v16, v16, v218
    v_sub_f32 v17, v17, v218
    v_sub_f32 v18, v18, v218
    v_sub_f32 v19, v19, v218
    v_sub_f32 v20, v20, v218
    v_sub_f32 v21, v21, v218
    v_sub_f32 v22, v22, v218
    v_sub_f32 v23, v23, v218
    v_sub_f32 v24, v24, v218
    v_sub_f32 v25, v25, v218
    v_sub_f32 v26, v26, v218
    v_sub_f32 v27, v27, v218
    v_sub_f32 v28, v28, v218
    v_sub_f32 v29, v29, v218
    v_sub_f32 v30, v30, v218
    v_sub_f32 v31, v31, v218
    v_exp_f32 v16, v16
    v_exp_f32 v17, v17
    v_exp_f32 v18, v18
    v_exp_f32 v19, v19
    v_exp_f32 v20, v20
    v_exp_f32 v21, v21
    v_exp_f32 v22, v22
    v_exp_f32 v23, v23
    v_exp_f32 v24, v24
    v_exp_f32 v25, v25
    v_exp_f32 v26, v26
    v_exp_f32 v27, v27
    v_exp_f32 v28, v28
    v_exp_f32 v29, v29
    v_exp_f32 v30, v30
    v_exp_f32 v31, v31
    v_mul_f32 v14, v217, v14
    v_add_f32 v14, v14, v16
    v_add_f32 v14, v14, v17
    v_add_f32 v14, v14, v18
    v_add_f32 v14, v14, v19
    v_add_f32 v14, v14, v20
    v_add_f32 v14, v14, v21
    v_add_f32 v14, v14, v22
    v_add_f32 v14, v14, v23
    v_add_f32 v14, v14, v24
    v_add_f32 v14, v14, v25
    v_add_f32 v14, v14, v26
    v_add_f32 v14, v14, v27
    v_add_f32 v14, v14, v28
    v_add_f32 v14, v14, v29
    v_add_f32 v14, v14, v30
    v_add_f32 v14, v14, v31
    v_accvgpr_read_b32 v192, a0
    v_mul_f32 v192, v217, v192
    v_accvgpr_write_b32 a0, v192
    v_accvgpr_read_b32 v193, a1
    v_mul_f32 v193, v217, v193
    v_accvgpr_write_b32 a1, v193
    v_accvgpr_read_b32 v194, a2
    v_mul_f32 v194, v217, v194
    v_accvgpr_write_b32 a2, v194
    v_accvgpr_read_b32 v195, a3
    v_mul_f32 v195, v217, v195
    v_accvgpr_write_b32 a3, v195
    v_accvgpr_read_b32 v192, a4
    v_mul_f32 v192, v217, v192
    v_accvgpr_write_b32 a4, v192
    v_accvgpr_read_b32 v193, a5
    v_mul_f32 v193, v217, v193
    v_accvgpr_write_b32 a5, v193
    v_accvgpr_read_b32 v194, a6
    v_mul_f32 v194, v217, v194
    v_accvgpr_write_b32 a6, v194
    v_accvgpr_read_b32 v195, a7
    v_mul_f32 v195, v217, v195
    v_accvgpr_write_b32 a7, v195
    v_accvgpr_read_b32 v192, a8
    v_mul_f32 v192, v217, v192
    v_accvgpr_write_b32 a8, v192
    v_accvgpr_read_b32 v193, a9
    v_mul_f32 v193, v217, v193
    v_accvgpr_write_b32 a9, v193
    v_accvgpr_read_b32 v194, a10
    v_mul_f32 v194, v217, v194
    v_accvgpr_write_b32 a10, v194
    v_accvgpr_read_b32 v195, a11
    v_mul_f32 v195, v217, v195
    v_accvgpr_write_b32 a11, v195
    v_accvgpr_read_b32 v192, a12
    v_mul_f32 v192, v217, v192
    v_accvgpr_write_b32 a12, v192
    v_accvgpr_read_b32 v193, a13
    v_mul_f32 v193, v217, v193
    v_accvgpr_write_b32 a13, v193
    v_accvgpr_read_b32 v194, a14
    v_mul_f32 v194, v217, v194
    v_accvgpr_write_b32 a14, v194
    v_accvgpr_read_b32 v195, a15
    v_mul_f32 v195, v217, v195
    v_accvgpr_write_b32 a15, v195
    v_accvgpr_read_b32 v192, a16
    v_mul_f32 v192, v217, v192
    v_accvgpr_write_b32 a16, v192
    v_accvgpr_read_b32 v193, a17
    v_mul_f32 v193, v217, v193
    v_accvgpr_write_b32 a17, v193
    v_accvgpr_read_b32 v194, a18
    v_mul_f32 v194, v217, v194
    v_accvgpr_write_b32 a18, v194
    v_accvgpr_read_b32 v195, a19
    v_mul_f32 v195, v217, v195
    v_accvgpr_write_b32 a19, v195
    v_accvgpr_read_b32 v192, a20
    v_mul_f32 v192, v217, v192
    v_accvgpr_write_b32 a20, v192
    v_accvgpr_read_b32 v193, a21
    v_mul_f32 v193, v217, v193
    v_accvgpr_write_b32 a21, v193
    v_accvgpr_read_b32 v194, a22
    v_mul_f32 v194, v217, v194
    v_accvgpr_write_b32 a22, v194
    v_accvgpr_read_b32 v195, a23
    v_mul_f32 v195, v217, v195
    v_accvgpr_write_b32 a23, v195
    v_accvgpr_read_b32 v192, a24
    v_mul_f32 v192, v217, v192
    v_accvgpr_write_b32 a24, v192
    v_accvgpr_read_b32 v193, a25
    v_mul_f32 v193, v217, v193
    v_accvgpr_write_b32 a25, v193
    v_accvgpr_read_b32 v194, a26
    v_mul_f32 v194, v217, v194
    v_accvgpr_write_b32 a26, v194
    v_accvgpr_read_b32 v195, a27
    v_mul_f32 v195, v217, v195
    v_accvgpr_write_b32 a27, v195
    v_accvgpr_read_b32 v192, a28
    v_mul_f32 v192, v217, v192
    v_accvgpr_write_b32 a28, v192
    v_accvgpr_read_b32 v193, a29
    v_mul_f32 v193, v217, v193
    v_accvgpr_write_b32 a29, v193
    v_accvgpr_read_b32 v194, a30
    v_mul_f32 v194, v217, v194
    v_accvgpr_write_b32 a30, v194
    v_accvgpr_read_b32 v195, a31
    v_mul_f32 v195, v217, v195
    v_accvgpr_write_b32 a31, v195
    v_accvgpr_read_b32 v192, a32
    v_mul_f32 v192, v217, v192
    v_accvgpr_write_b32 a32, v192
    v_accvgpr_read_b32 v193, a33
    v_mul_f32 v193, v217, v193
    v_accvgpr_write_b32 a33, v193
    v_accvgpr_read_b32 v194, a34
    v_mul_f32 v194, v217, v194
    v_accvgpr_write_b32 a34, v194
    v_accvgpr_read_b32 v195, a35
    v_mul_f32 v195, v217, v195
    v_accvgpr_write_b32 a35, v195
    v_accvgpr_read_b32 v192, a36
    v_mul_f32 v192, v217, v192
    v_accvgpr_write_b32 a36, v192
    v_accvgpr_read_b32 v193, a37
    v_mul_f32 v193, v217, v193
    v_accvgpr_write_b32 a37, v193
    v_accvgpr_read_b32 v194, a38
    v_mul_f32 v194, v217, v194
    v_accvgpr_write_b32 a38, v194
    v_accvgpr_read_b32 v195, a39
    v_mul_f32 v195, v217, v195
    v_accvgpr_write_b32 a39, v195
    v_accvgpr_read_b32 v192, a40
    v_mul_f32 v192, v217, v192
    v_accvgpr_write_b32 a40, v192
    v_accvgpr_read_b32 v193, a41
    v_mul_f32 v193, v217, v193
    v_accvgpr_write_b32 a41, v193
    v_accvgpr_read_b32 v194, a42
    v_mul_f32 v194, v217, v194
    v_accvgpr_write_b32 a42, v194
    v_accvgpr_read_b32 v195, a43
    v_mul_f32 v195, v217, v195
    v_accvgpr_write_b32 a43, v195
    v_accvgpr_read_b32 v192, a44
    v_mul_f32 v192, v217, v192
    v_accvgpr_write_b32 a44, v192
    v_accvgpr_read_b32 v193, a45
    v_mul_f32 v193, v217, v193
    v_accvgpr_write_b32 a45, v193
    v_accvgpr_read_b32 v194, a46
    v_mul_f32 v194, v217, v194
    v_accvgpr_write_b32 a46, v194
    v_accvgpr_read_b32 v195, a47
    v_mul_f32 v195, v217, v195
    v_accvgpr_write_b32 a47, v195
    v_accvgpr_read_b32 v192, a48
    v_mul_f32 v192, v217, v192
    v_accvgpr_write_b32 a48, v192
    v_accvgpr_read_b32 v193, a49
    v_mul_f32 v193, v217, v193
    v_accvgpr_write_b32 a49, v193
    v_accvgpr_read_b32 v194, a50
    v_mul_f32 v194, v217, v194
    v_accvgpr_write_b32 a50, v194
    v_accvgpr_read_b32 v195, a51
    v_mul_f32 v195, v217, v195
    v_accvgpr_write_b32 a51, v195
    v_accvgpr_read_b32 v192, a52
    v_mul_f32 v192, v217, v192
    v_accvgpr_write_b32 a52, v192
    v_accvgpr_read_b32 v193, a53
    v_mul_f32 v193, v217, v193
    v_accvgpr_write_b32 a53, v193
    v_accvgpr_read_b32 v194, a54
    v_mul_f32 v194, v217, v194
    v_accvgpr_write_b32 a54, v194
    v_accvgpr_read_b32 v195, a55
    v_mul_f32 v195, v217, v195
    v_accvgpr_write_b32 a55, v195
    v_accvgpr_read_b32 v192, a56
    v_mul_f32 v192, v217, v192
    v_accvgpr_write_b32 a56, v192
    v_accvgpr_read_b32 v193, a57
    v_mul_f32 v193, v217, v193
    v_accvgpr_write_b32 a57, v193
    v_accvgpr_read_b32 v194, a58
    v_mul_f32 v194, v217, v194
    v_accvgpr_write_b32 a58, v194
    v_accvgpr_read_b32 v195, a59
    v_mul_f32 v195, v217, v195
    v_accvgpr_write_b32 a59, v195
    v_accvgpr_read_b32 v192, a60
    v_mul_f32 v192, v217, v192
    v_accvgpr_write_b32 a60, v192
    v_accvgpr_read_b32 v193, a61
    v_mul_f32 v193, v217, v193
    v_accvgpr_write_b32 a61, v193
    v_accvgpr_read_b32 v194, a62
    v_mul_f32 v194, v217, v194
    v_accvgpr_write_b32 a62, v194
    v_accvgpr_read_b32 v195, a63
    v_mul_f32 v195, v217, v195
    v_accvgpr_write_b32 a63, v195
    v_cvt_pk_bf16_f32 v112, v16, v17
    v_cvt_pk_bf16_f32 v113, v18, v19
    v_cvt_pk_bf16_f32 v114, v20, v21
    v_cvt_pk_bf16_f32 v115, v22, v23
    v_cvt_pk_bf16_f32 v116, v24, v25
    v_cvt_pk_bf16_f32 v117, v26, v27
    v_cvt_pk_bf16_f32 v118, v28, v29
    v_cvt_pk_bf16_f32 v119, v30, v31
    s_nop 1
    v_mfma_f32_32x32x16_bf16 a[0:15], v[160:163], v[112:115], a[0:15]
    v_mfma_f32_32x32x16_bf16 a[16:31], v[164:167], v[112:115], a[16:31]
    v_mfma_f32_32x32x16_bf16 a[32:47], v[168:171], v[112:115], a[32:47]
    v_mfma_f32_32x32x16_bf16 a[48:63], v[172:175], v[112:115], a[48:63]
    v_mfma_f32_32x32x16_bf16 a[0:15], v[176:179], v[116:119], a[0:15]
    v_mfma_f32_32x32x16_bf16 a[16:31], v[180:183], v[116:119], a[16:31]
    v_mfma_f32_32x32x16_bf16 a[32:47], v[184:187], v[116:119], a[32:47]
    v_mfma_f32_32x32x16_bf16 a[48:63], v[188:191], v[116:119], a[48:63]
    s_nop 7
    s_nop 7
    s_add_u32 s22, s22, 8192
    s_add_u32 s23, s23, 8192
    s_add_u32 s21, s21, 1
    s_cmp_lt_u32 s21, s34
    s_cbranch_scc1 L_A_slow_lo
    v_accvgpr_write_b32 a64, 0
    v_accvgpr_write_b32 a65, 0
    v_accvgpr_write_b32 a66, 0
    v_accvgpr_write_b32 a67, 0
    v_accvgpr_write_b32 a68, 0
    v_accvgpr_write_b32 a69, 0
    v_accvgpr_write_b32 a70, 0
    v_accvgpr_write_b32 a71, 0
    v_accvgpr_write_b32 a72, 0
    v_accvgpr_write_b32 a73, 0
    v_accvgpr_write_b32 a74, 0
    v_accvgpr_write_b32 a75, 0
    v_accvgpr_write_b32 a76, 0
    v_accvgpr_write_b32 a77, 0
    v_accvgpr_write_b32 a78, 0
    v_accvgpr_write_b32 a79, 0
    v_accvgpr_write_b32 a80, 0
    v_accvgpr_write_b32 a81, 0
    v_accvgpr_write_b32 a82, 0
    v_accvgpr_write_b32 a83, 0
    v_accvgpr_write_b32 a84, 0
    v_accvgpr_write_b32 a85, 0
    v_accvgpr_write_b32 a86, 0
    v_accvgpr_write_b32 a87, 0
    v_accvgpr_write_b32 a88, 0
    v_accvgpr_write_b32 a89, 0
    v_accvgpr_write_b32 a90, 0
    v_accvgpr_write_b32 a91, 0
    v_accvgpr_write_b32 a92, 0
    v_accvgpr_write_b32 a93, 0
    v_accvgpr_write_b32 a94, 0
    v_accvgpr_write_b32 a95, 0
    v_accvgpr_write_b32 a96, 0
    v_accvgpr_write_b32 a97, 0
    v_accvgpr_write_b32 a98, 0
    v_accvgpr_write_b32 a99, 0
    v_accvgpr_write_b32 a100, 0
    v_accvgpr_write_b32 a101, 0
    v_accvgpr_write_b32 a102, 0
    v_accvgpr_write_b32 a103, 0
    v_accvgpr_write_b32 a104, 0
    v_accvgpr_write_b32 a105, 0
    v_accvgpr_write_b32 a106, 0
    v_accvgpr_write_b32 a107, 0
    v_accvgpr_write_b32 a108, 0
    v_accvgpr_write_b32 a109, 0
    v_accvgpr_write_b32 a110, 0
    v_accvgpr_write_b32 a111, 0
    v_accvgpr_write_b32 a112, 0
    v_accvgpr_write_b32 a113, 0
    v_accvgpr_write_b32 a114, 0
    v_accvgpr_write_b32 a115, 0
    v_accvgpr_write_b32 a116, 0
    v_accvgpr_write_b32 a117, 0
    v_accvgpr_write_b32 a118, 0
    v_accvgpr_write_b32 a119, 0
    v_accvgpr_write_b32 a120, 0
    v_accvgpr_write_b32 a121, 0
    v_accvgpr_write_b32 a122, 0
    v_accvgpr_write_b32 a123, 0
    v_accvgpr_write_b32 a124, 0
    v_accvgpr_write_b32 a125, 0
    v_accvgpr_write_b32 a126, 0
    v_accvgpr_write_b32 a127, 0
    v_mov_b32 v12, 0
    v_mov_b32 v216, 0xff7fffff
    v_and_b32 v2, 31, v0
    v_lshrrev_b32 v3, 5, v0
    v_lshlrev_b32 v3, 2, v3
    v_sub_u32 v2, v2, v3
    s_lshl_b32 s19, s33, 5
    v_add_u32 v219, s19, v2
    v_cvt_f32_i32 v219, v219
    s_add_u32 s34, s33, 1
    s_mov_b32 s21, 0
    s_lshl_b32 s22, s16, 19
    s_add_u32 s23, s22, 16777216
L_A_slow_hi:
    s_add_u32 s19, s22, 4096
    s_add_u32 s20, s23, 4096
    buffer_load_dwordx4 v[128:131], v1, s[4:7], s22 offen offset:0
    buffer_load_dwordx4 v[132:135], v1, s[4:7], s22 offen offset:1024
    buffer_load_dwordx4 v[136:139], v1, s[4:7], s22 offen offset:2048
    buffer_load_dwordx4 v[140:143], v1, s[4:7], s22 offen offset:3072
    buffer_load_dwordx4 v[144:147], v1, s[4:7], s19 offen offset:0
    buffer_load_dwordx4 v[148:151], v1, s[4:7], s19 offen offset:1024
    buffer_load_dwordx4 v[152:155], v1, s[4:7], s19 offen offset:2048
    buffer_load_dwordx4 v[156:159], v1, s[4:7], s19 offen offset:3072
    buffer_load_dwordx4 v[160:163], v1, s[4:7], s23 offen offset:0
    buffer_load_dwordx4 v[164:167], v1, s[4:7], s23 offen offset:1024
    buffer_load_dwordx4 v[168:171], v1, s[4:7], s23 offen offset:2048
    buffer_load_dwordx4 v[172:175], v1, s[4:7], s23 offen offset:3072
    buffer_load_dwordx4 v[176:179], v1, s[4:7], s20 offen offset:0
    buffer_load_dwordx4 v[180:183], v1, s[4:7], s20 offen offset:1024
    buffer_load_dwordx4 v[184:187], v1, s[4:7], s20 offen offset:2048
    buffer_load_dwordx4 v[188:191], v1, s[4:7], s20 offen offset:3072
    v_mov_b32 v217, 0
    v_mul_f32 v11, 0x7149f2ca, v219
    v_add_f32 v80, 0x70c9f2ca, v11
    v_add_f32 v81, 0xf0c9f2ca, v11
    v_add_f32 v82, 0xf1977617, v11
    v_add_f32 v83, 0xf1fc6f7c, v11
    v_add_f32 v84, 0xf2bd539d, v11
    v_add_f32 v85, 0xf2d691f6, v11
    v_add_f32 v86, 0xf2efd050, v11
    v_add_f32 v87, 0xf3048754, v11
    v_add_f32 v88, 0xf343a333, v11
    v_add_f32 v89, 0xf3504260, v11
    v_add_f32 v90, 0xf35ce18d, v11
    v_add_f32 v91, 0xf36980b9, v11
    v_add_f32 v92, 0xf3944e4c, v11
    v_add_f32 v93, 0xf39a9de3, v11
    v_add_f32 v94, 0xf3a0ed79, v11
    v_add_f32 v95, 0xf3a73d0f, v11
    v_min_f32 v80, v217, v80
    v_min_f32 v81, v217, v81
    v_min_f32 v82, v217, v82
    v_min_f32 v83, v217, v83
    v_min_f32 v84, v217, v84
    v_min_f32 v85, v217, v85
    v_min_f32 v86, v217, v86
    v_min_f32 v87, v217, v87
    v_min_f32 v88, v217, v88
    v_min_f32 v89, v217, v89
    v_min_f32 v90, v217, v90
    v_min_f32 v91, v217, v91
    v_min_f32 v92, v217, v92
    v_min_f32 v93, v217, v93
    v_min_f32 v94, v217, v94
    v_min_f32 v95, v217, v95
    v_add_f32 v219, 0xc2000000, v219
    s_waitcnt vmcnt(0)
    v_mfma_f32_32x32x16_bf16 v[16:31], v[128:131], a[160:163], v[80:95]
    v_mfma_f32_32x32x16_bf16 v[16:31], v[132:135], a[164:167], v[16:31]
    v_mfma_f32_32x32x16_bf16 v[16:31], v[136:139], a[168:171], v[16:31]
    v_mfma_f32_32x32x16_bf16 v[16:31], v[140:143], a[172:175], v[16:31]
    v_mfma_f32_32x32x16_bf16 v[16:31], v[144:147], a[176:179], v[16:31]
    v_mfma_f32_32x32x16_bf16 v[16:31], v[148:151], a[180:183], v[16:31]
    v_mfma_f32_32x32x16_bf16 v[16:31], v[152:155], a[184:187], v[16:31]
    v_mfma_f32_32x32x16_bf16 v[16:31], v[156:159], a[188:191], v[16:31]
    s_nop 7
    s_nop 7
    v_max3_f32 v218, v16, v17, v18
    v_max3_f32 v218, v218, v19, v20
    v_max3_f32 v218, v218, v21, v22
    v_max3_f32 v218, v218, v23, v24
    v_max3_f32 v218, v218, v25, v26
    v_max3_f32 v218, v218, v27, v28
    v_max3_f32 v218, v218, v29, v30
    v_max3_f32 v218, v218, v31, v216
    v_mov_b32 v3, v218
    s_nop 1
    v_permlane32_swap_b32 v218, v3
    s_nop 1
    v_max_f32 v218, v218, v3
    v_sub_f32 v217, v216, v218
    v_exp_f32 v217, v217
    v_mov_b32 v216, v218
    v_sub_f32 v16, v16, v218
    v_sub_f32 v17, v17, v218
    v_sub_f32 v18, v18, v218
    v_sub_f32 v19, v19, v218
    v_sub_f32 v20, v20, v218
    v_sub_f32 v21, v21, v218
    v_sub_f32 v22, v22, v218
    v_sub_f32 v23, v23, v218
    v_sub_f32 v24, v24, v218
    v_sub_f32 v25, v25, v218
    v_sub_f32 v26, v26, v218
    v_sub_f32 v27, v27, v218
    v_sub_f32 v28, v28, v218
    v_sub_f32 v29, v29, v218
    v_sub_f32 v30, v30, v218
    v_sub_f32 v31, v31, v218
    v_exp_f32 v16, v16
    v_exp_f32 v17, v17
    v_exp_f32 v18, v18
    v_exp_f32 v19, v19
    v_exp_f32 v20, v20
    v_exp_f32 v21, v21
    v_exp_f32 v22, v22
    v_exp_f32 v23, v23
    v_exp_f32 v24, v24
    v_exp_f32 v25, v25
    v_exp_f32 v26, v26
    v_exp_f32 v27, v27
    v_exp_f32 v28, v28
    v_exp_f32 v29, v29
    v_exp_f32 v30, v30
    v_exp_f32 v31, v31
    v_mul_f32 v12, v217, v12
    v_add_f32 v12, v12, v16
    v_add_f32 v12, v12, v17
    v_add_f32 v12, v12, v18
    v_add_f32 v12, v12, v19
    v_add_f32 v12, v12, v20
    v_add_f32 v12, v12, v21
    v_add_f32 v12, v12, v22
    v_add_f32 v12, v12, v23
    v_add_f32 v12, v12, v24
    v_add_f32 v12, v12, v25
    v_add_f32 v12, v12, v26
    v_add_f32 v12, v12, v27
    v_add_f32 v12, v12, v28
    v_add_f32 v12, v12, v29
    v_add_f32 v12, v12, v30
    v_add_f32 v12, v12, v31
    v_accvgpr_read_b32 v192, a64
    v_mul_f32 v192, v217, v192
    v_accvgpr_write_b32 a64, v192
    v_accvgpr_read_b32 v193, a65
    v_mul_f32 v193, v217, v193
    v_accvgpr_write_b32 a65, v193
    v_accvgpr_read_b32 v194, a66
    v_mul_f32 v194, v217, v194
    v_accvgpr_write_b32 a66, v194
    v_accvgpr_read_b32 v195, a67
    v_mul_f32 v195, v217, v195
    v_accvgpr_write_b32 a67, v195
    v_accvgpr_read_b32 v192, a68
    v_mul_f32 v192, v217, v192
    v_accvgpr_write_b32 a68, v192
    v_accvgpr_read_b32 v193, a69
    v_mul_f32 v193, v217, v193
    v_accvgpr_write_b32 a69, v193
    v_accvgpr_read_b32 v194, a70
    v_mul_f32 v194, v217, v194
    v_accvgpr_write_b32 a70, v194
    v_accvgpr_read_b32 v195, a71
    v_mul_f32 v195, v217, v195
    v_accvgpr_write_b32 a71, v195
    v_accvgpr_read_b32 v192, a72
    v_mul_f32 v192, v217, v192
    v_accvgpr_write_b32 a72, v192
    v_accvgpr_read_b32 v193, a73
    v_mul_f32 v193, v217, v193
    v_accvgpr_write_b32 a73, v193
    v_accvgpr_read_b32 v194, a74
    v_mul_f32 v194, v217, v194
    v_accvgpr_write_b32 a74, v194
    v_accvgpr_read_b32 v195, a75
    v_mul_f32 v195, v217, v195
    v_accvgpr_write_b32 a75, v195
    v_accvgpr_read_b32 v192, a76
    v_mul_f32 v192, v217, v192
    v_accvgpr_write_b32 a76, v192
    v_accvgpr_read_b32 v193, a77
    v_mul_f32 v193, v217, v193
    v_accvgpr_write_b32 a77, v193
    v_accvgpr_read_b32 v194, a78
    v_mul_f32 v194, v217, v194
    v_accvgpr_write_b32 a78, v194
    v_accvgpr_read_b32 v195, a79
    v_mul_f32 v195, v217, v195
    v_accvgpr_write_b32 a79, v195
    v_accvgpr_read_b32 v192, a80
    v_mul_f32 v192, v217, v192
    v_accvgpr_write_b32 a80, v192
    v_accvgpr_read_b32 v193, a81
    v_mul_f32 v193, v217, v193
    v_accvgpr_write_b32 a81, v193
    v_accvgpr_read_b32 v194, a82
    v_mul_f32 v194, v217, v194
    v_accvgpr_write_b32 a82, v194
    v_accvgpr_read_b32 v195, a83
    v_mul_f32 v195, v217, v195
    v_accvgpr_write_b32 a83, v195
    v_accvgpr_read_b32 v192, a84
    v_mul_f32 v192, v217, v192
    v_accvgpr_write_b32 a84, v192
    v_accvgpr_read_b32 v193, a85
    v_mul_f32 v193, v217, v193
    v_accvgpr_write_b32 a85, v193
    v_accvgpr_read_b32 v194, a86
    v_mul_f32 v194, v217, v194
    v_accvgpr_write_b32 a86, v194
    v_accvgpr_read_b32 v195, a87
    v_mul_f32 v195, v217, v195
    v_accvgpr_write_b32 a87, v195
    v_accvgpr_read_b32 v192, a88
    v_mul_f32 v192, v217, v192
    v_accvgpr_write_b32 a88, v192
    v_accvgpr_read_b32 v193, a89
    v_mul_f32 v193, v217, v193
    v_accvgpr_write_b32 a89, v193
    v_accvgpr_read_b32 v194, a90
    v_mul_f32 v194, v217, v194
    v_accvgpr_write_b32 a90, v194
    v_accvgpr_read_b32 v195, a91
    v_mul_f32 v195, v217, v195
    v_accvgpr_write_b32 a91, v195
    v_accvgpr_read_b32 v192, a92
    v_mul_f32 v192, v217, v192
    v_accvgpr_write_b32 a92, v192
    v_accvgpr_read_b32 v193, a93
    v_mul_f32 v193, v217, v193
    v_accvgpr_write_b32 a93, v193
    v_accvgpr_read_b32 v194, a94
    v_mul_f32 v194, v217, v194
    v_accvgpr_write_b32 a94, v194
    v_accvgpr_read_b32 v195, a95
    v_mul_f32 v195, v217, v195
    v_accvgpr_write_b32 a95, v195
    v_accvgpr_read_b32 v192, a96
    v_mul_f32 v192, v217, v192
    v_accvgpr_write_b32 a96, v192
    v_accvgpr_read_b32 v193, a97
    v_mul_f32 v193, v217, v193
    v_accvgpr_write_b32 a97, v193
    v_accvgpr_read_b32 v194, a98
    v_mul_f32 v194, v217, v194
    v_accvgpr_write_b32 a98, v194
    v_accvgpr_read_b32 v195, a99
    v_mul_f32 v195, v217, v195
    v_accvgpr_write_b32 a99, v195
    v_accvgpr_read_b32 v192, a100
    v_mul_f32 v192, v217, v192
    v_accvgpr_write_b32 a100, v192
    v_accvgpr_read_b32 v193, a101
    v_mul_f32 v193, v217, v193
    v_accvgpr_write_b32 a101, v193
    v_accvgpr_read_b32 v194, a102
    v_mul_f32 v194, v217, v194
    v_accvgpr_write_b32 a102, v194
    v_accvgpr_read_b32 v195, a103
    v_mul_f32 v195, v217, v195
    v_accvgpr_write_b32 a103, v195
    v_accvgpr_read_b32 v192, a104
    v_mul_f32 v192, v217, v192
    v_accvgpr_write_b32 a104, v192
    v_accvgpr_read_b32 v193, a105
    v_mul_f32 v193, v217, v193
    v_accvgpr_write_b32 a105, v193
    v_accvgpr_read_b32 v194, a106
    v_mul_f32 v194, v217, v194
    v_accvgpr_write_b32 a106, v194
    v_accvgpr_read_b32 v195, a107
    v_mul_f32 v195, v217, v195
    v_accvgpr_write_b32 a107, v195
    v_accvgpr_read_b32 v192, a108
    v_mul_f32 v192, v217, v192
    v_accvgpr_write_b32 a108, v192
    v_accvgpr_read_b32 v193, a109
    v_mul_f32 v193, v217, v193
    v_accvgpr_write_b32 a109, v193
    v_accvgpr_read_b32 v194, a110
    v_mul_f32 v194, v217, v194
    v_accvgpr_write_b32 a110, v194
    v_accvgpr_read_b32 v195, a111
    v_mul_f32 v195, v217, v195
    v_accvgpr_write_b32 a111, v195
    v_accvgpr_read_b32 v192, a112
    v_mul_f32 v192, v217, v192
    v_accvgpr_write_b32 a112, v192
    v_accvgpr_read_b32 v193, a113
    v_mul_f32 v193, v217, v193
    v_accvgpr_write_b32 a113, v193
    v_accvgpr_read_b32 v194, a114
    v_mul_f32 v194, v217, v194
    v_accvgpr_write_b32 a114, v194
    v_accvgpr_read_b32 v195, a115
    v_mul_f32 v195, v217, v195
    v_accvgpr_write_b32 a115, v195
    v_accvgpr_read_b32 v192, a116
    v_mul_f32 v192, v217, v192
    v_accvgpr_write_b32 a116, v192
    v_accvgpr_read_b32 v193, a117
    v_mul_f32 v193, v217, v193
    v_accvgpr_write_b32 a117, v193
    v_accvgpr_read_b32 v194, a118
    v_mul_f32 v194, v217, v194
    v_accvgpr_write_b32 a118, v194
    v_accvgpr_read_b32 v195, a119
    v_mul_f32 v195, v217, v195
    v_accvgpr_write_b32 a119, v195
    v_accvgpr_read_b32 v192, a120
    v_mul_f32 v192, v217, v192
    v_accvgpr_write_b32 a120, v192
    v_accvgpr_read_b32 v193, a121
    v_mul_f32 v193, v217, v193
    v_accvgpr_write_b32 a121, v193
    v_accvgpr_read_b32 v194, a122
    v_mul_f32 v194, v217, v194
    v_accvgpr_write_b32 a122, v194
    v_accvgpr_read_b32 v195, a123
    v_mul_f32 v195, v217, v195
    v_accvgpr_write_b32 a123, v195
    v_accvgpr_read_b32 v192, a124
    v_mul_f32 v192, v217, v192
    v_accvgpr_write_b32 a124, v192
    v_accvgpr_read_b32 v193, a125
    v_mul_f32 v193, v217, v193
    v_accvgpr_write_b32 a125, v193
    v_accvgpr_read_b32 v194, a126
    v_mul_f32 v194, v217, v194
    v_accvgpr_write_b32 a126, v194
    v_accvgpr_read_b32 v195, a127
    v_mul_f32 v195, v217, v195
    v_accvgpr_write_b32 a127, v195
    v_cvt_pk_bf16_f32 v112, v16, v17
    v_cvt_pk_bf16_f32 v113, v18, v19
    v_cvt_pk_bf16_f32 v114, v20, v21
    v_cvt_pk_bf16_f32 v115, v22, v23
    v_cvt_pk_bf16_f32 v116, v24, v25
    v_cvt_pk_bf16_f32 v117, v26, v27
    v_cvt_pk_bf16_f32 v118, v28, v29
    v_cvt_pk_bf16_f32 v119, v30, v31
    s_nop 1
    v_mfma_f32_32x32x16_bf16 a[64:79], v[160:163], v[112:115], a[64:79]
    v_mfma_f32_32x32x16_bf16 a[80:95], v[164:167], v[112:115], a[80:95]
    v_mfma_f32_32x32x16_bf16 a[96:111], v[168:171], v[112:115], a[96:111]
    v_mfma_f32_32x32x16_bf16 a[112:127], v[172:175], v[112:115], a[112:127]
    v_mfma_f32_32x32x16_bf16 a[64:79], v[176:179], v[116:119], a[64:79]
    v_mfma_f32_32x32x16_bf16 a[80:95], v[180:183], v[116:119], a[80:95]
    v_mfma_f32_32x32x16_bf16 a[96:111], v[184:187], v[116:119], a[96:111]
    v_mfma_f32_32x32x16_bf16 a[112:127], v[188:191], v[116:119], a[112:127]
    s_nop 7
    s_nop 7
    s_add_u32 s22, s22, 8192
    s_add_u32 s23, s23, 8192
    s_add_u32 s21, s21, 1
    s_cmp_lt_u32 s21, s34
    s_cbranch_scc1 L_A_slow_hi
    v_mov_b32 v2, v14
    v_mov_b32 v3, v14
    s_nop 1
    v_permlane32_swap_b32 v2, v3
    s_nop 1
    v_add_f32 v2, v2, v3
    v_rcp_f32 v2, v2
    s_lshl_b32 s19, s32, 18
    s_lshl_b32 s20, s16, 13
    s_add_u32 s19, s19, s20
    s_add_u32 s19, s19, 50331648
    s_add_u32 s20, s19, 4096
    v_accvgpr_read_b32 v128, a0
    v_accvgpr_read_b32 v129, a1
    v_accvgpr_read_b32 v130, a2
    v_accvgpr_read_b32 v131, a3
    v_accvgpr_read_b32 v132, a4
    v_accvgpr_read_b32 v133, a5
    v_accvgpr_read_b32 v134, a6
    v_accvgpr_read_b32 v135, a7
    v_mul_f32 v128, v2, v128
    v_mul_f32 v129, v2, v129
    v_mul_f32 v130, v2, v130
    v_mul_f32 v131, v2, v131
    v_mul_f32 v132, v2, v132
    v_mul_f32 v133, v2, v133
    v_mul_f32 v134, v2, v134
    v_mul_f32 v135, v2, v135
    v_cvt_pk_bf16_f32 v136, v128, v129
    v_cvt_pk_bf16_f32 v137, v130, v131
    v_cvt_pk_bf16_f32 v138, v132, v133
    v_cvt_pk_bf16_f32 v139, v134, v135
    buffer_store_dwordx4 v[136:139], v1, s[4:7], s19 offen offset:0 sc1
    v_accvgpr_read_b32 v140, a8
    v_accvgpr_read_b32 v141, a9
    v_accvgpr_read_b32 v142, a10
    v_accvgpr_read_b32 v143, a11
    v_accvgpr_read_b32 v144, a12
    v_accvgpr_read_b32 v145, a13
    v_accvgpr_read_b32 v146, a14
    v_accvgpr_read_b32 v147, a15
    v_mul_f32 v140, v2, v140
    v_mul_f32 v141, v2, v141
    v_mul_f32 v142, v2, v142
    v_mul_f32 v143, v2, v143
    v_mul_f32 v144, v2, v144
    v_mul_f32 v145, v2, v145
    v_mul_f32 v146, v2, v146
    v_mul_f32 v147, v2, v147
    v_cvt_pk_bf16_f32 v148, v140, v141
    v_cvt_pk_bf16_f32 v149, v142, v143
    v_cvt_pk_bf16_f32 v150, v144, v145
    v_cvt_pk_bf16_f32 v151, v146, v147
    buffer_store_dwordx4 v[148:151], v1, s[4:7], s19 offen offset:1024 sc1
    v_accvgpr_read_b32 v152, a16
    v_accvgpr_read_b32 v153, a17
    v_accvgpr_read_b32 v154, a18
    v_accvgpr_read_b32 v155, a19
    v_accvgpr_read_b32 v156, a20
    v_accvgpr_read_b32 v157, a21
    v_accvgpr_read_b32 v158, a22
    v_accvgpr_read_b32 v159, a23
    v_mul_f32 v152, v2, v152
    v_mul_f32 v153, v2, v153
    v_mul_f32 v154, v2, v154
    v_mul_f32 v155, v2, v155
    v_mul_f32 v156, v2, v156
    v_mul_f32 v157, v2, v157
    v_mul_f32 v158, v2, v158
    v_mul_f32 v159, v2, v159
    v_cvt_pk_bf16_f32 v160, v152, v153
    v_cvt_pk_bf16_f32 v161, v154, v155
    v_cvt_pk_bf16_f32 v162, v156, v157
    v_cvt_pk_bf16_f32 v163, v158, v159
    buffer_store_dwordx4 v[160:163], v1, s[4:7], s19 offen offset:2048 sc1
    v_accvgpr_read_b32 v164, a24
    v_accvgpr_read_b32 v165, a25
    v_accvgpr_read_b32 v166, a26
    v_accvgpr_read_b32 v167, a27
    v_accvgpr_read_b32 v168, a28
    v_accvgpr_read_b32 v169, a29
    v_accvgpr_read_b32 v170, a30
    v_accvgpr_read_b32 v171, a31
    v_mul_f32 v164, v2, v164
    v_mul_f32 v165, v2, v165
    v_mul_f32 v166, v2, v166
    v_mul_f32 v167, v2, v167
    v_mul_f32 v168, v2, v168
    v_mul_f32 v169, v2, v169
    v_mul_f32 v170, v2, v170
    v_mul_f32 v171, v2, v171
    v_cvt_pk_bf16_f32 v172, v164, v165
    v_cvt_pk_bf16_f32 v173, v166, v167
    v_cvt_pk_bf16_f32 v174, v168, v169
    v_cvt_pk_bf16_f32 v175, v170, v171
    buffer_store_dwordx4 v[172:175], v1, s[4:7], s19 offen offset:3072 sc1
    v_accvgpr_read_b32 v128, a32
    v_accvgpr_read_b32 v129, a33
    v_accvgpr_read_b32 v130, a34
    v_accvgpr_read_b32 v131, a35
    v_accvgpr_read_b32 v132, a36
    v_accvgpr_read_b32 v133, a37
    v_accvgpr_read_b32 v134, a38
    v_accvgpr_read_b32 v135, a39
    v_mul_f32 v128, v2, v128
    v_mul_f32 v129, v2, v129
    v_mul_f32 v130, v2, v130
    v_mul_f32 v131, v2, v131
    v_mul_f32 v132, v2, v132
    v_mul_f32 v133, v2, v133
    v_mul_f32 v134, v2, v134
    v_mul_f32 v135, v2, v135
    v_cvt_pk_bf16_f32 v136, v128, v129
    v_cvt_pk_bf16_f32 v137, v130, v131
    v_cvt_pk_bf16_f32 v138, v132, v133
    v_cvt_pk_bf16_f32 v139, v134, v135
    buffer_store_dwordx4 v[136:139], v1, s[4:7], s20 offen offset:0 sc1
    v_accvgpr_read_b32 v140, a40
    v_accvgpr_read_b32 v141, a41
    v_accvgpr_read_b32 v142, a42
    v_accvgpr_read_b32 v143, a43
    v_accvgpr_read_b32 v144, a44
    v_accvgpr_read_b32 v145, a45
    v_accvgpr_read_b32 v146, a46
    v_accvgpr_read_b32 v147, a47
    v_mul_f32 v140, v2, v140
    v_mul_f32 v141, v2, v141
    v_mul_f32 v142, v2, v142
    v_mul_f32 v143, v2, v143
    v_mul_f32 v144, v2, v144
    v_mul_f32 v145, v2, v145
    v_mul_f32 v146, v2, v146
    v_mul_f32 v147, v2, v147
    v_cvt_pk_bf16_f32 v148, v140, v141
    v_cvt_pk_bf16_f32 v149, v142, v143
    v_cvt_pk_bf16_f32 v150, v144, v145
    v_cvt_pk_bf16_f32 v151, v146, v147
    buffer_store_dwordx4 v[148:151], v1, s[4:7], s20 offen offset:1024 sc1
    v_accvgpr_read_b32 v152, a48
    v_accvgpr_read_b32 v153, a49
    v_accvgpr_read_b32 v154, a50
    v_accvgpr_read_b32 v155, a51
    v_accvgpr_read_b32 v156, a52
    v_accvgpr_read_b32 v157, a53
    v_accvgpr_read_b32 v158, a54
    v_accvgpr_read_b32 v159, a55
    v_mul_f32 v152, v2, v152
    v_mul_f32 v153, v2, v153
    v_mul_f32 v154, v2, v154
    v_mul_f32 v155, v2, v155
    v_mul_f32 v156, v2, v156
    v_mul_f32 v157, v2, v157
    v_mul_f32 v158, v2, v158
    v_mul_f32 v159, v2, v159
    v_cvt_pk_bf16_f32 v160, v152, v153
    v_cvt_pk_bf16_f32 v161, v154, v155
    v_cvt_pk_bf16_f32 v162, v156, v157
    v_cvt_pk_bf16_f32 v163, v158, v159
    buffer_store_dwordx4 v[160:163], v1, s[4:7], s20 offen offset:2048 sc1
    v_accvgpr_read_b32 v164, a56
    v_accvgpr_read_b32 v165, a57
    v_accvgpr_read_b32 v166, a58
    v_accvgpr_read_b32 v167, a59
    v_accvgpr_read_b32 v168, a60
    v_accvgpr_read_b32 v169, a61
    v_accvgpr_read_b32 v170, a62
    v_accvgpr_read_b32 v171, a63
    v_mul_f32 v164, v2, v164
    v_mul_f32 v165, v2, v165
    v_mul_f32 v166, v2, v166
    v_mul_f32 v167, v2, v167
    v_mul_f32 v168, v2, v168
    v_mul_f32 v169, v2, v169
    v_mul_f32 v170, v2, v170
    v_mul_f32 v171, v2, v171
    v_cvt_pk_bf16_f32 v172, v164, v165
    v_cvt_pk_bf16_f32 v173, v166, v167
    v_cvt_pk_bf16_f32 v174, v168, v169
    v_cvt_pk_bf16_f32 v175, v170, v171
    buffer_store_dwordx4 v[172:175], v1, s[4:7], s20 offen offset:3072 sc1
    v_mov_b32 v2, v12
    v_mov_b32 v3, v12
    s_nop 1
    v_permlane32_swap_b32 v2, v3
    s_nop 1
    v_add_f32 v2, v2, v3
    v_rcp_f32 v2, v2
    s_lshl_b32 s19, s33, 18
    s_lshl_b32 s20, s16, 13
    s_add_u32 s19, s19, s20
    s_add_u32 s19, s19, 50331648
    s_add_u32 s20, s19, 4096
    v_accvgpr_read_b32 v128, a64
    v_accvgpr_read_b32 v129, a65
    v_accvgpr_read_b32 v130, a66
    v_accvgpr_read_b32 v131, a67
    v_accvgpr_read_b32 v132, a68
    v_accvgpr_read_b32 v133, a69
    v_accvgpr_read_b32 v134, a70
    v_accvgpr_read_b32 v135, a71
    v_mul_f32 v128, v2, v128
    v_mul_f32 v129, v2, v129
    v_mul_f32 v130, v2, v130
    v_mul_f32 v131, v2, v131
    v_mul_f32 v132, v2, v132
    v_mul_f32 v133, v2, v133
    v_mul_f32 v134, v2, v134
    v_mul_f32 v135, v2, v135
    v_cvt_pk_bf16_f32 v136, v128, v129
    v_cvt_pk_bf16_f32 v137, v130, v131
    v_cvt_pk_bf16_f32 v138, v132, v133
    v_cvt_pk_bf16_f32 v139, v134, v135
    buffer_store_dwordx4 v[136:139], v1, s[4:7], s19 offen offset:0 sc1
    v_accvgpr_read_b32 v140, a72
    v_accvgpr_read_b32 v141, a73
    v_accvgpr_read_b32 v142, a74
    v_accvgpr_read_b32 v143, a75
    v_accvgpr_read_b32 v144, a76
    v_accvgpr_read_b32 v145, a77
    v_accvgpr_read_b32 v146, a78
    v_accvgpr_read_b32 v147, a79
    v_mul_f32 v140, v2, v140
    v_mul_f32 v141, v2, v141
    v_mul_f32 v142, v2, v142
    v_mul_f32 v143, v2, v143
    v_mul_f32 v144, v2, v144
    v_mul_f32 v145, v2, v145
    v_mul_f32 v146, v2, v146
    v_mul_f32 v147, v2, v147
    v_cvt_pk_bf16_f32 v148, v140, v141
    v_cvt_pk_bf16_f32 v149, v142, v143
    v_cvt_pk_bf16_f32 v150, v144, v145
    v_cvt_pk_bf16_f32 v151, v146, v147
    buffer_store_dwordx4 v[148:151], v1, s[4:7], s19 offen offset:1024 sc1
    v_accvgpr_read_b32 v152, a80
    v_accvgpr_read_b32 v153, a81
    v_accvgpr_read_b32 v154, a82
    v_accvgpr_read_b32 v155, a83
    v_accvgpr_read_b32 v156, a84
    v_accvgpr_read_b32 v157, a85
    v_accvgpr_read_b32 v158, a86
    v_accvgpr_read_b32 v159, a87
    v_mul_f32 v152, v2, v152
    v_mul_f32 v153, v2, v153
    v_mul_f32 v154, v2, v154
    v_mul_f32 v155, v2, v155
    v_mul_f32 v156, v2, v156
    v_mul_f32 v157, v2, v157
    v_mul_f32 v158, v2, v158
    v_mul_f32 v159, v2, v159
    v_cvt_pk_bf16_f32 v160, v152, v153
    v_cvt_pk_bf16_f32 v161, v154, v155
    v_cvt_pk_bf16_f32 v162, v156, v157
    v_cvt_pk_bf16_f32 v163, v158, v159
    buffer_store_dwordx4 v[160:163], v1, s[4:7], s19 offen offset:2048 sc1
    v_accvgpr_read_b32 v164, a88
    v_accvgpr_read_b32 v165, a89
    v_accvgpr_read_b32 v166, a90
    v_accvgpr_read_b32 v167, a91
    v_accvgpr_read_b32 v168, a92
    v_accvgpr_read_b32 v169, a93
    v_accvgpr_read_b32 v170, a94
    v_accvgpr_read_b32 v171, a95
    v_mul_f32 v164, v2, v164
    v_mul_f32 v165, v2, v165
    v_mul_f32 v166, v2, v166
    v_mul_f32 v167, v2, v167
    v_mul_f32 v168, v2, v168
    v_mul_f32 v169, v2, v169
    v_mul_f32 v170, v2, v170
    v_mul_f32 v171, v2, v171
    v_cvt_pk_bf16_f32 v172, v164, v165
    v_cvt_pk_bf16_f32 v173, v166, v167
    v_cvt_pk_bf16_f32 v174, v168, v169
    v_cvt_pk_bf16_f32 v175, v170, v171
    buffer_store_dwordx4 v[172:175], v1, s[4:7], s19 offen offset:3072 sc1
    v_accvgpr_read_b32 v128, a96
    v_accvgpr_read_b32 v129, a97
    v_accvgpr_read_b32 v130, a98
    v_accvgpr_read_b32 v131, a99
    v_accvgpr_read_b32 v132, a100
    v_accvgpr_read_b32 v133, a101
    v_accvgpr_read_b32 v134, a102
    v_accvgpr_read_b32 v135, a103
    v_mul_f32 v128, v2, v128
    v_mul_f32 v129, v2, v129
    v_mul_f32 v130, v2, v130
    v_mul_f32 v131, v2, v131
    v_mul_f32 v132, v2, v132
    v_mul_f32 v133, v2, v133
    v_mul_f32 v134, v2, v134
    v_mul_f32 v135, v2, v135
    v_cvt_pk_bf16_f32 v136, v128, v129
    v_cvt_pk_bf16_f32 v137, v130, v131
    v_cvt_pk_bf16_f32 v138, v132, v133
    v_cvt_pk_bf16_f32 v139, v134, v135
    buffer_store_dwordx4 v[136:139], v1, s[4:7], s20 offen offset:0 sc1
    v_accvgpr_read_b32 v140, a104
    v_accvgpr_read_b32 v141, a105
    v_accvgpr_read_b32 v142, a106
    v_accvgpr_read_b32 v143, a107
    v_accvgpr_read_b32 v144, a108
    v_accvgpr_read_b32 v145, a109
    v_accvgpr_read_b32 v146, a110
    v_accvgpr_read_b32 v147, a111
    v_mul_f32 v140, v2, v140
    v_mul_f32 v141, v2, v141
    v_mul_f32 v142, v2, v142
    v_mul_f32 v143, v2, v143
    v_mul_f32 v144, v2, v144
    v_mul_f32 v145, v2, v145
    v_mul_f32 v146, v2, v146
    v_mul_f32 v147, v2, v147
    v_cvt_pk_bf16_f32 v148, v140, v141
    v_cvt_pk_bf16_f32 v149, v142, v143
    v_cvt_pk_bf16_f32 v150, v144, v145
    v_cvt_pk_bf16_f32 v151, v146, v147
    buffer_store_dwordx4 v[148:151], v1, s[4:7], s20 offen offset:1024 sc1
    v_accvgpr_read_b32 v152, a112
    v_accvgpr_read_b32 v153, a113
    v_accvgpr_read_b32 v154, a114
    v_accvgpr_read_b32 v155, a115
    v_accvgpr_read_b32 v156, a116
    v_accvgpr_read_b32 v157, a117
    v_accvgpr_read_b32 v158, a118
    v_accvgpr_read_b32 v159, a119
    v_mul_f32 v152, v2, v152
    v_mul_f32 v153, v2, v153
    v_mul_f32 v154, v2, v154
    v_mul_f32 v155, v2, v155
    v_mul_f32 v156, v2, v156
    v_mul_f32 v157, v2, v157
    v_mul_f32 v158, v2, v158
    v_mul_f32 v159, v2, v159
    v_cvt_pk_bf16_f32 v160, v152, v153
    v_cvt_pk_bf16_f32 v161, v154, v155
    v_cvt_pk_bf16_f32 v162, v156, v157
    v_cvt_pk_bf16_f32 v163, v158, v159
    buffer_store_dwordx4 v[160:163], v1, s[4:7], s20 offen offset:2048 sc1
    v_accvgpr_read_b32 v164, a120
    v_accvgpr_read_b32 v165, a121
    v_accvgpr_read_b32 v166, a122
    v_accvgpr_read_b32 v167, a123
    v_accvgpr_read_b32 v168, a124
    v_accvgpr_read_b32 v169, a125
    v_accvgpr_read_b32 v170, a126
    v_accvgpr_read_b32 v171, a127
    v_mul_f32 v164, v2, v164
    v_mul_f32 v165, v2, v165
    v_mul_f32 v166, v2, v166
    v_mul_f32 v167, v2, v167
    v_mul_f32 v168, v2, v168
    v_mul_f32 v169, v2, v169
    v_mul_f32 v170, v2, v170
    v_mul_f32 v171, v2, v171
    v_cvt_pk_bf16_f32 v172, v164, v165
    v_cvt_pk_bf16_f32 v173, v166, v167
    v_cvt_pk_bf16_f32 v174, v168, v169
    v_cvt_pk_bf16_f32 v175, v170, v171
    buffer_store_dwordx4 v[172:175], v1, s[4:7], s20 offen offset:3072 sc1
    s_branch L_A_tail
L_pj_end:
    s_endpgm
L_end_proj_kernel:
.text
.globl mix_kernel
.p2align 8
.type mix_kernel,@function
mix_kernel:
    s_cmp_ge_u32 s2, 256
    s_cbranch_scc1 L_mix_end
    v_lshrrev_b32 v3, 6, v0
    s_nop 0
    v_readfirstlane_b32 s21, v3
    s_cmp_ge_u32 s21, 8
    s_cbranch_scc1 L_mix_O
    s_lshr_b32 s3, s2, 3
    s_lshl_b32 s3, s3, 3
    s_add_u32 s3, s3, s21
    v_and_b32 v162, 63, v0
    v_mov_b32 v163, v0
    v_mov_b32 v0, v162
    s_getpc_b64 s[8:9]
L_pc_mx:
    s_add_u32 s8, s8, mix_kernel-L_pc_mx
    s_addc_u32 s9, s9, -1
    s_mul_i32 s10, s3, ((((L_end_mix_kernel-mix_kernel)>>7)+255)>>8)
    v_min_u32 v160, ((((L_end_mix_kernel-mix_kernel)>>7)+255)>>8)-1, v0
    v_add_u32 v160, s10, v160
    v_min_u32 v160, ((L_end_mix_kernel-mix_kernel)>>7)-1, v160
    v_lshlrev_b32 v160, 7, v160
    global_load_dword v161, v160, s[8:9]
    v_mov_b32 v0, v163
    s_load_dwordx2 s[12:13], s[0:1], 88
    v_lshrrev_b32 v7, 6, v0
    v_and_b32 v0, 63, v0
    s_nop 0
    v_readfirstlane_b32 s18, v7
    s_mov_b32 s20, s2
    s_and_b32 s19, s20, 7
    s_lshr_b32 s20, s20, 3
    s_and_b32 s17, s20, 7
    s_lshr_b32 s20, s20, 3
    s_lshl_b32 s16, s19, 2
    s_add_u32 s16, s16, s20
    s_waitcnt lgkmcnt(0)
    s_mov_b32 s4, s12
    s_mov_b32 s5, s13
    s_mov_b32 s6, 92274688
    s_mov_b32 s7, 0x00020000
    v_lshlrev_b32 v1, 4, v0
    s_mul_i32 s22, s16, 151552
    s_add_u32 s22, s22, 79691776
    s_lshl_b32 s19, s18, 11
    s_add_u32 s22, s22, s19
    s_mov_b32 s23, s19
    s_lshl_b32 s19, s18, 10
    s_sub_u32 s25, 16384, s19
    s_mov_b32 m0, s23
    s_cmp_ge_u32 s18, 3
    buffer_load_dwordx4 v1, s[4:7], s22 offen lds
    buffer_load_dwordx4 v1, s[4:7], s22 offen offset:1024 lds
    s_cbranch_scc1 L_B_dskip_p0
    s_add_u32 m0, s23, s25
    s_add_u32 s19, s22, s25
    buffer_load_dwordx4 v1, s[4:7], s19 offen lds
L_B_dskip_p0:
    s_add_u32 s22, s22, 18944
    s_add_u32 s23, s23, 19456
    s_cmp_ge_u32 s23, 58368
    s_cselect_b32 s19, 58368, 0
    s_sub_u32 s23, s23, s19
    s_lshl_b32 s31, s17, 3
    s_add_u32 s31, s31, s18
    s_lshl_b32 s19, s16, 6
    s_add_u32 s19, s19, s31
    s_lshl_b32 s20, s19, 10
    s_add_u32 s20, s20, 75497472
    buffer_load_dwordx4 v[12:15], v1, s[4:7], s20 offen
    v_and_b32 v7, 31, v0
    v_lshlrev_b32 v8, 2, v7
    s_lshl_b32 s20, s19, 7
    s_add_u32 s20, s20, 78643200
    buffer_load_dword v16, v8, s[4:7], s20 offen
    s_mov_b32 m0, s23
    s_cmp_ge_u32 s18, 3
    buffer_load_dwordx4 v1, s[4:7], s22 offen lds
    buffer_load_dwordx4 v1, s[4:7], s22 offen offset:1024 lds
    s_cbranch_scc1 L_B_dskip_p1
    s_add_u32 m0, s23, s25
    s_add_u32 s19, s22, s25
    buffer_load_dwordx4 v1, s[4:7], s19 offen lds
L_B_dskip_p1:
    s_add_u32 s22, s22, 18944
    s_add_u32 s23, s23, 19456
    s_cmp_ge_u32 s23, 58368
    s_cselect_b32 s19, 58368, 0
    s_sub_u32 s23, s23, s19
    v_cmp_gt_u32 s[28:29], 32, v0
    v_mov_b32 v2, v1
    v_lshlrev_b32 v3, 4, v7
    v_add_u32 v3, 8192, v3
    v_lshrrev_b32 v8, 5, v0
    v_mul_u32_u24 v8, 304, v8
    v_min_u32 v9, 18, v7
    v_lshl_add_u32 v4, v9, 4, v8
    v_add_u32 v4, 9216, v4
    v_add_u32 v5, 19456, v2
    v_add_u32 v6, 19456, v3
    s_mov_b32 s24, 19456
    v_mov_b32 v44, 0
    v_mov_b32 v45, 0
    v_mov_b32 v46, 0
    v_mov_b32 v47, 0
    v_mov_b32 v48, 0
    v_mov_b32 v49, 0
    v_mov_b32 v50, 0
    v_mov_b32 v51, 0
    v_mov_b32 v28, 0
    v_mov_b32 v29, 0
    v_mov_b32 v30, 0
    v_mov_b32 v31, 0
    v_mov_b32 v32, 0
    v_mov_b32 v33, 0
    v_mov_b32 v34, 0
    v_mov_b32 v35, 0
    v_mov_b32 v36, 0
    v_mov_b32 v37, 0
    v_mov_b32 v38, 0
    v_mov_b32 v39, 0
    v_mov_b32 v40, 0
    v_mov_b32 v41, 0
    v_mov_b32 v42, 0
    v_mov_b32 v43, 0
    v_and_b32 v10, 31, v0
    v_cmp_gt_u32 s[38:39], 19, v10
    v_mov_b32 v116, 0
    v_mov_b32 v117, 0
    v_mov_b32 v118, 0
    v_mov_b32 v119, 0
    v_mov_b32 v120, 0
    v_mov_b32 v121, 0
    v_mov_b32 v122, 0
    v_mov_b32 v123, 0
    v_mov_b32 v124, 0
    v_mov_b32 v125, 0
    v_mov_b32 v126, 0
    v_mov_b32 v127, 0
    v_mov_b32 v128, 0
    v_mov_b32 v129, 0
    v_mov_b32 v130, 0
    v_mov_b32 v131, 0
    v_mov_b32 v60, 0
    v_mov_b32 v61, 0
    v_mov_b32 v62, 0
    v_mov_b32 v63, 0
    v_mov_b32 v64, 0
    v_mov_b32 v65, 0
    v_mov_b32 v66, 0
    v_mov_b32 v67, 0
    s_mov_b32 s30, 1602224128
    s_waitcnt vmcnt(2)
    s_barrier
    v_cndmask_b32 v16, 0, v16, s[28:29]
    v_mov_b32 v17, 0
    v_mov_b32 v18, 0
    s_nop 0
    v_mov_b32 v19, v16
    ds_read_b128 v[20:23], v2 offset:0
    s_mov_b64 exec, s[28:29]
    ds_read_b128 v[28:31], v3 offset:0
    s_mov_b64 exec, -1
    ds_read_b128 v[24:27], v2 offset:1024
    s_waitcnt lgkmcnt(0)
    v_mfma_f32_32x32x8bf16_1k v[68:83], v[28:29], v[16:17], 0
    v_mfma_f32_32x32x16_bf16 v[68:83], v[20:23], v[12:15], v[68:83]
    s_nop 7
    s_nop 7
    v_max3_f32 v7, v68, v69, v70
    v_max3_f32 v7, v7, v71, v72
    v_max3_f32 v7, v7, v73, v74
    v_max3_f32 v7, v7, v75, v76
    v_max3_f32 v7, v7, v77, v78
    v_max3_f32 v7, v7, v79, v80
    v_max3_f32 v7, v7, v81, v82
    v_max_f32 v7, v7, v83
    v_mov_b32 v8, v7
    s_nop 1
    v_permlane32_swap_b32 v7, v8
    s_nop 1
    v_max_f32 v7, v7, v8
    v_add_f32 v7, 0x42c00000, v7
    v_sub_f32 v100, 0, v7
    v_sub_f32 v101, 0, v7
    v_sub_f32 v102, 0, v7
    v_sub_f32 v103, 0, v7
    v_sub_f32 v104, 0, v7
    v_sub_f32 v105, 0, v7
    v_sub_f32 v106, 0, v7
    v_sub_f32 v107, 0, v7
    v_sub_f32 v108, 0, v7
    v_sub_f32 v109, 0, v7
    v_sub_f32 v110, 0, v7
    v_sub_f32 v111, 0, v7
    v_sub_f32 v112, 0, v7
    v_sub_f32 v113, 0, v7
    v_sub_f32 v114, 0, v7
    v_sub_f32 v115, 0, v7
    v_sub_f32 v68, v68, v7
    v_sub_f32 v69, v69, v7
    v_sub_f32 v70, v70, v7
    v_sub_f32 v71, v71, v7
    v_sub_f32 v72, v72, v7
    v_sub_f32 v73, v73, v7
    v_sub_f32 v74, v74, v7
    v_sub_f32 v75, v75, v7
    v_sub_f32 v76, v76, v7
    v_sub_f32 v77, v77, v7
    v_sub_f32 v78, v78, v7
    v_sub_f32 v79, v79, v7
    v_sub_f32 v80, v80, v7
    v_sub_f32 v81, v81, v7
    v_sub_f32 v82, v82, v7
    v_sub_f32 v83, v83, v7
    s_mov_b32 s21, 0
L_B_loop:
    v_cmp_lt_f32 vcc, s30, v126
    s_cbranch_vccnz L_B_rare
L_B_rare_ret:
    s_waitcnt lgkmcnt(0)
    v_exp_f32 v68, v68
    v_mfma_f32_32x32x8bf16_1k v[84:99], v[28:29], v[18:19], v[100:115]
    v_exp_f32 v69, v69
    v_exp_f32 v70, v70
    v_exp_f32 v71, v71
    v_cvt_pk_bf16_f32 v52, v68, v69
    v_mfma_f32_32x32x16_bf16 v[84:99], v[24:27], v[12:15], v[84:99]
    v_exp_f32 v72, v72
    v_exp_f32 v73, v73
    v_cvt_pk_bf16_f32 v53, v70, v71
    ds_read_b128 v[20:23], v2 offset:2048
    v_exp_f32 v74, v74
    v_exp_f32 v75, v75
    v_cvt_pk_bf16_f32 v54, v72, v73
    v_mfma_f32_32x32x16_bf16 v[116:131], v[44:47], v[60:63], v[116:131]
    v_exp_f32 v76, v76
    v_exp_f32 v77, v77
    v_cvt_pk_bf16_f32 v55, v74, v75
    s_mov_b64 exec, s[38:39]
    ds_read_b128 v[36:39], v4 offset:0
    ds_read_b128 v[40:43], v4 offset:608
    s_mov_b64 exec, -1
    v_exp_f32 v78, v78
    v_exp_f32 v79, v79
    v_cvt_pk_bf16_f32 v56, v76, v77
    v_mfma_f32_32x32x16_bf16 v[116:131], v[48:51], v[64:67], v[116:131]
    v_exp_f32 v80, v80
    v_exp_f32 v81, v81
    v_cvt_pk_bf16_f32 v57, v78, v79
    v_exp_f32 v82, v82
    v_exp_f32 v83, v83
    v_cvt_pk_bf16_f32 v58, v80, v81
    v_cvt_pk_bf16_f32 v59, v82, v83
    s_waitcnt lgkmcnt(0)
    v_exp_f32 v84, v84
    v_mfma_f32_32x32x8bf16_1k v[68:83], v[30:31], v[16:17], v[100:115]
    v_exp_f32 v85, v85
    v_exp_f32 v86, v86
    v_exp_f32 v87, v87
    v_cvt_pk_bf16_f32 v60, v84, v85
    v_mfma_f32_32x32x16_bf16 v[68:83], v[20:23], v[12:15], v[68:83]
    v_exp_f32 v88, v88
    v_exp_f32 v89, v89
    v_cvt_pk_bf16_f32 v61, v86, v87
    ds_read_b128 v[24:27], v2 offset:3072
    v_exp_f32 v90, v90
    v_exp_f32 v91, v91
    v_cvt_pk_bf16_f32 v62, v88, v89
    v_mfma_f32_32x32x16_bf16 v[116:131], v[36:39], v[52:55], v[116:131]
    v_exp_f32 v92, v92
    v_exp_f32 v93, v93
    v_cvt_pk_bf16_f32 v63, v90, v91
    s_mov_b64 exec, s[38:39]
    ds_read_b128 v[44:47], v4 offset:1216
    ds_read_b128 v[48:51], v4 offset:1824
    s_mov_b64 exec, -1
    v_exp_f32 v94, v94
    v_exp_f32 v95, v95
    v_cvt_pk_bf16_f32 v64, v92, v93
    v_mfma_f32_32x32x16_bf16 v[116:131], v[40:43], v[56:59], v[116:131]
    v_exp_f32 v96, v96
    v_exp_f32 v97, v97
    v_cvt_pk_bf16_f32 v65, v94, v95
    v_exp_f32 v98, v98
    v_exp_f32 v99, v99
    v_cvt_pk_bf16_f32 v66, v96, v97
    v_cvt_pk_bf16_f32 v67, v98, v99
    s_waitcnt lgkmcnt(0)
    v_exp_f32 v68, v68
    v_mfma_f32_32x32x8bf16_1k v[84:99], v[30:31], v[18:19], v[100:115]
    v_exp_f32 v69, v69
    v_exp_f32 v70, v70
    v_exp_f32 v71, v71
    v_cvt_pk_bf16_f32 v52, v68, v69
    v_mfma_f32_32x32x16_bf16 v[84:99], v[24:27], v[12:15], v[84:99]
    v_exp_f32 v72, v72
    v_exp_f32 v73, v73
    v_cvt_pk_bf16_f32 v53, v70, v71
    ds_read_b128 v[20:23], v2 offset:4096
    s_mov_b64 exec, s[28:29]
    ds_read_b128 v[32:35], v3 offset:512
    s_mov_b64 exec, -1
    v_exp_f32 v74, v74
    v_exp_f32 v75, v75
    v_cvt_pk_bf16_f32 v54, v72, v73
    v_mfma_f32_32x32x16_bf16 v[116:131], v[44:47], v[60:63], v[116:131]
    v_exp_f32 v76, v76
    v_exp_f32 v77, v77
    v_cvt_pk_bf16_f32 v55, v74, v75
    s_mov_b64 exec, s[38:39]
    ds_read_b128 v[36:39], v4 offset:2432
    ds_read_b128 v[40:43], v4 offset:3040
    s_mov_b64 exec, -1
    v_exp_f32 v78, v78
    v_exp_f32 v79, v79
    v_cvt_pk_bf16_f32 v56, v76, v77
    v_mfma_f32_32x32x16_bf16 v[116:131], v[48:51], v[64:67], v[116:131]
    v_exp_f32 v80, v80
    v_exp_f32 v81, v81
    v_cvt_pk_bf16_f32 v57, v78, v79
    v_exp_f32 v82, v82
    v_exp_f32 v83, v83
    v_cvt_pk_bf16_f32 v58, v80, v81
    v_cvt_pk_bf16_f32 v59, v82, v83
    s_waitcnt lgkmcnt(0)
    v_exp_f32 v84, v84
    v_mfma_f32_32x32x8bf16_1k v[68:83], v[32:33], v[16:17], v[100:115]
    v_exp_f32 v85, v85
    v_exp_f32 v86, v86
    v_exp_f32 v87, v87
    v_cvt_pk_bf16_f32 v60, v84, v85
    v_mfma_f32_32x32x16_bf16 v[68:83], v[20:23], v[12:15], v[68:83]
    v_exp_f32 v88, v88
    v_exp_f32 v89, v89
    v_cvt_pk_bf16_f32 v61, v86, v87
    ds_read_b128 v[24:27], v2 offset:5120
    v_exp_f32 v90, v90
    v_exp_f32 v91, v91
    v_cvt_pk_bf16_f32 v62, v88, v89
    v_mfma_f32_32x32x16_bf16 v[116:131], v[36:39], v[52:55], v[116:131]
    v_exp_f32 v92, v92
    v_exp_f32 v93, v93
    v_cvt_pk_bf16_f32 v63, v90, v91
    s_mov_b64 exec, s[38:39]
    ds_read_b128 v[44:47], v4 offset:3648
    ds_read_b128 v[48:51], v4 offset:4256
    s_mov_b64 exec, -1
    v_exp_f32 v94, v94
    v_exp_f32 v95, v95
    v_cvt_pk_bf16_f32 v64, v92, v93
    v_mfma_f32_32x32x16_bf16 v[116:131], v[40:43], v[56:59], v[116:131]
    v_exp_f32 v96, v96
    v_exp_f32 v97, v97
    v_cvt_pk_bf16_f32 v65, v94, v95
    v_exp_f32 v98, v98
    v_exp_f32 v99, v99
    v_cvt_pk_bf16_f32 v66, v96, v97
    v_cvt_pk_bf16_f32 v67, v98, v99
    s_waitcnt lgkmcnt(0)
    v_exp_f32 v68, v68
    v_mfma_f32_32x32x8bf16_1k v[84:99], v[32:33], v[18:19], v[100:115]
    v_exp_f32 v69, v69
    v_exp_f32 v70, v70
    v_exp_f32 v71, v71
    v_cvt_pk_bf16_f32 v52, v68, v69
    v_mfma_f32_32x32x16_bf16 v[84:99], v[24:27], v[12:15], v[84:99]
    v_exp_f32 v72, v72
    v_exp_f32 v73, v73
    v_cvt_pk_bf16_f32 v53, v70, v71
    ds_read_b128 v[20:23], v2 offset:6144
    v_exp_f32 v74, v74
    v_exp_f32 v75, v75
    v_cvt_pk_bf16_f32 v54, v72, v73
    v_mfma_f32_32x32x16_bf16 v[116:131], v[44:47], v[60:63], v[116:131]
    v_exp_f32 v76, v76
    v_exp_f32 v77, v77
    v_cvt_pk_bf16_f32 v55, v74, v75
    s_mov_b64 exec, s[38:39]
    ds_read_b128 v[36:39], v4 offset:4864
    ds_read_b128 v[40:43], v4 offset:5472
    s_mov_b64 exec, -1
    v_exp_f32 v78, v78
    v_exp_f32 v79, v79
    v_cvt_pk_bf16_f32 v56, v76, v77
    v_mfma_f32_32x32x16_bf16 v[116:131], v[48:51], v[64:67], v[116:131]
    v_exp_f32 v80, v80
    v_exp_f32 v81, v81
    v_cvt_pk_bf16_f32 v57, v78, v79
    v_exp_f32 v82, v82
    v_exp_f32 v83, v83
    v_cvt_pk_bf16_f32 v58, v80, v81
    v_cvt_pk_bf16_f32 v59, v82, v83
    s_waitcnt lgkmcnt(0)
    v_exp_f32 v84, v84
    v_mfma_f32_32x32x8bf16_1k v[68:83], v[34:35], v[16:17], v[100:115]
    v_exp_f32 v85, v85
    v_exp_f32 v86, v86
    v_exp_f32 v87, v87
    v_cvt_pk_bf16_f32 v60, v84, v85
    v_mfma_f32_32x32x16_bf16 v[68:83], v[20:23], v[12:15], v[68:83]
    v_exp_f32 v88, v88
    v_exp_f32 v89, v89
    v_cvt_pk_bf16_f32 v61, v86, v87
    ds_read_b128 v[24:27], v2 offset:7168
    v_exp_f32 v90, v90
    v_exp_f32 v91, v91
    v_cvt_pk_bf16_f32 v62, v88, v89
    v_mfma_f32_32x32x16_bf16 v[116:131], v[36:39], v[52:55], v[116:131]
    v_exp_f32 v92, v92
    v_exp_f32 v93, v93
    v_cvt_pk_bf16_f32 v63, v90, v91
    s_mov_b64 exec, s[38:39]
    ds_read_b128 v[44:47], v4 offset:6080
    ds_read_b128 v[48:51], v4 offset:6688
    s_mov_b64 exec, -1
    v_exp_f32 v94, v94
    v_exp_f32 v95, v95
    v_cvt_pk_bf16_f32 v64, v92, v93
    v_mfma_f32_32x32x16_bf16 v[116:131], v[40:43], v[56:59], v[116:131]
    v_exp_f32 v96, v96
    v_exp_f32 v97, v97
    v_cvt_pk_bf16_f32 v65, v94, v95
    v_exp_f32 v98, v98
    v_exp_f32 v99, v99
    v_cvt_pk_bf16_f32 v66, v96, v97
    v_cvt_pk_bf16_f32 v67, v98, v99
    s_waitcnt vmcnt(0)
    s_barrier
    s_waitcnt lgkmcnt(0)
    v_exp_f32 v68, v68
    v_mfma_f32_32x32x8bf16_1k v[84:99], v[34:35], v[18:19], v[100:115]
    v_exp_f32 v69, v69
    v_exp_f32 v70, v70
    v_exp_f32 v71, v71
    v_cvt_pk_bf16_f32 v52, v68, v69
    v_mfma_f32_32x32x16_bf16 v[84:99], v[24:27], v[12:15], v[84:99]
    v_exp_f32 v72, v72
    v_exp_f32 v73, v73
    v_cvt_pk_bf16_f32 v53, v70, v71
    ds_read_b128 v[20:23], v5 offset:0
    s_mov_b64 exec, s[28:29]
    ds_read_b128 v[28:31], v6 offset:0
    s_mov_b64 exec, -1
    v_exp_f32 v74, v74
    v_exp_f32 v75, v75
    v_cvt_pk_bf16_f32 v54, v72, v73
    v_mfma_f32_32x32x16_bf16 v[116:131], v[44:47], v[60:63], v[116:131]
    v_exp_f32 v76, v76
    v_exp_f32 v77, v77
    v_cvt_pk_bf16_f32 v55, v74, v75
    s_mov_b64 exec, s[38:39]
    ds_read_b128 v[36:39], v4 offset:7296
    ds_read_b128 v[40:43], v4 offset:7904
    s_mov_b64 exec, -1
    v_exp_f32 v78, v78
    v_exp_f32 v79, v79
    v_cvt_pk_bf16_f32 v56, v76, v77
    v_mfma_f32_32x32x16_bf16 v[116:131], v[48:51], v[64:67], v[116:131]
    v_exp_f32 v80, v80
    v_exp_f32 v81, v81
    v_cvt_pk_bf16_f32 v57, v78, v79
    s_cmp_ge_u32 s21, 6
    s_cbranch_scc1 L_B_nodma
    s_mov_b32 m0, s23
    s_cmp_ge_u32 s18, 3
    buffer_load_dwordx4 v1, s[4:7], s22 offen lds
    buffer_load_dwordx4 v1, s[4:7], s22 offen offset:1024 lds
    s_cbranch_scc1 L_B_dskip_lp
    s_add_u32 m0, s23, s25
    s_add_u32 s19, s22, s25
    buffer_load_dwordx4 v1, s[4:7], s19 offen lds
L_B_dskip_lp:
    s_add_u32 s22, s22, 18944
    s_add_u32 s23, s23, 19456
    s_cmp_ge_u32 s23, 58368
    s_cselect_b32 s19, 58368, 0
    s_sub_u32 s23, s23, s19
L_B_nodma:
    v_exp_f32 v82, v82
    v_exp_f32 v83, v83
    v_cvt_pk_bf16_f32 v58, v80, v81
    v_cvt_pk_bf16_f32 v59, v82, v83
    s_waitcnt lgkmcnt(0)
    v_exp_f32 v84, v84
    v_mfma_f32_32x32x8bf16_1k v[68:83], v[28:29], v[16:17], v[100:115]
    v_exp_f32 v85, v85
    v_exp_f32 v86, v86
    v_exp_f32 v87, v87
    v_cvt_pk_bf16_f32 v60, v84, v85
    v_mfma_f32_32x32x16_bf16 v[68:83], v[20:23], v[12:15], v[68:83]
    v_exp_f32 v88, v88
    v_exp_f32 v89, v89
    v_cvt_pk_bf16_f32 v61, v86, v87
    ds_read_b128 v[24:27], v5 offset:1024
    v_exp_f32 v90, v90
    v_exp_f32 v91, v91
    v_cvt_pk_bf16_f32 v62, v88, v89
    v_mfma_f32_32x32x16_bf16 v[116:131], v[36:39], v[52:55], v[116:131]
    v_exp_f32 v92, v92
    v_exp_f32 v93, v93
    v_cvt_pk_bf16_f32 v63, v90, v91
    s_mov_b64 exec, s[38:39]
    ds_read_b128 v[44:47], v4 offset:8512
    ds_read_b128 v[48:51], v4 offset:9120
    s_mov_b64 exec, -1
    v_exp_f32 v94, v94
    v_exp_f32 v95, v95
    v_cvt_pk_bf16_f32 v64, v92, v93
    v_mfma_f32_32x32x16_bf16 v[116:131], v[40:43], v[56:59], v[116:131]
    v_exp_f32 v96, v96
    v_exp_f32 v97, v97
    v_cvt_pk_bf16_f32 v65, v94, v95
    v_exp_f32 v98, v98
    v_exp_f32 v99, v99
    v_cvt_pk_bf16_f32 v66, v96, v97
    v_cvt_pk_bf16_f32 v67, v98, v99
    s_add_u32 s24, s24, 19456
    s_cmp_ge_u32 s24, 58368
    s_cselect_b32 s19, 58368, 0
    s_sub_u32 s24, s24, s19
    s_sub_u32 s19, 19456, s19
    v_sub_u32 v7, v5, v2
    v_add_u32 v4, v4, v7
    v_mov_b32 v2, v5
    v_mov_b32 v3, v6
    v_add_u32 v5, s19, v5
    v_add_u32 v6, s19, v6
    s_add_u32 s21, s21, 1
    s_cmp_lt_u32 s21, 8
    s_cbranch_scc1 L_B_loop
    v_mfma_f32_32x32x16_bf16 v[116:131], v[44:47], v[60:63], v[116:131]
    v_mfma_f32_32x32x16_bf16 v[116:131], v[48:51], v[64:67], v[116:131]
    s_nop 7
    s_nop 7
    v_mov_b32 v7, 0
    v_fma_f32 v7, v116, 0, v7
    v_fma_f32 v7, v117, 0, v7
    v_fma_f32 v7, v118, 0, v7
    v_fma_f32 v7, v119, 0, v7
    v_fma_f32 v7, v120, 0, v7
    v_fma_f32 v7, v121, 0, v7
    v_fma_f32 v7, v122, 0, v7
    v_fma_f32 v7, v123, 0, v7
    v_fma_f32 v7, v124, 0, v7
    v_fma_f32 v7, v125, 0, v7
    v_fma_f32 v7, v126, 0, v7
    v_cmp_u_f32 vcc, v7, v7
    s_cbranch_vccnz L_B_slow
L_B_epi:
    v_lshlrev_b32 v10, 4, v0
    v_and_b32 v10, 0x1ff, v10
    s_lshr_b32 s19, s16, 3
    s_add_u32 s19, s19, 32
    s_lshl_b32 s19, s19, 10
    s_lshr_b32 s20, s16, 2
    s_and_b32 s20, s20, 1
    s_lshl_b32 s20, s20, 9
    s_add_u32 s19, s19, s20
    s_and_b32 s20, s16, 3
    s_lshl_b32 s20, s20, 2
    s_add_u32 s19, s19, s20
    s_mul_i32 s20, s31, 36864
    s_add_u32 s20, s20, 88080384
    s_add_u32 s22, s20, s19
    s_lshl_b32 s19, s16, 10
    s_add_u32 s23, s20, s19
    v_mov_b32 v7, v126
    v_mov_b32 v8, v126
    s_nop 1
    v_permlane32_swap_b32 v7, v8
    s_nop 1
    v_rcp_f32 v7, v7
    s_nop 0
    v_mul_f32 v116, v7, v116
    v_mul_f32 v117, v7, v117
    v_mul_f32 v118, v7, v118
    v_mul_f32 v119, v7, v119
    v_mul_f32 v120, v7, v120
    v_mul_f32 v121, v7, v121
    v_mul_f32 v122, v7, v122
    v_mul_f32 v123, v7, v123
    v_mul_f32 v124, v7, v124
    v_mul_f32 v125, v7, v125
    v_cvt_pk_bf16_f32 v52, v116, v117
    v_cvt_pk_bf16_f32 v53, v118, v119
    v_cvt_pk_bf16_f32 v54, v120, v121
    v_cvt_pk_bf16_f32 v55, v122, v123
    v_cvt_pk_bf16_f32 v56, v124, v125
    buffer_store_dwordx4 v[52:55], v1, s[4:7], s23 offen sc1
    s_mov_b64 exec, s[28:29]
    buffer_store_dword v56, v10, s[4:7], s22 offen sc1
    s_mov_b64 exec, -1
    s_endpgm
L_B_rare:
    s_nop 7
    s_nop 7
    v_frexp_exp_i32_f32 v7, v126
    v_add_u32 v7, 0x60, v7
    v_max_i32 v7, 0, v7
    v_mov_b32 v9, v7
    s_nop 1
    v_permlane32_swap_b32 v7, v9
    s_nop 1
    v_cvt_f32_i32 v9, v7
    v_sub_u32 v8, 0, v7
    v_ldexp_f32 v116, v116, v8
    v_ldexp_f32 v117, v117, v8
    v_ldexp_f32 v118, v118, v8
    v_ldexp_f32 v119, v119, v8
    v_ldexp_f32 v120, v120, v8
    v_ldexp_f32 v121, v121, v8
    v_ldexp_f32 v122, v122, v8
    v_ldexp_f32 v123, v123, v8
    v_ldexp_f32 v124, v124, v8
    v_ldexp_f32 v125, v125, v8
    v_ldexp_f32 v126, v126, v8
    v_ldexp_f32 v127, v127, v8
    v_ldexp_f32 v128, v128, v8
    v_ldexp_f32 v129, v129, v8
    v_ldexp_f32 v130, v130, v8
    v_ldexp_f32 v131, v131, v8
    v_sub_f32 v100, v100, v9
    v_sub_f32 v101, v101, v9
    v_sub_f32 v102, v102, v9
    v_sub_f32 v103, v103, v9
    v_sub_f32 v104, v104, v9
    v_sub_f32 v105, v105, v9
    v_sub_f32 v106, v106, v9
    v_sub_f32 v107, v107, v9
    v_sub_f32 v108, v108, v9
    v_sub_f32 v109, v109, v9
    v_sub_f32 v110, v110, v9
    v_sub_f32 v111, v111, v9
    v_sub_f32 v112, v112, v9
    v_sub_f32 v113, v113, v9
    v_sub_f32 v114, v114, v9
    v_sub_f32 v115, v115, v9
    v_sub_f32 v68, v68, v9
    v_sub_f32 v69, v69, v9
    v_sub_f32 v70, v70, v9
    v_sub_f32 v71, v71, v9
    v_sub_f32 v72, v72, v9
    v_sub_f32 v73, v73, v9
    v_sub_f32 v74, v74, v9
    v_sub_f32 v75, v75, v9
    v_sub_f32 v76, v76, v9
    v_sub_f32 v77, v77, v9
    v_sub_f32 v78, v78, v9
    v_sub_f32 v79, v79, v9
    v_sub_f32 v80, v80, v9
    v_sub_f32 v81, v81, v9
    v_sub_f32 v82, v82, v9
    v_sub_f32 v83, v83, v9
    v_lshlrev_b32 v9, 16, v60
    v_and_b32 v10, 0xffff0000, v60
    v_ldexp_f32 v9, v9, v8
    v_ldexp_f32 v10, v10, v8
    v_cvt_pk_bf16_f32 v60, v9, v10
    v_lshlrev_b32 v9, 16, v61
    v_and_b32 v10, 0xffff0000, v61
    v_ldexp_f32 v9, v9, v8
    v_ldexp_f32 v10, v10, v8
    v_cvt_pk_bf16_f32 v61, v9, v10
    v_lshlrev_b32 v9, 16, v62
    v_and_b32 v10, 0xffff0000, v62
    v_ldexp_f32 v9, v9, v8
    v_ldexp_f32 v10, v10, v8
    v_cvt_pk_bf16_f32 v62, v9, v10
    v_lshlrev_b32 v9, 16, v63
    v_and_b32 v10, 0xffff0000, v63
    v_ldexp_f32 v9, v9, v8
    v_ldexp_f32 v10, v10, v8
    v_cvt_pk_bf16_f32 v63, v9, v10
    v_lshlrev_b32 v9, 16, v64
    v_and_b32 v10, 0xffff0000, v64
    v_ldexp_f32 v9, v9, v8
    v_ldexp_f32 v10, v10, v8
    v_cvt_pk_bf16_f32 v64, v9, v10
    v_lshlrev_b32 v9, 16, v65
    v_and_b32 v10, 0xffff0000, v65
    v_ldexp_f32 v9, v9, v8
    v_ldexp_f32 v10, v10, v8
    v_cvt_pk_bf16_f32 v65, v9, v10
    v_lshlrev_b32 v9, 16, v66
    v_and_b32 v10, 0xffff0000, v66
    v_ldexp_f32 v9, v9, v8
    v_ldexp_f32 v10, v10, v8
    v_cvt_pk_bf16_f32 v66, v9, v10
    v_lshlrev_b32 v9, 16, v67
    v_and_b32 v10, 0xffff0000, v67
    v_ldexp_f32 v9, v9, v8
    v_ldexp_f32 v10, v10, v8
    v_cvt_pk_bf16_f32 v67, v9, v10
    s_nop 1
    s_branch L_B_rare_ret
L_B_slow:
    v_and_b32 v7, 31, v0
    v_lshlrev_b32 v105, 4, v7
    v_add_u32 v105, 8192, v105
    v_lshrrev_b32 v8, 5, v0
    v_mul_u32_u24 v8, 304, v8
    v_min_u32 v9, 18, v7
    v_lshl_add_u32 v104, v9, 4, v8
    v_add_u32 v104, 9216, v104
    v_mov_b32 v100, 0xff7fffff
    v_mov_b32 v29, 0
    v_mov_b32 v116, 0
    v_mov_b32 v117, 0
    v_mov_b32 v118, 0
    v_mov_b32 v119, 0
    v_mov_b32 v120, 0
    v_mov_b32 v121, 0
    v_mov_b32 v122, 0
    v_mov_b32 v123, 0
    v_mov_b32 v124, 0
    v_mov_b32 v125, 0
    v_mov_b32 v126, 0
    v_mov_b32 v127, 0
    v_mov_b32 v128, 0
    v_mov_b32 v129, 0
    v_mov_b32 v130, 0
    v_mov_b32 v131, 0
    s_mov_b32 s21, 0
L_B_slow_loop:
    s_mul_i32 s22, s16, 151552
    s_add_u32 s22, s22, 79691776
    s_lshr_b32 s19, s21, 3
    s_mul_i32 s19, s19, 18944
    s_add_u32 s22, s22, s19
    s_and_b32 s19, s21, 7
    s_lshr_b32 s20, s19, 2
    s_lshl_b32 s20, s20, 9
    s_add_u32 s23, s22, s20
    s_and_b32 s20, s19, 3
    s_lshl_b32 s20, s20, 2
    s_add_u32 s23, s23, s20
    s_mul_i32 s20, s19, 1216
    s_add_u32 s24, s22, s20
    s_lshl_b32 s19, s19, 10
    s_add_u32 s22, s22, s19
    buffer_load_dwordx4 v[20:23], v1, s[4:7], s22 offen
    buffer_load_dword v28, v105, s[4:7], s23 offen
    buffer_load_dwordx4 v[36:39], v104, s[4:7], s24 offen
    buffer_load_dwordx4 v[40:43], v104, s[4:7], s24 offen offset:608
    s_waitcnt vmcnt(0)
    v_mfma_f32_32x32x8bf16_1k v[68:83], v[28:29], v[16:17], 0
    v_mfma_f32_32x32x16_bf16 v[68:83], v[20:23], v[12:15], v[68:83]
    s_nop 7
    s_nop 7
    v_max3_f32 v103, v68, v69, v70
    v_max3_f32 v103, v103, v71, v72
    v_max3_f32 v103, v103, v73, v74
    v_max3_f32 v103, v103, v75, v76
    v_max3_f32 v103, v103, v77, v78
    v_max3_f32 v103, v103, v79, v80
    v_max3_f32 v103, v103, v81, v82
    v_max3_f32 v103, v103, v83, v100
    v_mov_b32 v8, v103
    s_nop 1
    v_permlane32_swap_b32 v103, v8
    s_nop 1
    v_max_f32 v103, v103, v8
    v_sub_f32 v102, v100, v103
    v_exp_f32 v102, v102
    v_mov_b32 v100, v103
    v_sub_f32 v68, v68, v103
    v_sub_f32 v69, v69, v103
    v_sub_f32 v70, v70, v103
    v_sub_f32 v71, v71, v103
    v_sub_f32 v72, v72, v103
    v_sub_f32 v73, v73, v103
    v_sub_f32 v74, v74, v103
    v_sub_f32 v75, v75, v103
    v_sub_f32 v76, v76, v103
    v_sub_f32 v77, v77, v103
    v_sub_f32 v78, v78, v103
    v_sub_f32 v79, v79, v103
    v_sub_f32 v80, v80, v103
    v_sub_f32 v81, v81, v103
    v_sub_f32 v82, v82, v103
    v_sub_f32 v83, v83, v103
    v_exp_f32 v68, v68
    v_exp_f32 v69, v69
    v_exp_f32 v70, v70
    v_exp_f32 v71, v71
    v_exp_f32 v72, v72
    v_exp_f32 v73, v73
    v_exp_f32 v74, v74
    v_exp_f32 v75, v75
    v_exp_f32 v76, v76
    v_exp_f32 v77, v77
    v_exp_f32 v78, v78
    v_exp_f32 v79, v79
    v_exp_f32 v80, v80
    v_exp_f32 v81, v81
    v_exp_f32 v82, v82
    v_exp_f32 v83, v83
    v_mul_f32 v116, v102, v116
    v_mul_f32 v117, v102, v117
    v_mul_f32 v118, v102, v118
    v_mul_f32 v119, v102, v119
    v_mul_f32 v120, v102, v120
    v_mul_f32 v121, v102, v121
    v_mul_f32 v122, v102, v122
    v_mul_f32 v123, v102, v123
    v_mul_f32 v124, v102, v124
    v_mul_f32 v125, v102, v125
    v_mul_f32 v126, v102, v126
    v_mul_f32 v127, v102, v127
    v_mul_f32 v128, v102, v128
    v_mul_f32 v129, v102, v129
    v_mul_f32 v130, v102, v130
    v_mul_f32 v131, v102, v131
    v_cvt_pk_bf16_f32 v52, v68, v69
    v_cvt_pk_bf16_f32 v53, v70, v71
    v_cvt_pk_bf16_f32 v54, v72, v73
    v_cvt_pk_bf16_f32 v55, v74, v75
    v_cvt_pk_bf16_f32 v56, v76, v77
    v_cvt_pk_bf16_f32 v57, v78, v79
    v_cvt_pk_bf16_f32 v58, v80, v81
    v_cvt_pk_bf16_f32 v59, v82, v83
    s_nop 1
    v_mfma_f32_32x32x16_bf16 v[116:131], v[36:39], v[52:55], v[116:131]
    v_mfma_f32_32x32x16_bf16 v[116:131], v[40:43], v[56:59], v[116:131]
    s_nop 7
    s_nop 7
    s_add_u32 s21, s21, 1
    s_cmp_lt_u32 s21, 64
    s_cbranch_scc1 L_B_slow_loop
    s_branch L_B_epi
L_mix_O:
    s_cmp_ge_u32 s2, 192
    s_cbranch_scc1 L_mix_W
    s_sub_u32 s21, s21, 8
    v_and_b32 v0, 63, v0
    s_load_dwordx2 s[12:13], s[0:1], 88
    s_load_dwordx2 s[14:15], s[0:1], 72
    v_lshlrev_b32 v1, 4, v0
    v_and_b32 v3, 31, v0
    v_mul_u32_u24 v2, 2304, v3
    v_lshrrev_b32 v3, 5, v0
    v_lshl_add_u32 v2, v3, 3, v2
    s_and_b32 s19, s2, 7
    s_lshr_b32 s20, s2, 3
    s_and_b32 s22, s20, 3
    s_lshl_b32 s19, s19, 2
    s_add_u32 s22, s22, s19
    s_lshr_b32 s23, s20, 2
    s_waitcnt lgkmcnt(0)
    s_mov_b32 s4, s12
    s_mov_b32 s5, s13
    s_mov_b32 s6, 92274688
    s_mov_b32 s7, 0x00020000
    s_mov_b32 s8, s14
    s_mov_b32 s9, s15
    s_mov_b32 s10, 4718592
    s_mov_b32 s11, 0x00020000
    s_lshl_b32 s16, s22, 19
    s_lshl_b32 s19, s21, 16
    s_add_u32 s16, s16, s19
    s_add_u32 s16, s16, 50331648
    s_add_u32 s17, s16, 262144
    s_mul_i32 s18, s21, 1179648
    s_mul_i32 s19, s23, 3072
    s_add_u32 s18, s18, s19
    s_add_u32 s18, s18, 67108864
    s_setprio 0
    buffer_load_dwordx4 v[106:109], v1, s[4:7], s16 offen
    buffer_load_dwordx4 v[110:113], v1, s[4:7], s17 offen
    buffer_load_dwordx4 v[114:117], v1, s[4:7], s18 offen
    buffer_load_dwordx4 v[118:121], v1, s[4:7], s18 offen offset:1024
    buffer_load_dwordx4 v[122:125], v1, s[4:7], s18 offen offset:2048
    s_add_u32 s16, s16, 1024
    s_add_u32 s17, s17, 1024
    s_add_u32 s18, s18, 18432
    buffer_load_dwordx4 v[126:129], v1, s[4:7], s16 offen
    buffer_load_dwordx4 v[130:133], v1, s[4:7], s17 offen
    buffer_load_dwordx4 v[134:137], v1, s[4:7], s18 offen
    buffer_load_dwordx4 v[138:141], v1, s[4:7], s18 offen offset:1024
    buffer_load_dwordx4 v[142:145], v1, s[4:7], s18 offen offset:2048
    s_add_u32 s16, s16, 1024
    s_add_u32 s17, s17, 1024
    s_add_u32 s18, s18, 18432
    buffer_load_dwordx4 v[146:149], v1, s[4:7], s16 offen
    buffer_load_dwordx4 v[150:153], v1, s[4:7], s17 offen
    buffer_load_dwordx4 v[154:157], v1, s[4:7], s18 offen
    buffer_load_dwordx4 v[158:161], v1, s[4:7], s18 offen offset:1024
    buffer_load_dwordx4 v[162:165], v1, s[4:7], s18 offen offset:2048
    s_add_u32 s16, s16, 1024
    s_add_u32 s17, s17, 1024
    s_add_u32 s18, s18, 18432
    s_barrier
    s_waitcnt vmcnt(10)
    v_mfma_f32_32x32x16_bf16 v[10:25], v[114:117], v[106:109], 0
    v_mfma_f32_32x32x16_bf16 v[26:41], v[118:121], v[106:109], 0
    v_mfma_f32_32x32x16_bf16 v[42:57], v[122:125], v[106:109], 0
    v_mfma_f32_32x32x16_bf16 v[58:73], v[114:117], v[110:113], 0
    v_mfma_f32_32x32x16_bf16 v[74:89], v[118:121], v[110:113], 0
    v_mfma_f32_32x32x16_bf16 v[90:105], v[122:125], v[110:113], 0
    buffer_load_dwordx4 v[106:109], v1, s[4:7], s16 offen
    buffer_load_dwordx4 v[110:113], v1, s[4:7], s17 offen
    buffer_load_dwordx4 v[114:117], v1, s[4:7], s18 offen
    buffer_load_dwordx4 v[118:121], v1, s[4:7], s18 offen offset:1024
    buffer_load_dwordx4 v[122:125], v1, s[4:7], s18 offen offset:2048
    s_add_u32 s16, s16, 1024
    s_add_u32 s17, s17, 1024
    s_add_u32 s18, s18, 18432
    s_waitcnt vmcnt(10)
    v_mfma_f32_32x32x16_bf16 v[10:25], v[134:137], v[126:129], v[10:25]
    v_mfma_f32_32x32x16_bf16 v[26:41], v[138:141], v[126:129], v[26:41]
    v_mfma_f32_32x32x16_bf16 v[42:57], v[142:145], v[126:129], v[42:57]
    v_mfma_f32_32x32x16_bf16 v[58:73], v[134:137], v[130:133], v[58:73]
    v_mfma_f32_32x32x16_bf16 v[74:89], v[138:141], v[130:133], v[74:89]
    v_mfma_f32_32x32x16_bf16 v[90:105], v[142:145], v[130:133], v[90:105]
    buffer_load_dwordx4 v[126:129], v1, s[4:7], s16 offen
    buffer_load_dwordx4 v[130:133], v1, s[4:7], s17 offen
    buffer_load_dwordx4 v[134:137], v1, s[4:7], s18 offen
    buffer_load_dwordx4 v[138:141], v1, s[4:7], s18 offen offset:1024
    buffer_load_dwordx4 v[142:145], v1, s[4:7], s18 offen offset:2048
    s_add_u32 s16, s16, 1024
    s_add_u32 s17, s17, 1024
    s_add_u32 s18, s18, 18432
    s_waitcnt vmcnt(10)
    v_mfma_f32_32x32x16_bf16 v[10:25], v[154:157], v[146:149], v[10:25]
    v_mfma_f32_32x32x16_bf16 v[26:41], v[158:161], v[146:149], v[26:41]
    v_mfma_f32_32x32x16_bf16 v[42:57], v[162:165], v[146:149], v[42:57]
    v_mfma_f32_32x32x16_bf16 v[58:73], v[154:157], v[150:153], v[58:73]
    v_mfma_f32_32x32x16_bf16 v[74:89], v[158:161], v[150:153], v[74:89]
    v_mfma_f32_32x32x16_bf16 v[90:105], v[162:165], v[150:153], v[90:105]
    buffer_load_dwordx4 v[146:149], v1, s[4:7], s16 offen
    buffer_load_dwordx4 v[150:153], v1, s[4:7], s17 offen
    buffer_load_dwordx4 v[154:157], v1, s[4:7], s18 offen
    buffer_load_dwordx4 v[158:161], v1, s[4:7], s18 offen offset:1024
    buffer_load_dwordx4 v[162:165], v1, s[4:7], s18 offen offset:2048
    s_add_u32 s16, s16, 1024
    s_add_u32 s17, s17, 1024
    s_add_u32 s18, s18, 18432
    s_waitcnt vmcnt(10)
    v_mfma_f32_32x32x16_bf16 v[10:25], v[114:117], v[106:109], v[10:25]
    v_mfma_f32_32x32x16_bf16 v[26:41], v[118:121], v[106:109], v[26:41]
    v_mfma_f32_32x32x16_bf16 v[42:57], v[122:125], v[106:109], v[42:57]
    v_mfma_f32_32x32x16_bf16 v[58:73], v[114:117], v[110:113], v[58:73]
    v_mfma_f32_32x32x16_bf16 v[74:89], v[118:121], v[110:113], v[74:89]
    v_mfma_f32_32x32x16_bf16 v[90:105], v[122:125], v[110:113], v[90:105]
    buffer_load_dwordx4 v[106:109], v1, s[4:7], s16 offen
    buffer_load_dwordx4 v[110:113], v1, s[4:7], s17 offen
    buffer_load_dwordx4 v[114:117], v1, s[4:7], s18 offen
    buffer_load_dwordx4 v[118:121], v1, s[4:7], s18 offen offset:1024
    buffer_load_dwordx4 v[122:125], v1, s[4:7], s18 offen offset:2048
    s_add_u32 s16, s16, 1024
    s_add_u32 s17, s17, 1024
    s_add_u32 s18, s18, 18432
    s_waitcnt vmcnt(10)
    v_mfma_f32_32x32x16_bf16 v[10:25], v[134:137], v[126:129], v[10:25]
    v_mfma_f32_32x32x16_bf16 v[26:41], v[138:141], v[126:129], v[26:41]
    v_mfma_f32_32x32x16_bf16 v[42:57], v[142:145], v[126:129], v[42:57]
    v_mfma_f32_32x32x16_bf16 v[58:73], v[134:137], v[130:133], v[58:73]
    v_mfma_f32_32x32x16_bf16 v[74:89], v[138:141], v[130:133], v[74:89]
    v_mfma_f32_32x32x16_bf16 v[90:105], v[142:145], v[130:133], v[90:105]
    buffer_load_dwordx4 v[126:129], v1, s[4:7], s16 offen
    buffer_load_dwordx4 v[130:133], v1, s[4:7], s17 offen
    buffer_load_dwordx4 v[134:137], v1, s[4:7], s18 offen
    buffer_load_dwordx4 v[138:141], v1, s[4:7], s18 offen offset:1024
    buffer_load_dwordx4 v[142:145], v1, s[4:7], s18 offen offset:2048
    s_add_u32 s16, s16, 1024
    s_add_u32 s17, s17, 1024
    s_add_u32 s18, s18, 18432
    s_waitcnt vmcnt(10)
    v_mfma_f32_32x32x16_bf16 v[10:25], v[154:157], v[146:149], v[10:25]
    v_mfma_f32_32x32x16_bf16 v[26:41], v[158:161], v[146:149], v[26:41]
    v_mfma_f32_32x32x16_bf16 v[42:57], v[162:165], v[146:149], v[42:57]
    v_mfma_f32_32x32x16_bf16 v[58:73], v[154:157], v[150:153], v[58:73]
    v_mfma_f32_32x32x16_bf16 v[74:89], v[158:161], v[150:153], v[74:89]
    v_mfma_f32_32x32x16_bf16 v[90:105], v[162:165], v[150:153], v[90:105]
    buffer_load_dwordx4 v[146:149], v1, s[4:7], s16 offen
    buffer_load_dwordx4 v[150:153], v1, s[4:7], s17 offen
    buffer_load_dwordx4 v[154:157], v1, s[4:7], s18 offen
    buffer_load_dwordx4 v[158:161], v1, s[4:7], s18 offen offset:1024
    buffer_load_dwordx4 v[162:165], v1, s[4:7], s18 offen offset:2048
    s_add_u32 s16, s16, 1024
    s_add_u32 s17, s17, 1024
    s_add_u32 s18, s18, 18432
    s_waitcnt vmcnt(10)
    v_mfma_f32_32x32x16_bf16 v[10:25], v[114:117], v[106:109], v[10:25]
    v_mfma_f32_32x32x16_bf16 v[26:41], v[118:121], v[106:109], v[26:41]
    v_mfma_f32_32x32x16_bf16 v[42:57], v[122:125], v[106:109], v[42:57]
    v_mfma_f32_32x32x16_bf16 v[58:73], v[114:117], v[110:113], v[58:73]
    v_mfma_f32_32x32x16_bf16 v[74:89], v[118:121], v[110:113], v[74:89]
    v_mfma_f32_32x32x16_bf16 v[90:105], v[122:125], v[110:113], v[90:105]
    buffer_load_dwordx4 v[106:109], v1, s[4:7], s16 offen
    buffer_load_dwordx4 v[110:113], v1, s[4:7], s17 offen
    buffer_load_dwordx4 v[114:117], v1, s[4:7], s18 offen
    buffer_load_dwordx4 v[118:121], v1, s[4:7], s18 offen offset:1024
    buffer_load_dwordx4 v[122:125], v1, s[4:7], s18 offen offset:2048
    s_add_u32 s16, s16, 1024
    s_add_u32 s17, s17, 1024
    s_add_u32 s18, s18, 18432
    s_waitcnt vmcnt(10)
    v_mfma_f32_32x32x16_bf16 v[10:25], v[134:137], v[126:129], v[10:25]
    v_mfma_f32_32x32x16_bf16 v[26:41], v[138:141], v[126:129], v[26:41]
    v_mfma_f32_32x32x16_bf16 v[42:57], v[142:145], v[126:129], v[42:57]
    v_mfma_f32_32x32x16_bf16 v[58:73], v[134:137], v[130:133], v[58:73]
    v_mfma_f32_32x32x16_bf16 v[74:89], v[138:141], v[130:133], v[74:89]
    v_mfma_f32_32x32x16_bf16 v[90:105], v[142:145], v[130:133], v[90:105]
    buffer_load_dwordx4 v[126:129], v1, s[4:7], s16 offen
    buffer_load_dwordx4 v[130:133], v1, s[4:7], s17 offen
    buffer_load_dwordx4 v[134:137], v1, s[4:7], s18 offen
    buffer_load_dwordx4 v[138:141], v1, s[4:7], s18 offen offset:1024
    buffer_load_dwordx4 v[142:145], v1, s[4:7], s18 offen offset:2048
    s_add_u32 s16, s16, 1024
    s_add_u32 s17, s17, 1024
    s_add_u32 s18, s18, 18432
    s_barrier
    s_waitcnt vmcnt(10)
    v_mfma_f32_32x32x16_bf16 v[10:25], v[154:157], v[146:149], v[10:25]
    v_mfma_f32_32x32x16_bf16 v[26:41], v[158:161], v[146:149], v[26:41]
    v_mfma_f32_32x32x16_bf16 v[42:57], v[162:165], v[146:149], v[42:57]
    v_mfma_f32_32x32x16_bf16 v[58:73], v[154:157], v[150:153], v[58:73]
    v_mfma_f32_32x32x16_bf16 v[74:89], v[158:161], v[150:153], v[74:89]
    v_mfma_f32_32x32x16_bf16 v[90:105], v[162:165], v[150:153], v[90:105]
    buffer_load_dwordx4 v[146:149], v1, s[4:7], s16 offen
    buffer_load_dwordx4 v[150:153], v1, s[4:7], s17 offen
    buffer_load_dwordx4 v[154:157], v1, s[4:7], s18 offen
    buffer_load_dwordx4 v[158:161], v1, s[4:7], s18 offen offset:1024
    buffer_load_dwordx4 v[162:165], v1, s[4:7], s18 offen offset:2048
    s_add_u32 s16, s16, 1024
    s_add_u32 s17, s17, 1024
    s_add_u32 s18, s18, 18432
    s_waitcnt vmcnt(10)
    v_mfma_f32_32x32x16_bf16 v[10:25], v[114:117], v[106:109], v[10:25]
    v_mfma_f32_32x32x16_bf16 v[26:41], v[118:121], v[106:109], v[26:41]
    v_mfma_f32_32x32x16_bf16 v[42:57], v[122:125], v[106:109], v[42:57]
    v_mfma_f32_32x32x16_bf16 v[58:73], v[114:117], v[110:113], v[58:73]
    v_mfma_f32_32x32x16_bf16 v[74:89], v[118:121], v[110:113], v[74:89]
    v_mfma_f32_32x32x16_bf16 v[90:105], v[122:125], v[110:113], v[90:105]
    buffer_load_dwordx4 v[106:109], v1, s[4:7], s16 offen
    buffer_load_dwordx4 v[110:113], v1, s[4:7], s17 offen
    buffer_load_dwordx4 v[114:117], v1, s[4:7], s18 offen
    buffer_load_dwordx4 v[118:121], v1, s[4:7], s18 offen offset:1024
    buffer_load_dwordx4 v[122:125], v1, s[4:7], s18 offen offset:2048
    s_add_u32 s16, s16, 1024
    s_add_u32 s17, s17, 1024
    s_add_u32 s18, s18, 18432
    s_waitcnt vmcnt(10)
    v_mfma_f32_32x32x16_bf16 v[10:25], v[134:137], v[126:129], v[10:25]
    v_mfma_f32_32x32x16_bf16 v[26:41], v[138:141], v[126:129], v[26:41]
    v_mfma_f32_32x32x16_bf16 v[42:57], v[142:145], v[126:129], v[42:57]
    v_mfma_f32_32x32x16_bf16 v[58:73], v[134:137], v[130:133], v[58:73]
    v_mfma_f32_32x32x16_bf16 v[74:89], v[138:141], v[130:133], v[74:89]
    v_mfma_f32_32x32x16_bf16 v[90:105], v[142:145], v[130:133], v[90:105]
    buffer_load_dwordx4 v[126:129], v1, s[4:7], s16 offen
    buffer_load_dwordx4 v[130:133], v1, s[4:7], s17 offen
    buffer_load_dwordx4 v[134:137], v1, s[4:7], s18 offen
    buffer_load_dwordx4 v[138:141], v1, s[4:7], s18 offen offset:1024
    buffer_load_dwordx4 v[142:145], v1, s[4:7], s18 offen offset:2048
    s_add_u32 s16, s16, 1024
    s_add_u32 s17, s17, 1024
    s_add_u32 s18, s18, 18432
    s_waitcnt vmcnt(10)
    v_mfma_f32_32x32x16_bf16 v[10:25], v[154:157], v[146:149], v[10:25]
    v_mfma_f32_32x32x16_bf16 v[26:41], v[158:161], v[146:149], v[26:41]
    v_mfma_f32_32x32x16_bf16 v[42:57], v[162:165], v[146:149], v[42:57]
    v_mfma_f32_32x32x16_bf16 v[58:73], v[154:157], v[150:153], v[58:73]
    v_mfma_f32_32x32x16_bf16 v[74:89], v[158:161], v[150:153], v[74:89]
    v_mfma_f32_32x32x16_bf16 v[90:105], v[162:165], v[150:153], v[90:105]
    buffer_load_dwordx4 v[146:149], v1, s[4:7], s16 offen
    buffer_load_dwordx4 v[150:153], v1, s[4:7], s17 offen
    buffer_load_dwordx4 v[154:157], v1, s[4:7], s18 offen
    buffer_load_dwordx4 v[158:161], v1, s[4:7], s18 offen offset:1024
    buffer_load_dwordx4 v[162:165], v1, s[4:7], s18 offen offset:2048
    s_add_u32 s16, s16, 1024
    s_add_u32 s17, s17, 1024
    s_add_u32 s18, s18, 18432
    s_waitcnt vmcnt(10)
    v_mfma_f32_32x32x16_bf16 v[10:25], v[114:117], v[106:109], v[10:25]
    v_mfma_f32_32x32x16_bf16 v[26:41], v[118:121], v[106:109], v[26:41]
    v_mfma_f32_32x32x16_bf16 v[42:57], v[122:125], v[106:109], v[42:57]
    v_mfma_f32_32x32x16_bf16 v[58:73], v[114:117], v[110:113], v[58:73]
    v_mfma_f32_32x32x16_bf16 v[74:89], v[118:121], v[110:113], v[74:89]
    v_mfma_f32_32x32x16_bf16 v[90:105], v[122:125], v[110:113], v[90:105]
    buffer_load_dwordx4 v[106:109], v1, s[4:7], s16 offen
    buffer_load_dwordx4 v[110:113], v1, s[4:7], s17 offen
    buffer_load_dwordx4 v[114:117], v1, s[4:7], s18 offen
    buffer_load_dwordx4 v[118:121], v1, s[4:7], s18 offen offset:1024
    buffer_load_dwordx4 v[122:125], v1, s[4:7], s18 offen offset:2048
    s_add_u32 s16, s16, 1024
    s_add_u32 s17, s17, 1024
    s_add_u32 s18, s18, 18432
    s_waitcnt vmcnt(10)
    v_mfma_f32_32x32x16_bf16 v[10:25], v[134:137], v[126:129], v[10:25]
    v_mfma_f32_32x32x16_bf16 v[26:41], v[138:141], v[126:129], v[26:41]
    v_mfma_f32_32x32x16_bf16 v[42:57], v[142:145], v[126:129], v[42:57]
    v_mfma_f32_32x32x16_bf16 v[58:73], v[134:137], v[130:133], v[58:73]
    v_mfma_f32_32x32x16_bf16 v[74:89], v[138:141], v[130:133], v[74:89]
    v_mfma_f32_32x32x16_bf16 v[90:105], v[142:145], v[130:133], v[90:105]
    buffer_load_dwordx4 v[126:129], v1, s[4:7], s16 offen
    buffer_load_dwordx4 v[130:133], v1, s[4:7], s17 offen
    buffer_load_dwordx4 v[134:137], v1, s[4:7], s18 offen
    buffer_load_dwordx4 v[138:141], v1, s[4:7], s18 offen offset:1024
    buffer_load_dwordx4 v[142:145], v1, s[4:7], s18 offen offset:2048
    s_add_u32 s16, s16, 1024
    s_add_u32 s17, s17, 1024
    s_add_u32 s18, s18, 18432
    s_waitcnt vmcnt(10)
    v_mfma_f32_32x32x16_bf16 v[10:25], v[154:157], v[146:149], v[10:25]
    v_mfma_f32_32x32x16_bf16 v[26:41], v[158:161], v[146:149], v[26:41]
    v_mfma_f32_32x32x16_bf16 v[42:57], v[162:165], v[146:149], v[42:57]
    v_mfma_f32_32x32x16_bf16 v[58:73], v[154:157], v[150:153], v[58:73]
    v_mfma_f32_32x32x16_bf16 v[74:89], v[158:161], v[150:153], v[74:89]
    v_mfma_f32_32x32x16_bf16 v[90:105], v[162:165], v[150:153], v[90:105]
    buffer_load_dwordx4 v[146:149], v1, s[4:7], s16 offen
    buffer_load_dwordx4 v[150:153], v1, s[4:7], s17 offen
    buffer_load_dwordx4 v[154:157], v1, s[4:7], s18 offen
    buffer_load_dwordx4 v[158:161], v1, s[4:7], s18 offen offset:1024
    buffer_load_dwordx4 v[162:165], v1, s[4:7], s18 offen offset:2048
    s_add_u32 s16, s16, 1024
    s_add_u32 s17, s17, 1024
    s_add_u32 s18, s18, 18432
    s_waitcnt vmcnt(10)
    v_mfma_f32_32x32x16_bf16 v[10:25], v[114:117], v[106:109], v[10:25]
    v_mfma_f32_32x32x16_bf16 v[26:41], v[118:121], v[106:109], v[26:41]
    v_mfma_f32_32x32x16_bf16 v[42:57], v[122:125], v[106:109], v[42:57]
    v_mfma_f32_32x32x16_bf16 v[58:73], v[114:117], v[110:113], v[58:73]
    v_mfma_f32_32x32x16_bf16 v[74:89], v[118:121], v[110:113], v[74:89]
    v_mfma_f32_32x32x16_bf16 v[90:105], v[122:125], v[110:113], v[90:105]
    buffer_load_dwordx4 v[106:109], v1, s[4:7], s16 offen
    buffer_load_dwordx4 v[110:113], v1, s[4:7], s17 offen
    buffer_load_dwordx4 v[114:117], v1, s[4:7], s18 offen
    buffer_load_dwordx4 v[118:121], v1, s[4:7], s18 offen offset:1024
    buffer_load_dwordx4 v[122:125], v1, s[4:7], s18 offen offset:2048
    s_add_u32 s16, s16, 1024
    s_add_u32 s17, s17, 1024
    s_add_u32 s18, s18, 18432
    s_barrier
    s_waitcnt vmcnt(10)
    v_mfma_f32_32x32x16_bf16 v[10:25], v[134:137], v[126:129], v[10:25]
    v_mfma_f32_32x32x16_bf16 v[26:41], v[138:141], v[126:129], v[26:41]
    v_mfma_f32_32x32x16_bf16 v[42:57], v[142:145], v[126:129], v[42:57]
    v_mfma_f32_32x32x16_bf16 v[58:73], v[134:137], v[130:133], v[58:73]
    v_mfma_f32_32x32x16_bf16 v[74:89], v[138:141], v[130:133], v[74:89]
    v_mfma_f32_32x32x16_bf16 v[90:105], v[142:145], v[130:133], v[90:105]
    buffer_load_dwordx4 v[126:129], v1, s[4:7], s16 offen
    buffer_load_dwordx4 v[130:133], v1, s[4:7], s17 offen
    buffer_load_dwordx4 v[134:137], v1, s[4:7], s18 offen
    buffer_load_dwordx4 v[138:141], v1, s[4:7], s18 offen offset:1024
    buffer_load_dwordx4 v[142:145], v1, s[4:7], s18 offen offset:2048
    s_add_u32 s16, s16, 1024
    s_add_u32 s17, s17, 1024
    s_add_u32 s18, s18, 18432
    s_waitcnt vmcnt(10)
    v_mfma_f32_32x32x16_bf16 v[10:25], v[154:157], v[146:149], v[10:25]
    v_mfma_f32_32x32x16_bf16 v[26:41], v[158:161], v[146:149], v[26:41]
    v_mfma_f32_32x32x16_bf16 v[42:57], v[162:165], v[146:149], v[42:57]
    v_mfma_f32_32x32x16_bf16 v[58:73], v[154:157], v[150:153], v[58:73]
    v_mfma_f32_32x32x16_bf16 v[74:89], v[158:161], v[150:153], v[74:89]
    v_mfma_f32_32x32x16_bf16 v[90:105], v[162:165], v[150:153], v[90:105]
    buffer_load_dwordx4 v[146:149], v1, s[4:7], s16 offen
    buffer_load_dwordx4 v[150:153], v1, s[4:7], s17 offen
    buffer_load_dwordx4 v[154:157], v1, s[4:7], s18 offen
    buffer_load_dwordx4 v[158:161], v1, s[4:7], s18 offen offset:1024
    buffer_load_dwordx4 v[162:165], v1, s[4:7], s18 offen offset:2048
    s_add_u32 s16, s16, 1024
    s_add_u32 s17, s17, 1024
    s_add_u32 s18, s18, 18432
    s_waitcnt vmcnt(10)
    v_mfma_f32_32x32x16_bf16 v[10:25], v[114:117], v[106:109], v[10:25]
    v_mfma_f32_32x32x16_bf16 v[26:41], v[118:121], v[106:109], v[26:41]
    v_mfma_f32_32x32x16_bf16 v[42:57], v[122:125], v[106:109], v[42:57]
    v_mfma_f32_32x32x16_bf16 v[58:73], v[114:117], v[110:113], v[58:73]
    v_mfma_f32_32x32x16_bf16 v[74:89], v[118:121], v[110:113], v[74:89]
    v_mfma_f32_32x32x16_bf16 v[90:105], v[122:125], v[110:113], v[90:105]
    buffer_load_dwordx4 v[106:109], v1, s[4:7], s16 offen
    buffer_load_dwordx4 v[110:113], v1, s[4:7], s17 offen
    buffer_load_dwordx4 v[114:117], v1, s[4:7], s18 offen
    buffer_load_dwordx4 v[118:121], v1, s[4:7], s18 offen offset:1024
    buffer_load_dwordx4 v[122:125], v1, s[4:7], s18 offen offset:2048
    s_add_u32 s16, s16, 1024
    s_add_u32 s17, s17, 1024
    s_add_u32 s18, s18, 18432
    s_waitcnt vmcnt(10)
    v_mfma_f32_32x32x16_bf16 v[10:25], v[134:137], v[126:129], v[10:25]
    v_mfma_f32_32x32x16_bf16 v[26:41], v[138:141], v[126:129], v[26:41]
    v_mfma_f32_32x32x16_bf16 v[42:57], v[142:145], v[126:129], v[42:57]
    v_mfma_f32_32x32x16_bf16 v[58:73], v[134:137], v[130:133], v[58:73]
    v_mfma_f32_32x32x16_bf16 v[74:89], v[138:141], v[130:133], v[74:89]
    v_mfma_f32_32x32x16_bf16 v[90:105], v[142:145], v[130:133], v[90:105]
    buffer_load_dwordx4 v[126:129], v1, s[4:7], s16 offen
    buffer_load_dwordx4 v[130:133], v1, s[4:7], s17 offen
    buffer_load_dwordx4 v[134:137], v1, s[4:7], s18 offen
    buffer_load_dwordx4 v[138:141], v1, s[4:7], s18 offen offset:1024
    buffer_load_dwordx4 v[142:145], v1, s[4:7], s18 offen offset:2048
    s_add_u32 s16, s16, 1024
    s_add_u32 s17, s17, 1024
    s_add_u32 s18, s18, 18432
    s_waitcnt vmcnt(10)
    v_mfma_f32_32x32x16_bf16 v[10:25], v[154:157], v[146:149], v[10:25]
    v_mfma_f32_32x32x16_bf16 v[26:41], v[158:161], v[146:149], v[26:41]
    v_mfma_f32_32x32x16_bf16 v[42:57], v[162:165], v[146:149], v[42:57]
    v_mfma_f32_32x32x16_bf16 v[58:73], v[154:157], v[150:153], v[58:73]
    v_mfma_f32_32x32x16_bf16 v[74:89], v[158:161], v[150:153], v[74:89]
    v_mfma_f32_32x32x16_bf16 v[90:105], v[162:165], v[150:153], v[90:105]
    buffer_load_dwordx4 v[146:149], v1, s[4:7], s16 offen
    buffer_load_dwordx4 v[150:153], v1, s[4:7], s17 offen
    buffer_load_dwordx4 v[154:157], v1, s[4:7], s18 offen
    buffer_load_dwordx4 v[158:161], v1, s[4:7], s18 offen offset:1024
    buffer_load_dwordx4 v[162:165], v1, s[4:7], s18 offen offset:2048
    s_add_u32 s16, s16, 1024
    s_add_u32 s17, s17, 1024
    s_add_u32 s18, s18, 18432
    s_waitcnt vmcnt(10)
    v_mfma_f32_32x32x16_bf16 v[10:25], v[114:117], v[106:109], v[10:25]
    v_mfma_f32_32x32x16_bf16 v[26:41], v[118:121], v[106:109], v[26:41]
    v_mfma_f32_32x32x16_bf16 v[42:57], v[122:125], v[106:109], v[42:57]
    v_mfma_f32_32x32x16_bf16 v[58:73], v[114:117], v[110:113], v[58:73]
    v_mfma_f32_32x32x16_bf16 v[74:89], v[118:121], v[110:113], v[74:89]
    v_mfma_f32_32x32x16_bf16 v[90:105], v[122:125], v[110:113], v[90:105]
    buffer_load_dwordx4 v[106:109], v1, s[4:7], s16 offen
    buffer_load_dwordx4 v[110:113], v1, s[4:7], s17 offen
    buffer_load_dwordx4 v[114:117], v1, s[4:7], s18 offen
    buffer_load_dwordx4 v[118:121], v1, s[4:7], s18 offen offset:1024
    buffer_load_dwordx4 v[122:125], v1, s[4:7], s18 offen offset:2048
    s_add_u32 s16, s16, 1024
    s_add_u32 s17, s17, 1024
    s_add_u32 s18, s18, 18432
    s_waitcnt vmcnt(10)
    v_mfma_f32_32x32x16_bf16 v[10:25], v[134:137], v[126:129], v[10:25]
    v_mfma_f32_32x32x16_bf16 v[26:41], v[138:141], v[126:129], v[26:41]
    v_mfma_f32_32x32x16_bf16 v[42:57], v[142:145], v[126:129], v[42:57]
    v_mfma_f32_32x32x16_bf16 v[58:73], v[134:137], v[130:133], v[58:73]
    v_mfma_f32_32x32x16_bf16 v[74:89], v[138:141], v[130:133], v[74:89]
    v_mfma_f32_32x32x16_bf16 v[90:105], v[142:145], v[130:133], v[90:105]
    buffer_load_dwordx4 v[126:129], v1, s[4:7], s16 offen
    buffer_load_dwordx4 v[130:133], v1, s[4:7], s17 offen
    buffer_load_dwordx4 v[134:137], v1, s[4:7], s18 offen
    buffer_load_dwordx4 v[138:141], v1, s[4:7], s18 offen offset:1024
    buffer_load_dwordx4 v[142:145], v1, s[4:7], s18 offen offset:2048
    s_add_u32 s16, s16, 1024
    s_add_u32 s17, s17, 1024
    s_add_u32 s18, s18, 18432
    s_waitcnt vmcnt(10)
    v_mfma_f32_32x32x16_bf16 v[10:25], v[154:157], v[146:149], v[10:25]
    v_mfma_f32_32x32x16_bf16 v[26:41], v[158:161], v[146:149], v[26:41]
    v_mfma_f32_32x32x16_bf16 v[42:57], v[162:165], v[146:149], v[42:57]
    v_mfma_f32_32x32x16_bf16 v[58:73], v[154:157], v[150:153], v[58:73]
    v_mfma_f32_32x32x16_bf16 v[74:89], v[158:161], v[150:153], v[74:89]
    v_mfma_f32_32x32x16_bf16 v[90:105], v[162:165], v[150:153], v[90:105]
    buffer_load_dwordx4 v[146:149], v1, s[4:7], s16 offen
    buffer_load_dwordx4 v[150:153], v1, s[4:7], s17 offen
    buffer_load_dwordx4 v[154:157], v1, s[4:7], s18 offen
    buffer_load_dwordx4 v[158:161], v1, s[4:7], s18 offen offset:1024
    buffer_load_dwordx4 v[162:165], v1, s[4:7], s18 offen offset:2048
    s_add_u32 s16, s16, 1024
    s_add_u32 s17, s17, 1024
    s_add_u32 s18, s18, 18432
    s_barrier
    s_waitcnt vmcnt(10)
    v_mfma_f32_32x32x16_bf16 v[10:25], v[114:117], v[106:109], v[10:25]
    v_mfma_f32_32x32x16_bf16 v[26:41], v[118:121], v[106:109], v[26:41]
    v_mfma_f32_32x32x16_bf16 v[42:57], v[122:125], v[106:109], v[42:57]
    v_mfma_f32_32x32x16_bf16 v[58:73], v[114:117], v[110:113], v[58:73]
    v_mfma_f32_32x32x16_bf16 v[74:89], v[118:121], v[110:113], v[74:89]
    v_mfma_f32_32x32x16_bf16 v[90:105], v[122:125], v[110:113], v[90:105]
    buffer_load_dwordx4 v[106:109], v1, s[4:7], s16 offen
    buffer_load_dwordx4 v[110:113], v1, s[4:7], s17 offen
    buffer_load_dwordx4 v[114:117], v1, s[4:7], s18 offen
    buffer_load_dwordx4 v[118:121], v1, s[4:7], s18 offen offset:1024
    buffer_load_dwordx4 v[122:125], v1, s[4:7], s18 offen offset:2048
    s_add_u32 s16, s16, 1024
    s_add_u32 s17, s17, 1024
    s_add_u32 s18, s18, 18432
    s_waitcnt vmcnt(10)
    v_mfma_f32_32x32x16_bf16 v[10:25], v[134:137], v[126:129], v[10:25]
    v_mfma_f32_32x32x16_bf16 v[26:41], v[138:141], v[126:129], v[26:41]
    v_mfma_f32_32x32x16_bf16 v[42:57], v[142:145], v[126:129], v[42:57]
    v_mfma_f32_32x32x16_bf16 v[58:73], v[134:137], v[130:133], v[58:73]
    v_mfma_f32_32x32x16_bf16 v[74:89], v[138:141], v[130:133], v[74:89]
    v_mfma_f32_32x32x16_bf16 v[90:105], v[142:145], v[130:133], v[90:105]
    buffer_load_dwordx4 v[126:129], v1, s[4:7], s16 offen
    buffer_load_dwordx4 v[130:133], v1, s[4:7], s17 offen
    buffer_load_dwordx4 v[134:137], v1, s[4:7], s18 offen
    buffer_load_dwordx4 v[138:141], v1, s[4:7], s18 offen offset:1024
    buffer_load_dwordx4 v[142:145], v1, s[4:7], s18 offen offset:2048
    s_add_u32 s16, s16, 1024
    s_add_u32 s17, s17, 1024
    s_add_u32 s18, s18, 18432
    s_waitcnt vmcnt(10)
    v_mfma_f32_32x32x16_bf16 v[10:25], v[154:157], v[146:149], v[10:25]
    v_mfma_f32_32x32x16_bf16 v[26:41], v[158:161], v[146:149], v[26:41]
    v_mfma_f32_32x32x16_bf16 v[42:57], v[162:165], v[146:149], v[42:57]
    v_mfma_f32_32x32x16_bf16 v[58:73], v[154:157], v[150:153], v[58:73]
    v_mfma_f32_32x32x16_bf16 v[74:89], v[158:161], v[150:153], v[74:89]
    v_mfma_f32_32x32x16_bf16 v[90:105], v[162:165], v[150:153], v[90:105]
    buffer_load_dwordx4 v[146:149], v1, s[4:7], s16 offen
    buffer_load_dwordx4 v[150:153], v1, s[4:7], s17 offen
    buffer_load_dwordx4 v[154:157], v1, s[4:7], s18 offen
    buffer_load_dwordx4 v[158:161], v1, s[4:7], s18 offen offset:1024
    buffer_load_dwordx4 v[162:165], v1, s[4:7], s18 offen offset:2048
    s_add_u32 s16, s16, 1024
    s_add_u32 s17, s17, 1024
    s_add_u32 s18, s18, 18432
    s_waitcnt vmcnt(10)
    v_mfma_f32_32x32x16_bf16 v[10:25], v[114:117], v[106:109], v[10:25]
    v_mfma_f32_32x32x16_bf16 v[26:41], v[118:121], v[106:109], v[26:41]
    v_mfma_f32_32x32x16_bf16 v[42:57], v[122:125], v[106:109], v[42:57]
    v_mfma_f32_32x32x16_bf16 v[58:73], v[114:117], v[110:113], v[58:73]
    v_mfma_f32_32x32x16_bf16 v[74:89], v[118:121], v[110:113], v[74:89]
    v_mfma_f32_32x32x16_bf16 v[90:105], v[122:125], v[110:113], v[90:105]
    buffer_load_dwordx4 v[106:109], v1, s[4:7], s16 offen
    buffer_load_dwordx4 v[110:113], v1, s[4:7], s17 offen
    buffer_load_dwordx4 v[114:117], v1, s[4:7], s18 offen
    buffer_load_dwordx4 v[118:121], v1, s[4:7], s18 offen offset:1024
    buffer_load_dwordx4 v[122:125], v1, s[4:7], s18 offen offset:2048
    s_add_u32 s16, s16, 1024
    s_add_u32 s17, s17, 1024
    s_add_u32 s18, s18, 18432
    s_waitcnt vmcnt(10)
    v_mfma_f32_32x32x16_bf16 v[10:25], v[134:137], v[126:129], v[10:25]
    v_mfma_f32_32x32x16_bf16 v[26:41], v[138:141], v[126:129], v[26:41]
    v_mfma_f32_32x32x16_bf16 v[42:57], v[142:145], v[126:129], v[42:57]
    v_mfma_f32_32x32x16_bf16 v[58:73], v[134:137], v[130:133], v[58:73]
    v_mfma_f32_32x32x16_bf16 v[74:89], v[138:141], v[130:133], v[74:89]
    v_mfma_f32_32x32x16_bf16 v[90:105], v[142:145], v[130:133], v[90:105]
    buffer_load_dwordx4 v[126:129], v1, s[4:7], s16 offen
    buffer_load_dwordx4 v[130:133], v1, s[4:7], s17 offen
    buffer_load_dwordx4 v[134:137], v1, s[4:7], s18 offen
    buffer_load_dwordx4 v[138:141], v1, s[4:7], s18 offen offset:1024
    buffer_load_dwordx4 v[142:145], v1, s[4:7], s18 offen offset:2048
    s_add_u32 s16, s16, 1024
    s_add_u32 s17, s17, 1024
    s_add_u32 s18, s18, 18432
    s_waitcnt vmcnt(10)
    v_mfma_f32_32x32x16_bf16 v[10:25], v[154:157], v[146:149], v[10:25]
    v_mfma_f32_32x32x16_bf16 v[26:41], v[158:161], v[146:149], v[26:41]
    v_mfma_f32_32x32x16_bf16 v[42:57], v[162:165], v[146:149], v[42:57]
    v_mfma_f32_32x32x16_bf16 v[58:73], v[154:157], v[150:153], v[58:73]
    v_mfma_f32_32x32x16_bf16 v[74:89], v[158:161], v[150:153], v[74:89]
    v_mfma_f32_32x32x16_bf16 v[90:105], v[162:165], v[150:153], v[90:105]
    buffer_load_dwordx4 v[146:149], v1, s[4:7], s16 offen
    buffer_load_dwordx4 v[150:153], v1, s[4:7], s17 offen
    buffer_load_dwordx4 v[154:157], v1, s[4:7], s18 offen
    buffer_load_dwordx4 v[158:161], v1, s[4:7], s18 offen offset:1024
    buffer_load_dwordx4 v[162:165], v1, s[4:7], s18 offen offset:2048
    s_add_u32 s16, s16, 1024
    s_add_u32 s17, s17, 1024
    s_add_u32 s18, s18, 18432
    s_waitcnt vmcnt(10)
    v_mfma_f32_32x32x16_bf16 v[10:25], v[114:117], v[106:109], v[10:25]
    v_mfma_f32_32x32x16_bf16 v[26:41], v[118:121], v[106:109], v[26:41]
    v_mfma_f32_32x32x16_bf16 v[42:57], v[122:125], v[106:109], v[42:57]
    v_mfma_f32_32x32x16_bf16 v[58:73], v[114:117], v[110:113], v[58:73]
    v_mfma_f32_32x32x16_bf16 v[74:89], v[118:121], v[110:113], v[74:89]
    v_mfma_f32_32x32x16_bf16 v[90:105], v[122:125], v[110:113], v[90:105]
    buffer_load_dwordx4 v[106:109], v1, s[4:7], s16 offen
    buffer_load_dwordx4 v[110:113], v1, s[4:7], s17 offen
    buffer_load_dwordx4 v[114:117], v1, s[4:7], s18 offen
    buffer_load_dwordx4 v[118:121], v1, s[4:7], s18 offen offset:1024
    buffer_load_dwordx4 v[122:125], v1, s[4:7], s18 offen offset:2048
    s_add_u32 s16, s16, 1024
    s_add_u32 s17, s17, 1024
    s_add_u32 s18, s18, 18432
    s_waitcnt vmcnt(10)
    v_mfma_f32_32x32x16_bf16 v[10:25], v[134:137], v[126:129], v[10:25]
    v_mfma_f32_32x32x16_bf16 v[26:41], v[138:141], v[126:129], v[26:41]
    v_mfma_f32_32x32x16_bf16 v[42:57], v[142:145], v[126:129], v[42:57]
    v_mfma_f32_32x32x16_bf16 v[58:73], v[134:137], v[130:133], v[58:73]
    v_mfma_f32_32x32x16_bf16 v[74:89], v[138:141], v[130:133], v[74:89]
    v_mfma_f32_32x32x16_bf16 v[90:105], v[142:145], v[130:133], v[90:105]
    buffer_load_dwordx4 v[126:129], v1, s[4:7], s16 offen
    buffer_load_dwordx4 v[130:133], v1, s[4:7], s17 offen
    buffer_load_dwordx4 v[134:137], v1, s[4:7], s18 offen
    buffer_load_dwordx4 v[138:141], v1, s[4:7], s18 offen offset:1024
    buffer_load_dwordx4 v[142:145], v1, s[4:7], s18 offen offset:2048
    s_add_u32 s16, s16, 1024
    s_add_u32 s17, s17, 1024
    s_add_u32 s18, s18, 18432
    s_barrier
    s_waitcnt vmcnt(10)
    v_mfma_f32_32x32x16_bf16 v[10:25], v[154:157], v[146:149], v[10:25]
    v_mfma_f32_32x32x16_bf16 v[26:41], v[158:161], v[146:149], v[26:41]
    v_mfma_f32_32x32x16_bf16 v[42:57], v[162:165], v[146:149], v[42:57]
    v_mfma_f32_32x32x16_bf16 v[58:73], v[154:157], v[150:153], v[58:73]
    v_mfma_f32_32x32x16_bf16 v[74:89], v[158:161], v[150:153], v[74:89]
    v_mfma_f32_32x32x16_bf16 v[90:105], v[162:165], v[150:153], v[90:105]
    buffer_load_dwordx4 v[146:149], v1, s[4:7], s16 offen
    buffer_load_dwordx4 v[150:153], v1, s[4:7], s17 offen
    buffer_load_dwordx4 v[154:157], v1, s[4:7], s18 offen
    buffer_load_dwordx4 v[158:161], v1, s[4:7], s18 offen offset:1024
    buffer_load_dwordx4 v[162:165], v1, s[4:7], s18 offen offset:2048
    s_add_u32 s16, s16, 1024
    s_add_u32 s17, s17, 1024
    s_add_u32 s18, s18, 18432
    s_waitcnt vmcnt(10)
    v_mfma_f32_32x32x16_bf16 v[10:25], v[114:117], v[106:109], v[10:25]
    v_mfma_f32_32x32x16_bf16 v[26:41], v[118:121], v[106:109], v[26:41]
    v_mfma_f32_32x32x16_bf16 v[42:57], v[122:125], v[106:109], v[42:57]
    v_mfma_f32_32x32x16_bf16 v[58:73], v[114:117], v[110:113], v[58:73]
    v_mfma_f32_32x32x16_bf16 v[74:89], v[118:121], v[110:113], v[74:89]
    v_mfma_f32_32x32x16_bf16 v[90:105], v[122:125], v[110:113], v[90:105]
    buffer_load_dwordx4 v[106:109], v1, s[4:7], s16 offen
    buffer_load_dwordx4 v[110:113], v1, s[4:7], s17 offen
    buffer_load_dwordx4 v[114:117], v1, s[4:7], s18 offen
    buffer_load_dwordx4 v[118:121], v1, s[4:7], s18 offen offset:1024
    buffer_load_dwordx4 v[122:125], v1, s[4:7], s18 offen offset:2048
    s_add_u32 s16, s16, 1024
    s_add_u32 s17, s17, 1024
    s_add_u32 s18, s18, 18432
    s_waitcnt vmcnt(10)
    v_mfma_f32_32x32x16_bf16 v[10:25], v[134:137], v[126:129], v[10:25]
    v_mfma_f32_32x32x16_bf16 v[26:41], v[138:141], v[126:129], v[26:41]
    v_mfma_f32_32x32x16_bf16 v[42:57], v[142:145], v[126:129], v[42:57]
    v_mfma_f32_32x32x16_bf16 v[58:73], v[134:137], v[130:133], v[58:73]
    v_mfma_f32_32x32x16_bf16 v[74:89], v[138:141], v[130:133], v[74:89]
    v_mfma_f32_32x32x16_bf16 v[90:105], v[142:145], v[130:133], v[90:105]
    buffer_load_dwordx4 v[126:129], v1, s[4:7], s16 offen
    buffer_load_dwordx4 v[130:133], v1, s[4:7], s17 offen
    buffer_load_dwordx4 v[134:137], v1, s[4:7], s18 offen
    buffer_load_dwordx4 v[138:141], v1, s[4:7], s18 offen offset:1024
    buffer_load_dwordx4 v[142:145], v1, s[4:7], s18 offen offset:2048
    s_add_u32 s16, s16, 1024
    s_add_u32 s17, s17, 1024
    s_add_u32 s18, s18, 18432
    s_waitcnt vmcnt(10)
    v_mfma_f32_32x32x16_bf16 v[10:25], v[154:157], v[146:149], v[10:25]
    v_mfma_f32_32x32x16_bf16 v[26:41], v[158:161], v[146:149], v[26:41]
    v_mfma_f32_32x32x16_bf16 v[42:57], v[162:165], v[146:149], v[42:57]
    v_mfma_f32_32x32x16_bf16 v[58:73], v[154:157], v[150:153], v[58:73]
    v_mfma_f32_32x32x16_bf16 v[74:89], v[158:161], v[150:153], v[74:89]
    v_mfma_f32_32x32x16_bf16 v[90:105], v[162:165], v[150:153], v[90:105]
    buffer_load_dwordx4 v[146:149], v1, s[4:7], s16 offen
    buffer_load_dwordx4 v[150:153], v1, s[4:7], s17 offen
    buffer_load_dwordx4 v[154:157], v1, s[4:7], s18 offen
    buffer_load_dwordx4 v[158:161], v1, s[4:7], s18 offen offset:1024
    buffer_load_dwordx4 v[162:165], v1, s[4:7], s18 offen offset:2048
    s_add_u32 s16, s16, 1024
    s_add_u32 s17, s17, 1024
    s_add_u32 s18, s18, 18432
    s_waitcnt vmcnt(10)
    v_mfma_f32_32x32x16_bf16 v[10:25], v[114:117], v[106:109], v[10:25]
    v_mfma_f32_32x32x16_bf16 v[26:41], v[118:121], v[106:109], v[26:41]
    v_mfma_f32_32x32x16_bf16 v[42:57], v[122:125], v[106:109], v[42:57]
    v_mfma_f32_32x32x16_bf16 v[58:73], v[114:117], v[110:113], v[58:73]
    v_mfma_f32_32x32x16_bf16 v[74:89], v[118:121], v[110:113], v[74:89]
    v_mfma_f32_32x32x16_bf16 v[90:105], v[122:125], v[110:113], v[90:105]
    buffer_load_dwordx4 v[106:109], v1, s[4:7], s16 offen
    buffer_load_dwordx4 v[110:113], v1, s[4:7], s17 offen
    buffer_load_dwordx4 v[114:117], v1, s[4:7], s18 offen
    buffer_load_dwordx4 v[118:121], v1, s[4:7], s18 offen offset:1024
    buffer_load_dwordx4 v[122:125], v1, s[4:7], s18 offen offset:2048
    s_add_u32 s16, s16, 1024
    s_add_u32 s17, s17, 1024
    s_add_u32 s18, s18, 18432
    s_waitcnt vmcnt(10)
    v_mfma_f32_32x32x16_bf16 v[10:25], v[134:137], v[126:129], v[10:25]
    v_mfma_f32_32x32x16_bf16 v[26:41], v[138:141], v[126:129], v[26:41]
    v_mfma_f32_32x32x16_bf16 v[42:57], v[142:145], v[126:129], v[42:57]
    v_mfma_f32_32x32x16_bf16 v[58:73], v[134:137], v[130:133], v[58:73]
    v_mfma_f32_32x32x16_bf16 v[74:89], v[138:141], v[130:133], v[74:89]
    v_mfma_f32_32x32x16_bf16 v[90:105], v[142:145], v[130:133], v[90:105]
    buffer_load_dwordx4 v[126:129], v1, s[4:7], s16 offen
    buffer_load_dwordx4 v[130:133], v1, s[4:7], s17 offen
    buffer_load_dwordx4 v[134:137], v1, s[4:7], s18 offen
    buffer_load_dwordx4 v[138:141], v1, s[4:7], s18 offen offset:1024
    buffer_load_dwordx4 v[142:145], v1, s[4:7], s18 offen offset:2048
    s_add_u32 s16, s16, 1024
    s_add_u32 s17, s17, 1024
    s_add_u32 s18, s18, 18432
    s_waitcnt vmcnt(10)
    v_mfma_f32_32x32x16_bf16 v[10:25], v[154:157], v[146:149], v[10:25]
    v_mfma_f32_32x32x16_bf16 v[26:41], v[158:161], v[146:149], v[26:41]
    v_mfma_f32_32x32x16_bf16 v[42:57], v[162:165], v[146:149], v[42:57]
    v_mfma_f32_32x32x16_bf16 v[58:73], v[154:157], v[150:153], v[58:73]
    v_mfma_f32_32x32x16_bf16 v[74:89], v[158:161], v[150:153], v[74:89]
    v_mfma_f32_32x32x16_bf16 v[90:105], v[162:165], v[150:153], v[90:105]
    buffer_load_dwordx4 v[146:149], v1, s[4:7], s16 offen
    buffer_load_dwordx4 v[150:153], v1, s[4:7], s17 offen
    buffer_load_dwordx4 v[154:157], v1, s[4:7], s18 offen
    buffer_load_dwordx4 v[158:161], v1, s[4:7], s18 offen offset:1024
    buffer_load_dwordx4 v[162:165], v1, s[4:7], s18 offen offset:2048
    s_add_u32 s16, s16, 1024
    s_add_u32 s17, s17, 1024
    s_add_u32 s18, s18, 18432
    s_waitcnt vmcnt(10)
    v_mfma_f32_32x32x16_bf16 v[10:25], v[114:117], v[106:109], v[10:25]
    v_mfma_f32_32x32x16_bf16 v[26:41], v[118:121], v[106:109], v[26:41]
    v_mfma_f32_32x32x16_bf16 v[42:57], v[122:125], v[106:109], v[42:57]
    v_mfma_f32_32x32x16_bf16 v[58:73], v[114:117], v[110:113], v[58:73]
    v_mfma_f32_32x32x16_bf16 v[74:89], v[118:121], v[110:113], v[74:89]
    v_mfma_f32_32x32x16_bf16 v[90:105], v[122:125], v[110:113], v[90:105]
    buffer_load_dwordx4 v[106:109], v1, s[4:7], s16 offen
    buffer_load_dwordx4 v[110:113], v1, s[4:7], s17 offen
    buffer_load_dwordx4 v[114:117], v1, s[4:7], s18 offen
    buffer_load_dwordx4 v[118:121], v1, s[4:7], s18 offen offset:1024
    buffer_load_dwordx4 v[122:125], v1, s[4:7], s18 offen offset:2048
    s_add_u32 s16, s16, 1024
    s_add_u32 s17, s17, 1024
    s_add_u32 s18, s18, 18432
    s_barrier
    s_waitcnt vmcnt(10)
    v_mfma_f32_32x32x16_bf16 v[10:25], v[134:137], v[126:129], v[10:25]
    v_mfma_f32_32x32x16_bf16 v[26:41], v[138:141], v[126:129], v[26:41]
    v_mfma_f32_32x32x16_bf16 v[42:57], v[142:145], v[126:129], v[42:57]
    v_mfma_f32_32x32x16_bf16 v[58:73], v[134:137], v[130:133], v[58:73]
    v_mfma_f32_32x32x16_bf16 v[74:89], v[138:141], v[130:133], v[74:89]
    v_mfma_f32_32x32x16_bf16 v[90:105], v[142:145], v[130:133], v[90:105]
    buffer_load_dwordx4 v[126:129], v1, s[4:7], s16 offen
    buffer_load_dwordx4 v[130:133], v1, s[4:7], s17 offen
    buffer_load_dwordx4 v[134:137], v1, s[4:7], s18 offen
    buffer_load_dwordx4 v[138:141], v1, s[4:7], s18 offen offset:1024
    buffer_load_dwordx4 v[142:145], v1, s[4:7], s18 offen offset:2048
    s_add_u32 s16, s16, 1024
    s_add_u32 s17, s17, 1024
    s_add_u32 s18, s18, 18432
    s_waitcnt vmcnt(10)
    v_mfma_f32_32x32x16_bf16 v[10:25], v[154:157], v[146:149], v[10:25]
    v_mfma_f32_32x32x16_bf16 v[26:41], v[158:161], v[146:149], v[26:41]
    v_mfma_f32_32x32x16_bf16 v[42:57], v[162:165], v[146:149], v[42:57]
    v_mfma_f32_32x32x16_bf16 v[58:73], v[154:157], v[150:153], v[58:73]
    v_mfma_f32_32x32x16_bf16 v[74:89], v[158:161], v[150:153], v[74:89]
    v_mfma_f32_32x32x16_bf16 v[90:105], v[162:165], v[150:153], v[90:105]
    buffer_load_dwordx4 v[146:149], v1, s[4:7], s16 offen
    buffer_load_dwordx4 v[150:153], v1, s[4:7], s17 offen
    buffer_load_dwordx4 v[154:157], v1, s[4:7], s18 offen
    buffer_load_dwordx4 v[158:161], v1, s[4:7], s18 offen offset:1024
    buffer_load_dwordx4 v[162:165], v1, s[4:7], s18 offen offset:2048
    s_add_u32 s16, s16, 1024
    s_add_u32 s17, s17, 1024
    s_add_u32 s18, s18, 18432
    s_waitcnt vmcnt(10)
    v_mfma_f32_32x32x16_bf16 v[10:25], v[114:117], v[106:109], v[10:25]
    v_mfma_f32_32x32x16_bf16 v[26:41], v[118:121], v[106:109], v[26:41]
    v_mfma_f32_32x32x16_bf16 v[42:57], v[122:125], v[106:109], v[42:57]
    v_mfma_f32_32x32x16_bf16 v[58:73], v[114:117], v[110:113], v[58:73]
    v_mfma_f32_32x32x16_bf16 v[74:89], v[118:121], v[110:113], v[74:89]
    v_mfma_f32_32x32x16_bf16 v[90:105], v[122:125], v[110:113], v[90:105]
    buffer_load_dwordx4 v[106:109], v1, s[4:7], s16 offen
    buffer_load_dwordx4 v[110:113], v1, s[4:7], s17 offen
    buffer_load_dwordx4 v[114:117], v1, s[4:7], s18 offen
    buffer_load_dwordx4 v[118:121], v1, s[4:7], s18 offen offset:1024
    buffer_load_dwordx4 v[122:125], v1, s[4:7], s18 offen offset:2048
    s_add_u32 s16, s16, 1024
    s_add_u32 s17, s17, 1024
    s_add_u32 s18, s18, 18432
    s_waitcnt vmcnt(10)
    v_mfma_f32_32x32x16_bf16 v[10:25], v[134:137], v[126:129], v[10:25]
    v_mfma_f32_32x32x16_bf16 v[26:41], v[138:141], v[126:129], v[26:41]
    v_mfma_f32_32x32x16_bf16 v[42:57], v[142:145], v[126:129], v[42:57]
    v_mfma_f32_32x32x16_bf16 v[58:73], v[134:137], v[130:133], v[58:73]
    v_mfma_f32_32x32x16_bf16 v[74:89], v[138:141], v[130:133], v[74:89]
    v_mfma_f32_32x32x16_bf16 v[90:105], v[142:145], v[130:133], v[90:105]
    buffer_load_dwordx4 v[126:129], v1, s[4:7], s16 offen
    buffer_load_dwordx4 v[130:133], v1, s[4:7], s17 offen
    buffer_load_dwordx4 v[134:137], v1, s[4:7], s18 offen
    buffer_load_dwordx4 v[138:141], v1, s[4:7], s18 offen offset:1024
    buffer_load_dwordx4 v[142:145], v1, s[4:7], s18 offen offset:2048
    s_add_u32 s16, s16, 1024
    s_add_u32 s17, s17, 1024
    s_add_u32 s18, s18, 18432
    s_waitcnt vmcnt(10)
    v_mfma_f32_32x32x16_bf16 v[10:25], v[154:157], v[146:149], v[10:25]
    v_mfma_f32_32x32x16_bf16 v[26:41], v[158:161], v[146:149], v[26:41]
    v_mfma_f32_32x32x16_bf16 v[42:57], v[162:165], v[146:149], v[42:57]
    v_mfma_f32_32x32x16_bf16 v[58:73], v[154:157], v[150:153], v[58:73]
    v_mfma_f32_32x32x16_bf16 v[74:89], v[158:161], v[150:153], v[74:89]
    v_mfma_f32_32x32x16_bf16 v[90:105], v[162:165], v[150:153], v[90:105]
    buffer_load_dwordx4 v[146:149], v1, s[4:7], s16 offen
    buffer_load_dwordx4 v[150:153], v1, s[4:7], s17 offen
    buffer_load_dwordx4 v[154:157], v1, s[4:7], s18 offen
    buffer_load_dwordx4 v[158:161], v1, s[4:7], s18 offen offset:1024
    buffer_load_dwordx4 v[162:165], v1, s[4:7], s18 offen offset:2048
    s_add_u32 s16, s16, 1024
    s_add_u32 s17, s17, 1024
    s_add_u32 s18, s18, 18432
    s_waitcnt vmcnt(10)
    v_mfma_f32_32x32x16_bf16 v[10:25], v[114:117], v[106:109], v[10:25]
    v_mfma_f32_32x32x16_bf16 v[26:41], v[118:121], v[106:109], v[26:41]
    v_mfma_f32_32x32x16_bf16 v[42:57], v[122:125], v[106:109], v[42:57]
    v_mfma_f32_32x32x16_bf16 v[58:73], v[114:117], v[110:113], v[58:73]
    v_mfma_f32_32x32x16_bf16 v[74:89], v[118:121], v[110:113], v[74:89]
    v_mfma_f32_32x32x16_bf16 v[90:105], v[122:125], v[110:113], v[90:105]
    buffer_load_dwordx4 v[106:109], v1, s[4:7], s16 offen
    buffer_load_dwordx4 v[110:113], v1, s[4:7], s17 offen
    buffer_load_dwordx4 v[114:117], v1, s[4:7], s18 offen
    buffer_load_dwordx4 v[118:121], v1, s[4:7], s18 offen offset:1024
    buffer_load_dwordx4 v[122:125], v1, s[4:7], s18 offen offset:2048
    s_add_u32 s16, s16, 1024
    s_add_u32 s17, s17, 1024
    s_add_u32 s18, s18, 18432
    s_waitcnt vmcnt(10)
    v_mfma_f32_32x32x16_bf16 v[10:25], v[134:137], v[126:129], v[10:25]
    v_mfma_f32_32x32x16_bf16 v[26:41], v[138:141], v[126:129], v[26:41]
    v_mfma_f32_32x32x16_bf16 v[42:57], v[142:145], v[126:129], v[42:57]
    v_mfma_f32_32x32x16_bf16 v[58:73], v[134:137], v[130:133], v[58:73]
    v_mfma_f32_32x32x16_bf16 v[74:89], v[138:141], v[130:133], v[74:89]
    v_mfma_f32_32x32x16_bf16 v[90:105], v[142:145], v[130:133], v[90:105]
    buffer_load_dwordx4 v[126:129], v1, s[4:7], s16 offen
    buffer_load_dwordx4 v[130:133], v1, s[4:7], s17 offen
    buffer_load_dwordx4 v[134:137], v1, s[4:7], s18 offen
    buffer_load_dwordx4 v[138:141], v1, s[4:7], s18 offen offset:1024
    buffer_load_dwordx4 v[142:145], v1, s[4:7], s18 offen offset:2048
    s_add_u32 s16, s16, 1024
    s_add_u32 s17, s17, 1024
    s_add_u32 s18, s18, 18432
    s_waitcnt vmcnt(10)
    v_mfma_f32_32x32x16_bf16 v[10:25], v[154:157], v[146:149], v[10:25]
    v_mfma_f32_32x32x16_bf16 v[26:41], v[158:161], v[146:149], v[26:41]
    v_mfma_f32_32x32x16_bf16 v[42:57], v[162:165], v[146:149], v[42:57]
    v_mfma_f32_32x32x16_bf16 v[58:73], v[154:157], v[150:153], v[58:73]
    v_mfma_f32_32x32x16_bf16 v[74:89], v[158:161], v[150:153], v[74:89]
    v_mfma_f32_32x32x16_bf16 v[90:105], v[162:165], v[150:153], v[90:105]
    buffer_load_dwordx4 v[146:149], v1, s[4:7], s16 offen
    buffer_load_dwordx4 v[150:153], v1, s[4:7], s17 offen
    buffer_load_dwordx4 v[154:157], v1, s[4:7], s18 offen
    buffer_load_dwordx4 v[158:161], v1, s[4:7], s18 offen offset:1024
    buffer_load_dwordx4 v[162:165], v1, s[4:7], s18 offen offset:2048
    s_add_u32 s16, s16, 1024
    s_add_u32 s17, s17, 1024
    s_add_u32 s18, s18, 18432
    s_barrier
    s_waitcnt vmcnt(10)
    v_mfma_f32_32x32x16_bf16 v[10:25], v[114:117], v[106:109], v[10:25]
    v_mfma_f32_32x32x16_bf16 v[26:41], v[118:121], v[106:109], v[26:41]
    v_mfma_f32_32x32x16_bf16 v[42:57], v[122:125], v[106:109], v[42:57]
    v_mfma_f32_32x32x16_bf16 v[58:73], v[114:117], v[110:113], v[58:73]
    v_mfma_f32_32x32x16_bf16 v[74:89], v[118:121], v[110:113], v[74:89]
    v_mfma_f32_32x32x16_bf16 v[90:105], v[122:125], v[110:113], v[90:105]
    buffer_load_dwordx4 v[106:109], v1, s[4:7], s16 offen
    buffer_load_dwordx4 v[110:113], v1, s[4:7], s17 offen
    buffer_load_dwordx4 v[114:117], v1, s[4:7], s18 offen
    buffer_load_dwordx4 v[118:121], v1, s[4:7], s18 offen offset:1024
    buffer_load_dwordx4 v[122:125], v1, s[4:7], s18 offen offset:2048
    s_add_u32 s16, s16, 1024
    s_add_u32 s17, s17, 1024
    s_add_u32 s18, s18, 18432
    s_waitcnt vmcnt(10)
    v_mfma_f32_32x32x16_bf16 v[10:25], v[134:137], v[126:129], v[10:25]
    v_mfma_f32_32x32x16_bf16 v[26:41], v[138:141], v[126:129], v[26:41]
    v_mfma_f32_32x32x16_bf16 v[42:57], v[142:145], v[126:129], v[42:57]
    v_mfma_f32_32x32x16_bf16 v[58:73], v[134:137], v[130:133], v[58:73]
    v_mfma_f32_32x32x16_bf16 v[74:89], v[138:141], v[130:133], v[74:89]
    v_mfma_f32_32x32x16_bf16 v[90:105], v[142:145], v[130:133], v[90:105]
    buffer_load_dwordx4 v[126:129], v1, s[4:7], s16 offen
    buffer_load_dwordx4 v[130:133], v1, s[4:7], s17 offen
    buffer_load_dwordx4 v[134:137], v1, s[4:7], s18 offen
    buffer_load_dwordx4 v[138:141], v1, s[4:7], s18 offen offset:1024
    buffer_load_dwordx4 v[142:145], v1, s[4:7], s18 offen offset:2048
    s_add_u32 s16, s16, 1024
    s_add_u32 s17, s17, 1024
    s_add_u32 s18, s18, 18432
    s_waitcnt vmcnt(10)
    v_mfma_f32_32x32x16_bf16 v[10:25], v[154:157], v[146:149], v[10:25]
    v_mfma_f32_32x32x16_bf16 v[26:41], v[158:161], v[146:149], v[26:41]
    v_mfma_f32_32x32x16_bf16 v[42:57], v[162:165], v[146:149], v[42:57]
    v_mfma_f32_32x32x16_bf16 v[58:73], v[154:157], v[150:153], v[58:73]
    v_mfma_f32_32x32x16_bf16 v[74:89], v[158:161], v[150:153], v[74:89]
    v_mfma_f32_32x32x16_bf16 v[90:105], v[162:165], v[150:153], v[90:105]
    buffer_load_dwordx4 v[146:149], v1, s[4:7], s16 offen
    buffer_load_dwordx4 v[150:153], v1, s[4:7], s17 offen
    buffer_load_dwordx4 v[154:157], v1, s[4:7], s18 offen
    buffer_load_dwordx4 v[158:161], v1, s[4:7], s18 offen offset:1024
    buffer_load_dwordx4 v[162:165], v1, s[4:7], s18 offen offset:2048
    s_add_u32 s16, s16, 1024
    s_add_u32 s17, s17, 1024
    s_add_u32 s18, s18, 18432
    s_waitcnt vmcnt(10)
    v_mfma_f32_32x32x16_bf16 v[10:25], v[114:117], v[106:109], v[10:25]
    v_mfma_f32_32x32x16_bf16 v[26:41], v[118:121], v[106:109], v[26:41]
    v_mfma_f32_32x32x16_bf16 v[42:57], v[122:125], v[106:109], v[42:57]
    v_mfma_f32_32x32x16_bf16 v[58:73], v[114:117], v[110:113], v[58:73]
    v_mfma_f32_32x32x16_bf16 v[74:89], v[118:121], v[110:113], v[74:89]
    v_mfma_f32_32x32x16_bf16 v[90:105], v[122:125], v[110:113], v[90:105]
    buffer_load_dwordx4 v[106:109], v1, s[4:7], s16 offen
    buffer_load_dwordx4 v[110:113], v1, s[4:7], s17 offen
    buffer_load_dwordx4 v[114:117], v1, s[4:7], s18 offen
    buffer_load_dwordx4 v[118:121], v1, s[4:7], s18 offen offset:1024
    buffer_load_dwordx4 v[122:125], v1, s[4:7], s18 offen offset:2048
    s_add_u32 s16, s16, 1024
    s_add_u32 s17, s17, 1024
    s_add_u32 s18, s18, 18432
    s_waitcnt vmcnt(10)
    v_mfma_f32_32x32x16_bf16 v[10:25], v[134:137], v[126:129], v[10:25]
    v_mfma_f32_32x32x16_bf16 v[26:41], v[138:141], v[126:129], v[26:41]
    v_mfma_f32_32x32x16_bf16 v[42:57], v[142:145], v[126:129], v[42:57]
    v_mfma_f32_32x32x16_bf16 v[58:73], v[134:137], v[130:133], v[58:73]
    v_mfma_f32_32x32x16_bf16 v[74:89], v[138:141], v[130:133], v[74:89]
    v_mfma_f32_32x32x16_bf16 v[90:105], v[142:145], v[130:133], v[90:105]
    buffer_load_dwordx4 v[126:129], v1, s[4:7], s16 offen
    buffer_load_dwordx4 v[130:133], v1, s[4:7], s17 offen
    buffer_load_dwordx4 v[134:137], v1, s[4:7], s18 offen
    buffer_load_dwordx4 v[138:141], v1, s[4:7], s18 offen offset:1024
    buffer_load_dwordx4 v[142:145], v1, s[4:7], s18 offen offset:2048
    s_add_u32 s16, s16, 1024
    s_add_u32 s17, s17, 1024
    s_add_u32 s18, s18, 18432
    s_waitcnt vmcnt(10)
    v_mfma_f32_32x32x16_bf16 v[10:25], v[154:157], v[146:149], v[10:25]
    v_mfma_f32_32x32x16_bf16 v[26:41], v[158:161], v[146:149], v[26:41]
    v_mfma_f32_32x32x16_bf16 v[42:57], v[162:165], v[146:149], v[42:57]
    v_mfma_f32_32x32x16_bf16 v[58:73], v[154:157], v[150:153], v[58:73]
    v_mfma_f32_32x32x16_bf16 v[74:89], v[158:161], v[150:153], v[74:89]
    v_mfma_f32_32x32x16_bf16 v[90:105], v[162:165], v[150:153], v[90:105]
    buffer_load_dwordx4 v[146:149], v1, s[4:7], s16 offen
    buffer_load_dwordx4 v[150:153], v1, s[4:7], s17 offen
    buffer_load_dwordx4 v[154:157], v1, s[4:7], s18 offen
    buffer_load_dwordx4 v[158:161], v1, s[4:7], s18 offen offset:1024
    buffer_load_dwordx4 v[162:165], v1, s[4:7], s18 offen offset:2048
    s_add_u32 s16, s16, 1024
    s_add_u32 s17, s17, 1024
    s_add_u32 s18, s18, 18432
    s_waitcnt vmcnt(10)
    v_mfma_f32_32x32x16_bf16 v[10:25], v[114:117], v[106:109], v[10:25]
    v_mfma_f32_32x32x16_bf16 v[26:41], v[118:121], v[106:109], v[26:41]
    v_mfma_f32_32x32x16_bf16 v[42:57], v[122:125], v[106:109], v[42:57]
    v_mfma_f32_32x32x16_bf16 v[58:73], v[114:117], v[110:113], v[58:73]
    v_mfma_f32_32x32x16_bf16 v[74:89], v[118:121], v[110:113], v[74:89]
    v_mfma_f32_32x32x16_bf16 v[90:105], v[122:125], v[110:113], v[90:105]
    buffer_load_dwordx4 v[106:109], v1, s[4:7], s16 offen
    buffer_load_dwordx4 v[110:113], v1, s[4:7], s17 offen
    buffer_load_dwordx4 v[114:117], v1, s[4:7], s18 offen
    buffer_load_dwordx4 v[118:121], v1, s[4:7], s18 offen offset:1024
    buffer_load_dwordx4 v[122:125], v1, s[4:7], s18 offen offset:2048
    s_add_u32 s16, s16, 1024
    s_add_u32 s17, s17, 1024
    s_add_u32 s18, s18, 18432
    s_waitcnt vmcnt(10)
    v_mfma_f32_32x32x16_bf16 v[10:25], v[134:137], v[126:129], v[10:25]
    v_mfma_f32_32x32x16_bf16 v[26:41], v[138:141], v[126:129], v[26:41]
    v_mfma_f32_32x32x16_bf16 v[42:57], v[142:145], v[126:129], v[42:57]
    v_mfma_f32_32x32x16_bf16 v[58:73], v[134:137], v[130:133], v[58:73]
    v_mfma_f32_32x32x16_bf16 v[74:89], v[138:141], v[130:133], v[74:89]
    v_mfma_f32_32x32x16_bf16 v[90:105], v[142:145], v[130:133], v[90:105]
    buffer_load_dwordx4 v[126:129], v1, s[4:7], s16 offen
    buffer_load_dwordx4 v[130:133], v1, s[4:7], s17 offen
    buffer_load_dwordx4 v[134:137], v1, s[4:7], s18 offen
    buffer_load_dwordx4 v[138:141], v1, s[4:7], s18 offen offset:1024
    buffer_load_dwordx4 v[142:145], v1, s[4:7], s18 offen offset:2048
    s_add_u32 s16, s16, 1024
    s_add_u32 s17, s17, 1024
    s_add_u32 s18, s18, 18432
    s_barrier
    s_waitcnt vmcnt(10)
    v_mfma_f32_32x32x16_bf16 v[10:25], v[154:157], v[146:149], v[10:25]
    v_mfma_f32_32x32x16_bf16 v[26:41], v[158:161], v[146:149], v[26:41]
    v_mfma_f32_32x32x16_bf16 v[42:57], v[162:165], v[146:149], v[42:57]
    v_mfma_f32_32x32x16_bf16 v[58:73], v[154:157], v[150:153], v[58:73]
    v_mfma_f32_32x32x16_bf16 v[74:89], v[158:161], v[150:153], v[74:89]
    v_mfma_f32_32x32x16_bf16 v[90:105], v[162:165], v[150:153], v[90:105]
    buffer_load_dwordx4 v[146:149], v1, s[4:7], s16 offen
    buffer_load_dwordx4 v[150:153], v1, s[4:7], s17 offen
    buffer_load_dwordx4 v[154:157], v1, s[4:7], s18 offen
    buffer_load_dwordx4 v[158:161], v1, s[4:7], s18 offen offset:1024
    buffer_load_dwordx4 v[162:165], v1, s[4:7], s18 offen offset:2048
    s_add_u32 s16, s16, 1024
    s_add_u32 s17, s17, 1024
    s_add_u32 s18, s18, 18432
    s_waitcnt vmcnt(10)
    v_mfma_f32_32x32x16_bf16 v[10:25], v[114:117], v[106:109], v[10:25]
    v_mfma_f32_32x32x16_bf16 v[26:41], v[118:121], v[106:109], v[26:41]
    v_mfma_f32_32x32x16_bf16 v[42:57], v[122:125], v[106:109], v[42:57]
    v_mfma_f32_32x32x16_bf16 v[58:73], v[114:117], v[110:113], v[58:73]
    v_mfma_f32_32x32x16_bf16 v[74:89], v[118:121], v[110:113], v[74:89]
    v_mfma_f32_32x32x16_bf16 v[90:105], v[122:125], v[110:113], v[90:105]
    buffer_load_dwordx4 v[106:109], v1, s[4:7], s16 offen
    buffer_load_dwordx4 v[110:113], v1, s[4:7], s17 offen
    buffer_load_dwordx4 v[114:117], v1, s[4:7], s18 offen
    buffer_load_dwordx4 v[118:121], v1, s[4:7], s18 offen offset:1024
    buffer_load_dwordx4 v[122:125], v1, s[4:7], s18 offen offset:2048
    s_add_u32 s16, s16, 1024
    s_add_u32 s17, s17, 1024
    s_add_u32 s18, s18, 18432
    s_waitcnt vmcnt(10)
    v_mfma_f32_32x32x16_bf16 v[10:25], v[134:137], v[126:129], v[10:25]
    v_mfma_f32_32x32x16_bf16 v[26:41], v[138:141], v[126:129], v[26:41]
    v_mfma_f32_32x32x16_bf16 v[42:57], v[142:145], v[126:129], v[42:57]
    v_mfma_f32_32x32x16_bf16 v[58:73], v[134:137], v[130:133], v[58:73]
    v_mfma_f32_32x32x16_bf16 v[74:89], v[138:141], v[130:133], v[74:89]
    v_mfma_f32_32x32x16_bf16 v[90:105], v[142:145], v[130:133], v[90:105]
    buffer_load_dwordx4 v[126:129], v1, s[4:7], s16 offen
    buffer_load_dwordx4 v[130:133], v1, s[4:7], s17 offen
    buffer_load_dwordx4 v[134:137], v1, s[4:7], s18 offen
    buffer_load_dwordx4 v[138:141], v1, s[4:7], s18 offen offset:1024
    buffer_load_dwordx4 v[142:145], v1, s[4:7], s18 offen offset:2048
    s_add_u32 s16, s16, 1024
    s_add_u32 s17, s17, 1024
    s_add_u32 s18, s18, 18432
    s_waitcnt vmcnt(10)
    v_mfma_f32_32x32x16_bf16 v[10:25], v[154:157], v[146:149], v[10:25]
    v_mfma_f32_32x32x16_bf16 v[26:41], v[158:161], v[146:149], v[26:41]
    v_mfma_f32_32x32x16_bf16 v[42:57], v[162:165], v[146:149], v[42:57]
    v_mfma_f32_32x32x16_bf16 v[58:73], v[154:157], v[150:153], v[58:73]
    v_mfma_f32_32x32x16_bf16 v[74:89], v[158:161], v[150:153], v[74:89]
    v_mfma_f32_32x32x16_bf16 v[90:105], v[162:165], v[150:153], v[90:105]
    buffer_load_dwordx4 v[146:149], v1, s[4:7], s16 offen
    buffer_load_dwordx4 v[150:153], v1, s[4:7], s17 offen
    buffer_load_dwordx4 v[154:157], v1, s[4:7], s18 offen
    buffer_load_dwordx4 v[158:161], v1, s[4:7], s18 offen offset:1024
    buffer_load_dwordx4 v[162:165], v1, s[4:7], s18 offen offset:2048
    s_add_u32 s16, s16, 1024
    s_add_u32 s17, s17, 1024
    s_add_u32 s18, s18, 18432
    s_waitcnt vmcnt(10)
    v_mfma_f32_32x32x16_bf16 v[10:25], v[114:117], v[106:109], v[10:25]
    v_mfma_f32_32x32x16_bf16 v[26:41], v[118:121], v[106:109], v[26:41]
    v_mfma_f32_32x32x16_bf16 v[42:57], v[122:125], v[106:109], v[42:57]
    v_mfma_f32_32x32x16_bf16 v[58:73], v[114:117], v[110:113], v[58:73]
    v_mfma_f32_32x32x16_bf16 v[74:89], v[118:121], v[110:113], v[74:89]
    v_mfma_f32_32x32x16_bf16 v[90:105], v[122:125], v[110:113], v[90:105]
    buffer_load_dwordx4 v[106:109], v1, s[4:7], s16 offen
    buffer_load_dwordx4 v[110:113], v1, s[4:7], s17 offen
    buffer_load_dwordx4 v[114:117], v1, s[4:7], s18 offen
    buffer_load_dwordx4 v[118:121], v1, s[4:7], s18 offen offset:1024
    buffer_load_dwordx4 v[122:125], v1, s[4:7], s18 offen offset:2048
    s_add_u32 s16, s16, 1024
    s_add_u32 s17, s17, 1024
    s_add_u32 s18, s18, 18432
    s_waitcnt vmcnt(10)
    v_mfma_f32_32x32x16_bf16 v[10:25], v[134:137], v[126:129], v[10:25]
    v_mfma_f32_32x32x16_bf16 v[26:41], v[138:141], v[126:129], v[26:41]
    v_mfma_f32_32x32x16_bf16 v[42:57], v[142:145], v[126:129], v[42:57]
    v_mfma_f32_32x32x16_bf16 v[58:73], v[134:137], v[130:133], v[58:73]
    v_mfma_f32_32x32x16_bf16 v[74:89], v[138:141], v[130:133], v[74:89]
    v_mfma_f32_32x32x16_bf16 v[90:105], v[142:145], v[130:133], v[90:105]
    s_waitcnt vmcnt(5)
    v_mfma_f32_32x32x16_bf16 v[10:25], v[154:157], v[146:149], v[10:25]
    v_mfma_f32_32x32x16_bf16 v[26:41], v[158:161], v[146:149], v[26:41]
    v_mfma_f32_32x32x16_bf16 v[42:57], v[162:165], v[146:149], v[42:57]
    v_mfma_f32_32x32x16_bf16 v[58:73], v[154:157], v[150:153], v[58:73]
    v_mfma_f32_32x32x16_bf16 v[74:89], v[158:161], v[150:153], v[74:89]
    v_mfma_f32_32x32x16_bf16 v[90:105], v[162:165], v[150:153], v[90:105]
    s_waitcnt vmcnt(0)
    v_mfma_f32_32x32x16_bf16 v[10:25], v[114:117], v[106:109], v[10:25]
    v_mfma_f32_32x32x16_bf16 v[26:41], v[118:121], v[106:109], v[26:41]
    v_mfma_f32_32x32x16_bf16 v[42:57], v[122:125], v[106:109], v[42:57]
    v_mfma_f32_32x32x16_bf16 v[58:73], v[114:117], v[110:113], v[58:73]
    v_mfma_f32_32x32x16_bf16 v[74:89], v[118:121], v[110:113], v[74:89]
    v_mfma_f32_32x32x16_bf16 v[90:105], v[122:125], v[110:113], v[90:105]
    s_nop 7
    s_nop 7
    s_mul_i32 s19, s21, 24576
    s_add_u32 s19, s19, 58368
    v_add_u32 v4, s19, v1
    ds_write_b128 v4, v[10:13] offset:0
    ds_write_b128 v4, v[14:17] offset:1024
    ds_write_b128 v4, v[18:21] offset:2048
    ds_write_b128 v4, v[22:25] offset:3072
    ds_write_b128 v4, v[26:29] offset:4096
    ds_write_b128 v4, v[30:33] offset:5120
    ds_write_b128 v4, v[34:37] offset:6144
    ds_write_b128 v4, v[38:41] offset:7168
    ds_write_b128 v4, v[42:45] offset:8192
    ds_write_b128 v4, v[46:49] offset:9216
    ds_write_b128 v4, v[50:53] offset:10240
    ds_write_b128 v4, v[54:57] offset:11264
    ds_write_b128 v4, v[58:61] offset:12288
    ds_write_b128 v4, v[62:65] offset:13312
    ds_write_b128 v4, v[66:69] offset:14336
    ds_write_b128 v4, v[70:73] offset:15360
    ds_write_b128 v4, v[74:77] offset:16384
    ds_write_b128 v4, v[78:81] offset:17408
    ds_write_b128 v4, v[82:85] offset:18432
    ds_write_b128 v4, v[86:89] offset:19456
    ds_write_b128 v4, v[90:93] offset:20480
    ds_write_b128 v4, v[94:97] offset:21504
    ds_write_b128 v4, v[98:101] offset:22528
    ds_write_b128 v4, v[102:105] offset:23552
    s_waitcnt lgkmcnt(0)
    s_barrier
    s_mul_i32 s19, s21, 6144
    s_add_u32 s19, s19, 58368
    v_add_u32 v4, s19, v1
    v_add_u32 v5, 49152, v4
    ds_read_b128 v[10:13], v4 offset:0
    ds_read_b128 v[14:17], v4 offset:24576
    ds_read_b128 v[18:21], v5 offset:0
    ds_read_b128 v[22:25], v5 offset:24576
    ds_read_b128 v[26:29], v4 offset:1024
    ds_read_b128 v[30:33], v4 offset:25600
    ds_read_b128 v[34:37], v5 offset:1024
    ds_read_b128 v[38:41], v5 offset:25600
    ds_read_b128 v[42:45], v4 offset:2048
    ds_read_b128 v[46:49], v4 offset:26624
    ds_read_b128 v[50:53], v5 offset:2048
    ds_read_b128 v[54:57], v5 offset:26624
    ds_read_b128 v[58:61], v4 offset:3072
    ds_read_b128 v[62:65], v4 offset:27648
    ds_read_b128 v[66:69], v5 offset:3072
    ds_read_b128 v[70:73], v5 offset:27648
    ds_read_b128 v[74:77], v4 offset:4096
    ds_read_b128 v[78:81], v4 offset:28672
    ds_read_b128 v[82:85], v5 offset:4096
    ds_read_b128 v[86:89], v5 offset:28672
    ds_read_b128 v[90:93], v4 offset:5120
    ds_read_b128 v[94:97], v4 offset:29696
    ds_read_b128 v[98:101], v5 offset:5120
    ds_read_b128 v[102:105], v5 offset:29696
    s_mul_i32 s25, s22, 147456
    s_mul_i32 s19, s23, 192
    s_add_u32 s25, s25, s19
    s_waitcnt lgkmcnt(15)
    v_add_f32 v10, v10, v14
    v_add_f32 v18, v18, v22
    v_add_f32 v11, v11, v15
    v_add_f32 v19, v19, v23
    v_add_f32 v12, v12, v16
    v_add_f32 v20, v20, v24
    v_add_f32 v13, v13, v17
    v_add_f32 v21, v21, v25
    v_add_f32 v10, v10, v18
    v_add_f32 v11, v11, v19
    v_add_f32 v12, v12, v20
    v_add_f32 v13, v13, v21
    v_cvt_pk_bf16_f32 v10, v10, v11
    v_cvt_pk_bf16_f32 v11, v12, v13
    s_mul_i32 s19, s21, 6
    s_add_u32 s19, s19, 0
    s_lshr_b32 s20, s19, 2
    s_and_b32 s19, s19, 3
    s_lshl_b32 s19, s19, 4
    s_cmp_ge_u32 s20, 3
    s_cselect_b32 s26, 73536, 0
    s_lshl_b32 s20, s20, 6
    s_add_u32 s19, s19, s20
    s_add_u32 s19, s19, s26
    s_add_u32 s19, s19, s25
    buffer_store_dwordx2 v[10:11], v2, s[8:11], s19 offen
    s_waitcnt lgkmcnt(15)
    v_add_f32 v26, v26, v30
    v_add_f32 v34, v34, v38
    v_add_f32 v27, v27, v31
    v_add_f32 v35, v35, v39
    v_add_f32 v28, v28, v32
    v_add_f32 v36, v36, v40
    v_add_f32 v29, v29, v33
    v_add_f32 v37, v37, v41
    v_add_f32 v26, v26, v34
    v_add_f32 v27, v27, v35
    v_add_f32 v28, v28, v36
    v_add_f32 v29, v29, v37
    v_cvt_pk_bf16_f32 v26, v26, v27
    v_cvt_pk_bf16_f32 v27, v28, v29
    s_mul_i32 s19, s21, 6
    s_add_u32 s19, s19, 1
    s_lshr_b32 s20, s19, 2
    s_and_b32 s19, s19, 3
    s_lshl_b32 s19, s19, 4
    s_cmp_ge_u32 s20, 3
    s_cselect_b32 s26, 73536, 0
    s_lshl_b32 s20, s20, 6
    s_add_u32 s19, s19, s20
    s_add_u32 s19, s19, s26
    s_add_u32 s19, s19, s25
    buffer_store_dwordx2 v[26:27], v2, s[8:11], s19 offen
    s_waitcnt lgkmcnt(12)
    v_add_f32 v42, v42, v46
    v_add_f32 v50, v50, v54
    v_add_f32 v43, v43, v47
    v_add_f32 v51, v51, v55
    v_add_f32 v44, v44, v48
    v_add_f32 v52, v52, v56
    v_add_f32 v45, v45, v49
    v_add_f32 v53, v53, v57
    v_add_f32 v42, v42, v50
    v_add_f32 v43, v43, v51
    v_add_f32 v44, v44, v52
    v_add_f32 v45, v45, v53
    v_cvt_pk_bf16_f32 v42, v42, v43
    v_cvt_pk_bf16_f32 v43, v44, v45
    s_mul_i32 s19, s21, 6
    s_add_u32 s19, s19, 2
    s_lshr_b32 s20, s19, 2
    s_and_b32 s19, s19, 3
    s_lshl_b32 s19, s19, 4
    s_cmp_ge_u32 s20, 3
    s_cselect_b32 s26, 73536, 0
    s_lshl_b32 s20, s20, 6
    s_add_u32 s19, s19, s20
    s_add_u32 s19, s19, s26
    s_add_u32 s19, s19, s25
    buffer_store_dwordx2 v[42:43], v2, s[8:11], s19 offen
    s_waitcnt lgkmcnt(8)
    v_add_f32 v58, v58, v62
    v_add_f32 v66, v66, v70
    v_add_f32 v59, v59, v63
    v_add_f32 v67, v67, v71
    v_add_f32 v60, v60, v64
    v_add_f32 v68, v68, v72
    v_add_f32 v61, v61, v65
    v_add_f32 v69, v69, v73
    v_add_f32 v58, v58, v66
    v_add_f32 v59, v59, v67
    v_add_f32 v60, v60, v68
    v_add_f32 v61, v61, v69
    v_cvt_pk_bf16_f32 v58, v58, v59
    v_cvt_pk_bf16_f32 v59, v60, v61
    s_mul_i32 s19, s21, 6
    s_add_u32 s19, s19, 3
    s_lshr_b32 s20, s19, 2
    s_and_b32 s19, s19, 3
    s_lshl_b32 s19, s19, 4
    s_cmp_ge_u32 s20, 3
    s_cselect_b32 s26, 73536, 0
    s_lshl_b32 s20, s20, 6
    s_add_u32 s19, s19, s20
    s_add_u32 s19, s19, s26
    s_add_u32 s19, s19, s25
    buffer_store_dwordx2 v[58:59], v2, s[8:11], s19 offen
    s_waitcnt lgkmcnt(4)
    v_add_f32 v74, v74, v78
    v_add_f32 v82, v82, v86
    v_add_f32 v75, v75, v79
    v_add_f32 v83, v83, v87
    v_add_f32 v76, v76, v80
    v_add_f32 v84, v84, v88
    v_add_f32 v77, v77, v81
    v_add_f32 v85, v85, v89
    v_add_f32 v74, v74, v82
    v_add_f32 v75, v75, v83
    v_add_f32 v76, v76, v84
    v_add_f32 v77, v77, v85
    v_cvt_pk_bf16_f32 v74, v74, v75
    v_cvt_pk_bf16_f32 v75, v76, v77
    s_mul_i32 s19, s21, 6
    s_add_u32 s19, s19, 4
    s_lshr_b32 s20, s19, 2
    s_and_b32 s19, s19, 3
    s_lshl_b32 s19, s19, 4
    s_cmp_ge_u32 s20, 3
    s_cselect_b32 s26, 73536, 0
    s_lshl_b32 s20, s20, 6
    s_add_u32 s19, s19, s20
    s_add_u32 s19, s19, s26
    s_add_u32 s19, s19, s25
    buffer_store_dwordx2 v[74:75], v2, s[8:11], s19 offen
    s_waitcnt lgkmcnt(0)
    v_add_f32 v90, v90, v94
    v_add_f32 v98, v98, v102
    v_add_f32 v91, v91, v95
    v_add_f32 v99, v99, v103
    v_add_f32 v92, v92, v96
    v_add_f32 v100, v100, v104
    v_add_f32 v93, v93, v97
    v_add_f32 v101, v101, v105
    v_add_f32 v90, v90, v98
    v_add_f32 v91, v91, v99
    v_add_f32 v92, v92, v100
    v_add_f32 v93, v93, v101
    v_cvt_pk_bf16_f32 v90, v90, v91
    v_cvt_pk_bf16_f32 v91, v92, v93
    s_mul_i32 s19, s21, 6
    s_add_u32 s19, s19, 5
    s_lshr_b32 s20, s19, 2
    s_and_b32 s19, s19, 3
    s_lshl_b32 s19, s19, 4
    s_cmp_ge_u32 s20, 3
    s_cselect_b32 s26, 73536, 0
    s_lshl_b32 s20, s20, 6
    s_add_u32 s19, s19, s20
    s_add_u32 s19, s19, s26
    s_add_u32 s19, s19, s25
    buffer_store_dwordx2 v[90:91], v2, s[8:11], s19 offen
    s_endpgm
L_mix_W:
    v_and_b32 v0, 63, v0
    s_sub_u32 s20, s2, 192
    s_lshl_b32 s20, s20, 2
    s_add_u32 s20, s20, s21
    s_sub_u32 s20, s20, 8
    s_load_dwordx2 s[12:13], s[0:1], 88
    v_lshlrev_b32 v1, 4, v0
    s_waitcnt lgkmcnt(0)
    s_mov_b32 s4, s12
    s_mov_b32 s5, s13
    s_mov_b32 s6, 92274688
    s_mov_b32 s7, 0x00020000
    s_load_dwordx2 s[56:57], s[0:1], 64
    v_and_b32 v16, 31, v0
    v_lshlrev_b32 v16, 1, v16
    v_lshrrev_b32 v17, 5, v0
    v_mul_u32_u24 v18, 4608, v17
    v_add_u32 v18, v18, v16
    v_mul_u32_u24 v19, 82944, v17
    v_add_u32 v19, v19, v16
    s_waitcnt lgkmcnt(0)
    s_mov_b32 s40, s56
    s_mov_b32 s41, s57
    s_mov_b32 s42, 663552
    s_mov_b32 s43, 0x00020000
    s_add_u32 s55, s20, 0
    s_cmp_ge_u32 s55, 648
    s_cbranch_scc1 L_rb_skip0
    s_mul_i32 s49, s55, 3641
    s_lshr_b32 s49, s49, 16
    s_mul_i32 s50, s49, 18
    s_sub_u32 s50, s55, s50
    s_lshl_b32 s50, s50, 6
    s_cmp_ge_u32 s49, 32
    s_cbranch_scc1 L_rb_left0
    s_mul_i32 s51, s49, 20736
    s_add_u32 s51, s51, s50
    buffer_load_ushort v24, v18, s[40:43], s51 offen offset:0
    buffer_load_ushort v25, v18, s[40:43], s51 offen offset:1152
    buffer_load_ushort v26, v18, s[40:43], s51 offen offset:2304
    buffer_load_ushort v27, v18, s[40:43], s51 offen offset:3456
    s_add_u32 s52, s51, 9216
    buffer_load_ushort v28, v18, s[40:43], s52 offen
    s_add_u32 s52, s51, 10368
    buffer_load_ushort v29, v18, s[40:43], s52 offen
    s_add_u32 s52, s51, 11520
    buffer_load_ushort v30, v18, s[40:43], s52 offen
    s_add_u32 s52, s51, 12672
    buffer_load_ushort v31, v18, s[40:43], s52 offen
    s_branch L_rb_skip0
L_rb_left0:
    s_sub_u32 s49, s49, 32
    s_mul_i32 s51, s49, 165888
    s_add_u32 s51, s51, 18432
    s_add_u32 s51, s51, s50
    buffer_load_ushort v24, v19, s[40:43], s51 offen offset:0
    buffer_load_ushort v25, v19, s[40:43], s51 offen offset:1152
    s_add_u32 s52, s51, 20736
    buffer_load_ushort v26, v19, s[40:43], s52 offen
    s_add_u32 s52, s51, 21888
    buffer_load_ushort v27, v19, s[40:43], s52 offen
    s_add_u32 s52, s51, 41472
    buffer_load_ushort v28, v19, s[40:43], s52 offen
    s_add_u32 s52, s51, 42624
    buffer_load_ushort v29, v19, s[40:43], s52 offen
    s_add_u32 s52, s51, 62208
    buffer_load_ushort v30, v19, s[40:43], s52 offen
    s_add_u32 s52, s51, 63360
    buffer_load_ushort v31, v19, s[40:43], s52 offen
L_rb_skip0:
    s_add_u32 s55, s20, 256
    s_cmp_ge_u32 s55, 648
    s_cbranch_scc1 L_rb_skip1
    s_mul_i32 s49, s55, 3641
    s_lshr_b32 s49, s49, 16
    s_mul_i32 s50, s49, 18
    s_sub_u32 s50, s55, s50
    s_lshl_b32 s50, s50, 6
    s_cmp_ge_u32 s49, 32
    s_cbranch_scc1 L_rb_left1
    s_mul_i32 s51, s49, 20736
    s_add_u32 s51, s51, s50
    buffer_load_ushort v36, v18, s[40:43], s51 offen offset:0
    buffer_load_ushort v37, v18, s[40:43], s51 offen offset:1152
    buffer_load_ushort v38, v18, s[40:43], s51 offen offset:2304
    buffer_load_ushort v39, v18, s[40:43], s51 offen offset:3456
    s_add_u32 s52, s51, 9216
    buffer_load_ushort v40, v18, s[40:43], s52 offen
    s_add_u32 s52, s51, 10368
    buffer_load_ushort v41, v18, s[40:43], s52 offen
    s_add_u32 s52, s51, 11520
    buffer_load_ushort v42, v18, s[40:43], s52 offen
    s_add_u32 s52, s51, 12672
    buffer_load_ushort v43, v18, s[40:43], s52 offen
    s_branch L_rb_skip1
L_rb_left1:
    s_sub_u32 s49, s49, 32
    s_mul_i32 s51, s49, 165888
    s_add_u32 s51, s51, 18432
    s_add_u32 s51, s51, s50
    buffer_load_ushort v36, v19, s[40:43], s51 offen offset:0
    buffer_load_ushort v37, v19, s[40:43], s51 offen offset:1152
    s_add_u32 s52, s51, 20736
    buffer_load_ushort v38, v19, s[40:43], s52 offen
    s_add_u32 s52, s51, 21888
    buffer_load_ushort v39, v19, s[40:43], s52 offen
    s_add_u32 s52, s51, 41472
    buffer_load_ushort v40, v19, s[40:43], s52 offen
    s_add_u32 s52, s51, 42624
    buffer_load_ushort v41, v19, s[40:43], s52 offen
    s_add_u32 s52, s51, 62208
    buffer_load_ushort v42, v19, s[40:43], s52 offen
    s_add_u32 s52, s51, 63360
    buffer_load_ushort v43, v19, s[40:43], s52 offen
L_rb_skip1:
    s_add_u32 s55, s20, 512
    s_cmp_ge_u32 s55, 648
    s_cbranch_scc1 L_rb_skip2
    s_mul_i32 s49, s55, 3641
    s_lshr_b32 s49, s49, 16
    s_mul_i32 s50, s49, 18
    s_sub_u32 s50, s55, s50
    s_lshl_b32 s50, s50, 6
    s_cmp_ge_u32 s49, 32
    s_cbranch_scc1 L_rb_left2
    s_mul_i32 s51, s49, 20736
    s_add_u32 s51, s51, s50
    buffer_load_ushort v48, v18, s[40:43], s51 offen offset:0
    buffer_load_ushort v49, v18, s[40:43], s51 offen offset:1152
    buffer_load_ushort v50, v18, s[40:43], s51 offen offset:2304
    buffer_load_ushort v51, v18, s[40:43], s51 offen offset:3456
    s_add_u32 s52, s51, 9216
    buffer_load_ushort v52, v18, s[40:43], s52 offen
    s_add_u32 s52, s51, 10368
    buffer_load_ushort v53, v18, s[40:43], s52 offen
    s_add_u32 s52, s51, 11520
    buffer_load_ushort v54, v18, s[40:43], s52 offen
    s_add_u32 s52, s51, 12672
    buffer_load_ushort v55, v18, s[40:43], s52 offen
    s_branch L_rb_skip2
L_rb_left2:
    s_sub_u32 s49, s49, 32
    s_mul_i32 s51, s49, 165888
    s_add_u32 s51, s51, 18432
    s_add_u32 s51, s51, s50
    buffer_load_ushort v48, v19, s[40:43], s51 offen offset:0
    buffer_load_ushort v49, v19, s[40:43], s51 offen offset:1152
    s_add_u32 s52, s51, 20736
    buffer_load_ushort v50, v19, s[40:43], s52 offen
    s_add_u32 s52, s51, 21888
    buffer_load_ushort v51, v19, s[40:43], s52 offen
    s_add_u32 s52, s51, 41472
    buffer_load_ushort v52, v19, s[40:43], s52 offen
    s_add_u32 s52, s51, 42624
    buffer_load_ushort v53, v19, s[40:43], s52 offen
    s_add_u32 s52, s51, 62208
    buffer_load_ushort v54, v19, s[40:43], s52 offen
    s_add_u32 s52, s51, 63360
    buffer_load_ushort v55, v19, s[40:43], s52 offen
L_rb_skip2:
    s_waitcnt vmcnt(0)
    s_add_u32 s55, s20, 0
    s_cmp_ge_u32 s55, 648
    s_cbranch_scc1 L_rb_end
    s_lshl_b32 s53, s55, 10
    s_add_u32 s53, s53, 73400320
    v_lshl_or_b32 v32, v25, 16, v24
    v_lshl_or_b32 v33, v27, 16, v26
    v_lshl_or_b32 v34, v29, 16, v28
    v_lshl_or_b32 v35, v31, 16, v30
    buffer_store_dwordx4 v[32:35], v1, s[4:7], s53 offen
    s_add_u32 s55, s20, 256
    s_cmp_ge_u32 s55, 648
    s_cbranch_scc1 L_rb_end
    s_lshl_b32 s53, s55, 10
    s_add_u32 s53, s53, 73400320
    v_lshl_or_b32 v44, v37, 16, v36
    v_lshl_or_b32 v45, v39, 16, v38
    v_lshl_or_b32 v46, v41, 16, v40
    v_lshl_or_b32 v47, v43, 16, v42
    buffer_store_dwordx4 v[44:47], v1, s[4:7], s53 offen
    s_add_u32 s55, s20, 512
    s_cmp_ge_u32 s55, 648
    s_cbranch_scc1 L_rb_end
    s_lshl_b32 s53, s55, 10
    s_add_u32 s53, s53, 73400320
    v_lshl_or_b32 v56, v49, 16, v48
    v_lshl_or_b32 v57, v51, 16, v50
    v_lshl_or_b32 v58, v53, 16, v52
    v_lshl_or_b32 v59, v55, 16, v54
    buffer_store_dwordx4 v[56:59], v1, s[4:7], s53 offen
L_rb_end:
L_mix_end:
    s_endpgm
L_end_mix_kernel:
.text
.globl oprojb_kernel
.p2align 8
.type oprojb_kernel,@function
oprojb_kernel:
    s_cmp_ge_u32 s2, 384
    s_cbranch_scc1 L_opb_end
    s_load_dwordx2 s[12:13], s[0:1], 88
    s_load_dwordx2 s[14:15], s[0:1], 72
    v_lshrrev_b32 v3, 6, v0
    v_and_b32 v0, 63, v0
    s_nop 0
    v_readfirstlane_b32 s21, v3
    s_lshr_b32 s3, s2, 3
    s_lshl_b32 s3, s3, 2
    s_add_u32 s3, s3, s21
    s_and_b32 s3, s3, 31
    s_getpc_b64 s[28:29]
L_pc_ob:
    s_add_u32 s28, s28, oprojb_kernel-L_pc_ob
    s_addc_u32 s29, s29, -1
    s_mul_i32 s30, s3, ((((L_end_oprojb_kernel-oprojb_kernel)>>7)+31)>>5)
    v_min_u32 v204, ((((L_end_oprojb_kernel-oprojb_kernel)>>7)+31)>>5)-1, v0
    v_add_u32 v204, s30, v204
    v_min_u32 v204, ((L_end_oprojb_kernel-oprojb_kernel)>>7)-1, v204
    v_lshlrev_b32 v204, 7, v204
    global_load_dword v205, v204, s[28:29]
    s_and_b32 s18, s2, 7
    s_lshr_b32 s19, s2, 3
    s_and_b32 s20, s19, 7
    s_lshl_b32 s18, s18, 3
    s_add_u32 s20, s20, s18
    s_lshr_b32 s22, s19, 3
    v_lshlrev_b32 v1, 4, v0
    v_and_b32 v3, 31, v0
    v_mul_u32_u24 v2, 2304, v3
    v_lshrrev_b32 v3, 5, v0
    v_lshl_add_u32 v2, v3, 3, v2
    s_mul_i32 s16, s20, 36864
    s_mul_i32 s18, s21, 9216
    s_add_u32 s16, s16, s18
    s_add_u32 s16, s16, 88080384
    s_mul_i32 s17, s21, 165888
    s_mul_i32 s18, s22, 3072
    s_add_u32 s17, s17, s18
    s_add_u32 s17, s17, 73400320
    s_waitcnt lgkmcnt(0)
    s_mov_b32 s4, s12
    s_mov_b32 s5, s13
    s_mov_b32 s6, 92274688
    s_mov_b32 s7, 0x00020000
    s_mov_b32 s8, s14
    s_mov_b32 s9, s15
    s_mov_b32 s10, 4718592
    s_mov_b32 s11, 0x00020000
    buffer_load_dwordx4 v[56:59], v1, s[4:7], s16 offen
    buffer_load_dwordx4 v[60:63], v1, s[4:7], s17 offen
    buffer_load_dwordx4 v[64:67], v1, s[4:7], s17 offen offset:1024
    buffer_load_dwordx4 v[68:71], v1, s[4:7], s17 offen offset:2048
    s_add_u32 s17, s17, 18432
    buffer_load_dwordx4 v[72:75], v1, s[4:7], s16 offen offset:1024
    buffer_load_dwordx4 v[76:79], v1, s[4:7], s17 offen
    buffer_load_dwordx4 v[80:83], v1, s[4:7], s17 offen offset:1024
    buffer_load_dwordx4 v[84:87], v1, s[4:7], s17 offen offset:2048
    s_add_u32 s17, s17, 18432
    buffer_load_dwordx4 v[88:91], v1, s[4:7], s16 offen offset:2048
    buffer_load_dwordx4 v[92:95], v1, s[4:7], s17 offen
    buffer_load_dwordx4 v[96:99], v1, s[4:7], s17 offen offset:1024
    buffer_load_dwordx4 v[100:103], v1, s[4:7], s17 offen offset:2048
    s_add_u32 s17, s17, 18432
    buffer_load_dwordx4 v[104:107], v1, s[4:7], s16 offen offset:3072
    buffer_load_dwordx4 v[108:111], v1, s[4:7], s17 offen
    buffer_load_dwordx4 v[112:115], v1, s[4:7], s17 offen offset:1024
    buffer_load_dwordx4 v[116:119], v1, s[4:7], s17 offen offset:2048
    s_add_u32 s17, s17, 18432
    s_add_u32 s16, s16, 4096
    buffer_load_dwordx4 v[120:123], v1, s[4:7], s16 offen
    buffer_load_dwordx4 v[124:127], v1, s[4:7], s17 offen
    buffer_load_dwordx4 v[128:131], v1, s[4:7], s17 offen offset:1024
    buffer_load_dwordx4 v[132:135], v1, s[4:7], s17 offen offset:2048
    s_add_u32 s17, s17, 18432
    buffer_load_dwordx4 v[136:139], v1, s[4:7], s16 offen offset:1024
    buffer_load_dwordx4 v[140:143], v1, s[4:7], s17 offen
    buffer_load_dwordx4 v[144:147], v1, s[4:7], s17 offen offset:1024
    buffer_load_dwordx4 v[148:151], v1, s[4:7], s17 offen offset:2048
    s_add_u32 s17, s17, 18432
    buffer_load_dwordx4 v[152:155], v1, s[4:7], s16 offen offset:2048
    buffer_load_dwordx4 v[156:159], v1, s[4:7], s17 offen
    buffer_load_dwordx4 v[160:163], v1, s[4:7], s17 offen offset:1024
    buffer_load_dwordx4 v[164:167], v1, s[4:7], s17 offen offset:2048
    s_add_u32 s17, s17, 18432
    buffer_load_dwordx4 v[168:171], v1, s[4:7], s16 offen offset:3072
    buffer_load_dwordx4 v[172:175], v1, s[4:7], s17 offen
    buffer_load_dwordx4 v[176:179], v1, s[4:7], s17 offen offset:1024
    buffer_load_dwordx4 v[180:183], v1, s[4:7], s17 offen offset:2048
    s_add_u32 s17, s17, 18432
    s_add_u32 s16, s16, 4096
    buffer_load_dwordx4 v[184:187], v1, s[4:7], s16 offen
    buffer_load_dwordx4 v[188:191], v1, s[4:7], s17 offen
    buffer_load_dwordx4 v[192:195], v1, s[4:7], s17 offen offset:1024
    buffer_load_dwordx4 v[196:199], v1, s[4:7], s17 offen offset:2048
    s_add_u32 s17, s17, 18432
    s_waitcnt vmcnt(32)
    v_mfma_f32_32x32x16_bf16 v[8:23], v[60:63], v[56:59], 0
    v_mfma_f32_32x32x16_bf16 v[24:39], v[64:67], v[56:59], 0
    v_mfma_f32_32x32x16_bf16 v[40:55], v[68:71], v[56:59], 0
    s_waitcnt vmcnt(28)
    v_mfma_f32_32x32x16_bf16 v[8:23], v[76:79], v[72:75], v[8:23]
    v_mfma_f32_32x32x16_bf16 v[24:39], v[80:83], v[72:75], v[24:39]
    v_mfma_f32_32x32x16_bf16 v[40:55], v[84:87], v[72:75], v[40:55]
    s_waitcnt vmcnt(24)
    v_mfma_f32_32x32x16_bf16 v[8:23], v[92:95], v[88:91], v[8:23]
    v_mfma_f32_32x32x16_bf16 v[24:39], v[96:99], v[88:91], v[24:39]
    v_mfma_f32_32x32x16_bf16 v[40:55], v[100:103], v[88:91], v[40:55]
    s_waitcnt vmcnt(20)
    v_mfma_f32_32x32x16_bf16 v[8:23], v[108:111], v[104:107], v[8:23]
    v_mfma_f32_32x32x16_bf16 v[24:39], v[112:115], v[104:107], v[24:39]
    v_mfma_f32_32x32x16_bf16 v[40:55], v[116:119], v[104:107], v[40:55]
    s_waitcnt vmcnt(16)
    v_mfma_f32_32x32x16_bf16 v[8:23], v[124:127], v[120:123], v[8:23]
    v_mfma_f32_32x32x16_bf16 v[24:39], v[128:131], v[120:123], v[24:39]
    v_mfma_f32_32x32x16_bf16 v[40:55], v[132:135], v[120:123], v[40:55]
    s_waitcnt vmcnt(12)
    v_mfma_f32_32x32x16_bf16 v[8:23], v[140:143], v[136:139], v[8:23]
    v_mfma_f32_32x32x16_bf16 v[24:39], v[144:147], v[136:139], v[24:39]
    v_mfma_f32_32x32x16_bf16 v[40:55], v[148:151], v[136:139], v[40:55]
    s_waitcnt vmcnt(8)
    v_mfma_f32_32x32x16_bf16 v[8:23], v[156:159], v[152:155], v[8:23]
    v_mfma_f32_32x32x16_bf16 v[24:39], v[160:163], v[152:155], v[24:39]
    v_mfma_f32_32x32x16_bf16 v[40:55], v[164:167], v[152:155], v[40:55]
    s_waitcnt vmcnt(4)
    v_mfma_f32_32x32x16_bf16 v[8:23], v[172:175], v[168:171], v[8:23]
    v_mfma_f32_32x32x16_bf16 v[24:39], v[176:179], v[168:171], v[24:39]
    v_mfma_f32_32x32x16_bf16 v[40:55], v[180:183], v[168:171], v[40:55]
    s_waitcnt vmcnt(0)
    v_mfma_f32_32x32x16_bf16 v[8:23], v[188:191], v[184:187], v[8:23]
    v_mfma_f32_32x32x16_bf16 v[24:39], v[192:195], v[184:187], v[24:39]
    v_mfma_f32_32x32x16_bf16 v[40:55], v[196:199], v[184:187], v[40:55]
    s_mul_i32 s18, s21, 12288
    v_add_u32 v4, s18, v1
    s_mul_i32 s23, s20, 73728
    s_mul_i32 s19, s22, 192
    s_add_u32 s23, s23, s19
    s_add_u32 s23, s23, 1152
    s_nop 7
    s_nop 3
    ds_write_b128 v4, v[8:11] offset:0
    ds_write_b128 v4, v[12:15] offset:1024
    ds_write_b128 v4, v[16:19] offset:2048
    ds_write_b128 v4, v[20:23] offset:3072
    ds_write_b128 v4, v[24:27] offset:4096
    ds_write_b128 v4, v[28:31] offset:5120
    ds_write_b128 v4, v[32:35] offset:6144
    ds_write_b128 v4, v[36:39] offset:7168
    ds_write_b128 v4, v[40:43] offset:8192
    ds_write_b128 v4, v[44:47] offset:9216
    ds_write_b128 v4, v[48:51] offset:10240
    ds_write_b128 v4, v[52:55] offset:11264
    s_waitcnt lgkmcnt(0)
    s_barrier
    s_mul_i32 s18, s21, 3072
    v_add_u32 v4, s18, v1
    ds_read_b128 v[56:59], v4 offset:0
    ds_read_b128 v[60:63], v4 offset:12288
    ds_read_b128 v[64:67], v4 offset:24576
    ds_read_b128 v[68:71], v4 offset:36864
    ds_read_b128 v[72:75], v4 offset:1024
    ds_read_b128 v[76:79], v4 offset:13312
    ds_read_b128 v[80:83], v4 offset:25600
    ds_read_b128 v[84:87], v4 offset:37888
    ds_read_b128 v[88:91], v4 offset:2048
    ds_read_b128 v[92:95], v4 offset:14336
    ds_read_b128 v[96:99], v4 offset:26624
    ds_read_b128 v[100:103], v4 offset:38912
    s_waitcnt lgkmcnt(8)
    v_add_f32 v56, v56, v60
    v_add_f32 v64, v64, v68
    v_add_f32 v57, v57, v61
    v_add_f32 v65, v65, v69
    v_add_f32 v58, v58, v62
    v_add_f32 v66, v66, v70
    v_add_f32 v59, v59, v63
    v_add_f32 v67, v67, v71
    v_add_f32 v56, v56, v64
    v_add_f32 v57, v57, v65
    v_add_f32 v58, v58, v66
    v_add_f32 v59, v59, v67
    v_cvt_pk_bf16_f32 v56, v56, v57
    v_cvt_pk_bf16_f32 v57, v58, v59
    s_mul_i32 s18, s21, 48
    s_add_u32 s18, s18, s23
    buffer_store_dwordx2 v[56:57], v2, s[8:11], s18 offen offset:0
    s_waitcnt lgkmcnt(4)
    v_add_f32 v72, v72, v76
    v_add_f32 v80, v80, v84
    v_add_f32 v73, v73, v77
    v_add_f32 v81, v81, v85
    v_add_f32 v74, v74, v78
    v_add_f32 v82, v82, v86
    v_add_f32 v75, v75, v79
    v_add_f32 v83, v83, v87
    v_add_f32 v72, v72, v80
    v_add_f32 v73, v73, v81
    v_add_f32 v74, v74, v82
    v_add_f32 v75, v75, v83
    v_cvt_pk_bf16_f32 v72, v72, v73
    v_cvt_pk_bf16_f32 v73, v74, v75
    s_mul_i32 s18, s21, 48
    s_add_u32 s18, s18, s23
    buffer_store_dwordx2 v[72:73], v2, s[8:11], s18 offen offset:16
    s_waitcnt lgkmcnt(0)
    v_add_f32 v88, v88, v92
    v_add_f32 v96, v96, v100
    v_add_f32 v89, v89, v93
    v_add_f32 v97, v97, v101
    v_add_f32 v90, v90, v94
    v_add_f32 v98, v98, v102
    v_add_f32 v91, v91, v95
    v_add_f32 v99, v99, v103
    v_add_f32 v88, v88, v96
    v_add_f32 v89, v89, v97
    v_add_f32 v90, v90, v98
    v_add_f32 v91, v91, v99
    v_cvt_pk_bf16_f32 v88, v88, v89
    v_cvt_pk_bf16_f32 v89, v90, v91
    s_mul_i32 s18, s21, 48
    s_add_u32 s18, s18, s23
    buffer_store_dwordx2 v[88:89], v2, s[8:11], s18 offen offset:32
L_opb_end:
    s_endpgm
L_end_oprojb_kernel:
.section .rodata,"a"
.p2align 6
.amdhsa_kernel proj_kernel
  .amdhsa_next_free_vgpr 512
  .amdhsa_next_free_sgpr 102
  .amdhsa_accum_offset 256
  .amdhsa_group_segment_fixed_size 0
  .amdhsa_kernarg_size 96
  .amdhsa_user_sgpr_count 2
  .amdhsa_user_sgpr_kernarg_segment_ptr 1
  .amdhsa_system_sgpr_workgroup_id_x 1
  .amdhsa_float_denorm_mode_32 3
.end_amdhsa_kernel
.p2align 6
.amdhsa_kernel mix_kernel
  .amdhsa_next_free_vgpr 168
  .amdhsa_next_free_sgpr 102
  .amdhsa_accum_offset 168
  .amdhsa_group_segment_fixed_size 0
  .amdhsa_kernarg_size 96
  .amdhsa_user_sgpr_count 2
  .amdhsa_user_sgpr_kernarg_segment_ptr 1
  .amdhsa_system_sgpr_workgroup_id_x 1
  .amdhsa_float_denorm_mode_32 3
.end_amdhsa_kernel
.p2align 6
.amdhsa_kernel oprojb_kernel
  .amdhsa_next_free_vgpr 208
  .amdhsa_next_free_sgpr 102
  .amdhsa_accum_offset 208
  .amdhsa_group_segment_fixed_size 0
  .amdhsa_kernarg_size 96
  .amdhsa_user_sgpr_count 2
  .amdhsa_user_sgpr_kernarg_segment_ptr 1
  .amdhsa_system_sgpr_workgroup_id_x 1
  .amdhsa_float_denorm_mode_32 3
.end_amdhsa_kernel
```
